```python
import torch

def _softmax(x, axis=-1):
    return torch.softmax(x, dim=axis)
def _gelu(x):
    return torch.nn.functional.gelu(x, approximate="tanh")
def _silu(x):
    return torch.nn.functional.silu(x)
def _sigmoid(x):
    return torch.sigmoid(x)
def _layernorm(x, axis=-1, eps=1e-5):
    m = x.mean(dim=axis, keepdim=True)
    v = x.var(dim=axis, keepdim=True, unbiased=False)
    return (x - m) / torch.sqrt(v + eps)
def _scatter_add(tgt, idx, src, axis=0):
    return tgt.clone().index_add_(axis, idx, src)
def _segment_sum(src, seg, n):
    out = torch.zeros((n,) + src.shape[1:], dtype=src.dtype)
    return out.index_add_(0, seg, src)
def _pad(x, pw):
    flat = tuple(v for pair in reversed(pw) for v in pair)
    return torch.nn.functional.pad(x, flat)

kernel_name = 'recurrent_scan__mha_block__glu_gated_reglu__prompt'

def setup_inputs():

    _w = (lambda a: (lambda t: t.to(torch.bfloat16) if t.is_floating_point() else t)(torch.as_tensor(a)))
    def _A_setup():
        B, S, D, H = 1, 2048, 1024, 32
        return {
            "x": _w((lambda *s: torch.randn(*s, dtype=torch.bfloat16) * 0.05)(B, S, D)),
            "wqkv": _w((lambda *s: torch.randn(*s, dtype=torch.bfloat16) * 0.2)(D, 3 * D)),
            "wo": _w((lambda *s: torch.randn(*s, dtype=torch.bfloat16) * 0.2)(D, D)),
        }
    _A_in = _A_setup()

    def _B_setup():
        B, S, D, F = 1, 2048, 1024, 3584
        return {
            "x": _w((lambda *s: torch.randn(*s, dtype=torch.bfloat16) * 0.05)(B, S, D)),
            "W_gate": _w((lambda *s: torch.randn(*s, dtype=torch.bfloat16) * 0.1)(D, F) * (2.0 / D) ** 0.5),
            "W_up": _w((lambda *s: torch.randn(*s, dtype=torch.bfloat16) * 0.1)(D, F) * (2.0 / D) ** 0.5),
            "W_down": _w((lambda *s: torch.randn(*s, dtype=torch.bfloat16) * 0.1)(F, D) * (1.0 / F) ** 0.5),
        }
    _B_in = _B_setup()

    return {
        "A_x": _A_in["x"],
        "A_wqkv": _A_in["wqkv"],
        "A_wo": _A_in["wo"],
        "B_x": _B_in["x"],
        "B_W_gate": _B_in["W_gate"],
        "B_W_up": _B_in["W_up"],
        "B_W_down": _B_in["W_down"],
    }

def reference(A_x, A_wqkv, A_wo, B_x, B_W_gate, B_W_up, B_W_down):
    def _A_ref(x, wqkv, wo):
        B, S, D = x.shape
        H = 32
        Dh = D // H
        qkv = (lambda x, *d: x.permute(*d))((x @ wqkv).reshape(B, S, 3, H, Dh), 2, 0, 3, 1, 4)
        q, k, v = qkv[0], qkv[1], qkv[2]
        scores = torch.einsum("bhqd,bhkd->bhqk", q, k) * (Dh ** -0.5)
        p = _softmax(scores, axis=-1)
        o = torch.einsum("bhqk,bhkd->bhqd", p, v)
        return (lambda x, *d: x.permute(*d))(o, 0, 2, 1, 3).reshape(B, S, D) @ wo

    def _B_ref(x, W_gate, W_up, W_down):
        gate = torch.einsum("bsd,df->bsf", x, W_gate)
        up = torch.einsum("bsd,df->bsf", x, W_up)
        gate = gate * (lambda x, dt: x.to(dt))(gate > 0, gate.dtype)
        h = gate * up
        return torch.einsum("bsf,fd->bsd", h, W_down)

    x = A_x
    xn = _layernorm(x, axis=-1)
    s = _A_ref(xn, A_wqkv, A_wo)
    g = _silu(_B_ref(xn, B_W_gate, B_W_up, B_W_down))
    return x + s * g
```

```asm
; @launch grid=(256,1,1) block=(256,1,1) lds=163840
.amdgcn_target "amdgcn-amd-amdhsa--gfx950"
.text
.globl recurrent_scan__mha_block__glu_gated_reglu__prompt_kernel
.p2align 8
.type recurrent_scan__mha_block__glu_gated_reglu__prompt_kernel,@function
recurrent_scan__mha_block__glu_gated_reglu__prompt_kernel:
    s_cmp_ge_u32 s2, 256
    s_cbranch_scc1 L_g1_done
    s_load_dwordx2 s[68:69], s[0:1], 0
    s_load_dwordx2 s[96:97], s[0:1], 64
    s_load_dwordx2 s[4:5], s[0:1], 72
    s_load_dwordx2 s[6:7], s[0:1], 8
    s_load_dwordx4 s[8:11], s[0:1], 32
    s_load_dwordx2 s[88:89], s[0:1], 48
    s_load_dwordx2 s[92:93], s[0:1], 16
    s_mov_b32 s90, 7340032
    s_mov_b32 s91, 0x00020000
    s_mov_b32 s94, 2097152
    s_mov_b32 s95, 0x00020000
    v_lshrrev_b32 v1, 6, v0
    v_and_b32 v0, 63, v0
    v_readfirstlane_b32 s36, v1
    s_and_b32 s46, s2, 7
    s_lshr_b32 s47, s2, 3
    s_and_b32 s47, s47, 7
    s_lshr_b32 s45, s2, 6
    s_lshr_b32 s48, s36, 1
    s_and_b32 s49, s36, 1
    s_lshl_b32 s77, s45, 3
    s_add_u32 s77, s77, s46
    s_lshl_b32 s52, s47, 5
    s_add_u32 s52, s52, s77
    s_lshl_b32 s52, s52, 14
    s_lshl_b32 s53, s36, 9
    s_add_u32 s52, s52, s53
    v_and_b32 v68, 7, v0
    v_lshrrev_b32 v69, 3, v0
    v_lshlrev_b32 v70, 11, v68
    v_lshl_add_u32 v70, v69, 4, v70
    s_mov_b32 s70, 4194304
    s_mov_b32 s71, 0x00020000
    s_mov_b32 s98, 256
    s_mov_b32 s99, 0x00020000
    s_waitcnt lgkmcnt(0)
    buffer_load_dwordx4 v[16:19], v70, s[68:71], s52 offen offset:0
    buffer_load_dwordx4 v[20:23], v70, s[68:71], s52 offen offset:128
    buffer_load_dwordx4 v[24:27], v70, s[68:71], s52 offen offset:256
    buffer_load_dwordx4 v[28:31], v70, s[68:71], s52 offen offset:384
    s_mul_i32 s52, s46, 3
    s_add_u32 s52, s52, 1
    s_add_u32 s53, s46, 24
    s_lshl_b32 s54, s46, 1
    s_add_u32 s54, s54, s45
    s_add_u32 s54, s54, 30
    s_cmp_eq_u32 s45, 1
    s_cselect_b32 s50, s53, s54
    s_mul_i32 s53, s46, 6
    s_lshl_b32 s54, s45, 1
    s_add_u32 s53, s53, s54
    s_add_u32 s53, s53, 6
    s_cmp_eq_u32 s45, 0
    s_cselect_b32 s50, s52, s50
    s_cselect_b32 s51, s46, s53
    s_mov_b32 s55, 7168
    s_cselect_b32 s55, 6144, s55
    s_lshl_b32 s41, s55, 5
    v_lshrrev_b32 v2, 3, v0
    s_lshl_b32 s52, s36, 3
    v_add_u32 v2, s52, v2
    v_bfe_u32 v3, v0, 4, 1
    s_lshl_b32 s52, s49, 1
    v_or_b32 v3, s52, v3
    v_bfe_u32 v4, v0, 1, 2
    v_xor_b32 v4, v4, v3
    v_lshlrev_b32 v4, 5, v4
    v_and_b32 v5, 1, v0
    v_lshl_add_u32 v4, v5, 4, v4
    s_mov_b32 s52, 6144
    v_mad_u32_u24 v13, v2, s52, v4
    v_mad_u32_u24 v14, v2, s55, v4
    s_mov_b32 s52, 7168
    v_mad_u32_u24 v15, v2, s52, v4
    s_lshl_b32 s52, s36, 12
    v_lshl_add_u32 v12, v0, 4, s52
    s_lshl_b32 s42, s48, 15
    s_lshl_b32 s52, s49, 12
    s_add_u32 s42, s42, s52
    s_lshl_b32 s43, s36, 10
    s_add_u32 s43, s43, 65536
    s_mov_b32 s37, 0
    s_mov_b32 s38, 0
    s_mov_b32 s39, 0
    s_mov_b32 s40, 0
    s_lshl_b32 s52, s47, 19
    s_add_u32 s12, s4, s52
    s_addc_u32 s13, s5, 0
    s_mov_b32 s14, 524288
    s_mov_b32 s15, 0x00020000
    s_lshl_b32 s56, s50, 7
    s_add_u32 s16, s6, s56
    s_addc_u32 s17, s7, 0
    s_sub_u32 s18, 6291456, s56
    s_mov_b32 s19, 0x00020000
    s_cmp_eq_u32 s45, 0
    s_cbranch_scc1 L_g1_srdB
    s_add_u32 s52, s51, 1
    s_lshl_b32 s56, s51, 7
    s_add_u32 s20, s8, s56
    s_addc_u32 s21, s9, 0
    s_sub_u32 s22, 7340032, s56
    s_mov_b32 s23, 0x00020000
    s_lshl_b32 s56, s51, 7
    s_add_u32 s24, s10, s56
    s_addc_u32 s25, s11, 0
    s_sub_u32 s26, 7340032, s56
    s_mov_b32 s27, 0x00020000
    s_lshl_b32 s56, s52, 7
    s_add_u32 s28, s8, s56
    s_addc_u32 s29, s9, 0
    s_sub_u32 s30, 7340032, s56
    s_mov_b32 s31, 0x00020000
    s_lshl_b32 s56, s52, 7
    s_add_u32 s32, s10, s56
    s_addc_u32 s33, s11, 0
    s_sub_u32 s34, 7340032, s56
    s_mov_b32 s35, 0x00020000
    s_branch L_g1_srd_done
L_g1_srdB:
    s_sub_u32 s52, s50, 1
    s_add_u32 s53, s50, 1
    s_lshl_b32 s56, s52, 7
    s_add_u32 s20, s6, s56
    s_addc_u32 s21, s7, 0
    s_sub_u32 s22, 6291456, s56
    s_mov_b32 s23, 0x00020000
    s_lshl_b32 s56, s51, 7
    s_add_u32 s24, s8, s56
    s_addc_u32 s25, s9, 0
    s_sub_u32 s26, 7340032, s56
    s_mov_b32 s27, 0x00020000
    s_lshl_b32 s56, s53, 7
    s_add_u32 s28, s6, s56
    s_addc_u32 s29, s7, 0
    s_sub_u32 s30, 6291456, s56
    s_mov_b32 s31, 0x00020000
    s_lshl_b32 s56, s51, 7
    s_add_u32 s32, s10, s56
    s_addc_u32 s33, s11, 0
    s_sub_u32 s34, 7340032, s56
    s_mov_b32 s35, 0x00020000
L_g1_srd_done:
    v_mov_b32 v77, 0x40000000
    v_mov_b32 v80, 0x40000000
    s_mov_b32 s3, 16
    s_mov_b32 s100, 524288
    s_mov_b32 s101, 2
    s_lshl_b32 s78, s2, 11
    s_mov_b32 s79, s78
    s_cmp_eq_u32 s36, 3
    s_cbranch_scc1 L_g1_pfset
    s_cmp_eq_u32 s36, 1
    s_cselect_b32 s88, s8, s10
    s_cselect_b32 s89, s9, s11
    s_cmp_eq_u32 s36, 0
    s_cselect_b32 s88, s6, s88
    s_cselect_b32 s89, s7, s89
    s_cselect_b32 s3, 6, 7
    s_mov_b32 s52, 9363
    s_cselect_b32 s52, 10923, s52
    s_lshl_b32 s100, s3, 15
    s_lshl_b32 s90, s3, 20
    s_mul_i32 s78, s2, s3
    s_lshl_b32 s78, s78, 7
    s_mov_b32 s101, 99
    v_mul_u32_u24 v74, s52, v0
    v_lshrrev_b32 v74, 16, v74
    v_mul_u32_u24 v75, s3, v74
    v_sub_u32 v75, v0, v75
    v_lshlrev_b32 v75, 7, v75
    v_mul_lo_u32 v76, v74, s100
    v_add_u32 v75, v75, v76
    v_cmp_gt_u32 vcc, 9, v74
    v_mov_b32 v76, 0x40000000
    s_nop 0
    v_cndmask_b32 v77, v76, v75, vcc
    v_cmp_gt_u32 vcc, 4, v74
    s_nop 1
    v_cndmask_b32 v80, v76, v75, vcc
    v_cndmask_b32 v77, v77, v76, vcc
L_g1_pfset:
    buffer_load_dword a228, v80, s[88:91], s78 offen
    v_mov_b32 v74, 0
    s_mov_b64 exec, 1
    buffer_load_dword v75, v74, s[12:15], 0 offen
    buffer_load_dword v75, v74, s[96:99], 0 offen
    buffer_load_dword v75, v74, s[16:19], 0 offen
    buffer_load_dword v75, v74, s[24:27], 0 offen
    buffer_load_dword v75, v74, s[32:35], 0 offen
    s_mov_b64 exec, -1
    s_getpc_b64 s[64:65]
L_pc_f0:
    s_add_u32 s64, s64, L_g1_head_qk - L_pc_f0
    s_addc_u32 s65, s65, 0
    s_mov_b32 s66, L_g1_done - L_g1_head_qk
    s_mov_b32 s67, 0x00020000
    s_lshr_b32 s52, s2, 3
    s_lshl_b32 s52, s52, 2
    s_add_u32 s52, s52, s36
    s_mul_i32 s52, s52, 640
    v_lshlrev_b32 v79, 7, v0
    s_mov_b64 exec, 31
    buffer_load_dword v75, v79, s[64:67], s52 offen
    s_mov_b64 exec, -1
    s_lshl_b32 s52, s48, 15
    v_lshl_add_u32 v1, v0, 4, s52
    v_lshrrev_b32 v96, 4, v0
    v_bfe_u32 v97, v0, 2, 2
    v_lshl_add_u32 v98, v96, 3, v97
    v_lshlrev_b32 v98, 7, v98
    v_and_b32 v99, 3, v0
    v_lshl_add_u32 v98, v99, 3, v98
    v_bfe_u32 v99, v0, 3, 2
    s_lshl_b32 s52, s49, 1
    s_mov_b32 s53, 0
    s_add_u32 s54, s52, 0
    s_lshl_b32 s53, s53, 14
    s_add_u32 s53, s53, 65536
    v_xor_b32 v100, s54, v99
    v_lshl_add_u32 v100, v100, 5, v98
    v_add_u32 v2, s53, v100
    s_mov_b32 s53, 0
    s_add_u32 s54, s52, 1
    s_lshl_b32 s53, s53, 14
    s_add_u32 s53, s53, 65536
    v_xor_b32 v100, s54, v99
    v_lshl_add_u32 v100, v100, 5, v98
    v_add_u32 v3, s53, v100
    s_add_u32 s53, s52, 1
    s_mov_b32 s54, 0
    s_lshl_b32 s53, s53, 14
    s_add_u32 s53, s53, 65536
    v_xor_b32 v100, s54, v99
    v_lshl_add_u32 v100, v100, 5, v98
    v_add_u32 v4, s53, v100
    s_add_u32 s53, s52, 1
    s_mov_b32 s54, 1
    s_lshl_b32 s53, s53, 14
    s_add_u32 s53, s53, 65536
    v_xor_b32 v100, s54, v99
    v_lshl_add_u32 v100, v100, 5, v98
    v_add_u32 v5, s53, v100
    s_add_u32 s53, s52, 1
    s_mov_b32 s54, 2
    s_lshl_b32 s53, s53, 14
    s_add_u32 s53, s53, 65536
    v_xor_b32 v100, s54, v99
    v_lshl_add_u32 v100, v100, 5, v98
    v_add_u32 v6, s53, v100
    s_add_u32 s53, s52, 1
    s_mov_b32 s54, 3
    s_lshl_b32 s53, s53, 14
    s_add_u32 s53, s53, 65536
    v_xor_b32 v100, s54, v99
    v_lshl_add_u32 v100, v100, 5, v98
    v_add_u32 v7, s53, v100
    s_add_u32 s53, s52, 2
    s_add_u32 s54, s52, 0
    s_cmp_eq_u32 s45, 0
    s_cselect_b32 s53, 2, s53
    s_cselect_b32 s54, s54, 0
    s_lshl_b32 s53, s53, 14
    s_add_u32 s53, s53, 65536
    v_xor_b32 v100, s54, v99
    v_lshl_add_u32 v100, v100, 5, v98
    v_add_u32 v8, s53, v100
    s_add_u32 s53, s52, 2
    s_add_u32 s54, s52, 1
    s_cmp_eq_u32 s45, 0
    s_cselect_b32 s53, 2, s53
    s_cselect_b32 s54, s54, 1
    s_lshl_b32 s53, s53, 14
    s_add_u32 s53, s53, 65536
    v_xor_b32 v100, s54, v99
    v_lshl_add_u32 v100, v100, 5, v98
    v_add_u32 v9, s53, v100
    s_add_u32 s53, s52, 2
    s_add_u32 s54, s52, 0
    s_cmp_eq_u32 s45, 0
    s_cselect_b32 s53, 4, s53
    s_cselect_b32 s54, s54, 2
    s_lshl_b32 s53, s53, 14
    s_add_u32 s53, s53, 65536
    v_xor_b32 v100, s54, v99
    v_lshl_add_u32 v100, v100, 5, v98
    v_add_u32 v10, s53, v100
    s_add_u32 s53, s52, 2
    s_add_u32 s54, s52, 1
    s_cmp_eq_u32 s45, 0
    s_cselect_b32 s53, 4, s53
    s_cselect_b32 s54, s54, 3
    s_lshl_b32 s53, s53, 14
    s_add_u32 s53, s53, 65536
    v_xor_b32 v100, s54, v99
    v_lshl_add_u32 v100, v100, 5, v98
    v_add_u32 v11, s53, v100
    s_add_u32 s64, s4, 23068672
    s_addc_u32 s65, s5, 0
    s_mov_b32 s66, 14680064
    s_mov_b32 s67, 0x00020000
    s_add_u32 s72, s4, 12582912
    s_addc_u32 s73, s5, 0
    s_mov_b32 s74, 4194304
    s_mov_b32 s75, 0x00020000
    s_mov_b32 s44, 6
    s_add_u32 s68, s4, 20971520
    s_addc_u32 s69, s5, 0
    s_mov_b32 s70, 40960
    s_mov_b32 s71, 0x00020000
    s_lshl_b32 s52, s2, 7
    v_lshlrev_b32 v78, 15, v0
    s_mov_b64 exec, 3
    buffer_store_dword v74, v78, s[68:71], s52 offen sc1
    s_mov_b64 exec, -1
    s_add_u32 s68, s4, 4194304
    s_addc_u32 s69, s5, 0
    s_mov_b32 s70, 8388608
    s_mov_b32 s71, 0x00020000
    v_lshrrev_b32 v72, 2, v69
    v_lshlrev_b32 v72, 14, v72
    v_and_b32 v70, 3, v69
    v_lshl_add_u32 v72, v70, 8, v72
    v_lshl_add_u32 v72, v68, 4, v72
    s_lshr_b32 s76, s77, 1
    s_lshl_b32 s76, s76, 10
    s_and_b32 s52, s77, 1
    s_lshl_b32 s52, s52, 7
    s_add_u32 s76, s76, s52
    s_lshl_b32 s52, s36, 17
    s_add_u32 s76, s76, s52
    v_lshlrev_b32 v68, 4, v68
    s_lshl_b32 s52, s36, 2
    v_add_u32 v69, s52, v68
    s_waitcnt vmcnt(11)
    v_lshlrev_b32 v32, 16, v16
    v_and_b32 v33, 0xffff0000, v16
    v_lshlrev_b32 v34, 16, v17
    v_and_b32 v35, 0xffff0000, v17
    v_lshlrev_b32 v36, 16, v18
    v_and_b32 v37, 0xffff0000, v18
    v_lshlrev_b32 v38, 16, v19
    v_and_b32 v39, 0xffff0000, v19
    s_waitcnt vmcnt(10)
    v_lshlrev_b32 v40, 16, v20
    v_and_b32 v41, 0xffff0000, v20
    v_lshlrev_b32 v42, 16, v21
    v_and_b32 v43, 0xffff0000, v21
    v_lshlrev_b32 v44, 16, v22
    v_and_b32 v45, 0xffff0000, v22
    v_lshlrev_b32 v46, 16, v23
    v_and_b32 v47, 0xffff0000, v23
    s_waitcnt vmcnt(9)
    v_lshlrev_b32 v48, 16, v24
    v_and_b32 v49, 0xffff0000, v24
    v_lshlrev_b32 v50, 16, v25
    v_and_b32 v51, 0xffff0000, v25
    v_lshlrev_b32 v52, 16, v26
    v_and_b32 v53, 0xffff0000, v26
    v_lshlrev_b32 v54, 16, v27
    v_and_b32 v55, 0xffff0000, v27
    s_waitcnt vmcnt(8)
    v_lshlrev_b32 v56, 16, v28
    v_and_b32 v57, 0xffff0000, v28
    v_lshlrev_b32 v58, 16, v29
    v_and_b32 v59, 0xffff0000, v29
    v_lshlrev_b32 v60, 16, v30
    v_and_b32 v61, 0xffff0000, v30
    v_lshlrev_b32 v62, 16, v31
    v_and_b32 v63, 0xffff0000, v31
    v_add_f32 v64, v32, v36
    v_add_f32 v65, v33, v37
    v_add_f32 v66, v34, v38
    v_add_f32 v67, v35, v39
    v_add_f32 v64, v64, v40
    v_add_f32 v65, v65, v41
    v_add_f32 v66, v66, v42
    v_add_f32 v67, v67, v43
    v_add_f32 v64, v64, v44
    v_add_f32 v65, v65, v45
    v_add_f32 v66, v66, v46
    v_add_f32 v67, v67, v47
    v_add_f32 v64, v64, v48
    v_add_f32 v65, v65, v49
    v_add_f32 v66, v66, v50
    v_add_f32 v67, v67, v51
    v_add_f32 v64, v64, v52
    v_add_f32 v65, v65, v53
    v_add_f32 v66, v66, v54
    v_add_f32 v67, v67, v55
    v_add_f32 v64, v64, v56
    v_add_f32 v65, v65, v57
    v_add_f32 v66, v66, v58
    v_add_f32 v67, v67, v59
    v_add_f32 v64, v64, v60
    v_add_f32 v65, v65, v61
    v_add_f32 v66, v66, v62
    v_add_f32 v67, v67, v63
    v_add_f32 v64, v64, v65
    v_add_f32 v66, v66, v67
    v_add_f32 v64, v64, v66
    s_nop 1
    v_add_f32_dpp v64, v64, v64 row_ror:8 row_mask:0xf bank_mask:0xf
    v_mov_b32 v70, v64
    s_nop 1
    v_permlane16_swap_b32 v64, v70
    v_add_f32 v64, v64, v70
    v_mov_b32 v70, v64
    s_nop 1
    v_permlane32_swap_b32 v64, v70
    v_add_f32 v64, v64, v70
    v_mul_f32 v73, 0x3b800000, v64
    ds_write_b32 v69, v73
    v_sub_f32 v32, v32, v73
    v_sub_f32 v33, v33, v73
    v_sub_f32 v34, v34, v73
    v_sub_f32 v35, v35, v73
    v_sub_f32 v36, v36, v73
    v_sub_f32 v37, v37, v73
    v_sub_f32 v38, v38, v73
    v_sub_f32 v39, v39, v73
    v_sub_f32 v40, v40, v73
    v_sub_f32 v41, v41, v73
    v_sub_f32 v42, v42, v73
    v_sub_f32 v43, v43, v73
    v_sub_f32 v44, v44, v73
    v_sub_f32 v45, v45, v73
    v_sub_f32 v46, v46, v73
    v_sub_f32 v47, v47, v73
    v_sub_f32 v48, v48, v73
    v_sub_f32 v49, v49, v73
    v_sub_f32 v50, v50, v73
    v_sub_f32 v51, v51, v73
    v_sub_f32 v52, v52, v73
    v_sub_f32 v53, v53, v73
    v_sub_f32 v54, v54, v73
    v_sub_f32 v55, v55, v73
    v_sub_f32 v56, v56, v73
    v_sub_f32 v57, v57, v73
    v_sub_f32 v58, v58, v73
    v_sub_f32 v59, v59, v73
    v_sub_f32 v60, v60, v73
    v_sub_f32 v61, v61, v73
    v_sub_f32 v62, v62, v73
    v_sub_f32 v63, v63, v73
    v_mul_f32 v64, v32, v32
    v_mul_f32 v65, v33, v33
    v_mul_f32 v66, v34, v34
    v_mul_f32 v67, v35, v35
    v_fmac_f32 v64, v36, v36
    v_fmac_f32 v65, v37, v37
    v_fmac_f32 v66, v38, v38
    v_fmac_f32 v67, v39, v39
    v_fmac_f32 v64, v40, v40
    v_fmac_f32 v65, v41, v41
    v_fmac_f32 v66, v42, v42
    v_fmac_f32 v67, v43, v43
    v_fmac_f32 v64, v44, v44
    v_fmac_f32 v65, v45, v45
    v_fmac_f32 v66, v46, v46
    v_fmac_f32 v67, v47, v47
    v_fmac_f32 v64, v48, v48
    v_fmac_f32 v65, v49, v49
    v_fmac_f32 v66, v50, v50
    v_fmac_f32 v67, v51, v51
    v_fmac_f32 v64, v52, v52
    v_fmac_f32 v65, v53, v53
    v_fmac_f32 v66, v54, v54
    v_fmac_f32 v67, v55, v55
    v_fmac_f32 v64, v56, v56
    v_fmac_f32 v65, v57, v57
    v_fmac_f32 v66, v58, v58
    v_fmac_f32 v67, v59, v59
    v_fmac_f32 v64, v60, v60
    v_fmac_f32 v65, v61, v61
    v_fmac_f32 v66, v62, v62
    v_fmac_f32 v67, v63, v63
    v_add_f32 v64, v64, v65
    v_add_f32 v66, v66, v67
    v_add_f32 v64, v64, v66
    s_nop 1
    v_add_f32_dpp v64, v64, v64 row_ror:8 row_mask:0xf bank_mask:0xf
    v_mov_b32 v70, v64
    s_nop 1
    v_permlane16_swap_b32 v64, v70
    v_add_f32 v64, v64, v70
    v_mov_b32 v70, v64
    s_nop 1
    v_permlane32_swap_b32 v64, v70
    v_add_f32 v64, v64, v70
    ds_write_b32 v69, v64 offset:128
    s_waitcnt lgkmcnt(0)
    s_barrier
    ds_read_b128 v[16:19], v68
    ds_read_b128 v[20:23], v68 offset:128
    s_waitcnt lgkmcnt(1)
    v_add_f32 v64, v16, v17
    v_add_f32 v65, v18, v19
    v_add_f32 v64, v64, v65
    v_mul_f32 v64, 0x3e800000, v64
    v_sub_f32 v73, v73, v64
    v_sub_f32 v16, v16, v64
    v_sub_f32 v17, v17, v64
    v_sub_f32 v18, v18, v64
    v_sub_f32 v19, v19, v64
    v_mul_f32 v66, v16, v16
    v_fmac_f32 v66, v17, v17
    v_fmac_f32 v66, v18, v18
    v_fmac_f32 v66, v19, v19
    s_waitcnt lgkmcnt(0)
    v_add_f32 v20, v20, v21
    v_add_f32 v22, v22, v23
    v_add_f32 v20, v20, v22
    v_mov_b32 v65, 0x3727c5ac
    v_fmac_f32 v65, 0x3a800000, v20
    v_fmac_f32 v65, 0x3e800000, v66
    v_rsq_f32 v65, v65
    s_nop 0
    v_mul_f32 v73, v73, v65
    v_fma_f32 v32, v32, v65, v73
    v_fma_f32 v33, v33, v65, v73
    v_fma_f32 v34, v34, v65, v73
    v_fma_f32 v35, v35, v65, v73
    v_fma_f32 v36, v36, v65, v73
    v_fma_f32 v37, v37, v65, v73
    v_fma_f32 v38, v38, v65, v73
    v_fma_f32 v39, v39, v65, v73
    v_cvt_pk_bf16_f32 v16, v32, v33
    v_cvt_pk_bf16_f32 v17, v34, v35
    v_cvt_pk_bf16_f32 v18, v36, v37
    v_cvt_pk_bf16_f32 v19, v38, v39
    buffer_store_dwordx4 v[16:19], v72, s[12:15], s76 offen sc1
    s_add_u32 s76, s76, 0x8000
    v_fma_f32 v40, v40, v65, v73
    v_fma_f32 v41, v41, v65, v73
    v_fma_f32 v42, v42, v65, v73
    v_fma_f32 v43, v43, v65, v73
    v_fma_f32 v44, v44, v65, v73
    v_fma_f32 v45, v45, v65, v73
    v_fma_f32 v46, v46, v65, v73
    v_fma_f32 v47, v47, v65, v73
    v_cvt_pk_bf16_f32 v20, v40, v41
    v_cvt_pk_bf16_f32 v21, v42, v43
    v_cvt_pk_bf16_f32 v22, v44, v45
    v_cvt_pk_bf16_f32 v23, v46, v47
    buffer_store_dwordx4 v[20:23], v72, s[12:15], s76 offen sc1
    s_add_u32 s76, s76, 0x8000
    v_fma_f32 v48, v48, v65, v73
    v_fma_f32 v49, v49, v65, v73
    v_fma_f32 v50, v50, v65, v73
    v_fma_f32 v51, v51, v65, v73
    v_fma_f32 v52, v52, v65, v73
    v_fma_f32 v53, v53, v65, v73
    v_fma_f32 v54, v54, v65, v73
    v_fma_f32 v55, v55, v65, v73
    v_cvt_pk_bf16_f32 v24, v48, v49
    v_cvt_pk_bf16_f32 v25, v50, v51
    v_cvt_pk_bf16_f32 v26, v52, v53
    v_cvt_pk_bf16_f32 v27, v54, v55
    buffer_store_dwordx4 v[24:27], v72, s[12:15], s76 offen sc1
    s_add_u32 s76, s76, 0x8000
    v_fma_f32 v56, v56, v65, v73
    v_fma_f32 v57, v57, v65, v73
    v_fma_f32 v58, v58, v65, v73
    v_fma_f32 v59, v59, v65, v73
    v_fma_f32 v60, v60, v65, v73
    v_fma_f32 v61, v61, v65, v73
    v_fma_f32 v62, v62, v65, v73
    v_fma_f32 v63, v63, v65, v73
    v_cvt_pk_bf16_f32 v28, v56, v57
    v_cvt_pk_bf16_f32 v29, v58, v59
    v_cvt_pk_bf16_f32 v30, v60, v61
    v_cvt_pk_bf16_f32 v31, v62, v63
    buffer_store_dwordx4 v[28:31], v72, s[12:15], s76 offen sc1
    v_accvgpr_write_b32 a0, 0
    v_accvgpr_write_b32 a1, 0
    v_accvgpr_write_b32 a2, 0
    v_accvgpr_write_b32 a3, 0
    s_waitcnt vmcnt(0)
    s_barrier
    s_cmp_lg_u32 s36, 3
    s_cbranch_scc1 L_g1_nopub
    s_lshl_b32 s52, s47, 5
    v_mov_b32 v70, 1
    v_mov_b32 v71, 0
    s_mov_b64 exec, 1
    buffer_atomic_add v70, v71, s[96:99], s52 offen sc1
    s_mov_b64 exec, -1
L_g1_nopub:
    s_add_u32 m0, s43, 0
    s_nop 0
    buffer_load_dwordx4 v13, s[16:19], s38 offen lds
    s_add_u32 m0, s43, 16384
    s_nop 0
    buffer_load_dwordx4 v14, s[20:23], s39 offen lds
    s_add_u32 m0, s43, 32768
    s_nop 0
    buffer_load_dwordx4 v15, s[24:27], s40 offen lds
    s_add_u32 m0, s43, 49152
    s_nop 0
    buffer_load_dwordx4 v14, s[28:31], s39 offen lds
    s_add_u32 m0, s43, 65536
    s_nop 0
    buffer_load_dwordx4 v15, s[32:35], s40 offen lds
    s_add_u32 s38, s38, 196608
    s_add_u32 s39, s39, s41
    s_add_u32 s40, s40, 229376
    s_add_u32 m0, s43, 4096
    s_nop 0
    buffer_load_dwordx4 v13, s[16:19], s38 offen lds
    s_add_u32 m0, s43, 20480
    s_nop 0
    buffer_load_dwordx4 v14, s[20:23], s39 offen lds
    s_add_u32 m0, s43, 36864
    s_nop 0
    buffer_load_dwordx4 v15, s[24:27], s40 offen lds
    s_add_u32 m0, s43, 53248
    s_nop 0
    buffer_load_dwordx4 v14, s[28:31], s39 offen lds
    s_add_u32 m0, s43, 69632
    s_nop 0
    buffer_load_dwordx4 v15, s[32:35], s40 offen lds
    s_add_u32 s38, s38, 196608
    s_add_u32 s39, s39, s41
    s_add_u32 s40, s40, 229376
    buffer_load_dword a228, v77, s[88:91], s78 offen
    s_mul_i32 s52, s100, 9
    s_cmp_eq_u32 s36, 3
    s_cselect_b32 s52, 0, s52
    s_add_u32 s78, s78, s52
    v_mfma_f32_32x32x16_bf16 a[144:159], a[0:3], a[0:3], 0
    v_mfma_f32_32x32x16_bf16 a[160:175], a[0:3], a[0:3], 0
    v_mfma_f32_32x32x16_bf16 a[176:191], a[0:3], a[0:3], 0
    v_mfma_f32_32x32x16_bf16 a[192:207], a[0:3], a[0:3], 0
    v_mfma_f32_32x32x16_bf16 a[208:223], a[0:3], a[0:3], 0
    v_mfma_f32_32x32x16_bf16 v[16:31], a[0:3], a[0:3], 0
    v_mfma_f32_32x32x16_bf16 v[32:47], a[0:3], a[0:3], 0
    v_mfma_f32_32x32x16_bf16 v[48:63], a[0:3], a[0:3], 0
    v_mfma_f32_32x32x16_bf16 v[64:79], a[0:3], a[0:3], 0
    v_mfma_f32_32x32x16_bf16 v[80:95], a[0:3], a[0:3], 0
    v_mfma_f32_32x32x16_bf16 v[96:111], a[0:3], a[0:3], 0
    v_mfma_f32_32x32x16_bf16 v[112:127], a[0:3], a[0:3], 0
    v_mfma_f32_32x32x16_bf16 v[128:143], a[0:3], a[0:3], 0
    v_mfma_f32_32x32x16_bf16 v[144:159], a[0:3], a[0:3], 0
    v_mfma_f32_32x32x16_bf16 v[160:175], a[0:3], a[0:3], 0
    v_mfma_f32_32x32x16_bf16 v[176:191], a[0:3], a[0:3], 0
    v_mfma_f32_32x32x16_bf16 v[192:207], a[0:3], a[0:3], 0
    v_mfma_f32_32x32x16_bf16 v[208:223], a[0:3], a[0:3], 0
    v_mfma_f32_32x32x16_bf16 v[224:239], a[0:3], a[0:3], 0
    v_mfma_f32_32x32x16_bf16 v[240:255], a[0:3], a[0:3], 0
    s_cmp_lg_u32 s36, 3
    s_cbranch_scc1 L_g1_nopoll
    v_accvgpr_write_b32 a226, v1
    v_accvgpr_write_b32 a227, v2
    s_waitcnt vmcnt(0)
    v_and_b32 v2, 7, v0
    v_lshlrev_b32 v2, 5, v2
    s_mov_b32 s53, 65536
L_g1_poll:
    buffer_load_dword v1, v2, s[96:99], 0 offen sc1
    s_sub_u32 s53, s53, 1
    s_cbranch_scc1 L_g1_poll_end
    s_waitcnt vmcnt(0)
    v_cmp_gt_u32 vcc, 32, v1
    s_cbranch_vccnz L_g1_poll
L_g1_poll_end:
    v_accvgpr_read_b32 v1, a226
    v_accvgpr_read_b32 v2, a227
L_g1_nopoll:
    s_barrier
    s_add_u32 m0, s42, 0
    s_nop 0
    buffer_load_dwordx4 v12, s[12:15], s37 offen offset:0 lds
    buffer_load_dwordx4 v12, s[12:15], s37 offen offset:1024 lds
    buffer_load_dwordx4 v12, s[12:15], s37 offen offset:2048 lds
    buffer_load_dwordx4 v12, s[12:15], s37 offen offset:3072 lds
    s_add_u32 s37, s37, 0x4000
    s_add_u32 m0, s42, 8192
    s_nop 0
    buffer_load_dwordx4 v12, s[12:15], s37 offen offset:0 lds
    buffer_load_dwordx4 v12, s[12:15], s37 offen offset:1024 lds
    buffer_load_dwordx4 v12, s[12:15], s37 offen offset:2048 lds
    buffer_load_dwordx4 v12, s[12:15], s37 offen offset:3072 lds
    s_add_u32 s37, s37, 0x4000
    s_waitcnt vmcnt(4)
    s_barrier
    ds_read_b128 a[0:3], v1 offset:0
    ds_read_b128 a[4:7], v1 offset:1024
    ds_read_b128 a[8:11], v1 offset:2048
    ds_read_b128 a[12:15], v1 offset:3072
    ds_read_b128 a[16:19], v1 offset:4096
    ds_read_b128 a[20:23], v1 offset:5120
    ds_read_b128 a[24:27], v1 offset:6144
    ds_read_b128 a[28:31], v1 offset:7168
    ds_read_b64_tr_b16 a[64:65], v2 offset:0
    ds_read_b64_tr_b16 a[66:67], v2 offset:512
    ds_read_b64_tr_b16 a[68:69], v3 offset:0
    ds_read_b64_tr_b16 a[70:71], v3 offset:512
    ds_read_b64_tr_b16 a[72:73], v4 offset:0
    ds_read_b64_tr_b16 a[74:75], v4 offset:512
    ds_read_b64_tr_b16 a[76:77], v5 offset:0
    ds_read_b64_tr_b16 a[78:79], v5 offset:512
    ds_read_b64_tr_b16 a[80:81], v6 offset:0
    ds_read_b64_tr_b16 a[82:83], v6 offset:512
    ds_read_b64_tr_b16 a[84:85], v7 offset:0
    ds_read_b64_tr_b16 a[86:87], v7 offset:512
    ds_read_b64_tr_b16 a[88:89], v8 offset:0
    ds_read_b64_tr_b16 a[90:91], v8 offset:512
    ds_read_b64_tr_b16 a[92:93], v9 offset:0
    ds_read_b64_tr_b16 a[94:95], v9 offset:512
    ds_read_b64_tr_b16 a[96:97], v10 offset:0
    ds_read_b64_tr_b16 a[98:99], v10 offset:512
    ds_read_b64_tr_b16 a[100:101], v11 offset:0
    ds_read_b64_tr_b16 a[102:103], v11 offset:512
    s_cmp_ge_u32 s45, 2
    s_cbranch_scc1 L_g1_head_v
L_g1_head_qk:
    s_waitcnt vmcnt(0) lgkmcnt(0)
    s_barrier
    v_mfma_f32_16x16x32_bf16 v[16:19], a[64:67], a[0:3], v[16:19]
    ds_read_b128 a[32:35], v1 offset:8192
    v_mfma_f32_16x16x32_bf16 v[20:23], a[64:67], a[4:7], v[20:23]
    ds_read_b128 a[36:39], v1 offset:9216
    v_mfma_f32_16x16x32_bf16 v[24:27], a[64:67], a[8:11], v[24:27]
    s_add_u32 m0, s42, 16384
    v_mfma_f32_16x16x32_bf16 v[28:31], a[64:67], a[12:15], v[28:31]
    buffer_load_dwordx4 v12, s[12:15], s37 offen offset:0 lds
    v_mfma_f32_16x16x32_bf16 v[32:35], a[64:67], a[16:19], v[32:35]
    ds_read_b128 a[40:43], v1 offset:10240
    v_mfma_f32_16x16x32_bf16 v[36:39], a[64:67], a[20:23], v[36:39]
    ds_read_b128 a[44:47], v1 offset:11264
    v_mfma_f32_16x16x32_bf16 v[40:43], a[64:67], a[24:27], v[40:43]
    ds_read_b128 a[48:51], v1 offset:12288
    v_mfma_f32_16x16x32_bf16 v[44:47], a[64:67], a[28:31], v[44:47]
    buffer_load_dwordx4 v12, s[12:15], s37 offen offset:1024 lds
    v_mfma_f32_16x16x32_bf16 v[76:79], a[68:71], a[28:31], v[76:79]
    ds_read_b128 a[52:55], v1 offset:13312
    v_mfma_f32_16x16x32_bf16 v[72:75], a[68:71], a[24:27], v[72:75]
    ds_read_b128 a[56:59], v1 offset:14336
    v_mfma_f32_16x16x32_bf16 v[68:71], a[68:71], a[20:23], v[68:71]
    ds_read_b128 a[60:63], v1 offset:15360
    v_mfma_f32_16x16x32_bf16 v[64:67], a[68:71], a[16:19], v[64:67]
    buffer_load_dwordx4 v12, s[12:15], s37 offen offset:2048 lds
    v_mfma_f32_16x16x32_bf16 v[60:63], a[68:71], a[12:15], v[60:63]
    ds_read_b64_tr_b16 a[104:105], v2 offset:4096
    v_mfma_f32_16x16x32_bf16 v[56:59], a[68:71], a[8:11], v[56:59]
    ds_read_b64_tr_b16 a[106:107], v2 offset:4608
    v_mfma_f32_16x16x32_bf16 v[52:55], a[68:71], a[4:7], v[52:55]
    ds_read_b64_tr_b16 a[108:109], v3 offset:4096
    v_mfma_f32_16x16x32_bf16 v[48:51], a[68:71], a[0:3], v[48:51]
    buffer_load_dwordx4 v12, s[12:15], s37 offen offset:3072 lds
    v_mfma_f32_16x16x32_bf16 v[80:83], a[72:75], a[0:3], v[80:83]
    ds_read_b64_tr_b16 a[110:111], v3 offset:4608
    v_mfma_f32_16x16x32_bf16 v[84:87], a[72:75], a[4:7], v[84:87]
    ds_read_b64_tr_b16 a[112:113], v4 offset:4096
    v_mfma_f32_16x16x32_bf16 v[88:91], a[72:75], a[8:11], v[88:91]
    s_add_u32 s37, s37, 0x4000
    s_add_u32 m0, s43, 8192
    v_mfma_f32_16x16x32_bf16 v[92:95], a[72:75], a[12:15], v[92:95]
    buffer_load_dwordx4 v13, s[16:19], s38 offen lds
    v_mfma_f32_16x16x32_bf16 v[96:99], a[72:75], a[16:19], v[96:99]
    ds_read_b64_tr_b16 a[114:115], v4 offset:4608
    v_mfma_f32_16x16x32_bf16 v[100:103], a[72:75], a[20:23], v[100:103]
    ds_read_b64_tr_b16 a[116:117], v5 offset:4096
    v_mfma_f32_16x16x32_bf16 v[104:107], a[72:75], a[24:27], v[104:107]
    s_add_u32 m0, s43, 24576
    v_mfma_f32_16x16x32_bf16 v[108:111], a[72:75], a[28:31], v[108:111]
    buffer_load_dwordx4 v14, s[20:23], s39 offen lds
    v_mfma_f32_16x16x32_bf16 v[140:143], a[76:79], a[28:31], v[140:143]
    ds_read_b64_tr_b16 a[118:119], v5 offset:4608
    v_mfma_f32_16x16x32_bf16 v[136:139], a[76:79], a[24:27], v[136:139]
    ds_read_b64_tr_b16 a[120:121], v6 offset:4096
    v_mfma_f32_16x16x32_bf16 v[132:135], a[76:79], a[20:23], v[132:135]
    s_add_u32 m0, s43, 40960
    v_mfma_f32_16x16x32_bf16 v[128:131], a[76:79], a[16:19], v[128:131]
    buffer_load_dwordx4 v15, s[24:27], s40 offen lds
    v_mfma_f32_16x16x32_bf16 v[124:127], a[76:79], a[12:15], v[124:127]
    ds_read_b64_tr_b16 a[122:123], v6 offset:4608
    v_mfma_f32_16x16x32_bf16 v[120:123], a[76:79], a[8:11], v[120:123]
    ds_read_b64_tr_b16 a[124:125], v7 offset:4096
    v_mfma_f32_16x16x32_bf16 v[116:119], a[76:79], a[4:7], v[116:119]
    s_add_u32 m0, s43, 57344
    v_mfma_f32_16x16x32_bf16 v[112:115], a[76:79], a[0:3], v[112:115]
    buffer_load_dwordx4 v14, s[28:31], s39 offen lds
    v_mfma_f32_16x16x32_bf16 v[144:147], a[80:83], a[0:3], v[144:147]
    ds_read_b64_tr_b16 a[126:127], v7 offset:4608
    v_mfma_f32_16x16x32_bf16 v[148:151], a[80:83], a[4:7], v[148:151]
    ds_read_b64_tr_b16 a[128:129], v8 offset:4096
    v_mfma_f32_16x16x32_bf16 v[152:155], a[80:83], a[8:11], v[152:155]
    s_add_u32 m0, s43, 73728
    v_mfma_f32_16x16x32_bf16 v[156:159], a[80:83], a[12:15], v[156:159]
    buffer_load_dwordx4 v15, s[32:35], s40 offen lds
    v_mfma_f32_16x16x32_bf16 v[160:163], a[80:83], a[16:19], v[160:163]
    ds_read_b64_tr_b16 a[130:131], v8 offset:4608
    v_mfma_f32_16x16x32_bf16 v[164:167], a[80:83], a[20:23], v[164:167]
    s_add_u32 s38, s38, 196608
    s_add_u32 s39, s39, s41
    v_mfma_f32_16x16x32_bf16 v[168:171], a[80:83], a[24:27], v[168:171]
    s_add_u32 s40, s40, 229376
    s_add_u32 m0, s42, 24576
    v_mfma_f32_16x16x32_bf16 v[172:175], a[80:83], a[28:31], v[172:175]
    buffer_load_dwordx4 v12, s[12:15], s37 offen offset:0 lds
    v_mfma_f32_16x16x32_bf16 v[204:207], a[84:87], a[28:31], v[204:207]
    ds_read_b64_tr_b16 a[132:133], v9 offset:4096
    v_mfma_f32_16x16x32_bf16 v[200:203], a[84:87], a[24:27], v[200:203]
    ds_read_b64_tr_b16 a[134:135], v9 offset:4608
    v_mfma_f32_16x16x32_bf16 v[196:199], a[84:87], a[20:23], v[196:199]
    ds_read_b64_tr_b16 a[136:137], v10 offset:4096
    v_mfma_f32_16x16x32_bf16 v[192:195], a[84:87], a[16:19], v[192:195]
    buffer_load_dwordx4 v12, s[12:15], s37 offen offset:1024 lds
    v_mfma_f32_16x16x32_bf16 v[188:191], a[84:87], a[12:15], v[188:191]
    ds_read_b64_tr_b16 a[138:139], v10 offset:4608
    v_mfma_f32_16x16x32_bf16 v[184:187], a[84:87], a[8:11], v[184:187]
    ds_read_b64_tr_b16 a[140:141], v11 offset:4096
    v_mfma_f32_16x16x32_bf16 v[180:183], a[84:87], a[4:7], v[180:183]
    ds_read_b64_tr_b16 a[142:143], v11 offset:4608
    v_mfma_f32_16x16x32_bf16 v[176:179], a[84:87], a[0:3], v[176:179]
    buffer_load_dwordx4 v12, s[12:15], s37 offen offset:2048 lds
    v_mfma_f32_16x16x32_bf16 v[208:211], a[88:91], a[0:3], v[208:211]
    v_mfma_f32_16x16x32_bf16 v[212:215], a[88:91], a[4:7], v[212:215]
    v_mfma_f32_16x16x32_bf16 v[216:219], a[88:91], a[8:11], v[216:219]
    v_mfma_f32_16x16x32_bf16 v[220:223], a[88:91], a[12:15], v[220:223]
    buffer_load_dwordx4 v12, s[12:15], s37 offen offset:3072 lds
    v_mfma_f32_16x16x32_bf16 v[224:227], a[88:91], a[16:19], v[224:227]
    v_mfma_f32_16x16x32_bf16 v[228:231], a[88:91], a[20:23], v[228:231]
    v_mfma_f32_16x16x32_bf16 v[232:235], a[88:91], a[24:27], v[232:235]
    s_add_u32 s37, s37, 0x4000
    s_add_u32 m0, s43, 12288
    v_mfma_f32_16x16x32_bf16 v[236:239], a[88:91], a[28:31], v[236:239]
    buffer_load_dwordx4 v13, s[16:19], s38 offen lds
    v_mfma_f32_16x16x32_bf16 a[156:159], a[92:95], a[28:31], a[156:159]
    v_mfma_f32_16x16x32_bf16 a[152:155], a[92:95], a[24:27], a[152:155]
    v_mfma_f32_16x16x32_bf16 a[148:151], a[92:95], a[20:23], a[148:151]
    s_add_u32 m0, s43, 28672
    v_mfma_f32_16x16x32_bf16 a[144:147], a[92:95], a[16:19], a[144:147]
    buffer_load_dwordx4 v14, s[20:23], s39 offen lds
    v_mfma_f32_16x16x32_bf16 v[252:255], a[92:95], a[12:15], v[252:255]
    v_mfma_f32_16x16x32_bf16 v[248:251], a[92:95], a[8:11], v[248:251]
    v_mfma_f32_16x16x32_bf16 v[244:247], a[92:95], a[4:7], v[244:247]
    s_add_u32 m0, s43, 45056
    v_mfma_f32_16x16x32_bf16 v[240:243], a[92:95], a[0:3], v[240:243]
    buffer_load_dwordx4 v15, s[24:27], s40 offen lds
    v_mfma_f32_16x16x32_bf16 a[160:163], a[96:99], a[0:3], a[160:163]
    v_mfma_f32_16x16x32_bf16 a[164:167], a[96:99], a[4:7], a[164:167]
    v_mfma_f32_16x16x32_bf16 a[168:171], a[96:99], a[8:11], a[168:171]
    s_add_u32 m0, s43, 61440
    v_mfma_f32_16x16x32_bf16 a[172:175], a[96:99], a[12:15], a[172:175]
    buffer_load_dwordx4 v14, s[28:31], s39 offen lds
    v_mfma_f32_16x16x32_bf16 a[176:179], a[96:99], a[16:19], a[176:179]
    v_mfma_f32_16x16x32_bf16 a[180:183], a[96:99], a[20:23], a[180:183]
    v_mfma_f32_16x16x32_bf16 a[184:187], a[96:99], a[24:27], a[184:187]
    s_add_u32 m0, s43, 77824
    v_mfma_f32_16x16x32_bf16 a[188:191], a[96:99], a[28:31], a[188:191]
    buffer_load_dwordx4 v15, s[32:35], s40 offen lds
    v_mfma_f32_16x16x32_bf16 a[220:223], a[100:103], a[28:31], a[220:223]
    s_add_u32 s38, s38, 196608
    v_mfma_f32_16x16x32_bf16 a[216:219], a[100:103], a[24:27], a[216:219]
    s_add_u32 s39, s39, s41
    v_mfma_f32_16x16x32_bf16 a[212:215], a[100:103], a[20:23], a[212:215]
    s_add_u32 s40, s40, 229376
    v_mfma_f32_16x16x32_bf16 a[208:211], a[100:103], a[16:19], a[208:211]
    v_mfma_f32_16x16x32_bf16 a[204:207], a[100:103], a[12:15], a[204:207]
    v_mfma_f32_16x16x32_bf16 a[200:203], a[100:103], a[8:11], a[200:203]
    v_mfma_f32_16x16x32_bf16 a[196:199], a[100:103], a[4:7], a[196:199]
    v_mfma_f32_16x16x32_bf16 a[192:195], a[100:103], a[0:3], a[192:195]
    s_waitcnt vmcnt(9) lgkmcnt(0)
    s_barrier
    v_mfma_f32_16x16x32_bf16 v[16:19], a[104:107], a[32:35], v[16:19]
    ds_read_b128 a[0:3], v1 offset:16384
    v_mfma_f32_16x16x32_bf16 v[20:23], a[104:107], a[36:39], v[20:23]
    ds_read_b128 a[4:7], v1 offset:17408
    v_mfma_f32_16x16x32_bf16 v[24:27], a[104:107], a[40:43], v[24:27]
    s_add_u32 m0, s42, 0
    v_mfma_f32_16x16x32_bf16 v[28:31], a[104:107], a[44:47], v[28:31]
    buffer_load_dwordx4 v12, s[12:15], s37 offen offset:0 lds
    v_mfma_f32_16x16x32_bf16 v[32:35], a[104:107], a[48:51], v[32:35]
    ds_read_b128 a[8:11], v1 offset:18432
    v_mfma_f32_16x16x32_bf16 v[36:39], a[104:107], a[52:55], v[36:39]
    ds_read_b128 a[12:15], v1 offset:19456
    v_mfma_f32_16x16x32_bf16 v[40:43], a[104:107], a[56:59], v[40:43]
    ds_read_b128 a[16:19], v1 offset:20480
    v_mfma_f32_16x16x32_bf16 v[44:47], a[104:107], a[60:63], v[44:47]
    buffer_load_dwordx4 v12, s[12:15], s37 offen offset:1024 lds
    v_mfma_f32_16x16x32_bf16 v[76:79], a[108:111], a[60:63], v[76:79]
    ds_read_b128 a[20:23], v1 offset:21504
    v_mfma_f32_16x16x32_bf16 v[72:75], a[108:111], a[56:59], v[72:75]
    ds_read_b128 a[24:27], v1 offset:22528
    v_mfma_f32_16x16x32_bf16 v[68:71], a[108:111], a[52:55], v[68:71]
    ds_read_b128 a[28:31], v1 offset:23552
    v_mfma_f32_16x16x32_bf16 v[64:67], a[108:111], a[48:51], v[64:67]
    buffer_load_dwordx4 v12, s[12:15], s37 offen offset:2048 lds
    v_mfma_f32_16x16x32_bf16 v[60:63], a[108:111], a[44:47], v[60:63]
    ds_read_b64_tr_b16 a[64:65], v2 offset:8192
    v_mfma_f32_16x16x32_bf16 v[56:59], a[108:111], a[40:43], v[56:59]
    ds_read_b64_tr_b16 a[66:67], v2 offset:8704
    v_mfma_f32_16x16x32_bf16 v[52:55], a[108:111], a[36:39], v[52:55]
    ds_read_b64_tr_b16 a[68:69], v3 offset:8192
    v_mfma_f32_16x16x32_bf16 v[48:51], a[108:111], a[32:35], v[48:51]
    buffer_load_dwordx4 v12, s[12:15], s37 offen offset:3072 lds
    v_mfma_f32_16x16x32_bf16 v[80:83], a[112:115], a[32:35], v[80:83]
    ds_read_b64_tr_b16 a[70:71], v3 offset:8704
    v_mfma_f32_16x16x32_bf16 v[84:87], a[112:115], a[36:39], v[84:87]
    ds_read_b64_tr_b16 a[72:73], v4 offset:8192
    v_mfma_f32_16x16x32_bf16 v[88:91], a[112:115], a[40:43], v[88:91]
    s_add_u32 s37, s37, 0x4000
    s_add_u32 m0, s43, 0
    v_mfma_f32_16x16x32_bf16 v[92:95], a[112:115], a[44:47], v[92:95]
    buffer_load_dwordx4 v13, s[16:19], s38 offen lds
    v_mfma_f32_16x16x32_bf16 v[96:99], a[112:115], a[48:51], v[96:99]
    ds_read_b64_tr_b16 a[74:75], v4 offset:8704
    v_mfma_f32_16x16x32_bf16 v[100:103], a[112:115], a[52:55], v[100:103]
    ds_read_b64_tr_b16 a[76:77], v5 offset:8192
    v_mfma_f32_16x16x32_bf16 v[104:107], a[112:115], a[56:59], v[104:107]
    s_add_u32 m0, s43, 16384
    v_mfma_f32_16x16x32_bf16 v[108:111], a[112:115], a[60:63], v[108:111]
    buffer_load_dwordx4 v14, s[20:23], s39 offen lds
    v_mfma_f32_16x16x32_bf16 v[140:143], a[116:119], a[60:63], v[140:143]
    ds_read_b64_tr_b16 a[78:79], v5 offset:8704
    v_mfma_f32_16x16x32_bf16 v[136:139], a[116:119], a[56:59], v[136:139]
    ds_read_b64_tr_b16 a[80:81], v6 offset:8192
    v_mfma_f32_16x16x32_bf16 v[132:135], a[116:119], a[52:55], v[132:135]
    s_add_u32 m0, s43, 32768
    v_mfma_f32_16x16x32_bf16 v[128:131], a[116:119], a[48:51], v[128:131]
    buffer_load_dwordx4 v15, s[24:27], s40 offen lds
    v_mfma_f32_16x16x32_bf16 v[124:127], a[116:119], a[44:47], v[124:127]
    ds_read_b64_tr_b16 a[82:83], v6 offset:8704
    v_mfma_f32_16x16x32_bf16 v[120:123], a[116:119], a[40:43], v[120:123]
    ds_read_b64_tr_b16 a[84:85], v7 offset:8192
    v_mfma_f32_16x16x32_bf16 v[116:119], a[116:119], a[36:39], v[116:119]
    s_add_u32 m0, s43, 49152
    v_mfma_f32_16x16x32_bf16 v[112:115], a[116:119], a[32:35], v[112:115]
    buffer_load_dwordx4 v14, s[28:31], s39 offen lds
    v_mfma_f32_16x16x32_bf16 v[144:147], a[120:123], a[32:35], v[144:147]
    ds_read_b64_tr_b16 a[86:87], v7 offset:8704
    v_mfma_f32_16x16x32_bf16 v[148:151], a[120:123], a[36:39], v[148:151]
    ds_read_b64_tr_b16 a[88:89], v8 offset:8192
    v_mfma_f32_16x16x32_bf16 v[152:155], a[120:123], a[40:43], v[152:155]
    s_add_u32 m0, s43, 65536
    v_mfma_f32_16x16x32_bf16 v[156:159], a[120:123], a[44:47], v[156:159]
    buffer_load_dwordx4 v15, s[32:35], s40 offen lds
    v_mfma_f32_16x16x32_bf16 v[160:163], a[120:123], a[48:51], v[160:163]
    ds_read_b64_tr_b16 a[90:91], v8 offset:8704
    v_mfma_f32_16x16x32_bf16 v[164:167], a[120:123], a[52:55], v[164:167]
    s_add_u32 s38, s38, 196608
    s_add_u32 s39, s39, s41
    v_mfma_f32_16x16x32_bf16 v[168:171], a[120:123], a[56:59], v[168:171]
    s_add_u32 s40, s40, 229376
    s_add_u32 m0, s42, 8192
    v_mfma_f32_16x16x32_bf16 v[172:175], a[120:123], a[60:63], v[172:175]
    buffer_load_dwordx4 v12, s[12:15], s37 offen offset:0 lds
    v_mfma_f32_16x16x32_bf16 v[204:207], a[124:127], a[60:63], v[204:207]
    ds_read_b64_tr_b16 a[92:93], v9 offset:8192
    v_mfma_f32_16x16x32_bf16 v[200:203], a[124:127], a[56:59], v[200:203]
    ds_read_b64_tr_b16 a[94:95], v9 offset:8704
    v_mfma_f32_16x16x32_bf16 v[196:199], a[124:127], a[52:55], v[196:199]
    ds_read_b64_tr_b16 a[96:97], v10 offset:8192
    v_mfma_f32_16x16x32_bf16 v[192:195], a[124:127], a[48:51], v[192:195]
    buffer_load_dwordx4 v12, s[12:15], s37 offen offset:1024 lds
    v_mfma_f32_16x16x32_bf16 v[188:191], a[124:127], a[44:47], v[188:191]
    ds_read_b64_tr_b16 a[98:99], v10 offset:8704
    v_mfma_f32_16x16x32_bf16 v[184:187], a[124:127], a[40:43], v[184:187]
    ds_read_b64_tr_b16 a[100:101], v11 offset:8192
    v_mfma_f32_16x16x32_bf16 v[180:183], a[124:127], a[36:39], v[180:183]
    ds_read_b64_tr_b16 a[102:103], v11 offset:8704
    v_mfma_f32_16x16x32_bf16 v[176:179], a[124:127], a[32:35], v[176:179]
    buffer_load_dwordx4 v12, s[12:15], s37 offen offset:2048 lds
    v_mfma_f32_16x16x32_bf16 v[208:211], a[128:131], a[32:35], v[208:211]
    v_mfma_f32_16x16x32_bf16 v[212:215], a[128:131], a[36:39], v[212:215]
    v_mfma_f32_16x16x32_bf16 v[216:219], a[128:131], a[40:43], v[216:219]
    v_mfma_f32_16x16x32_bf16 v[220:223], a[128:131], a[44:47], v[220:223]
    buffer_load_dwordx4 v12, s[12:15], s37 offen offset:3072 lds
    v_mfma_f32_16x16x32_bf16 v[224:227], a[128:131], a[48:51], v[224:227]
    v_mfma_f32_16x16x32_bf16 v[228:231], a[128:131], a[52:55], v[228:231]
    v_mfma_f32_16x16x32_bf16 v[232:235], a[128:131], a[56:59], v[232:235]
    s_add_u32 s37, s37, 0x4000
    s_add_u32 m0, s43, 4096
    v_mfma_f32_16x16x32_bf16 v[236:239], a[128:131], a[60:63], v[236:239]
    buffer_load_dwordx4 v13, s[16:19], s38 offen lds
    v_mfma_f32_16x16x32_bf16 a[156:159], a[132:135], a[60:63], a[156:159]
    v_mfma_f32_16x16x32_bf16 a[152:155], a[132:135], a[56:59], a[152:155]
    v_mfma_f32_16x16x32_bf16 a[148:151], a[132:135], a[52:55], a[148:151]
    s_add_u32 m0, s43, 20480
    v_mfma_f32_16x16x32_bf16 a[144:147], a[132:135], a[48:51], a[144:147]
    buffer_load_dwordx4 v14, s[20:23], s39 offen lds
    v_mfma_f32_16x16x32_bf16 v[252:255], a[132:135], a[44:47], v[252:255]
    v_mfma_f32_16x16x32_bf16 v[248:251], a[132:135], a[40:43], v[248:251]
    v_mfma_f32_16x16x32_bf16 v[244:247], a[132:135], a[36:39], v[244:247]
    s_add_u32 m0, s43, 36864
    v_mfma_f32_16x16x32_bf16 v[240:243], a[132:135], a[32:35], v[240:243]
    buffer_load_dwordx4 v15, s[24:27], s40 offen lds
    v_mfma_f32_16x16x32_bf16 a[160:163], a[136:139], a[32:35], a[160:163]
    v_mfma_f32_16x16x32_bf16 a[164:167], a[136:139], a[36:39], a[164:167]
    v_mfma_f32_16x16x32_bf16 a[168:171], a[136:139], a[40:43], a[168:171]
    s_add_u32 m0, s43, 53248
    v_mfma_f32_16x16x32_bf16 a[172:175], a[136:139], a[44:47], a[172:175]
    buffer_load_dwordx4 v14, s[28:31], s39 offen lds
    v_mfma_f32_16x16x32_bf16 a[176:179], a[136:139], a[48:51], a[176:179]
    v_mfma_f32_16x16x32_bf16 a[180:183], a[136:139], a[52:55], a[180:183]
    v_mfma_f32_16x16x32_bf16 a[184:187], a[136:139], a[56:59], a[184:187]
    s_add_u32 m0, s43, 69632
    v_mfma_f32_16x16x32_bf16 a[188:191], a[136:139], a[60:63], a[188:191]
    buffer_load_dwordx4 v15, s[32:35], s40 offen lds
    v_mfma_f32_16x16x32_bf16 a[220:223], a[140:143], a[60:63], a[220:223]
    s_add_u32 s38, s38, 196608
    v_mfma_f32_16x16x32_bf16 a[216:219], a[140:143], a[56:59], a[216:219]
    s_add_u32 s39, s39, s41
    v_mfma_f32_16x16x32_bf16 a[212:215], a[140:143], a[52:55], a[212:215]
    s_add_u32 s40, s40, 229376
    v_mfma_f32_16x16x32_bf16 a[208:211], a[140:143], a[48:51], a[208:211]
    v_mfma_f32_16x16x32_bf16 a[204:207], a[140:143], a[44:47], a[204:207]
    v_mfma_f32_16x16x32_bf16 a[200:203], a[140:143], a[40:43], a[200:203]
    v_mfma_f32_16x16x32_bf16 a[196:199], a[140:143], a[36:39], a[196:199]
    v_mfma_f32_16x16x32_bf16 a[192:195], a[140:143], a[32:35], a[192:195]
    v_cmp_gt_u32 vcc, s3, v0
    v_lshlrev_b32 v0, 7, v0
    s_andn2_b64 exec, exec, vcc
    v_mov_b32 v0, 0x40000000
    s_mov_b64 exec, -1
    s_waitcnt vmcnt(18) lgkmcnt(0)
    s_barrier
    v_mfma_f32_16x16x32_bf16 v[16:19], a[64:67], a[0:3], v[16:19]
    ds_read_b128 a[32:35], v1 offset:24576
    v_mfma_f32_16x16x32_bf16 v[20:23], a[64:67], a[4:7], v[20:23]
    ds_read_b128 a[36:39], v1 offset:25600
    v_mfma_f32_16x16x32_bf16 v[24:27], a[64:67], a[8:11], v[24:27]
    ds_read_b128 a[40:43], v1 offset:26624
    v_mfma_f32_16x16x32_bf16 v[28:31], a[64:67], a[12:15], v[28:31]
    buffer_load_dword a226, v0, s[88:91], s78 offen
    v_mfma_f32_16x16x32_bf16 v[32:35], a[64:67], a[16:19], v[32:35]
    ds_read_b128 a[44:47], v1 offset:27648
    v_mfma_f32_16x16x32_bf16 v[36:39], a[64:67], a[20:23], v[36:39]
    ds_read_b128 a[48:51], v1 offset:28672
    v_mfma_f32_16x16x32_bf16 v[40:43], a[64:67], a[24:27], v[40:43]
    ds_read_b128 a[52:55], v1 offset:29696
    v_mfma_f32_16x16x32_bf16 v[44:47], a[64:67], a[28:31], v[44:47]
    ds_read_b128 a[56:59], v1 offset:30720
    v_mfma_f32_16x16x32_bf16 v[76:79], a[68:71], a[28:31], v[76:79]
    ds_read_b128 a[60:63], v1 offset:31744
    v_mfma_f32_16x16x32_bf16 v[72:75], a[68:71], a[24:27], v[72:75]
    s_add_u32 s78, s78, s100
    s_add_u32 m0, s42, 16384
    v_mfma_f32_16x16x32_bf16 v[68:71], a[68:71], a[20:23], v[68:71]
    buffer_load_dwordx4 v12, s[12:15], s37 offen offset:0 lds
    v_mfma_f32_16x16x32_bf16 v[64:67], a[68:71], a[16:19], v[64:67]
    ds_read_b64_tr_b16 a[104:105], v2 offset:12288
    v_mfma_f32_16x16x32_bf16 v[60:63], a[68:71], a[12:15], v[60:63]
    ds_read_b64_tr_b16 a[106:107], v2 offset:12800
    v_mfma_f32_16x16x32_bf16 v[56:59], a[68:71], a[8:11], v[56:59]
    ds_read_b64_tr_b16 a[108:109], v3 offset:12288
    v_mfma_f32_16x16x32_bf16 v[52:55], a[68:71], a[4:7], v[52:55]
    ds_read_b64_tr_b16 a[110:111], v3 offset:12800
    v_mfma_f32_16x16x32_bf16 v[48:51], a[68:71], a[0:3], v[48:51]
    ds_read_b64_tr_b16 a[112:113], v4 offset:12288
    v_mfma_f32_16x16x32_bf16 v[80:83], a[72:75], a[0:3], v[80:83]
    ds_read_b64_tr_b16 a[114:115], v4 offset:12800
    v_mfma_f32_16x16x32_bf16 v[84:87], a[72:75], a[4:7], v[84:87]
    buffer_load_dwordx4 v12, s[12:15], s37 offen offset:1024 lds
    v_mfma_f32_16x16x32_bf16 v[88:91], a[72:75], a[8:11], v[88:91]
    ds_read_b64_tr_b16 a[116:117], v5 offset:12288
    v_mfma_f32_16x16x32_bf16 v[92:95], a[72:75], a[12:15], v[92:95]
    ds_read_b64_tr_b16 a[118:119], v5 offset:12800
    v_mfma_f32_16x16x32_bf16 v[96:99], a[72:75], a[16:19], v[96:99]
    ds_read_b64_tr_b16 a[120:121], v6 offset:12288
    v_mfma_f32_16x16x32_bf16 v[100:103], a[72:75], a[20:23], v[100:103]
    ds_read_b64_tr_b16 a[122:123], v6 offset:12800
    v_mfma_f32_16x16x32_bf16 v[104:107], a[72:75], a[24:27], v[104:107]
    ds_read_b64_tr_b16 a[124:125], v7 offset:12288
    v_mfma_f32_16x16x32_bf16 v[108:111], a[72:75], a[28:31], v[108:111]
    ds_read_b64_tr_b16 a[126:127], v7 offset:12800
    v_mfma_f32_16x16x32_bf16 v[140:143], a[76:79], a[28:31], v[140:143]
    buffer_load_dwordx4 v12, s[12:15], s37 offen offset:2048 lds
    v_mfma_f32_16x16x32_bf16 v[136:139], a[76:79], a[24:27], v[136:139]
    ds_read_b64_tr_b16 a[128:129], v8 offset:12288
    v_mfma_f32_16x16x32_bf16 v[132:135], a[76:79], a[20:23], v[132:135]
    ds_read_b64_tr_b16 a[130:131], v8 offset:12800
    v_mfma_f32_16x16x32_bf16 v[128:131], a[76:79], a[16:19], v[128:131]
    ds_read_b64_tr_b16 a[132:133], v9 offset:12288
    v_mfma_f32_16x16x32_bf16 v[124:127], a[76:79], a[12:15], v[124:127]
    ds_read_b64_tr_b16 a[134:135], v9 offset:12800
    v_mfma_f32_16x16x32_bf16 v[120:123], a[76:79], a[8:11], v[120:123]
    ds_read_b64_tr_b16 a[136:137], v10 offset:12288
    v_mfma_f32_16x16x32_bf16 v[116:119], a[76:79], a[4:7], v[116:119]
    ds_read_b64_tr_b16 a[138:139], v10 offset:12800
    v_mfma_f32_16x16x32_bf16 v[112:115], a[76:79], a[0:3], v[112:115]
    buffer_load_dwordx4 v12, s[12:15], s37 offen offset:3072 lds
    v_mfma_f32_16x16x32_bf16 v[144:147], a[80:83], a[0:3], v[144:147]
    ds_read_b64_tr_b16 a[140:141], v11 offset:12288
    v_mfma_f32_16x16x32_bf16 v[148:151], a[80:83], a[4:7], v[148:151]
    ds_read_b64_tr_b16 a[142:143], v11 offset:12800
    v_mfma_f32_16x16x32_bf16 v[152:155], a[80:83], a[8:11], v[152:155]
    v_mfma_f32_16x16x32_bf16 v[156:159], a[80:83], a[12:15], v[156:159]
    v_mfma_f32_16x16x32_bf16 v[160:163], a[80:83], a[16:19], v[160:163]
    v_mfma_f32_16x16x32_bf16 v[164:167], a[80:83], a[20:23], v[164:167]
    s_add_u32 s37, s37, 0x4000
    s_add_u32 m0, s43, 8192
    v_mfma_f32_16x16x32_bf16 v[168:171], a[80:83], a[24:27], v[168:171]
    buffer_load_dwordx4 v13, s[16:19], s38 offen lds
    v_mfma_f32_16x16x32_bf16 v[172:175], a[80:83], a[28:31], v[172:175]
    v_mfma_f32_16x16x32_bf16 v[204:207], a[84:87], a[28:31], v[204:207]
    v_mfma_f32_16x16x32_bf16 v[200:203], a[84:87], a[24:27], v[200:203]
    v_mfma_f32_16x16x32_bf16 v[196:199], a[84:87], a[20:23], v[196:199]
    v_mfma_f32_16x16x32_bf16 v[192:195], a[84:87], a[16:19], v[192:195]
    v_mfma_f32_16x16x32_bf16 v[188:191], a[84:87], a[12:15], v[188:191]
    s_add_u32 m0, s43, 24576
    v_mfma_f32_16x16x32_bf16 v[184:187], a[84:87], a[8:11], v[184:187]
    buffer_load_dwordx4 v14, s[20:23], s39 offen lds
    v_mfma_f32_16x16x32_bf16 v[180:183], a[84:87], a[4:7], v[180:183]
    v_mfma_f32_16x16x32_bf16 v[176:179], a[84:87], a[0:3], v[176:179]
    v_mfma_f32_16x16x32_bf16 v[208:211], a[88:91], a[0:3], v[208:211]
    v_mfma_f32_16x16x32_bf16 v[212:215], a[88:91], a[4:7], v[212:215]
    v_mfma_f32_16x16x32_bf16 v[216:219], a[88:91], a[8:11], v[216:219]
    v_mfma_f32_16x16x32_bf16 v[220:223], a[88:91], a[12:15], v[220:223]
    s_add_u32 m0, s43, 40960
    v_mfma_f32_16x16x32_bf16 v[224:227], a[88:91], a[16:19], v[224:227]
    buffer_load_dwordx4 v15, s[24:27], s40 offen lds
    v_mfma_f32_16x16x32_bf16 v[228:231], a[88:91], a[20:23], v[228:231]
    v_mfma_f32_16x16x32_bf16 v[232:235], a[88:91], a[24:27], v[232:235]
    v_mfma_f32_16x16x32_bf16 v[236:239], a[88:91], a[28:31], v[236:239]
    v_mfma_f32_16x16x32_bf16 a[156:159], a[92:95], a[28:31], a[156:159]
    v_mfma_f32_16x16x32_bf16 a[152:155], a[92:95], a[24:27], a[152:155]
    v_mfma_f32_16x16x32_bf16 a[148:151], a[92:95], a[20:23], a[148:151]
    s_add_u32 m0, s43, 57344
    v_mfma_f32_16x16x32_bf16 a[144:147], a[92:95], a[16:19], a[144:147]
    buffer_load_dwordx4 v14, s[28:31], s39 offen lds
    v_mfma_f32_16x16x32_bf16 v[252:255], a[92:95], a[12:15], v[252:255]
    v_mfma_f32_16x16x32_bf16 v[248:251], a[92:95], a[8:11], v[248:251]
    v_mfma_f32_16x16x32_bf16 v[244:247], a[92:95], a[4:7], v[244:247]
    v_mfma_f32_16x16x32_bf16 v[240:243], a[92:95], a[0:3], v[240:243]
    v_mfma_f32_16x16x32_bf16 a[160:163], a[96:99], a[0:3], a[160:163]
    v_mfma_f32_16x16x32_bf16 a[164:167], a[96:99], a[4:7], a[164:167]
    s_add_u32 m0, s43, 73728
    v_mfma_f32_16x16x32_bf16 a[168:171], a[96:99], a[8:11], a[168:171]
    buffer_load_dwordx4 v15, s[32:35], s40 offen lds
    v_mfma_f32_16x16x32_bf16 a[172:175], a[96:99], a[12:15], a[172:175]
    s_add_u32 s38, s38, 196608
    v_mfma_f32_16x16x32_bf16 a[176:179], a[96:99], a[16:19], a[176:179]
    s_add_u32 s39, s39, s41
    v_mfma_f32_16x16x32_bf16 a[180:183], a[96:99], a[20:23], a[180:183]
    s_add_u32 s40, s40, 229376
    v_mfma_f32_16x16x32_bf16 a[184:187], a[96:99], a[24:27], a[184:187]
    v_mfma_f32_16x16x32_bf16 a[188:191], a[96:99], a[28:31], a[188:191]
    v_mfma_f32_16x16x32_bf16 a[220:223], a[100:103], a[28:31], a[220:223]
    v_mfma_f32_16x16x32_bf16 a[216:219], a[100:103], a[24:27], a[216:219]
    v_mfma_f32_16x16x32_bf16 a[212:215], a[100:103], a[20:23], a[212:215]
    v_mfma_f32_16x16x32_bf16 a[208:211], a[100:103], a[16:19], a[208:211]
    v_mfma_f32_16x16x32_bf16 a[204:207], a[100:103], a[12:15], a[204:207]
    v_mfma_f32_16x16x32_bf16 a[200:203], a[100:103], a[8:11], a[200:203]
    v_mfma_f32_16x16x32_bf16 a[196:199], a[100:103], a[4:7], a[196:199]
    v_mfma_f32_16x16x32_bf16 a[192:195], a[100:103], a[0:3], a[192:195]
    s_waitcnt vmcnt(18) lgkmcnt(0)
    s_barrier
    v_mfma_f32_16x16x32_bf16 v[16:19], a[104:107], a[32:35], v[16:19]
    ds_read_b128 a[0:3], v1 offset:0
    v_mfma_f32_16x16x32_bf16 v[20:23], a[104:107], a[36:39], v[20:23]
    ds_read_b128 a[4:7], v1 offset:1024
    v_mfma_f32_16x16x32_bf16 v[24:27], a[104:107], a[40:43], v[24:27]
    ds_read_b128 a[8:11], v1 offset:2048
    v_mfma_f32_16x16x32_bf16 v[28:31], a[104:107], a[44:47], v[28:31]
    buffer_load_dword a226, v0, s[88:91], s78 offen
    v_mfma_f32_16x16x32_bf16 v[32:35], a[104:107], a[48:51], v[32:35]
    ds_read_b128 a[12:15], v1 offset:3072
    v_mfma_f32_16x16x32_bf16 v[36:39], a[104:107], a[52:55], v[36:39]
    ds_read_b128 a[16:19], v1 offset:4096
    v_mfma_f32_16x16x32_bf16 v[40:43], a[104:107], a[56:59], v[40:43]
    ds_read_b128 a[20:23], v1 offset:5120
    v_mfma_f32_16x16x32_bf16 v[44:47], a[104:107], a[60:63], v[44:47]
    ds_read_b128 a[24:27], v1 offset:6144
    v_mfma_f32_16x16x32_bf16 v[76:79], a[108:111], a[60:63], v[76:79]
    ds_read_b128 a[28:31], v1 offset:7168
    v_mfma_f32_16x16x32_bf16 v[72:75], a[108:111], a[56:59], v[72:75]
    s_add_u32 s78, s78, s100
    s_add_u32 m0, s42, 24576
    v_mfma_f32_16x16x32_bf16 v[68:71], a[108:111], a[52:55], v[68:71]
    buffer_load_dwordx4 v12, s[12:15], s37 offen offset:0 lds
    v_mfma_f32_16x16x32_bf16 v[64:67], a[108:111], a[48:51], v[64:67]
    ds_read_b64_tr_b16 a[64:65], v2 offset:0
    v_mfma_f32_16x16x32_bf16 v[60:63], a[108:111], a[44:47], v[60:63]
    ds_read_b64_tr_b16 a[66:67], v2 offset:512
    v_mfma_f32_16x16x32_bf16 v[56:59], a[108:111], a[40:43], v[56:59]
    ds_read_b64_tr_b16 a[68:69], v3 offset:0
    v_mfma_f32_16x16x32_bf16 v[52:55], a[108:111], a[36:39], v[52:55]
    ds_read_b64_tr_b16 a[70:71], v3 offset:512
    v_mfma_f32_16x16x32_bf16 v[48:51], a[108:111], a[32:35], v[48:51]
    ds_read_b64_tr_b16 a[72:73], v4 offset:0
    v_mfma_f32_16x16x32_bf16 v[80:83], a[112:115], a[32:35], v[80:83]
    ds_read_b64_tr_b16 a[74:75], v4 offset:512
    v_mfma_f32_16x16x32_bf16 v[84:87], a[112:115], a[36:39], v[84:87]
    buffer_load_dwordx4 v12, s[12:15], s37 offen offset:1024 lds
    v_mfma_f32_16x16x32_bf16 v[88:91], a[112:115], a[40:43], v[88:91]
    ds_read_b64_tr_b16 a[76:77], v5 offset:0
    v_mfma_f32_16x16x32_bf16 v[92:95], a[112:115], a[44:47], v[92:95]
    ds_read_b64_tr_b16 a[78:79], v5 offset:512
    v_mfma_f32_16x16x32_bf16 v[96:99], a[112:115], a[48:51], v[96:99]
    ds_read_b64_tr_b16 a[80:81], v6 offset:0
    v_mfma_f32_16x16x32_bf16 v[100:103], a[112:115], a[52:55], v[100:103]
    ds_read_b64_tr_b16 a[82:83], v6 offset:512
    v_mfma_f32_16x16x32_bf16 v[104:107], a[112:115], a[56:59], v[104:107]
    ds_read_b64_tr_b16 a[84:85], v7 offset:0
    v_mfma_f32_16x16x32_bf16 v[108:111], a[112:115], a[60:63], v[108:111]
    ds_read_b64_tr_b16 a[86:87], v7 offset:512
    v_mfma_f32_16x16x32_bf16 v[140:143], a[116:119], a[60:63], v[140:143]
    buffer_load_dwordx4 v12, s[12:15], s37 offen offset:2048 lds
    v_mfma_f32_16x16x32_bf16 v[136:139], a[116:119], a[56:59], v[136:139]
    ds_read_b64_tr_b16 a[88:89], v8 offset:0
    v_mfma_f32_16x16x32_bf16 v[132:135], a[116:119], a[52:55], v[132:135]
    ds_read_b64_tr_b16 a[90:91], v8 offset:512
    v_mfma_f32_16x16x32_bf16 v[128:131], a[116:119], a[48:51], v[128:131]
    ds_read_b64_tr_b16 a[92:93], v9 offset:0
    v_mfma_f32_16x16x32_bf16 v[124:127], a[116:119], a[44:47], v[124:127]
    ds_read_b64_tr_b16 a[94:95], v9 offset:512
    v_mfma_f32_16x16x32_bf16 v[120:123], a[116:119], a[40:43], v[120:123]
    ds_read_b64_tr_b16 a[96:97], v10 offset:0
    v_mfma_f32_16x16x32_bf16 v[116:119], a[116:119], a[36:39], v[116:119]
    ds_read_b64_tr_b16 a[98:99], v10 offset:512
    v_mfma_f32_16x16x32_bf16 v[112:115], a[116:119], a[32:35], v[112:115]
    buffer_load_dwordx4 v12, s[12:15], s37 offen offset:3072 lds
    v_mfma_f32_16x16x32_bf16 v[144:147], a[120:123], a[32:35], v[144:147]
    ds_read_b64_tr_b16 a[100:101], v11 offset:0
    v_mfma_f32_16x16x32_bf16 v[148:151], a[120:123], a[36:39], v[148:151]
    ds_read_b64_tr_b16 a[102:103], v11 offset:512
    v_mfma_f32_16x16x32_bf16 v[152:155], a[120:123], a[40:43], v[152:155]
    v_mfma_f32_16x16x32_bf16 v[156:159], a[120:123], a[44:47], v[156:159]
    v_mfma_f32_16x16x32_bf16 v[160:163], a[120:123], a[48:51], v[160:163]
    v_mfma_f32_16x16x32_bf16 v[164:167], a[120:123], a[52:55], v[164:167]
    s_add_u32 s37, s37, 0x4000
    s_add_u32 m0, s43, 12288
    v_mfma_f32_16x16x32_bf16 v[168:171], a[120:123], a[56:59], v[168:171]
    buffer_load_dwordx4 v13, s[16:19], s38 offen lds
    v_mfma_f32_16x16x32_bf16 v[172:175], a[120:123], a[60:63], v[172:175]
    v_mfma_f32_16x16x32_bf16 v[204:207], a[124:127], a[60:63], v[204:207]
    v_mfma_f32_16x16x32_bf16 v[200:203], a[124:127], a[56:59], v[200:203]
    v_mfma_f32_16x16x32_bf16 v[196:199], a[124:127], a[52:55], v[196:199]
    v_mfma_f32_16x16x32_bf16 v[192:195], a[124:127], a[48:51], v[192:195]
    v_mfma_f32_16x16x32_bf16 v[188:191], a[124:127], a[44:47], v[188:191]
    s_add_u32 m0, s43, 28672
    v_mfma_f32_16x16x32_bf16 v[184:187], a[124:127], a[40:43], v[184:187]
    buffer_load_dwordx4 v14, s[20:23], s39 offen lds
    v_mfma_f32_16x16x32_bf16 v[180:183], a[124:127], a[36:39], v[180:183]
    v_mfma_f32_16x16x32_bf16 v[176:179], a[124:127], a[32:35], v[176:179]
    v_mfma_f32_16x16x32_bf16 v[208:211], a[128:131], a[32:35], v[208:211]
    v_mfma_f32_16x16x32_bf16 v[212:215], a[128:131], a[36:39], v[212:215]
    v_mfma_f32_16x16x32_bf16 v[216:219], a[128:131], a[40:43], v[216:219]
    v_mfma_f32_16x16x32_bf16 v[220:223], a[128:131], a[44:47], v[220:223]
    s_add_u32 m0, s43, 45056
    v_mfma_f32_16x16x32_bf16 v[224:227], a[128:131], a[48:51], v[224:227]
    buffer_load_dwordx4 v15, s[24:27], s40 offen lds
    v_mfma_f32_16x16x32_bf16 v[228:231], a[128:131], a[52:55], v[228:231]
    v_mfma_f32_16x16x32_bf16 v[232:235], a[128:131], a[56:59], v[232:235]
    v_mfma_f32_16x16x32_bf16 v[236:239], a[128:131], a[60:63], v[236:239]
    v_mfma_f32_16x16x32_bf16 a[156:159], a[132:135], a[60:63], a[156:159]
    v_mfma_f32_16x16x32_bf16 a[152:155], a[132:135], a[56:59], a[152:155]
    v_mfma_f32_16x16x32_bf16 a[148:151], a[132:135], a[52:55], a[148:151]
    s_add_u32 m0, s43, 61440
    v_mfma_f32_16x16x32_bf16 a[144:147], a[132:135], a[48:51], a[144:147]
    buffer_load_dwordx4 v14, s[28:31], s39 offen lds
    v_mfma_f32_16x16x32_bf16 v[252:255], a[132:135], a[44:47], v[252:255]
    v_mfma_f32_16x16x32_bf16 v[248:251], a[132:135], a[40:43], v[248:251]
    v_mfma_f32_16x16x32_bf16 v[244:247], a[132:135], a[36:39], v[244:247]
    v_mfma_f32_16x16x32_bf16 v[240:243], a[132:135], a[32:35], v[240:243]
    v_mfma_f32_16x16x32_bf16 a[160:163], a[136:139], a[32:35], a[160:163]
    v_mfma_f32_16x16x32_bf16 a[164:167], a[136:139], a[36:39], a[164:167]
    s_add_u32 m0, s43, 77824
    v_mfma_f32_16x16x32_bf16 a[168:171], a[136:139], a[40:43], a[168:171]
    buffer_load_dwordx4 v15, s[32:35], s40 offen lds
    v_mfma_f32_16x16x32_bf16 a[172:175], a[136:139], a[44:47], a[172:175]
    s_add_u32 s38, s38, 196608
    v_mfma_f32_16x16x32_bf16 a[176:179], a[136:139], a[48:51], a[176:179]
    s_add_u32 s39, s39, s41
    v_mfma_f32_16x16x32_bf16 a[180:183], a[136:139], a[52:55], a[180:183]
    s_add_u32 s40, s40, 229376
    v_mfma_f32_16x16x32_bf16 a[184:187], a[136:139], a[56:59], a[184:187]
    v_mfma_f32_16x16x32_bf16 a[188:191], a[136:139], a[60:63], a[188:191]
    v_mfma_f32_16x16x32_bf16 a[220:223], a[140:143], a[60:63], a[220:223]
    v_mfma_f32_16x16x32_bf16 a[216:219], a[140:143], a[56:59], a[216:219]
    v_mfma_f32_16x16x32_bf16 a[212:215], a[140:143], a[52:55], a[212:215]
    v_mfma_f32_16x16x32_bf16 a[208:211], a[140:143], a[48:51], a[208:211]
    v_mfma_f32_16x16x32_bf16 a[204:207], a[140:143], a[44:47], a[204:207]
    v_mfma_f32_16x16x32_bf16 a[200:203], a[140:143], a[40:43], a[200:203]
    v_mfma_f32_16x16x32_bf16 a[196:199], a[140:143], a[36:39], a[196:199]
    v_mfma_f32_16x16x32_bf16 a[192:195], a[140:143], a[32:35], a[192:195]
.p2align 6
L_g1_loop_qk:
    s_waitcnt vmcnt(20) lgkmcnt(0)
    s_barrier
    v_mfma_f32_16x16x32_bf16 v[16:19], a[64:67], a[0:3], v[16:19]
    ds_read_b128 a[32:35], v1 offset:8192
    v_mfma_f32_16x16x32_bf16 v[20:23], a[64:67], a[4:7], v[20:23]
    ds_read_b128 a[36:39], v1 offset:9216
    v_mfma_f32_16x16x32_bf16 v[24:27], a[64:67], a[8:11], v[24:27]
    ds_read_b128 a[40:43], v1 offset:10240
    v_mfma_f32_16x16x32_bf16 v[28:31], a[64:67], a[12:15], v[28:31]
    buffer_load_dword a226, v0, s[88:91], s78 offen
    v_mfma_f32_16x16x32_bf16 v[32:35], a[64:67], a[16:19], v[32:35]
    ds_read_b128 a[44:47], v1 offset:11264
    v_mfma_f32_16x16x32_bf16 v[36:39], a[64:67], a[20:23], v[36:39]
    ds_read_b128 a[48:51], v1 offset:12288
    v_mfma_f32_16x16x32_bf16 v[40:43], a[64:67], a[24:27], v[40:43]
    ds_read_b128 a[52:55], v1 offset:13312
    v_mfma_f32_16x16x32_bf16 v[44:47], a[64:67], a[28:31], v[44:47]
    ds_read_b128 a[56:59], v1 offset:14336
    v_mfma_f32_16x16x32_bf16 v[76:79], a[68:71], a[28:31], v[76:79]
    ds_read_b128 a[60:63], v1 offset:15360
    v_mfma_f32_16x16x32_bf16 v[72:75], a[68:71], a[24:27], v[72:75]
    s_add_u32 s78, s78, s100
    s_add_u32 m0, s42, 0
    v_mfma_f32_16x16x32_bf16 v[68:71], a[68:71], a[20:23], v[68:71]
    buffer_load_dwordx4 v12, s[12:15], s37 offen offset:0 lds
    v_mfma_f32_16x16x32_bf16 v[64:67], a[68:71], a[16:19], v[64:67]
    ds_read_b64_tr_b16 a[104:105], v2 offset:4096
    v_mfma_f32_16x16x32_bf16 v[60:63], a[68:71], a[12:15], v[60:63]
    ds_read_b64_tr_b16 a[106:107], v2 offset:4608
    v_mfma_f32_16x16x32_bf16 v[56:59], a[68:71], a[8:11], v[56:59]
    ds_read_b64_tr_b16 a[108:109], v3 offset:4096
    v_mfma_f32_16x16x32_bf16 v[52:55], a[68:71], a[4:7], v[52:55]
    ds_read_b64_tr_b16 a[110:111], v3 offset:4608
    v_mfma_f32_16x16x32_bf16 v[48:51], a[68:71], a[0:3], v[48:51]
    ds_read_b64_tr_b16 a[112:113], v4 offset:4096
    v_mfma_f32_16x16x32_bf16 v[80:83], a[72:75], a[0:3], v[80:83]
    ds_read_b64_tr_b16 a[114:115], v4 offset:4608
    v_mfma_f32_16x16x32_bf16 v[84:87], a[72:75], a[4:7], v[84:87]
    buffer_load_dwordx4 v12, s[12:15], s37 offen offset:1024 lds
    v_mfma_f32_16x16x32_bf16 v[88:91], a[72:75], a[8:11], v[88:91]
    ds_read_b64_tr_b16 a[116:117], v5 offset:4096
    v_mfma_f32_16x16x32_bf16 v[92:95], a[72:75], a[12:15], v[92:95]
    ds_read_b64_tr_b16 a[118:119], v5 offset:4608
    v_mfma_f32_16x16x32_bf16 v[96:99], a[72:75], a[16:19], v[96:99]
    ds_read_b64_tr_b16 a[120:121], v6 offset:4096
    v_mfma_f32_16x16x32_bf16 v[100:103], a[72:75], a[20:23], v[100:103]
    ds_read_b64_tr_b16 a[122:123], v6 offset:4608
    v_mfma_f32_16x16x32_bf16 v[104:107], a[72:75], a[24:27], v[104:107]
    ds_read_b64_tr_b16 a[124:125], v7 offset:4096
    v_mfma_f32_16x16x32_bf16 v[108:111], a[72:75], a[28:31], v[108:111]
    ds_read_b64_tr_b16 a[126:127], v7 offset:4608
    v_mfma_f32_16x16x32_bf16 v[140:143], a[76:79], a[28:31], v[140:143]
    buffer_load_dwordx4 v12, s[12:15], s37 offen offset:2048 lds
    v_mfma_f32_16x16x32_bf16 v[136:139], a[76:79], a[24:27], v[136:139]
    ds_read_b64_tr_b16 a[128:129], v8 offset:4096
    v_mfma_f32_16x16x32_bf16 v[132:135], a[76:79], a[20:23], v[132:135]
    ds_read_b64_tr_b16 a[130:131], v8 offset:4608
    v_mfma_f32_16x16x32_bf16 v[128:131], a[76:79], a[16:19], v[128:131]
    ds_read_b64_tr_b16 a[132:133], v9 offset:4096
    v_mfma_f32_16x16x32_bf16 v[124:127], a[76:79], a[12:15], v[124:127]
    ds_read_b64_tr_b16 a[134:135], v9 offset:4608
    v_mfma_f32_16x16x32_bf16 v[120:123], a[76:79], a[8:11], v[120:123]
    ds_read_b64_tr_b16 a[136:137], v10 offset:4096
    v_mfma_f32_16x16x32_bf16 v[116:119], a[76:79], a[4:7], v[116:119]
    ds_read_b64_tr_b16 a[138:139], v10 offset:4608
    v_mfma_f32_16x16x32_bf16 v[112:115], a[76:79], a[0:3], v[112:115]
    buffer_load_dwordx4 v12, s[12:15], s37 offen offset:3072 lds
    v_mfma_f32_16x16x32_bf16 v[144:147], a[80:83], a[0:3], v[144:147]
    ds_read_b64_tr_b16 a[140:141], v11 offset:4096
    v_mfma_f32_16x16x32_bf16 v[148:151], a[80:83], a[4:7], v[148:151]
    ds_read_b64_tr_b16 a[142:143], v11 offset:4608
    v_mfma_f32_16x16x32_bf16 v[152:155], a[80:83], a[8:11], v[152:155]
    v_mfma_f32_16x16x32_bf16 v[156:159], a[80:83], a[12:15], v[156:159]
    v_mfma_f32_16x16x32_bf16 v[160:163], a[80:83], a[16:19], v[160:163]
    v_mfma_f32_16x16x32_bf16 v[164:167], a[80:83], a[20:23], v[164:167]
    s_add_u32 s37, s37, 0x4000
    s_add_u32 m0, s43, 0
    v_mfma_f32_16x16x32_bf16 v[168:171], a[80:83], a[24:27], v[168:171]
    buffer_load_dwordx4 v13, s[16:19], s38 offen lds
    v_mfma_f32_16x16x32_bf16 v[172:175], a[80:83], a[28:31], v[172:175]
    v_mfma_f32_16x16x32_bf16 v[204:207], a[84:87], a[28:31], v[204:207]
    v_mfma_f32_16x16x32_bf16 v[200:203], a[84:87], a[24:27], v[200:203]
    v_mfma_f32_16x16x32_bf16 v[196:199], a[84:87], a[20:23], v[196:199]
    v_mfma_f32_16x16x32_bf16 v[192:195], a[84:87], a[16:19], v[192:195]
    v_mfma_f32_16x16x32_bf16 v[188:191], a[84:87], a[12:15], v[188:191]
    s_add_u32 m0, s43, 16384
    v_mfma_f32_16x16x32_bf16 v[184:187], a[84:87], a[8:11], v[184:187]
    buffer_load_dwordx4 v14, s[20:23], s39 offen lds
    v_mfma_f32_16x16x32_bf16 v[180:183], a[84:87], a[4:7], v[180:183]
    v_mfma_f32_16x16x32_bf16 v[176:179], a[84:87], a[0:3], v[176:179]
    v_mfma_f32_16x16x32_bf16 v[208:211], a[88:91], a[0:3], v[208:211]
    v_mfma_f32_16x16x32_bf16 v[212:215], a[88:91], a[4:7], v[212:215]
    v_mfma_f32_16x16x32_bf16 v[216:219], a[88:91], a[8:11], v[216:219]
    v_mfma_f32_16x16x32_bf16 v[220:223], a[88:91], a[12:15], v[220:223]
    s_add_u32 m0, s43, 32768
    v_mfma_f32_16x16x32_bf16 v[224:227], a[88:91], a[16:19], v[224:227]
    buffer_load_dwordx4 v15, s[24:27], s40 offen lds
    v_mfma_f32_16x16x32_bf16 v[228:231], a[88:91], a[20:23], v[228:231]
    v_mfma_f32_16x16x32_bf16 v[232:235], a[88:91], a[24:27], v[232:235]
    v_mfma_f32_16x16x32_bf16 v[236:239], a[88:91], a[28:31], v[236:239]
    v_mfma_f32_16x16x32_bf16 a[156:159], a[92:95], a[28:31], a[156:159]
    v_mfma_f32_16x16x32_bf16 a[152:155], a[92:95], a[24:27], a[152:155]
    v_mfma_f32_16x16x32_bf16 a[148:151], a[92:95], a[20:23], a[148:151]
    s_add_u32 m0, s43, 49152
    v_mfma_f32_16x16x32_bf16 a[144:147], a[92:95], a[16:19], a[144:147]
    buffer_load_dwordx4 v14, s[28:31], s39 offen lds
    v_mfma_f32_16x16x32_bf16 v[252:255], a[92:95], a[12:15], v[252:255]
    v_mfma_f32_16x16x32_bf16 v[248:251], a[92:95], a[8:11], v[248:251]
    v_mfma_f32_16x16x32_bf16 v[244:247], a[92:95], a[4:7], v[244:247]
    v_mfma_f32_16x16x32_bf16 v[240:243], a[92:95], a[0:3], v[240:243]
    v_mfma_f32_16x16x32_bf16 a[160:163], a[96:99], a[0:3], a[160:163]
    v_mfma_f32_16x16x32_bf16 a[164:167], a[96:99], a[4:7], a[164:167]
    s_add_u32 m0, s43, 65536
    v_mfma_f32_16x16x32_bf16 a[168:171], a[96:99], a[8:11], a[168:171]
    buffer_load_dwordx4 v15, s[32:35], s40 offen lds
    v_mfma_f32_16x16x32_bf16 a[172:175], a[96:99], a[12:15], a[172:175]
    s_add_u32 s38, s38, 196608
    v_mfma_f32_16x16x32_bf16 a[176:179], a[96:99], a[16:19], a[176:179]
    s_add_u32 s39, s39, s41
    v_mfma_f32_16x16x32_bf16 a[180:183], a[96:99], a[20:23], a[180:183]
    s_add_u32 s40, s40, 229376
    v_mfma_f32_16x16x32_bf16 a[184:187], a[96:99], a[24:27], a[184:187]
    v_mfma_f32_16x16x32_bf16 a[188:191], a[96:99], a[28:31], a[188:191]
    v_mfma_f32_16x16x32_bf16 a[220:223], a[100:103], a[28:31], a[220:223]
    v_mfma_f32_16x16x32_bf16 a[216:219], a[100:103], a[24:27], a[216:219]
    v_mfma_f32_16x16x32_bf16 a[212:215], a[100:103], a[20:23], a[212:215]
    v_mfma_f32_16x16x32_bf16 a[208:211], a[100:103], a[16:19], a[208:211]
    v_mfma_f32_16x16x32_bf16 a[204:207], a[100:103], a[12:15], a[204:207]
    v_mfma_f32_16x16x32_bf16 a[200:203], a[100:103], a[8:11], a[200:203]
    v_mfma_f32_16x16x32_bf16 a[196:199], a[100:103], a[4:7], a[196:199]
    v_mfma_f32_16x16x32_bf16 a[192:195], a[100:103], a[0:3], a[192:195]
    s_waitcnt vmcnt(20) lgkmcnt(0)
    s_barrier
    v_mfma_f32_16x16x32_bf16 v[16:19], a[104:107], a[32:35], v[16:19]
    ds_read_b128 a[0:3], v1 offset:16384
    v_mfma_f32_16x16x32_bf16 v[20:23], a[104:107], a[36:39], v[20:23]
    ds_read_b128 a[4:7], v1 offset:17408
    v_mfma_f32_16x16x32_bf16 v[24:27], a[104:107], a[40:43], v[24:27]
    ds_read_b128 a[8:11], v1 offset:18432
    v_mfma_f32_16x16x32_bf16 v[28:31], a[104:107], a[44:47], v[28:31]
    buffer_load_dword a226, v0, s[88:91], s78 offen
    v_mfma_f32_16x16x32_bf16 v[32:35], a[104:107], a[48:51], v[32:35]
    ds_read_b128 a[12:15], v1 offset:19456
    v_mfma_f32_16x16x32_bf16 v[36:39], a[104:107], a[52:55], v[36:39]
    ds_read_b128 a[16:19], v1 offset:20480
    v_mfma_f32_16x16x32_bf16 v[40:43], a[104:107], a[56:59], v[40:43]
    ds_read_b128 a[20:23], v1 offset:21504
    v_mfma_f32_16x16x32_bf16 v[44:47], a[104:107], a[60:63], v[44:47]
    ds_read_b128 a[24:27], v1 offset:22528
    v_mfma_f32_16x16x32_bf16 v[76:79], a[108:111], a[60:63], v[76:79]
    ds_read_b128 a[28:31], v1 offset:23552
    v_mfma_f32_16x16x32_bf16 v[72:75], a[108:111], a[56:59], v[72:75]
    s_add_u32 s78, s78, s100
    s_add_u32 m0, s42, 8192
    v_mfma_f32_16x16x32_bf16 v[68:71], a[108:111], a[52:55], v[68:71]
    buffer_load_dwordx4 v12, s[12:15], s37 offen offset:0 lds
    v_mfma_f32_16x16x32_bf16 v[64:67], a[108:111], a[48:51], v[64:67]
    ds_read_b64_tr_b16 a[64:65], v2 offset:8192
    v_mfma_f32_16x16x32_bf16 v[60:63], a[108:111], a[44:47], v[60:63]
    ds_read_b64_tr_b16 a[66:67], v2 offset:8704
    v_mfma_f32_16x16x32_bf16 v[56:59], a[108:111], a[40:43], v[56:59]
    ds_read_b64_tr_b16 a[68:69], v3 offset:8192
    v_mfma_f32_16x16x32_bf16 v[52:55], a[108:111], a[36:39], v[52:55]
    ds_read_b64_tr_b16 a[70:71], v3 offset:8704
    v_mfma_f32_16x16x32_bf16 v[48:51], a[108:111], a[32:35], v[48:51]
    ds_read_b64_tr_b16 a[72:73], v4 offset:8192
    v_mfma_f32_16x16x32_bf16 v[80:83], a[112:115], a[32:35], v[80:83]
    ds_read_b64_tr_b16 a[74:75], v4 offset:8704
    v_mfma_f32_16x16x32_bf16 v[84:87], a[112:115], a[36:39], v[84:87]
    buffer_load_dwordx4 v12, s[12:15], s37 offen offset:1024 lds
    v_mfma_f32_16x16x32_bf16 v[88:91], a[112:115], a[40:43], v[88:91]
    ds_read_b64_tr_b16 a[76:77], v5 offset:8192
    v_mfma_f32_16x16x32_bf16 v[92:95], a[112:115], a[44:47], v[92:95]
    ds_read_b64_tr_b16 a[78:79], v5 offset:8704
    v_mfma_f32_16x16x32_bf16 v[96:99], a[112:115], a[48:51], v[96:99]
    ds_read_b64_tr_b16 a[80:81], v6 offset:8192
    v_mfma_f32_16x16x32_bf16 v[100:103], a[112:115], a[52:55], v[100:103]
    ds_read_b64_tr_b16 a[82:83], v6 offset:8704
    v_mfma_f32_16x16x32_bf16 v[104:107], a[112:115], a[56:59], v[104:107]
    ds_read_b64_tr_b16 a[84:85], v7 offset:8192
    v_mfma_f32_16x16x32_bf16 v[108:111], a[112:115], a[60:63], v[108:111]
    ds_read_b64_tr_b16 a[86:87], v7 offset:8704
    v_mfma_f32_16x16x32_bf16 v[140:143], a[116:119], a[60:63], v[140:143]
    buffer_load_dwordx4 v12, s[12:15], s37 offen offset:2048 lds
    v_mfma_f32_16x16x32_bf16 v[136:139], a[116:119], a[56:59], v[136:139]
    ds_read_b64_tr_b16 a[88:89], v8 offset:8192
    v_mfma_f32_16x16x32_bf16 v[132:135], a[116:119], a[52:55], v[132:135]
    ds_read_b64_tr_b16 a[90:91], v8 offset:8704
    v_mfma_f32_16x16x32_bf16 v[128:131], a[116:119], a[48:51], v[128:131]
    ds_read_b64_tr_b16 a[92:93], v9 offset:8192
    v_mfma_f32_16x16x32_bf16 v[124:127], a[116:119], a[44:47], v[124:127]
    ds_read_b64_tr_b16 a[94:95], v9 offset:8704
    v_mfma_f32_16x16x32_bf16 v[120:123], a[116:119], a[40:43], v[120:123]
    ds_read_b64_tr_b16 a[96:97], v10 offset:8192
    v_mfma_f32_16x16x32_bf16 v[116:119], a[116:119], a[36:39], v[116:119]
    ds_read_b64_tr_b16 a[98:99], v10 offset:8704
    v_mfma_f32_16x16x32_bf16 v[112:115], a[116:119], a[32:35], v[112:115]
    buffer_load_dwordx4 v12, s[12:15], s37 offen offset:3072 lds
    v_mfma_f32_16x16x32_bf16 v[144:147], a[120:123], a[32:35], v[144:147]
    ds_read_b64_tr_b16 a[100:101], v11 offset:8192
    v_mfma_f32_16x16x32_bf16 v[148:151], a[120:123], a[36:39], v[148:151]
    ds_read_b64_tr_b16 a[102:103], v11 offset:8704
    v_mfma_f32_16x16x32_bf16 v[152:155], a[120:123], a[40:43], v[152:155]
    v_mfma_f32_16x16x32_bf16 v[156:159], a[120:123], a[44:47], v[156:159]
    v_mfma_f32_16x16x32_bf16 v[160:163], a[120:123], a[48:51], v[160:163]
    v_mfma_f32_16x16x32_bf16 v[164:167], a[120:123], a[52:55], v[164:167]
    s_add_u32 s37, s37, 0x4000
    s_add_u32 m0, s43, 4096
    v_mfma_f32_16x16x32_bf16 v[168:171], a[120:123], a[56:59], v[168:171]
    buffer_load_dwordx4 v13, s[16:19], s38 offen lds
    v_mfma_f32_16x16x32_bf16 v[172:175], a[120:123], a[60:63], v[172:175]
    v_mfma_f32_16x16x32_bf16 v[204:207], a[124:127], a[60:63], v[204:207]
    v_mfma_f32_16x16x32_bf16 v[200:203], a[124:127], a[56:59], v[200:203]
    v_mfma_f32_16x16x32_bf16 v[196:199], a[124:127], a[52:55], v[196:199]
    v_mfma_f32_16x16x32_bf16 v[192:195], a[124:127], a[48:51], v[192:195]
    v_mfma_f32_16x16x32_bf16 v[188:191], a[124:127], a[44:47], v[188:191]
    s_add_u32 m0, s43, 20480
    v_mfma_f32_16x16x32_bf16 v[184:187], a[124:127], a[40:43], v[184:187]
    buffer_load_dwordx4 v14, s[20:23], s39 offen lds
    v_mfma_f32_16x16x32_bf16 v[180:183], a[124:127], a[36:39], v[180:183]
    v_mfma_f32_16x16x32_bf16 v[176:179], a[124:127], a[32:35], v[176:179]
    v_mfma_f32_16x16x32_bf16 v[208:211], a[128:131], a[32:35], v[208:211]
    v_mfma_f32_16x16x32_bf16 v[212:215], a[128:131], a[36:39], v[212:215]
    v_mfma_f32_16x16x32_bf16 v[216:219], a[128:131], a[40:43], v[216:219]
    v_mfma_f32_16x16x32_bf16 v[220:223], a[128:131], a[44:47], v[220:223]
    s_add_u32 m0, s43, 36864
    v_mfma_f32_16x16x32_bf16 v[224:227], a[128:131], a[48:51], v[224:227]
    buffer_load_dwordx4 v15, s[24:27], s40 offen lds
    v_mfma_f32_16x16x32_bf16 v[228:231], a[128:131], a[52:55], v[228:231]
    v_mfma_f32_16x16x32_bf16 v[232:235], a[128:131], a[56:59], v[232:235]
    v_mfma_f32_16x16x32_bf16 v[236:239], a[128:131], a[60:63], v[236:239]
    v_mfma_f32_16x16x32_bf16 a[156:159], a[132:135], a[60:63], a[156:159]
    v_mfma_f32_16x16x32_bf16 a[152:155], a[132:135], a[56:59], a[152:155]
    v_mfma_f32_16x16x32_bf16 a[148:151], a[132:135], a[52:55], a[148:151]
    s_add_u32 m0, s43, 53248
    v_mfma_f32_16x16x32_bf16 a[144:147], a[132:135], a[48:51], a[144:147]
    buffer_load_dwordx4 v14, s[28:31], s39 offen lds
    v_mfma_f32_16x16x32_bf16 v[252:255], a[132:135], a[44:47], v[252:255]
    v_mfma_f32_16x16x32_bf16 v[248:251], a[132:135], a[40:43], v[248:251]
    v_mfma_f32_16x16x32_bf16 v[244:247], a[132:135], a[36:39], v[244:247]
    v_mfma_f32_16x16x32_bf16 v[240:243], a[132:135], a[32:35], v[240:243]
    v_mfma_f32_16x16x32_bf16 a[160:163], a[136:139], a[32:35], a[160:163]
    v_mfma_f32_16x16x32_bf16 a[164:167], a[136:139], a[36:39], a[164:167]
    s_add_u32 m0, s43, 69632
    v_mfma_f32_16x16x32_bf16 a[168:171], a[136:139], a[40:43], a[168:171]
    buffer_load_dwordx4 v15, s[32:35], s40 offen lds
    v_mfma_f32_16x16x32_bf16 a[172:175], a[136:139], a[44:47], a[172:175]
    s_add_u32 s38, s38, 196608
    v_mfma_f32_16x16x32_bf16 a[176:179], a[136:139], a[48:51], a[176:179]
    s_add_u32 s39, s39, s41
    v_mfma_f32_16x16x32_bf16 a[180:183], a[136:139], a[52:55], a[180:183]
    s_add_u32 s40, s40, 229376
    v_mfma_f32_16x16x32_bf16 a[184:187], a[136:139], a[56:59], a[184:187]
    v_mfma_f32_16x16x32_bf16 a[188:191], a[136:139], a[60:63], a[188:191]
    v_mfma_f32_16x16x32_bf16 a[220:223], a[140:143], a[60:63], a[220:223]
    v_mfma_f32_16x16x32_bf16 a[216:219], a[140:143], a[56:59], a[216:219]
    v_mfma_f32_16x16x32_bf16 a[212:215], a[140:143], a[52:55], a[212:215]
    v_mfma_f32_16x16x32_bf16 a[208:211], a[140:143], a[48:51], a[208:211]
    v_mfma_f32_16x16x32_bf16 a[204:207], a[140:143], a[44:47], a[204:207]
    v_mfma_f32_16x16x32_bf16 a[200:203], a[140:143], a[40:43], a[200:203]
    v_mfma_f32_16x16x32_bf16 a[196:199], a[140:143], a[36:39], a[196:199]
    v_mfma_f32_16x16x32_bf16 a[192:195], a[140:143], a[32:35], a[192:195]
    s_waitcnt vmcnt(20) lgkmcnt(0)
    s_barrier
    v_mfma_f32_16x16x32_bf16 v[16:19], a[64:67], a[0:3], v[16:19]
    ds_read_b128 a[32:35], v1 offset:24576
    v_mfma_f32_16x16x32_bf16 v[20:23], a[64:67], a[4:7], v[20:23]
    ds_read_b128 a[36:39], v1 offset:25600
    v_mfma_f32_16x16x32_bf16 v[24:27], a[64:67], a[8:11], v[24:27]
    ds_read_b128 a[40:43], v1 offset:26624
    v_mfma_f32_16x16x32_bf16 v[28:31], a[64:67], a[12:15], v[28:31]
    buffer_load_dword a226, v0, s[88:91], s78 offen
    v_mfma_f32_16x16x32_bf16 v[32:35], a[64:67], a[16:19], v[32:35]
    ds_read_b128 a[44:47], v1 offset:27648
    v_mfma_f32_16x16x32_bf16 v[36:39], a[64:67], a[20:23], v[36:39]
    ds_read_b128 a[48:51], v1 offset:28672
    v_mfma_f32_16x16x32_bf16 v[40:43], a[64:67], a[24:27], v[40:43]
    ds_read_b128 a[52:55], v1 offset:29696
    v_mfma_f32_16x16x32_bf16 v[44:47], a[64:67], a[28:31], v[44:47]
    ds_read_b128 a[56:59], v1 offset:30720
    v_mfma_f32_16x16x32_bf16 v[76:79], a[68:71], a[28:31], v[76:79]
    ds_read_b128 a[60:63], v1 offset:31744
    v_mfma_f32_16x16x32_bf16 v[72:75], a[68:71], a[24:27], v[72:75]
    s_add_u32 s78, s78, s100
    s_add_u32 m0, s42, 16384
    v_mfma_f32_16x16x32_bf16 v[68:71], a[68:71], a[20:23], v[68:71]
    buffer_load_dwordx4 v12, s[12:15], s37 offen offset:0 lds
    v_mfma_f32_16x16x32_bf16 v[64:67], a[68:71], a[16:19], v[64:67]
    ds_read_b64_tr_b16 a[104:105], v2 offset:12288
    v_mfma_f32_16x16x32_bf16 v[60:63], a[68:71], a[12:15], v[60:63]
    ds_read_b64_tr_b16 a[106:107], v2 offset:12800
    v_mfma_f32_16x16x32_bf16 v[56:59], a[68:71], a[8:11], v[56:59]
    ds_read_b64_tr_b16 a[108:109], v3 offset:12288
    v_mfma_f32_16x16x32_bf16 v[52:55], a[68:71], a[4:7], v[52:55]
    ds_read_b64_tr_b16 a[110:111], v3 offset:12800
    v_mfma_f32_16x16x32_bf16 v[48:51], a[68:71], a[0:3], v[48:51]
    ds_read_b64_tr_b16 a[112:113], v4 offset:12288
    v_mfma_f32_16x16x32_bf16 v[80:83], a[72:75], a[0:3], v[80:83]
    ds_read_b64_tr_b16 a[114:115], v4 offset:12800
    v_mfma_f32_16x16x32_bf16 v[84:87], a[72:75], a[4:7], v[84:87]
    buffer_load_dwordx4 v12, s[12:15], s37 offen offset:1024 lds
    v_mfma_f32_16x16x32_bf16 v[88:91], a[72:75], a[8:11], v[88:91]
    ds_read_b64_tr_b16 a[116:117], v5 offset:12288
    v_mfma_f32_16x16x32_bf16 v[92:95], a[72:75], a[12:15], v[92:95]
    ds_read_b64_tr_b16 a[118:119], v5 offset:12800
    v_mfma_f32_16x16x32_bf16 v[96:99], a[72:75], a[16:19], v[96:99]
    ds_read_b64_tr_b16 a[120:121], v6 offset:12288
    v_mfma_f32_16x16x32_bf16 v[100:103], a[72:75], a[20:23], v[100:103]
    ds_read_b64_tr_b16 a[122:123], v6 offset:12800
    v_mfma_f32_16x16x32_bf16 v[104:107], a[72:75], a[24:27], v[104:107]
    ds_read_b64_tr_b16 a[124:125], v7 offset:12288
    v_mfma_f32_16x16x32_bf16 v[108:111], a[72:75], a[28:31], v[108:111]
    ds_read_b64_tr_b16 a[126:127], v7 offset:12800
    v_mfma_f32_16x16x32_bf16 v[140:143], a[76:79], a[28:31], v[140:143]
    buffer_load_dwordx4 v12, s[12:15], s37 offen offset:2048 lds
    v_mfma_f32_16x16x32_bf16 v[136:139], a[76:79], a[24:27], v[136:139]
    ds_read_b64_tr_b16 a[128:129], v8 offset:12288
    v_mfma_f32_16x16x32_bf16 v[132:135], a[76:79], a[20:23], v[132:135]
    ds_read_b64_tr_b16 a[130:131], v8 offset:12800
    v_mfma_f32_16x16x32_bf16 v[128:131], a[76:79], a[16:19], v[128:131]
    ds_read_b64_tr_b16 a[132:133], v9 offset:12288
    v_mfma_f32_16x16x32_bf16 v[124:127], a[76:79], a[12:15], v[124:127]
    ds_read_b64_tr_b16 a[134:135], v9 offset:12800
    v_mfma_f32_16x16x32_bf16 v[120:123], a[76:79], a[8:11], v[120:123]
    ds_read_b64_tr_b16 a[136:137], v10 offset:12288
    v_mfma_f32_16x16x32_bf16 v[116:119], a[76:79], a[4:7], v[116:119]
    ds_read_b64_tr_b16 a[138:139], v10 offset:12800
    v_mfma_f32_16x16x32_bf16 v[112:115], a[76:79], a[0:3], v[112:115]
    buffer_load_dwordx4 v12, s[12:15], s37 offen offset:3072 lds
    v_mfma_f32_16x16x32_bf16 v[144:147], a[80:83], a[0:3], v[144:147]
    ds_read_b64_tr_b16 a[140:141], v11 offset:12288
    v_mfma_f32_16x16x32_bf16 v[148:151], a[80:83], a[4:7], v[148:151]
    ds_read_b64_tr_b16 a[142:143], v11 offset:12800
    v_mfma_f32_16x16x32_bf16 v[152:155], a[80:83], a[8:11], v[152:155]
    v_mfma_f32_16x16x32_bf16 v[156:159], a[80:83], a[12:15], v[156:159]
    v_mfma_f32_16x16x32_bf16 v[160:163], a[80:83], a[16:19], v[160:163]
    v_mfma_f32_16x16x32_bf16 v[164:167], a[80:83], a[20:23], v[164:167]
    s_add_u32 s37, s37, 0x4000
    s_add_u32 m0, s43, 8192
    v_mfma_f32_16x16x32_bf16 v[168:171], a[80:83], a[24:27], v[168:171]
    buffer_load_dwordx4 v13, s[16:19], s38 offen lds
    v_mfma_f32_16x16x32_bf16 v[172:175], a[80:83], a[28:31], v[172:175]
    v_mfma_f32_16x16x32_bf16 v[204:207], a[84:87], a[28:31], v[204:207]
    v_mfma_f32_16x16x32_bf16 v[200:203], a[84:87], a[24:27], v[200:203]
    v_mfma_f32_16x16x32_bf16 v[196:199], a[84:87], a[20:23], v[196:199]
    v_mfma_f32_16x16x32_bf16 v[192:195], a[84:87], a[16:19], v[192:195]
    v_mfma_f32_16x16x32_bf16 v[188:191], a[84:87], a[12:15], v[188:191]
    s_add_u32 m0, s43, 24576
    v_mfma_f32_16x16x32_bf16 v[184:187], a[84:87], a[8:11], v[184:187]
    buffer_load_dwordx4 v14, s[20:23], s39 offen lds
    v_mfma_f32_16x16x32_bf16 v[180:183], a[84:87], a[4:7], v[180:183]
    v_mfma_f32_16x16x32_bf16 v[176:179], a[84:87], a[0:3], v[176:179]
    v_mfma_f32_16x16x32_bf16 v[208:211], a[88:91], a[0:3], v[208:211]
    v_mfma_f32_16x16x32_bf16 v[212:215], a[88:91], a[4:7], v[212:215]
    v_mfma_f32_16x16x32_bf16 v[216:219], a[88:91], a[8:11], v[216:219]
    v_mfma_f32_16x16x32_bf16 v[220:223], a[88:91], a[12:15], v[220:223]
    s_add_u32 m0, s43, 40960
    v_mfma_f32_16x16x32_bf16 v[224:227], a[88:91], a[16:19], v[224:227]
    buffer_load_dwordx4 v15, s[24:27], s40 offen lds
    v_mfma_f32_16x16x32_bf16 v[228:231], a[88:91], a[20:23], v[228:231]
    v_mfma_f32_16x16x32_bf16 v[232:235], a[88:91], a[24:27], v[232:235]
    v_mfma_f32_16x16x32_bf16 v[236:239], a[88:91], a[28:31], v[236:239]
    v_mfma_f32_16x16x32_bf16 a[156:159], a[92:95], a[28:31], a[156:159]
    v_mfma_f32_16x16x32_bf16 a[152:155], a[92:95], a[24:27], a[152:155]
    v_mfma_f32_16x16x32_bf16 a[148:151], a[92:95], a[20:23], a[148:151]
    s_add_u32 m0, s43, 57344
    v_mfma_f32_16x16x32_bf16 a[144:147], a[92:95], a[16:19], a[144:147]
    buffer_load_dwordx4 v14, s[28:31], s39 offen lds
    v_mfma_f32_16x16x32_bf16 v[252:255], a[92:95], a[12:15], v[252:255]
    v_mfma_f32_16x16x32_bf16 v[248:251], a[92:95], a[8:11], v[248:251]
    v_mfma_f32_16x16x32_bf16 v[244:247], a[92:95], a[4:7], v[244:247]
    v_mfma_f32_16x16x32_bf16 v[240:243], a[92:95], a[0:3], v[240:243]
    v_mfma_f32_16x16x32_bf16 a[160:163], a[96:99], a[0:3], a[160:163]
    v_mfma_f32_16x16x32_bf16 a[164:167], a[96:99], a[4:7], a[164:167]
    s_add_u32 m0, s43, 73728
    v_mfma_f32_16x16x32_bf16 a[168:171], a[96:99], a[8:11], a[168:171]
    buffer_load_dwordx4 v15, s[32:35], s40 offen lds
    v_mfma_f32_16x16x32_bf16 a[172:175], a[96:99], a[12:15], a[172:175]
    s_add_u32 s38, s38, 196608
    v_mfma_f32_16x16x32_bf16 a[176:179], a[96:99], a[16:19], a[176:179]
    s_add_u32 s39, s39, s41
    v_mfma_f32_16x16x32_bf16 a[180:183], a[96:99], a[20:23], a[180:183]
    s_add_u32 s40, s40, 229376
    v_mfma_f32_16x16x32_bf16 a[184:187], a[96:99], a[24:27], a[184:187]
    v_mfma_f32_16x16x32_bf16 a[188:191], a[96:99], a[28:31], a[188:191]
    v_mfma_f32_16x16x32_bf16 a[220:223], a[100:103], a[28:31], a[220:223]
    v_mfma_f32_16x16x32_bf16 a[216:219], a[100:103], a[24:27], a[216:219]
    v_mfma_f32_16x16x32_bf16 a[212:215], a[100:103], a[20:23], a[212:215]
    v_mfma_f32_16x16x32_bf16 a[208:211], a[100:103], a[16:19], a[208:211]
    v_mfma_f32_16x16x32_bf16 a[204:207], a[100:103], a[12:15], a[204:207]
    v_mfma_f32_16x16x32_bf16 a[200:203], a[100:103], a[8:11], a[200:203]
    v_mfma_f32_16x16x32_bf16 a[196:199], a[100:103], a[4:7], a[196:199]
    v_mfma_f32_16x16x32_bf16 a[192:195], a[100:103], a[0:3], a[192:195]
    s_waitcnt vmcnt(20) lgkmcnt(0)
    s_barrier
    v_mfma_f32_16x16x32_bf16 v[16:19], a[104:107], a[32:35], v[16:19]
    ds_read_b128 a[0:3], v1 offset:0
    v_mfma_f32_16x16x32_bf16 v[20:23], a[104:107], a[36:39], v[20:23]
    ds_read_b128 a[4:7], v1 offset:1024
    v_mfma_f32_16x16x32_bf16 v[24:27], a[104:107], a[40:43], v[24:27]
    ds_read_b128 a[8:11], v1 offset:2048
    v_mfma_f32_16x16x32_bf16 v[28:31], a[104:107], a[44:47], v[28:31]
    buffer_load_dword a226, v0, s[88:91], s78 offen
    v_mfma_f32_16x16x32_bf16 v[32:35], a[104:107], a[48:51], v[32:35]
    ds_read_b128 a[12:15], v1 offset:3072
    v_mfma_f32_16x16x32_bf16 v[36:39], a[104:107], a[52:55], v[36:39]
    ds_read_b128 a[16:19], v1 offset:4096
    v_mfma_f32_16x16x32_bf16 v[40:43], a[104:107], a[56:59], v[40:43]
    ds_read_b128 a[20:23], v1 offset:5120
    v_mfma_f32_16x16x32_bf16 v[44:47], a[104:107], a[60:63], v[44:47]
    ds_read_b128 a[24:27], v1 offset:6144
    v_mfma_f32_16x16x32_bf16 v[76:79], a[108:111], a[60:63], v[76:79]
    ds_read_b128 a[28:31], v1 offset:7168
    v_mfma_f32_16x16x32_bf16 v[72:75], a[108:111], a[56:59], v[72:75]
    s_add_u32 s78, s78, s100
    s_add_u32 m0, s42, 24576
    v_mfma_f32_16x16x32_bf16 v[68:71], a[108:111], a[52:55], v[68:71]
    buffer_load_dwordx4 v12, s[12:15], s37 offen offset:0 lds
    v_mfma_f32_16x16x32_bf16 v[64:67], a[108:111], a[48:51], v[64:67]
    ds_read_b64_tr_b16 a[64:65], v2 offset:0
    v_mfma_f32_16x16x32_bf16 v[60:63], a[108:111], a[44:47], v[60:63]
    ds_read_b64_tr_b16 a[66:67], v2 offset:512
    v_mfma_f32_16x16x32_bf16 v[56:59], a[108:111], a[40:43], v[56:59]
    ds_read_b64_tr_b16 a[68:69], v3 offset:0
    v_mfma_f32_16x16x32_bf16 v[52:55], a[108:111], a[36:39], v[52:55]
    ds_read_b64_tr_b16 a[70:71], v3 offset:512
    v_mfma_f32_16x16x32_bf16 v[48:51], a[108:111], a[32:35], v[48:51]
    ds_read_b64_tr_b16 a[72:73], v4 offset:0
    v_mfma_f32_16x16x32_bf16 v[80:83], a[112:115], a[32:35], v[80:83]
    ds_read_b64_tr_b16 a[74:75], v4 offset:512
    v_mfma_f32_16x16x32_bf16 v[84:87], a[112:115], a[36:39], v[84:87]
    buffer_load_dwordx4 v12, s[12:15], s37 offen offset:1024 lds
    v_mfma_f32_16x16x32_bf16 v[88:91], a[112:115], a[40:43], v[88:91]
    ds_read_b64_tr_b16 a[76:77], v5 offset:0
    v_mfma_f32_16x16x32_bf16 v[92:95], a[112:115], a[44:47], v[92:95]
    ds_read_b64_tr_b16 a[78:79], v5 offset:512
    v_mfma_f32_16x16x32_bf16 v[96:99], a[112:115], a[48:51], v[96:99]
    ds_read_b64_tr_b16 a[80:81], v6 offset:0
    v_mfma_f32_16x16x32_bf16 v[100:103], a[112:115], a[52:55], v[100:103]
    ds_read_b64_tr_b16 a[82:83], v6 offset:512
    v_mfma_f32_16x16x32_bf16 v[104:107], a[112:115], a[56:59], v[104:107]
    ds_read_b64_tr_b16 a[84:85], v7 offset:0
    v_mfma_f32_16x16x32_bf16 v[108:111], a[112:115], a[60:63], v[108:111]
    ds_read_b64_tr_b16 a[86:87], v7 offset:512
    v_mfma_f32_16x16x32_bf16 v[140:143], a[116:119], a[60:63], v[140:143]
    buffer_load_dwordx4 v12, s[12:15], s37 offen offset:2048 lds
    v_mfma_f32_16x16x32_bf16 v[136:139], a[116:119], a[56:59], v[136:139]
    ds_read_b64_tr_b16 a[88:89], v8 offset:0
    v_mfma_f32_16x16x32_bf16 v[132:135], a[116:119], a[52:55], v[132:135]
    ds_read_b64_tr_b16 a[90:91], v8 offset:512
    v_mfma_f32_16x16x32_bf16 v[128:131], a[116:119], a[48:51], v[128:131]
    ds_read_b64_tr_b16 a[92:93], v9 offset:0
    v_mfma_f32_16x16x32_bf16 v[124:127], a[116:119], a[44:47], v[124:127]
    ds_read_b64_tr_b16 a[94:95], v9 offset:512
    v_mfma_f32_16x16x32_bf16 v[120:123], a[116:119], a[40:43], v[120:123]
    ds_read_b64_tr_b16 a[96:97], v10 offset:0
    v_mfma_f32_16x16x32_bf16 v[116:119], a[116:119], a[36:39], v[116:119]
    ds_read_b64_tr_b16 a[98:99], v10 offset:512
    v_mfma_f32_16x16x32_bf16 v[112:115], a[116:119], a[32:35], v[112:115]
    buffer_load_dwordx4 v12, s[12:15], s37 offen offset:3072 lds
    v_mfma_f32_16x16x32_bf16 v[144:147], a[120:123], a[32:35], v[144:147]
    ds_read_b64_tr_b16 a[100:101], v11 offset:0
    v_mfma_f32_16x16x32_bf16 v[148:151], a[120:123], a[36:39], v[148:151]
    ds_read_b64_tr_b16 a[102:103], v11 offset:512
    v_mfma_f32_16x16x32_bf16 v[152:155], a[120:123], a[40:43], v[152:155]
    v_mfma_f32_16x16x32_bf16 v[156:159], a[120:123], a[44:47], v[156:159]
    v_mfma_f32_16x16x32_bf16 v[160:163], a[120:123], a[48:51], v[160:163]
    v_mfma_f32_16x16x32_bf16 v[164:167], a[120:123], a[52:55], v[164:167]
    s_add_u32 s37, s37, 0x4000
    s_add_u32 m0, s43, 12288
    v_mfma_f32_16x16x32_bf16 v[168:171], a[120:123], a[56:59], v[168:171]
    buffer_load_dwordx4 v13, s[16:19], s38 offen lds
    v_mfma_f32_16x16x32_bf16 v[172:175], a[120:123], a[60:63], v[172:175]
    v_mfma_f32_16x16x32_bf16 v[204:207], a[124:127], a[60:63], v[204:207]
    v_mfma_f32_16x16x32_bf16 v[200:203], a[124:127], a[56:59], v[200:203]
    v_mfma_f32_16x16x32_bf16 v[196:199], a[124:127], a[52:55], v[196:199]
    v_mfma_f32_16x16x32_bf16 v[192:195], a[124:127], a[48:51], v[192:195]
    v_mfma_f32_16x16x32_bf16 v[188:191], a[124:127], a[44:47], v[188:191]
    s_add_u32 m0, s43, 28672
    v_mfma_f32_16x16x32_bf16 v[184:187], a[124:127], a[40:43], v[184:187]
    buffer_load_dwordx4 v14, s[20:23], s39 offen lds
    v_mfma_f32_16x16x32_bf16 v[180:183], a[124:127], a[36:39], v[180:183]
    v_mfma_f32_16x16x32_bf16 v[176:179], a[124:127], a[32:35], v[176:179]
    v_mfma_f32_16x16x32_bf16 v[208:211], a[128:131], a[32:35], v[208:211]
    v_mfma_f32_16x16x32_bf16 v[212:215], a[128:131], a[36:39], v[212:215]
    v_mfma_f32_16x16x32_bf16 v[216:219], a[128:131], a[40:43], v[216:219]
    v_mfma_f32_16x16x32_bf16 v[220:223], a[128:131], a[44:47], v[220:223]
    s_add_u32 m0, s43, 45056
    v_mfma_f32_16x16x32_bf16 v[224:227], a[128:131], a[48:51], v[224:227]
    buffer_load_dwordx4 v15, s[24:27], s40 offen lds
    v_mfma_f32_16x16x32_bf16 v[228:231], a[128:131], a[52:55], v[228:231]
    v_mfma_f32_16x16x32_bf16 v[232:235], a[128:131], a[56:59], v[232:235]
    v_mfma_f32_16x16x32_bf16 v[236:239], a[128:131], a[60:63], v[236:239]
    v_mfma_f32_16x16x32_bf16 a[156:159], a[132:135], a[60:63], a[156:159]
    v_mfma_f32_16x16x32_bf16 a[152:155], a[132:135], a[56:59], a[152:155]
    v_mfma_f32_16x16x32_bf16 a[148:151], a[132:135], a[52:55], a[148:151]
    s_add_u32 m0, s43, 61440
    v_mfma_f32_16x16x32_bf16 a[144:147], a[132:135], a[48:51], a[144:147]
    buffer_load_dwordx4 v14, s[28:31], s39 offen lds
    v_mfma_f32_16x16x32_bf16 v[252:255], a[132:135], a[44:47], v[252:255]
    v_mfma_f32_16x16x32_bf16 v[248:251], a[132:135], a[40:43], v[248:251]
    v_mfma_f32_16x16x32_bf16 v[244:247], a[132:135], a[36:39], v[244:247]
    v_mfma_f32_16x16x32_bf16 v[240:243], a[132:135], a[32:35], v[240:243]
    v_mfma_f32_16x16x32_bf16 a[160:163], a[136:139], a[32:35], a[160:163]
    v_mfma_f32_16x16x32_bf16 a[164:167], a[136:139], a[36:39], a[164:167]
    s_add_u32 m0, s43, 77824
    v_mfma_f32_16x16x32_bf16 a[168:171], a[136:139], a[40:43], a[168:171]
    buffer_load_dwordx4 v15, s[32:35], s40 offen lds
    v_mfma_f32_16x16x32_bf16 a[172:175], a[136:139], a[44:47], a[172:175]
    s_add_u32 s38, s38, 196608
    v_mfma_f32_16x16x32_bf16 a[176:179], a[136:139], a[48:51], a[176:179]
    s_add_u32 s39, s39, s41
    v_mfma_f32_16x16x32_bf16 a[180:183], a[136:139], a[52:55], a[180:183]
    s_add_u32 s40, s40, 229376
    v_mfma_f32_16x16x32_bf16 a[184:187], a[136:139], a[56:59], a[184:187]
    v_mfma_f32_16x16x32_bf16 a[188:191], a[136:139], a[60:63], a[188:191]
    s_sub_u32 s44, s44, 1
    v_mfma_f32_16x16x32_bf16 a[220:223], a[140:143], a[60:63], a[220:223]
    s_cmp_eq_u32 s44, s101
    v_mfma_f32_16x16x32_bf16 a[216:219], a[140:143], a[56:59], a[216:219]
    s_cselect_b32 s88, s92, s88
    v_mfma_f32_16x16x32_bf16 a[212:215], a[140:143], a[52:55], a[212:215]
    s_cselect_b32 s89, s93, s89
    v_mfma_f32_16x16x32_bf16 a[208:211], a[140:143], a[48:51], a[208:211]
    s_cselect_b32 s90, s94, s90
    v_mfma_f32_16x16x32_bf16 a[204:207], a[140:143], a[44:47], a[204:207]
    s_cselect_b32 s78, s79, s78
    v_mfma_f32_16x16x32_bf16 a[200:203], a[140:143], a[40:43], a[200:203]
    s_cmp_lg_u32 s44, 0
    v_mfma_f32_16x16x32_bf16 a[196:199], a[140:143], a[36:39], a[196:199]
    v_mfma_f32_16x16x32_bf16 a[192:195], a[140:143], a[32:35], a[192:195]
    s_cbranch_scc1 L_g1_loop_qk
    v_mbcnt_lo_u32_b32 v0, -1, 0
    v_mbcnt_hi_u32_b32 v0, -1, v0
    s_load_dwordx2 s[6:7], s[0:1], 48
    s_load_dwordx2 s[8:9], s[0:1], 16
    s_load_dwordx2 s[10:11], s[0:1], 0
    s_load_dwordx2 s[12:13], s[0:1], 56
    v_lshrrev_b32 v13, 4, v0
    v_lshlrev_b32 v13, 9, v13
    v_bfe_u32 v14, v0, 3, 1
    v_lshl_add_u32 v13, v14, 8, v13
    v_and_b32 v14, 7, v0
    v_lshl_add_u32 v13, v14, 4, v13
    s_cmp_eq_u32 s45, 0
    s_cbranch_scc1 L_g1_tailB
    s_waitcnt vmcnt(20) lgkmcnt(0)
    s_barrier
    v_mfma_f32_16x16x32_bf16 v[16:19], a[64:67], a[0:3], v[16:19]
    ds_read_b128 a[32:35], v1 offset:8192
    v_mfma_f32_16x16x32_bf16 v[20:23], a[64:67], a[4:7], v[20:23]
    ds_read_b128 a[36:39], v1 offset:9216
    v_mfma_f32_16x16x32_bf16 v[24:27], a[64:67], a[8:11], v[24:27]
    ds_read_b128 a[40:43], v1 offset:10240
    v_mfma_f32_16x16x32_bf16 v[28:31], a[64:67], a[12:15], v[28:31]
    ds_read_b128 a[44:47], v1 offset:11264
    v_mfma_f32_16x16x32_bf16 v[32:35], a[64:67], a[16:19], v[32:35]
    ds_read_b128 a[48:51], v1 offset:12288
    v_mfma_f32_16x16x32_bf16 v[36:39], a[64:67], a[20:23], v[36:39]
    ds_read_b128 a[52:55], v1 offset:13312
    v_mfma_f32_16x16x32_bf16 v[40:43], a[64:67], a[24:27], v[40:43]
    ds_read_b128 a[56:59], v1 offset:14336
    v_mfma_f32_16x16x32_bf16 v[44:47], a[64:67], a[28:31], v[44:47]
    ds_read_b128 a[60:63], v1 offset:15360
    v_mfma_f32_16x16x32_bf16 v[76:79], a[68:71], a[28:31], v[76:79]
    ds_read_b64_tr_b16 a[104:105], v2 offset:4096
    v_mfma_f32_16x16x32_bf16 v[72:75], a[68:71], a[24:27], v[72:75]
    ds_read_b64_tr_b16 a[106:107], v2 offset:4608
    v_mfma_f32_16x16x32_bf16 v[68:71], a[68:71], a[20:23], v[68:71]
    ds_read_b64_tr_b16 a[108:109], v3 offset:4096
    v_mfma_f32_16x16x32_bf16 v[64:67], a[68:71], a[16:19], v[64:67]
    ds_read_b64_tr_b16 a[110:111], v3 offset:4608
    v_mfma_f32_16x16x32_bf16 v[60:63], a[68:71], a[12:15], v[60:63]
    ds_read_b64_tr_b16 a[112:113], v4 offset:4096
    v_mfma_f32_16x16x32_bf16 v[56:59], a[68:71], a[8:11], v[56:59]
    ds_read_b64_tr_b16 a[114:115], v4 offset:4608
    v_mfma_f32_16x16x32_bf16 v[52:55], a[68:71], a[4:7], v[52:55]
    ds_read_b64_tr_b16 a[128:129], v8 offset:4096
    v_mfma_f32_16x16x32_bf16 v[48:51], a[68:71], a[0:3], v[48:51]
    ds_read_b64_tr_b16 a[130:131], v8 offset:4608
    v_mfma_f32_16x16x32_bf16 v[80:83], a[72:75], a[0:3], v[80:83]
    v_mfma_f32_16x16x32_bf16 v[84:87], a[72:75], a[4:7], v[84:87]
    v_mfma_f32_16x16x32_bf16 v[88:91], a[72:75], a[8:11], v[88:91]
    v_mfma_f32_16x16x32_bf16 v[92:95], a[72:75], a[12:15], v[92:95]
    v_mfma_f32_16x16x32_bf16 v[96:99], a[72:75], a[16:19], v[96:99]
    v_mfma_f32_16x16x32_bf16 v[100:103], a[72:75], a[20:23], v[100:103]
    v_mfma_f32_16x16x32_bf16 v[104:107], a[72:75], a[24:27], v[104:107]
    v_mfma_f32_16x16x32_bf16 v[108:111], a[72:75], a[28:31], v[108:111]
    v_mfma_f32_16x16x32_bf16 v[208:211], a[88:91], a[0:3], v[208:211]
    v_mfma_f32_16x16x32_bf16 v[212:215], a[88:91], a[4:7], v[212:215]
    v_mfma_f32_16x16x32_bf16 v[216:219], a[88:91], a[8:11], v[216:219]
    v_mfma_f32_16x16x32_bf16 v[220:223], a[88:91], a[12:15], v[220:223]
    v_mfma_f32_16x16x32_bf16 v[224:227], a[88:91], a[16:19], v[224:227]
    v_mfma_f32_16x16x32_bf16 v[228:231], a[88:91], a[20:23], v[228:231]
    v_mfma_f32_16x16x32_bf16 v[232:235], a[88:91], a[24:27], v[232:235]
    v_mfma_f32_16x16x32_bf16 v[236:239], a[88:91], a[28:31], v[236:239]
    s_waitcnt vmcnt(10) lgkmcnt(0)
    s_barrier
    v_mfma_f32_16x16x32_bf16 v[16:19], a[104:107], a[32:35], v[16:19]
    ds_read_b128 a[0:3], v1 offset:16384
    v_mfma_f32_16x16x32_bf16 v[20:23], a[104:107], a[36:39], v[20:23]
    ds_read_b128 a[4:7], v1 offset:17408
    v_mfma_f32_16x16x32_bf16 v[24:27], a[104:107], a[40:43], v[24:27]
    ds_read_b128 a[8:11], v1 offset:18432
    v_mfma_f32_16x16x32_bf16 v[28:31], a[104:107], a[44:47], v[28:31]
    ds_read_b128 a[12:15], v1 offset:19456
    v_mfma_f32_16x16x32_bf16 v[32:35], a[104:107], a[48:51], v[32:35]
    ds_read_b128 a[16:19], v1 offset:20480
    v_mfma_f32_16x16x32_bf16 v[36:39], a[104:107], a[52:55], v[36:39]
    ds_read_b128 a[20:23], v1 offset:21504
    v_mfma_f32_16x16x32_bf16 v[40:43], a[104:107], a[56:59], v[40:43]
    ds_read_b128 a[24:27], v1 offset:22528
    v_mfma_f32_16x16x32_bf16 v[44:47], a[104:107], a[60:63], v[44:47]
    ds_read_b128 a[28:31], v1 offset:23552
    v_mfma_f32_16x16x32_bf16 v[76:79], a[108:111], a[60:63], v[76:79]
    ds_read_b64_tr_b16 a[64:65], v2 offset:8192
    v_mfma_f32_16x16x32_bf16 v[72:75], a[108:111], a[56:59], v[72:75]
    ds_read_b64_tr_b16 a[66:67], v2 offset:8704
    v_mfma_f32_16x16x32_bf16 v[68:71], a[108:111], a[52:55], v[68:71]
    ds_read_b64_tr_b16 a[68:69], v3 offset:8192
    v_mfma_f32_16x16x32_bf16 v[64:67], a[108:111], a[48:51], v[64:67]
    ds_read_b64_tr_b16 a[70:71], v3 offset:8704
    v_mfma_f32_16x16x32_bf16 v[60:63], a[108:111], a[44:47], v[60:63]
    ds_read_b64_tr_b16 a[72:73], v4 offset:8192
    v_mfma_f32_16x16x32_bf16 v[56:59], a[108:111], a[40:43], v[56:59]
    ds_read_b64_tr_b16 a[74:75], v4 offset:8704
    v_mfma_f32_16x16x32_bf16 v[52:55], a[108:111], a[36:39], v[52:55]
    ds_read_b64_tr_b16 a[88:89], v8 offset:8192
    v_mfma_f32_16x16x32_bf16 v[48:51], a[108:111], a[32:35], v[48:51]
    ds_read_b64_tr_b16 a[90:91], v8 offset:8704
    v_mfma_f32_16x16x32_bf16 v[80:83], a[112:115], a[32:35], v[80:83]
    v_mfma_f32_16x16x32_bf16 v[84:87], a[112:115], a[36:39], v[84:87]
    v_mfma_f32_16x16x32_bf16 v[88:91], a[112:115], a[40:43], v[88:91]
    v_mfma_f32_16x16x32_bf16 v[92:95], a[112:115], a[44:47], v[92:95]
    v_mfma_f32_16x16x32_bf16 v[96:99], a[112:115], a[48:51], v[96:99]
    v_mfma_f32_16x16x32_bf16 v[100:103], a[112:115], a[52:55], v[100:103]
    v_mfma_f32_16x16x32_bf16 v[104:107], a[112:115], a[56:59], v[104:107]
    v_mfma_f32_16x16x32_bf16 v[108:111], a[112:115], a[60:63], v[108:111]
    v_mfma_f32_16x16x32_bf16 v[208:211], a[128:131], a[32:35], v[208:211]
    v_mfma_f32_16x16x32_bf16 v[212:215], a[128:131], a[36:39], v[212:215]
    v_mfma_f32_16x16x32_bf16 v[216:219], a[128:131], a[40:43], v[216:219]
    v_mfma_f32_16x16x32_bf16 v[220:223], a[128:131], a[44:47], v[220:223]
    v_mfma_f32_16x16x32_bf16 v[224:227], a[128:131], a[48:51], v[224:227]
    v_mfma_f32_16x16x32_bf16 v[228:231], a[128:131], a[52:55], v[228:231]
    v_mfma_f32_16x16x32_bf16 v[232:235], a[128:131], a[56:59], v[232:235]
    v_mfma_f32_16x16x32_bf16 v[236:239], a[128:131], a[60:63], v[236:239]
    s_waitcnt vmcnt(0) lgkmcnt(0)
    s_barrier
    v_mfma_f32_16x16x32_bf16 v[16:19], a[64:67], a[0:3], v[16:19]
    ds_read_b128 a[32:35], v1 offset:24576
    v_mfma_f32_16x16x32_bf16 v[20:23], a[64:67], a[4:7], v[20:23]
    ds_read_b128 a[36:39], v1 offset:25600
    v_mfma_f32_16x16x32_bf16 v[24:27], a[64:67], a[8:11], v[24:27]
    ds_read_b128 a[40:43], v1 offset:26624
    v_mfma_f32_16x16x32_bf16 v[28:31], a[64:67], a[12:15], v[28:31]
    ds_read_b128 a[44:47], v1 offset:27648
    v_mfma_f32_16x16x32_bf16 v[32:35], a[64:67], a[16:19], v[32:35]
    ds_read_b128 a[48:51], v1 offset:28672
    v_mfma_f32_16x16x32_bf16 v[36:39], a[64:67], a[20:23], v[36:39]
    ds_read_b128 a[52:55], v1 offset:29696
    v_mfma_f32_16x16x32_bf16 v[40:43], a[64:67], a[24:27], v[40:43]
    ds_read_b128 a[56:59], v1 offset:30720
    v_mfma_f32_16x16x32_bf16 v[44:47], a[64:67], a[28:31], v[44:47]
    ds_read_b128 a[60:63], v1 offset:31744
    v_mfma_f32_16x16x32_bf16 v[76:79], a[68:71], a[28:31], v[76:79]
    ds_read_b64_tr_b16 a[104:105], v2 offset:12288
    v_mfma_f32_16x16x32_bf16 v[72:75], a[68:71], a[24:27], v[72:75]
    ds_read_b64_tr_b16 a[106:107], v2 offset:12800
    v_mfma_f32_16x16x32_bf16 v[68:71], a[68:71], a[20:23], v[68:71]
    ds_read_b64_tr_b16 a[108:109], v3 offset:12288
    v_mfma_f32_16x16x32_bf16 v[64:67], a[68:71], a[16:19], v[64:67]
    ds_read_b64_tr_b16 a[110:111], v3 offset:12800
    v_mfma_f32_16x16x32_bf16 v[60:63], a[68:71], a[12:15], v[60:63]
    ds_read_b64_tr_b16 a[112:113], v4 offset:12288
    v_mfma_f32_16x16x32_bf16 v[56:59], a[68:71], a[8:11], v[56:59]
    ds_read_b64_tr_b16 a[114:115], v4 offset:12800
    v_mfma_f32_16x16x32_bf16 v[52:55], a[68:71], a[4:7], v[52:55]
    ds_read_b64_tr_b16 a[128:129], v8 offset:12288
    v_mfma_f32_16x16x32_bf16 v[48:51], a[68:71], a[0:3], v[48:51]
    ds_read_b64_tr_b16 a[130:131], v8 offset:12800
    v_mfma_f32_16x16x32_bf16 v[80:83], a[72:75], a[0:3], v[80:83]
    v_mfma_f32_16x16x32_bf16 v[84:87], a[72:75], a[4:7], v[84:87]
    v_mfma_f32_16x16x32_bf16 v[88:91], a[72:75], a[8:11], v[88:91]
    v_mfma_f32_16x16x32_bf16 v[92:95], a[72:75], a[12:15], v[92:95]
    v_mfma_f32_16x16x32_bf16 v[96:99], a[72:75], a[16:19], v[96:99]
    v_mfma_f32_16x16x32_bf16 v[100:103], a[72:75], a[20:23], v[100:103]
    v_mfma_f32_16x16x32_bf16 v[104:107], a[72:75], a[24:27], v[104:107]
    v_mfma_f32_16x16x32_bf16 v[108:111], a[72:75], a[28:31], v[108:111]
    v_mfma_f32_16x16x32_bf16 v[208:211], a[88:91], a[0:3], v[208:211]
    v_mfma_f32_16x16x32_bf16 v[212:215], a[88:91], a[4:7], v[212:215]
    v_mfma_f32_16x16x32_bf16 v[216:219], a[88:91], a[8:11], v[216:219]
    v_mfma_f32_16x16x32_bf16 v[220:223], a[88:91], a[12:15], v[220:223]
    v_mfma_f32_16x16x32_bf16 v[224:227], a[88:91], a[16:19], v[224:227]
    v_mfma_f32_16x16x32_bf16 v[228:231], a[88:91], a[20:23], v[228:231]
    v_mfma_f32_16x16x32_bf16 v[232:235], a[88:91], a[24:27], v[232:235]
    v_mfma_f32_16x16x32_bf16 v[236:239], a[88:91], a[28:31], v[236:239]
    s_waitcnt lgkmcnt(0)
    v_mfma_f32_16x16x32_bf16 v[16:19], a[104:107], a[32:35], v[16:19]
    ds_read_b128 a[0:3], v1 offset:0
    s_getpc_b64 s[96:97]
L_pc_fk:
    v_mfma_f32_16x16x32_bf16 v[20:23], a[104:107], a[36:39], v[20:23]
    ds_read_b128 a[4:7], v1 offset:1024
    s_add_u32 s96, s96, L_p2_entry - L_pc_fk
    v_mfma_f32_16x16x32_bf16 v[24:27], a[104:107], a[40:43], v[24:27]
    ds_read_b128 a[8:11], v1 offset:2048
    s_addc_u32 s97, s97, 0
    v_mfma_f32_16x16x32_bf16 v[28:31], a[104:107], a[44:47], v[28:31]
    ds_read_b128 a[12:15], v1 offset:3072
    s_mov_b32 s98, L_g1_done - L_p2_entry
    v_mfma_f32_16x16x32_bf16 v[32:35], a[104:107], a[48:51], v[32:35]
    ds_read_b128 a[16:19], v1 offset:4096
    s_mov_b32 s99, 0x00020000
    v_mfma_f32_16x16x32_bf16 v[36:39], a[104:107], a[52:55], v[36:39]
    ds_read_b128 a[20:23], v1 offset:5120
    s_lshr_b32 s52, s2, 3
    v_mfma_f32_16x16x32_bf16 v[40:43], a[104:107], a[56:59], v[40:43]
    ds_read_b128 a[24:27], v1 offset:6144
    s_lshl_b32 s52, s52, 2
    v_mfma_f32_16x16x32_bf16 v[44:47], a[104:107], a[60:63], v[44:47]
    ds_read_b128 a[28:31], v1 offset:7168
    s_add_u32 s52, s52, s36
    v_mfma_f32_16x16x32_bf16 v[76:79], a[108:111], a[60:63], v[76:79]
    ds_read_b64_tr_b16 a[76:77], v5 offset:0
    s_mul_i32 s52, s52, 384
    v_mfma_f32_16x16x32_bf16 v[72:75], a[108:111], a[56:59], v[72:75]
    ds_read_b64_tr_b16 a[78:79], v5 offset:512
    v_lshlrev_b32 v15, 7, v0
    v_mfma_f32_16x16x32_bf16 v[68:71], a[108:111], a[52:55], v[68:71]
    ds_read_b64_tr_b16 a[92:93], v9 offset:0
    s_mov_b64 exec, 7
    buffer_load_dword a226, v15, s[96:99], s52 offen
    s_mov_b64 exec, -1
    v_mfma_f32_16x16x32_bf16 v[64:67], a[108:111], a[48:51], v[64:67]
    ds_read_b64_tr_b16 a[94:95], v9 offset:512
    v_mfma_f32_16x16x32_bf16 v[60:63], a[108:111], a[44:47], v[60:63]
    v_mfma_f32_16x16x32_bf16 v[56:59], a[108:111], a[40:43], v[56:59]
    v_mfma_f32_16x16x32_bf16 v[52:55], a[108:111], a[36:39], v[52:55]
    v_mfma_f32_16x16x32_bf16 v[48:51], a[108:111], a[32:35], v[48:51]
    v_mfma_f32_16x16x32_bf16 v[80:83], a[112:115], a[32:35], v[80:83]
    v_mfma_f32_16x16x32_bf16 v[84:87], a[112:115], a[36:39], v[84:87]
    v_mfma_f32_16x16x32_bf16 v[88:91], a[112:115], a[40:43], v[88:91]
    v_mfma_f32_16x16x32_bf16 v[92:95], a[112:115], a[44:47], v[92:95]
    v_mfma_f32_16x16x32_bf16 v[96:99], a[112:115], a[48:51], v[96:99]
    v_mfma_f32_16x16x32_bf16 v[100:103], a[112:115], a[52:55], v[100:103]
    v_mfma_f32_16x16x32_bf16 v[104:107], a[112:115], a[56:59], v[104:107]
    v_mfma_f32_16x16x32_bf16 v[108:111], a[112:115], a[60:63], v[108:111]
    v_mfma_f32_16x16x32_bf16 v[208:211], a[128:131], a[32:35], v[208:211]
    v_mfma_f32_16x16x32_bf16 v[212:215], a[128:131], a[36:39], v[212:215]
    v_mfma_f32_16x16x32_bf16 v[216:219], a[128:131], a[40:43], v[216:219]
    v_mfma_f32_16x16x32_bf16 v[220:223], a[128:131], a[44:47], v[220:223]
    v_mfma_f32_16x16x32_bf16 v[224:227], a[128:131], a[48:51], v[224:227]
    v_mfma_f32_16x16x32_bf16 v[228:231], a[128:131], a[52:55], v[228:231]
    v_mfma_f32_16x16x32_bf16 v[232:235], a[128:131], a[56:59], v[232:235]
    v_mfma_f32_16x16x32_bf16 v[236:239], a[128:131], a[60:63], v[236:239]
    s_waitcnt lgkmcnt(0)
    v_mfma_f32_16x16x32_bf16 v[140:143], a[76:79], a[28:31], v[140:143]
    ds_read_b128 a[32:35], v1 offset:8192
    v_mfma_f32_16x16x32_bf16 v[136:139], a[76:79], a[24:27], v[136:139]
    ds_read_b128 a[36:39], v1 offset:9216
    v_mfma_f32_16x16x32_bf16 v[132:135], a[76:79], a[20:23], v[132:135]
    ds_read_b128 a[40:43], v1 offset:10240
    v_mfma_f32_16x16x32_bf16 v[128:131], a[76:79], a[16:19], v[128:131]
    ds_read_b128 a[44:47], v1 offset:11264
    v_mfma_f32_16x16x32_bf16 v[124:127], a[76:79], a[12:15], v[124:127]
    ds_read_b128 a[48:51], v1 offset:12288
    v_mfma_f32_16x16x32_bf16 v[120:123], a[76:79], a[8:11], v[120:123]
    ds_read_b128 a[52:55], v1 offset:13312
    v_mfma_f32_16x16x32_bf16 v[116:119], a[76:79], a[4:7], v[116:119]
    ds_read_b128 a[56:59], v1 offset:14336
    v_mfma_f32_16x16x32_bf16 v[112:115], a[76:79], a[0:3], v[112:115]
    ds_read_b128 a[60:63], v1 offset:15360
    v_mfma_f32_16x16x32_bf16 a[156:159], a[92:95], a[28:31], a[156:159]
    ds_read_b64_tr_b16 a[116:117], v5 offset:4096
    v_mfma_f32_16x16x32_bf16 a[152:155], a[92:95], a[24:27], a[152:155]
    ds_read_b64_tr_b16 a[118:119], v5 offset:4608
    v_mfma_f32_16x16x32_bf16 a[148:151], a[92:95], a[20:23], a[148:151]
    ds_read_b64_tr_b16 a[132:133], v9 offset:4096
    v_mfma_f32_16x16x32_bf16 a[144:147], a[92:95], a[16:19], a[144:147]
    ds_read_b64_tr_b16 a[134:135], v9 offset:4608
    v_mfma_f32_16x16x32_bf16 v[252:255], a[92:95], a[12:15], v[252:255]
    s_lshl_b32 s52, s50, 1
    s_add_u32 s52, s52, s49
    v_mfma_f32_16x16x32_bf16 v[248:251], a[92:95], a[8:11], v[248:251]
    s_lshl_b32 s76, s52, 17
    s_lshl_b32 s53, s47, 14
    v_mfma_f32_16x16x32_bf16 v[244:247], a[92:95], a[4:7], v[244:247]
    s_add_u32 s76, s76, s53
    s_lshl_b32 s53, s48, 13
    v_mfma_f32_16x16x32_bf16 v[240:243], a[92:95], a[0:3], v[240:243]
    s_add_u32 s76, s76, s53
    v_cvt_pk_bf16_f32 v16, v16, v17
    s_waitcnt lgkmcnt(0)
    v_mfma_f32_16x16x32_bf16 v[140:143], a[116:119], a[60:63], v[140:143]
    ds_read_b128 a[0:3], v1 offset:16384
    v_cvt_pk_bf16_f32 v17, v18, v19
    v_mfma_f32_16x16x32_bf16 v[136:139], a[116:119], a[56:59], v[136:139]
    ds_read_b128 a[4:7], v1 offset:17408
    v_cvt_pk_bf16_f32 v18, v48, v49
    v_mfma_f32_16x16x32_bf16 v[132:135], a[116:119], a[52:55], v[132:135]
    ds_read_b128 a[8:11], v1 offset:18432
    v_cvt_pk_bf16_f32 v19, v50, v51
    v_mfma_f32_16x16x32_bf16 v[128:131], a[116:119], a[48:51], v[128:131]
    ds_read_b128 a[12:15], v1 offset:19456
    buffer_store_dwordx4 v[16:19], v13, s[68:71], s76 offen offset:0 sc1
    v_mfma_f32_16x16x32_bf16 v[124:127], a[116:119], a[44:47], v[124:127]
    ds_read_b128 a[16:19], v1 offset:20480
    v_cvt_pk_bf16_f32 v20, v20, v21
    v_mfma_f32_16x16x32_bf16 v[120:123], a[116:119], a[40:43], v[120:123]
    ds_read_b128 a[20:23], v1 offset:21504
    v_cvt_pk_bf16_f32 v21, v22, v23
    v_mfma_f32_16x16x32_bf16 v[116:119], a[116:119], a[36:39], v[116:119]
    ds_read_b128 a[24:27], v1 offset:22528
    v_cvt_pk_bf16_f32 v22, v52, v53
    v_mfma_f32_16x16x32_bf16 v[112:115], a[116:119], a[32:35], v[112:115]
    ds_read_b128 a[28:31], v1 offset:23552
    v_cvt_pk_bf16_f32 v23, v54, v55
    v_mfma_f32_16x16x32_bf16 a[156:159], a[132:135], a[60:63], a[156:159]
    ds_read_b64_tr_b16 a[76:77], v5 offset:8192
    buffer_store_dwordx4 v[20:23], v13, s[68:71], s76 offen offset:128 sc1
    v_mfma_f32_16x16x32_bf16 a[152:155], a[132:135], a[56:59], a[152:155]
    ds_read_b64_tr_b16 a[78:79], v5 offset:8704
    v_cvt_pk_bf16_f32 v24, v24, v25
    v_mfma_f32_16x16x32_bf16 a[148:151], a[132:135], a[52:55], a[148:151]
    ds_read_b64_tr_b16 a[92:93], v9 offset:8192
    v_cvt_pk_bf16_f32 v25, v26, v27
    v_mfma_f32_16x16x32_bf16 a[144:147], a[132:135], a[48:51], a[144:147]
    ds_read_b64_tr_b16 a[94:95], v9 offset:8704
    v_cvt_pk_bf16_f32 v26, v56, v57
    v_mfma_f32_16x16x32_bf16 v[252:255], a[132:135], a[44:47], v[252:255]
    v_cvt_pk_bf16_f32 v27, v58, v59
    buffer_store_dwordx4 v[24:27], v13, s[68:71], s76 offen offset:2048 sc1
    v_mfma_f32_16x16x32_bf16 v[248:251], a[132:135], a[40:43], v[248:251]
    v_cvt_pk_bf16_f32 v28, v28, v29
    v_cvt_pk_bf16_f32 v29, v30, v31
    v_mfma_f32_16x16x32_bf16 v[244:247], a[132:135], a[36:39], v[244:247]
    v_cvt_pk_bf16_f32 v30, v60, v61
    v_cvt_pk_bf16_f32 v31, v62, v63
    v_mfma_f32_16x16x32_bf16 v[240:243], a[132:135], a[32:35], v[240:243]
    buffer_store_dwordx4 v[28:31], v13, s[68:71], s76 offen offset:2176 sc1
    v_cvt_pk_bf16_f32 v32, v32, v33
    s_waitcnt lgkmcnt(0)
    v_mfma_f32_16x16x32_bf16 v[140:143], a[76:79], a[28:31], v[140:143]
    ds_read_b128 a[32:35], v1 offset:24576
    v_cvt_pk_bf16_f32 v33, v34, v35
    v_mfma_f32_16x16x32_bf16 v[136:139], a[76:79], a[24:27], v[136:139]
    ds_read_b128 a[36:39], v1 offset:25600
    v_cvt_pk_bf16_f32 v34, v64, v65
    v_mfma_f32_16x16x32_bf16 v[132:135], a[76:79], a[20:23], v[132:135]
    ds_read_b128 a[40:43], v1 offset:26624
    v_cvt_pk_bf16_f32 v35, v66, v67
    v_mfma_f32_16x16x32_bf16 v[128:131], a[76:79], a[16:19], v[128:131]
    ds_read_b128 a[44:47], v1 offset:27648
    s_add_u32 s76, s76, 4096
    v_mfma_f32_16x16x32_bf16 v[124:127], a[76:79], a[12:15], v[124:127]
    ds_read_b128 a[48:51], v1 offset:28672
    buffer_store_dwordx4 v[32:35], v13, s[68:71], s76 offen offset:0 sc1
    v_mfma_f32_16x16x32_bf16 v[120:123], a[76:79], a[8:11], v[120:123]
    ds_read_b128 a[52:55], v1 offset:29696
    v_cvt_pk_bf16_f32 v36, v36, v37
    v_mfma_f32_16x16x32_bf16 v[116:119], a[76:79], a[4:7], v[116:119]
    ds_read_b128 a[56:59], v1 offset:30720
    v_cvt_pk_bf16_f32 v37, v38, v39
    v_mfma_f32_16x16x32_bf16 v[112:115], a[76:79], a[0:3], v[112:115]
    ds_read_b128 a[60:63], v1 offset:31744
    v_cvt_pk_bf16_f32 v38, v68, v69
    v_mfma_f32_16x16x32_bf16 a[156:159], a[92:95], a[28:31], a[156:159]
    ds_read_b64_tr_b16 a[116:117], v5 offset:12288
    v_cvt_pk_bf16_f32 v39, v70, v71
    v_mfma_f32_16x16x32_bf16 a[152:155], a[92:95], a[24:27], a[152:155]
    ds_read_b64_tr_b16 a[118:119], v5 offset:12800
    buffer_store_dwordx4 v[36:39], v13, s[68:71], s76 offen offset:128 sc1
    v_mfma_f32_16x16x32_bf16 a[148:151], a[92:95], a[20:23], a[148:151]
    ds_read_b64_tr_b16 a[132:133], v9 offset:12288
    v_cvt_pk_bf16_f32 v40, v40, v41
    v_mfma_f32_16x16x32_bf16 a[144:147], a[92:95], a[16:19], a[144:147]
    ds_read_b64_tr_b16 a[134:135], v9 offset:12800
    v_cvt_pk_bf16_f32 v41, v42, v43
    v_mfma_f32_16x16x32_bf16 v[252:255], a[92:95], a[12:15], v[252:255]
    v_cvt_pk_bf16_f32 v42, v72, v73
    v_cvt_pk_bf16_f32 v43, v74, v75
    v_mfma_f32_16x16x32_bf16 v[248:251], a[92:95], a[8:11], v[248:251]
    buffer_store_dwordx4 v[40:43], v13, s[68:71], s76 offen offset:2048 sc1
    v_cvt_pk_bf16_f32 v44, v44, v45
    v_mfma_f32_16x16x32_bf16 v[244:247], a[92:95], a[4:7], v[244:247]
    v_cvt_pk_bf16_f32 v45, v46, v47
    v_cvt_pk_bf16_f32 v46, v76, v77
    v_mfma_f32_16x16x32_bf16 v[240:243], a[92:95], a[0:3], v[240:243]
    v_cvt_pk_bf16_f32 v47, v78, v79
    buffer_store_dwordx4 v[44:47], v13, s[68:71], s76 offen offset:2176 sc1
    s_waitcnt lgkmcnt(0)
    v_mfma_f32_16x16x32_bf16 v[140:143], a[116:119], a[60:63], v[140:143]
    ds_read_b128 a[0:3], v1 offset:0
    v_mfma_f32_16x16x32_bf16 v[136:139], a[116:119], a[56:59], v[136:139]
    ds_read_b128 a[4:7], v1 offset:1024
    v_mfma_f32_16x16x32_bf16 v[132:135], a[116:119], a[52:55], v[132:135]
    ds_read_b128 a[8:11], v1 offset:2048
    v_mfma_f32_16x16x32_bf16 v[128:131], a[116:119], a[48:51], v[128:131]
    ds_read_b128 a[12:15], v1 offset:3072
    v_mfma_f32_16x16x32_bf16 v[124:127], a[116:119], a[44:47], v[124:127]
    ds_read_b128 a[16:19], v1 offset:4096
    v_mfma_f32_16x16x32_bf16 v[120:123], a[116:119], a[40:43], v[120:123]
    ds_read_b128 a[20:23], v1 offset:5120
    v_mfma_f32_16x16x32_bf16 v[116:119], a[116:119], a[36:39], v[116:119]
    ds_read_b128 a[24:27], v1 offset:6144
    v_mfma_f32_16x16x32_bf16 v[112:115], a[116:119], a[32:35], v[112:115]
    ds_read_b128 a[28:31], v1 offset:7168
    v_mfma_f32_16x16x32_bf16 a[156:159], a[132:135], a[60:63], a[156:159]
    ds_read_b64_tr_b16 a[80:81], v6 offset:0
    v_mfma_f32_16x16x32_bf16 a[152:155], a[132:135], a[56:59], a[152:155]
    ds_read_b64_tr_b16 a[82:83], v6 offset:512
    v_mfma_f32_16x16x32_bf16 a[148:151], a[132:135], a[52:55], a[148:151]
    ds_read_b64_tr_b16 a[84:85], v7 offset:0
    v_mfma_f32_16x16x32_bf16 a[144:147], a[132:135], a[48:51], a[144:147]
    ds_read_b64_tr_b16 a[86:87], v7 offset:512
    v_mfma_f32_16x16x32_bf16 v[252:255], a[132:135], a[44:47], v[252:255]
    ds_read_b64_tr_b16 a[96:97], v10 offset:0
    v_mfma_f32_16x16x32_bf16 v[248:251], a[132:135], a[40:43], v[248:251]
    ds_read_b64_tr_b16 a[98:99], v10 offset:512
    v_mfma_f32_16x16x32_bf16 v[244:247], a[132:135], a[36:39], v[244:247]
    ds_read_b64_tr_b16 a[100:101], v11 offset:0
    v_mfma_f32_16x16x32_bf16 v[240:243], a[132:135], a[32:35], v[240:243]
    ds_read_b64_tr_b16 a[102:103], v11 offset:512
    s_waitcnt lgkmcnt(0)
    v_mfma_f32_16x16x32_bf16 v[144:147], a[80:83], a[0:3], v[144:147]
    ds_read_b128 a[32:35], v1 offset:8192
    v_mfma_f32_16x16x32_bf16 v[148:151], a[80:83], a[4:7], v[148:151]
    ds_read_b128 a[36:39], v1 offset:9216
    v_mfma_f32_16x16x32_bf16 v[152:155], a[80:83], a[8:11], v[152:155]
    ds_read_b128 a[40:43], v1 offset:10240
    v_mfma_f32_16x16x32_bf16 v[156:159], a[80:83], a[12:15], v[156:159]
    ds_read_b128 a[44:47], v1 offset:11264
    v_mfma_f32_16x16x32_bf16 v[160:163], a[80:83], a[16:19], v[160:163]
    ds_read_b128 a[48:51], v1 offset:12288
    v_mfma_f32_16x16x32_bf16 v[164:167], a[80:83], a[20:23], v[164:167]
    ds_read_b128 a[52:55], v1 offset:13312
    v_mfma_f32_16x16x32_bf16 v[168:171], a[80:83], a[24:27], v[168:171]
    ds_read_b128 a[56:59], v1 offset:14336
    v_mfma_f32_16x16x32_bf16 v[172:175], a[80:83], a[28:31], v[172:175]
    ds_read_b128 a[60:63], v1 offset:15360
    v_mfma_f32_16x16x32_bf16 v[204:207], a[84:87], a[28:31], v[204:207]
    ds_read_b64_tr_b16 a[120:121], v6 offset:4096
    v_mfma_f32_16x16x32_bf16 v[200:203], a[84:87], a[24:27], v[200:203]
    ds_read_b64_tr_b16 a[122:123], v6 offset:4608
    v_mfma_f32_16x16x32_bf16 v[196:199], a[84:87], a[20:23], v[196:199]
    ds_read_b64_tr_b16 a[124:125], v7 offset:4096
    v_mfma_f32_16x16x32_bf16 v[192:195], a[84:87], a[16:19], v[192:195]
    ds_read_b64_tr_b16 a[126:127], v7 offset:4608
    v_mfma_f32_16x16x32_bf16 v[188:191], a[84:87], a[12:15], v[188:191]
    ds_read_b64_tr_b16 a[136:137], v10 offset:4096
    v_mfma_f32_16x16x32_bf16 v[184:187], a[84:87], a[8:11], v[184:187]
    ds_read_b64_tr_b16 a[138:139], v10 offset:4608
    v_mfma_f32_16x16x32_bf16 v[180:183], a[84:87], a[4:7], v[180:183]
    ds_read_b64_tr_b16 a[140:141], v11 offset:4096
    v_mfma_f32_16x16x32_bf16 v[176:179], a[84:87], a[0:3], v[176:179]
    ds_read_b64_tr_b16 a[142:143], v11 offset:4608
    v_mfma_f32_16x16x32_bf16 a[160:163], a[96:99], a[0:3], a[160:163]
    v_max_f32 v80, 0, v80
    v_max_f32 v81, 0, v81
    v_mfma_f32_16x16x32_bf16 a[164:167], a[96:99], a[4:7], a[164:167]
    v_max_f32 v82, 0, v82
    v_max_f32 v83, 0, v83
    v_mfma_f32_16x16x32_bf16 a[168:171], a[96:99], a[8:11], a[168:171]
    v_mul_f32 v80, v80, v208
    v_mul_f32 v81, v81, v209
    v_mfma_f32_16x16x32_bf16 a[172:175], a[96:99], a[12:15], a[172:175]
    v_mul_f32 v82, v82, v210
    v_mul_f32 v83, v83, v211
    v_mfma_f32_16x16x32_bf16 a[176:179], a[96:99], a[16:19], a[176:179]
    v_max_f32 v112, 0, v112
    v_max_f32 v113, 0, v113
    v_mfma_f32_16x16x32_bf16 a[180:183], a[96:99], a[20:23], a[180:183]
    v_max_f32 v114, 0, v114
    v_max_f32 v115, 0, v115
    v_mfma_f32_16x16x32_bf16 a[184:187], a[96:99], a[24:27], a[184:187]
    v_mul_f32 v112, v112, v240
    v_mul_f32 v113, v113, v241
    v_mfma_f32_16x16x32_bf16 a[188:191], a[96:99], a[28:31], a[188:191]
    v_mul_f32 v114, v114, v242
    v_mul_f32 v115, v115, v243
    v_mfma_f32_16x16x32_bf16 a[220:223], a[100:103], a[28:31], a[220:223]
    v_cvt_pk_bf16_f32 v80, v80, v81
    v_cvt_pk_bf16_f32 v81, v82, v83
    v_mfma_f32_16x16x32_bf16 a[216:219], a[100:103], a[24:27], a[216:219]
    v_cvt_pk_bf16_f32 v82, v112, v113
    v_cvt_pk_bf16_f32 v83, v114, v115
    v_mfma_f32_16x16x32_bf16 a[212:215], a[100:103], a[20:23], a[212:215]
    v_max_f32 v84, 0, v84
    v_max_f32 v85, 0, v85
    v_mfma_f32_16x16x32_bf16 a[208:211], a[100:103], a[16:19], a[208:211]
    v_max_f32 v86, 0, v86
    v_max_f32 v87, 0, v87
    v_mfma_f32_16x16x32_bf16 a[204:207], a[100:103], a[12:15], a[204:207]
    v_mul_f32 v84, v84, v212
    v_mul_f32 v85, v85, v213
    v_mfma_f32_16x16x32_bf16 a[200:203], a[100:103], a[8:11], a[200:203]
    v_mul_f32 v86, v86, v214
    v_mul_f32 v87, v87, v215
    v_mfma_f32_16x16x32_bf16 a[196:199], a[100:103], a[4:7], a[196:199]
    v_max_f32 v116, 0, v116
    v_max_f32 v117, 0, v117
    v_mfma_f32_16x16x32_bf16 a[192:195], a[100:103], a[0:3], a[192:195]
    v_max_f32 v118, 0, v118
    v_max_f32 v119, 0, v119
    s_waitcnt lgkmcnt(0)
    v_mfma_f32_16x16x32_bf16 v[144:147], a[120:123], a[32:35], v[144:147]
    ds_read_b128 a[0:3], v1 offset:16384
    v_mul_f32 v116, v116, v244
    v_mfma_f32_16x16x32_bf16 v[148:151], a[120:123], a[36:39], v[148:151]
    ds_read_b128 a[4:7], v1 offset:17408
    v_mul_f32 v117, v117, v245
    v_mfma_f32_16x16x32_bf16 v[152:155], a[120:123], a[40:43], v[152:155]
    ds_read_b128 a[8:11], v1 offset:18432
    v_mul_f32 v118, v118, v246
    v_mfma_f32_16x16x32_bf16 v[156:159], a[120:123], a[44:47], v[156:159]
    ds_read_b128 a[12:15], v1 offset:19456
    v_mul_f32 v119, v119, v247
    v_mfma_f32_16x16x32_bf16 v[160:163], a[120:123], a[48:51], v[160:163]
    ds_read_b128 a[16:19], v1 offset:20480
    v_cvt_pk_bf16_f32 v84, v84, v85
    v_mfma_f32_16x16x32_bf16 v[164:167], a[120:123], a[52:55], v[164:167]
    ds_read_b128 a[20:23], v1 offset:21504
    v_cvt_pk_bf16_f32 v85, v86, v87
    v_mfma_f32_16x16x32_bf16 v[168:171], a[120:123], a[56:59], v[168:171]
    ds_read_b128 a[24:27], v1 offset:22528
    v_cvt_pk_bf16_f32 v86, v116, v117
    v_mfma_f32_16x16x32_bf16 v[172:175], a[120:123], a[60:63], v[172:175]
    ds_read_b128 a[28:31], v1 offset:23552
    v_cvt_pk_bf16_f32 v87, v118, v119
    v_mfma_f32_16x16x32_bf16 v[204:207], a[124:127], a[60:63], v[204:207]
    ds_read_b64_tr_b16 a[80:81], v6 offset:8192
    v_max_f32 v88, 0, v88
    v_mfma_f32_16x16x32_bf16 v[200:203], a[124:127], a[56:59], v[200:203]
    ds_read_b64_tr_b16 a[82:83], v6 offset:8704
    v_max_f32 v89, 0, v89
    v_mfma_f32_16x16x32_bf16 v[196:199], a[124:127], a[52:55], v[196:199]
    ds_read_b64_tr_b16 a[84:85], v7 offset:8192
    v_max_f32 v90, 0, v90
    v_mfma_f32_16x16x32_bf16 v[192:195], a[124:127], a[48:51], v[192:195]
    ds_read_b64_tr_b16 a[86:87], v7 offset:8704
    v_max_f32 v91, 0, v91
    v_mfma_f32_16x16x32_bf16 v[188:191], a[124:127], a[44:47], v[188:191]
    ds_read_b64_tr_b16 a[96:97], v10 offset:8192
    v_mul_f32 v88, v88, v216
    v_mfma_f32_16x16x32_bf16 v[184:187], a[124:127], a[40:43], v[184:187]
    ds_read_b64_tr_b16 a[98:99], v10 offset:8704
    v_mul_f32 v89, v89, v217
    v_mfma_f32_16x16x32_bf16 v[180:183], a[124:127], a[36:39], v[180:183]
    ds_read_b64_tr_b16 a[100:101], v11 offset:8192
    v_mul_f32 v90, v90, v218
    v_mfma_f32_16x16x32_bf16 v[176:179], a[124:127], a[32:35], v[176:179]
    ds_read_b64_tr_b16 a[102:103], v11 offset:8704
    v_mul_f32 v91, v91, v219
    v_mfma_f32_16x16x32_bf16 a[160:163], a[136:139], a[32:35], a[160:163]
    v_max_f32 v120, 0, v120
    v_max_f32 v121, 0, v121
    v_mfma_f32_16x16x32_bf16 a[164:167], a[136:139], a[36:39], a[164:167]
    v_max_f32 v122, 0, v122
    v_max_f32 v123, 0, v123
    v_mfma_f32_16x16x32_bf16 a[168:171], a[136:139], a[40:43], a[168:171]
    v_mul_f32 v120, v120, v248
    v_mul_f32 v121, v121, v249
    v_mfma_f32_16x16x32_bf16 a[172:175], a[136:139], a[44:47], a[172:175]
    v_mul_f32 v122, v122, v250
    v_mul_f32 v123, v123, v251
    v_mfma_f32_16x16x32_bf16 a[176:179], a[136:139], a[48:51], a[176:179]
    v_cvt_pk_bf16_f32 v88, v88, v89
    v_cvt_pk_bf16_f32 v89, v90, v91
    v_mfma_f32_16x16x32_bf16 a[180:183], a[136:139], a[52:55], a[180:183]
    v_cvt_pk_bf16_f32 v90, v120, v121
    v_cvt_pk_bf16_f32 v91, v122, v123
    v_mfma_f32_16x16x32_bf16 a[184:187], a[136:139], a[56:59], a[184:187]
    v_max_f32 v92, 0, v92
    v_max_f32 v93, 0, v93
    v_mfma_f32_16x16x32_bf16 a[188:191], a[136:139], a[60:63], a[188:191]
    v_max_f32 v94, 0, v94
    v_max_f32 v95, 0, v95
    v_mfma_f32_16x16x32_bf16 a[220:223], a[140:143], a[60:63], a[220:223]
    v_mul_f32 v92, v92, v220
    v_mul_f32 v93, v93, v221
    v_mfma_f32_16x16x32_bf16 a[216:219], a[140:143], a[56:59], a[216:219]
    v_mul_f32 v94, v94, v222
    v_mul_f32 v95, v95, v223
    v_mfma_f32_16x16x32_bf16 a[212:215], a[140:143], a[52:55], a[212:215]
    v_max_f32 v124, 0, v124
    v_max_f32 v125, 0, v125
    v_mfma_f32_16x16x32_bf16 a[208:211], a[140:143], a[48:51], a[208:211]
    v_max_f32 v126, 0, v126
    v_max_f32 v127, 0, v127
    v_mfma_f32_16x16x32_bf16 a[204:207], a[140:143], a[44:47], a[204:207]
    v_mul_f32 v124, v124, v252
    v_mul_f32 v125, v125, v253
    v_mfma_f32_16x16x32_bf16 a[200:203], a[140:143], a[40:43], a[200:203]
    v_mul_f32 v126, v126, v254
    v_mul_f32 v127, v127, v255
    v_mfma_f32_16x16x32_bf16 a[196:199], a[140:143], a[36:39], a[196:199]
    v_cvt_pk_bf16_f32 v92, v92, v93
    v_cvt_pk_bf16_f32 v93, v94, v95
    v_mfma_f32_16x16x32_bf16 a[192:195], a[140:143], a[32:35], a[192:195]
    v_cvt_pk_bf16_f32 v94, v124, v125
    v_cvt_pk_bf16_f32 v95, v126, v127
    s_waitcnt lgkmcnt(0)
    v_mfma_f32_16x16x32_bf16 v[144:147], a[80:83], a[0:3], v[144:147]
    ds_read_b128 a[32:35], v1 offset:24576
    v_max_f32 v96, 0, v96
    v_mfma_f32_16x16x32_bf16 v[148:151], a[80:83], a[4:7], v[148:151]
    ds_read_b128 a[36:39], v1 offset:25600
    v_max_f32 v97, 0, v97
    v_mfma_f32_16x16x32_bf16 v[152:155], a[80:83], a[8:11], v[152:155]
    ds_read_b128 a[40:43], v1 offset:26624
    v_max_f32 v98, 0, v98
    v_mfma_f32_16x16x32_bf16 v[156:159], a[80:83], a[12:15], v[156:159]
    ds_read_b128 a[44:47], v1 offset:27648
    v_max_f32 v99, 0, v99
    v_mfma_f32_16x16x32_bf16 v[160:163], a[80:83], a[16:19], v[160:163]
    ds_read_b128 a[48:51], v1 offset:28672
    v_mul_f32 v96, v96, v224
    v_mfma_f32_16x16x32_bf16 v[164:167], a[80:83], a[20:23], v[164:167]
    ds_read_b128 a[52:55], v1 offset:29696
    v_mul_f32 v97, v97, v225
    v_mfma_f32_16x16x32_bf16 v[168:171], a[80:83], a[24:27], v[168:171]
    ds_read_b128 a[56:59], v1 offset:30720
    v_mul_f32 v98, v98, v226
    v_mfma_f32_16x16x32_bf16 v[172:175], a[80:83], a[28:31], v[172:175]
    ds_read_b128 a[60:63], v1 offset:31744
    v_mul_f32 v99, v99, v227
    v_mfma_f32_16x16x32_bf16 v[204:207], a[84:87], a[28:31], v[204:207]
    ds_read_b64_tr_b16 a[120:121], v6 offset:12288
    v_accvgpr_read_b32 v208, a144
    v_mfma_f32_16x16x32_bf16 v[200:203], a[84:87], a[24:27], v[200:203]
    ds_read_b64_tr_b16 a[122:123], v6 offset:12800
    v_accvgpr_read_b32 v209, a145
    v_mfma_f32_16x16x32_bf16 v[196:199], a[84:87], a[20:23], v[196:199]
    ds_read_b64_tr_b16 a[124:125], v7 offset:12288
    v_accvgpr_read_b32 v210, a146
    v_mfma_f32_16x16x32_bf16 v[192:195], a[84:87], a[16:19], v[192:195]
    ds_read_b64_tr_b16 a[126:127], v7 offset:12800
    v_accvgpr_read_b32 v211, a147
    v_mfma_f32_16x16x32_bf16 v[188:191], a[84:87], a[12:15], v[188:191]
    ds_read_b64_tr_b16 a[136:137], v10 offset:12288
    v_max_f32 v128, 0, v128
    v_mfma_f32_16x16x32_bf16 v[184:187], a[84:87], a[8:11], v[184:187]
    ds_read_b64_tr_b16 a[138:139], v10 offset:12800
    v_max_f32 v129, 0, v129
    v_mfma_f32_16x16x32_bf16 v[180:183], a[84:87], a[4:7], v[180:183]
    ds_read_b64_tr_b16 a[140:141], v11 offset:12288
    v_max_f32 v130, 0, v130
    v_mfma_f32_16x16x32_bf16 v[176:179], a[84:87], a[0:3], v[176:179]
    ds_read_b64_tr_b16 a[142:143], v11 offset:12800
    v_max_f32 v131, 0, v131
    v_mfma_f32_16x16x32_bf16 a[160:163], a[96:99], a[0:3], a[160:163]
    v_mul_f32 v128, v128, v208
    v_mul_f32 v129, v129, v209
    v_mfma_f32_16x16x32_bf16 a[164:167], a[96:99], a[4:7], a[164:167]
    v_mul_f32 v130, v130, v210
    v_mul_f32 v131, v131, v211
    v_mfma_f32_16x16x32_bf16 a[168:171], a[96:99], a[8:11], a[168:171]
    v_cvt_pk_bf16_f32 v96, v96, v97
    v_cvt_pk_bf16_f32 v97, v98, v99
    v_mfma_f32_16x16x32_bf16 a[172:175], a[96:99], a[12:15], a[172:175]
    v_cvt_pk_bf16_f32 v98, v128, v129
    v_cvt_pk_bf16_f32 v99, v130, v131
    v_mfma_f32_16x16x32_bf16 a[176:179], a[96:99], a[16:19], a[176:179]
    v_max_f32 v100, 0, v100
    v_max_f32 v101, 0, v101
    v_mfma_f32_16x16x32_bf16 a[180:183], a[96:99], a[20:23], a[180:183]
    v_max_f32 v102, 0, v102
    v_max_f32 v103, 0, v103
    v_mfma_f32_16x16x32_bf16 a[184:187], a[96:99], a[24:27], a[184:187]
    v_mul_f32 v100, v100, v228
    v_mul_f32 v101, v101, v229
    v_mfma_f32_16x16x32_bf16 a[188:191], a[96:99], a[28:31], a[188:191]
    v_mul_f32 v102, v102, v230
    v_mul_f32 v103, v103, v231
    v_mfma_f32_16x16x32_bf16 a[220:223], a[100:103], a[28:31], a[220:223]
    v_accvgpr_read_b32 v212, a148
    v_accvgpr_read_b32 v213, a149
    v_mfma_f32_16x16x32_bf16 a[216:219], a[100:103], a[24:27], a[216:219]
    v_accvgpr_read_b32 v214, a150
    v_accvgpr_read_b32 v215, a151
    v_mfma_f32_16x16x32_bf16 a[212:215], a[100:103], a[20:23], a[212:215]
    v_max_f32 v132, 0, v132
    v_max_f32 v133, 0, v133
    v_mfma_f32_16x16x32_bf16 a[208:211], a[100:103], a[16:19], a[208:211]
    v_max_f32 v134, 0, v134
    v_max_f32 v135, 0, v135
    v_mfma_f32_16x16x32_bf16 a[204:207], a[100:103], a[12:15], a[204:207]
    v_mul_f32 v132, v132, v212
    v_mul_f32 v133, v133, v213
    v_mfma_f32_16x16x32_bf16 a[200:203], a[100:103], a[8:11], a[200:203]
    v_mul_f32 v134, v134, v214
    v_mul_f32 v135, v135, v215
    v_mfma_f32_16x16x32_bf16 a[196:199], a[100:103], a[4:7], a[196:199]
    v_cvt_pk_bf16_f32 v100, v100, v101
    v_cvt_pk_bf16_f32 v101, v102, v103
    v_mfma_f32_16x16x32_bf16 a[192:195], a[100:103], a[0:3], a[192:195]
    v_cvt_pk_bf16_f32 v102, v132, v133
    v_cvt_pk_bf16_f32 v103, v134, v135
    s_waitcnt lgkmcnt(0)
    v_mfma_f32_16x16x32_bf16 v[144:147], a[120:123], a[32:35], v[144:147]
    v_max_f32 v104, 0, v104
    v_max_f32 v105, 0, v105
    v_mfma_f32_16x16x32_bf16 v[148:151], a[120:123], a[36:39], v[148:151]
    v_max_f32 v106, 0, v106
    v_max_f32 v107, 0, v107
    v_mfma_f32_16x16x32_bf16 v[152:155], a[120:123], a[40:43], v[152:155]
    v_mul_f32 v104, v104, v232
    v_mul_f32 v105, v105, v233
    v_mfma_f32_16x16x32_bf16 v[156:159], a[120:123], a[44:47], v[156:159]
    v_mul_f32 v106, v106, v234
    v_mul_f32 v107, v107, v235
    v_mfma_f32_16x16x32_bf16 v[160:163], a[120:123], a[48:51], v[160:163]
    v_accvgpr_read_b32 v208, a152
    v_accvgpr_read_b32 v209, a153
    v_mfma_f32_16x16x32_bf16 v[164:167], a[120:123], a[52:55], v[164:167]
    v_accvgpr_read_b32 v210, a154
    v_accvgpr_read_b32 v211, a155
    v_mfma_f32_16x16x32_bf16 v[168:171], a[120:123], a[56:59], v[168:171]
    v_max_f32 v136, 0, v136
    v_max_f32 v137, 0, v137
    v_mfma_f32_16x16x32_bf16 v[172:175], a[120:123], a[60:63], v[172:175]
    v_max_f32 v138, 0, v138
    v_max_f32 v139, 0, v139
    v_mfma_f32_16x16x32_bf16 v[204:207], a[124:127], a[60:63], v[204:207]
    v_mul_f32 v136, v136, v208
    v_mul_f32 v137, v137, v209
    v_mfma_f32_16x16x32_bf16 v[200:203], a[124:127], a[56:59], v[200:203]
    v_mul_f32 v138, v138, v210
    v_mul_f32 v139, v139, v211
    v_mfma_f32_16x16x32_bf16 v[196:199], a[124:127], a[52:55], v[196:199]
    v_cvt_pk_bf16_f32 v104, v104, v105
    v_cvt_pk_bf16_f32 v105, v106, v107
    v_mfma_f32_16x16x32_bf16 v[192:195], a[124:127], a[48:51], v[192:195]
    v_cvt_pk_bf16_f32 v106, v136, v137
    v_cvt_pk_bf16_f32 v107, v138, v139
    v_mfma_f32_16x16x32_bf16 v[188:191], a[124:127], a[44:47], v[188:191]
    v_max_f32 v108, 0, v108
    v_max_f32 v109, 0, v109
    v_mfma_f32_16x16x32_bf16 v[184:187], a[124:127], a[40:43], v[184:187]
    v_max_f32 v110, 0, v110
    v_max_f32 v111, 0, v111
    v_mfma_f32_16x16x32_bf16 v[180:183], a[124:127], a[36:39], v[180:183]
    v_mul_f32 v108, v108, v236
    v_mul_f32 v109, v109, v237
    v_mfma_f32_16x16x32_bf16 v[176:179], a[124:127], a[32:35], v[176:179]
    v_mul_f32 v110, v110, v238
    v_mul_f32 v111, v111, v239
    v_mfma_f32_16x16x32_bf16 a[160:163], a[136:139], a[32:35], a[160:163]
    v_accvgpr_read_b32 v212, a156
    v_accvgpr_read_b32 v213, a157
    v_mfma_f32_16x16x32_bf16 a[164:167], a[136:139], a[36:39], a[164:167]
    v_accvgpr_read_b32 v214, a158
    v_accvgpr_read_b32 v215, a159
    v_mfma_f32_16x16x32_bf16 a[168:171], a[136:139], a[40:43], a[168:171]
    v_max_f32 v140, 0, v140
    v_max_f32 v141, 0, v141
    v_mfma_f32_16x16x32_bf16 a[172:175], a[136:139], a[44:47], a[172:175]
    v_max_f32 v142, 0, v142
    v_max_f32 v143, 0, v143
    v_mfma_f32_16x16x32_bf16 a[176:179], a[136:139], a[48:51], a[176:179]
    v_mul_f32 v140, v140, v212
    v_mul_f32 v141, v141, v213
    v_mfma_f32_16x16x32_bf16 a[180:183], a[136:139], a[52:55], a[180:183]
    v_mul_f32 v142, v142, v214
    v_mul_f32 v143, v143, v215
    v_mfma_f32_16x16x32_bf16 a[184:187], a[136:139], a[56:59], a[184:187]
    v_cvt_pk_bf16_f32 v108, v108, v109
    v_cvt_pk_bf16_f32 v109, v110, v111
    v_mfma_f32_16x16x32_bf16 a[188:191], a[136:139], a[60:63], a[188:191]
    v_cvt_pk_bf16_f32 v110, v140, v141
    v_cvt_pk_bf16_f32 v111, v142, v143
    v_mfma_f32_16x16x32_bf16 a[220:223], a[140:143], a[60:63], a[220:223]
    v_mfma_f32_16x16x32_bf16 a[216:219], a[140:143], a[56:59], a[216:219]
    v_mfma_f32_16x16x32_bf16 a[212:215], a[140:143], a[52:55], a[212:215]
    v_mfma_f32_16x16x32_bf16 a[208:211], a[140:143], a[48:51], a[208:211]
    v_mfma_f32_16x16x32_bf16 a[204:207], a[140:143], a[44:47], a[204:207]
    v_mfma_f32_16x16x32_bf16 a[200:203], a[140:143], a[40:43], a[200:203]
    v_mfma_f32_16x16x32_bf16 a[196:199], a[140:143], a[36:39], a[196:199]
    v_mfma_f32_16x16x32_bf16 a[192:195], a[140:143], a[32:35], a[192:195]
    s_waitcnt vmcnt(0)
    s_barrier
    s_cmp_lg_u32 s36, 3
    s_cbranch_scc1 L_g1_noq_k
    s_add_u32 s96, s4, 20971520
    s_addc_u32 s97, s5, 0
    s_mov_b32 s98, 40960
    s_mov_b32 s99, 0x00020000
    s_lshl_b32 s52, s45, 3
    s_add_u32 s52, s52, s46
    s_lshl_b32 s52, s52, 9
    s_add_u32 s52, s52, 16384
    v_mov_b32 v1, 1
    v_lshlrev_b32 v2, 7, v0
    s_mov_b64 exec, 15
    buffer_atomic_add v1, v2, s[96:99], s52 offen sc1
    s_mov_b64 exec, -1
L_g1_noq_k:
    s_nop 3
    v_accvgpr_read_b32 v208, a160
    v_accvgpr_read_b32 v209, a161
    v_accvgpr_read_b32 v210, a162
    v_accvgpr_read_b32 v211, a163
    v_max_f32 v144, 0, v144
    v_max_f32 v145, 0, v145
    v_max_f32 v146, 0, v146
    v_max_f32 v147, 0, v147
    v_pk_mul_f32 v[144:145], v[144:145], v[208:209]
    v_pk_mul_f32 v[146:147], v[146:147], v[210:211]
    v_accvgpr_read_b32 v212, a192
    v_accvgpr_read_b32 v213, a193
    v_accvgpr_read_b32 v214, a194
    v_accvgpr_read_b32 v215, a195
    v_max_f32 v176, 0, v176
    v_max_f32 v177, 0, v177
    v_max_f32 v178, 0, v178
    v_max_f32 v179, 0, v179
    v_pk_mul_f32 v[176:177], v[176:177], v[212:213]
    v_pk_mul_f32 v[178:179], v[178:179], v[214:215]
    v_cvt_pk_bf16_f32 v144, v144, v145
    v_cvt_pk_bf16_f32 v145, v146, v147
    v_cvt_pk_bf16_f32 v146, v176, v177
    v_cvt_pk_bf16_f32 v147, v178, v179
    v_accvgpr_read_b32 v216, a164
    v_accvgpr_read_b32 v217, a165
    v_accvgpr_read_b32 v218, a166
    v_accvgpr_read_b32 v219, a167
    v_max_f32 v148, 0, v148
    v_max_f32 v149, 0, v149
    v_max_f32 v150, 0, v150
    v_max_f32 v151, 0, v151
    v_pk_mul_f32 v[148:149], v[148:149], v[216:217]
    v_pk_mul_f32 v[150:151], v[150:151], v[218:219]
    v_accvgpr_read_b32 v220, a196
    v_accvgpr_read_b32 v221, a197
    v_accvgpr_read_b32 v222, a198
    v_accvgpr_read_b32 v223, a199
    v_max_f32 v180, 0, v180
    v_max_f32 v181, 0, v181
    v_max_f32 v182, 0, v182
    v_max_f32 v183, 0, v183
    v_pk_mul_f32 v[180:181], v[180:181], v[220:221]
    v_pk_mul_f32 v[182:183], v[182:183], v[222:223]
    v_cvt_pk_bf16_f32 v148, v148, v149
    v_cvt_pk_bf16_f32 v149, v150, v151
    v_cvt_pk_bf16_f32 v150, v180, v181
    v_cvt_pk_bf16_f32 v151, v182, v183
    v_accvgpr_read_b32 v224, a168
    v_accvgpr_read_b32 v225, a169
    v_accvgpr_read_b32 v226, a170
    v_accvgpr_read_b32 v227, a171
    v_max_f32 v152, 0, v152
    v_max_f32 v153, 0, v153
    v_max_f32 v154, 0, v154
    v_max_f32 v155, 0, v155
    v_pk_mul_f32 v[152:153], v[152:153], v[224:225]
    v_pk_mul_f32 v[154:155], v[154:155], v[226:227]
    v_accvgpr_read_b32 v228, a200
    v_accvgpr_read_b32 v229, a201
    v_accvgpr_read_b32 v230, a202
    v_accvgpr_read_b32 v231, a203
    v_max_f32 v184, 0, v184
    v_max_f32 v185, 0, v185
    v_max_f32 v186, 0, v186
    v_max_f32 v187, 0, v187
    v_pk_mul_f32 v[184:185], v[184:185], v[228:229]
    v_pk_mul_f32 v[186:187], v[186:187], v[230:231]
    v_cvt_pk_bf16_f32 v152, v152, v153
    v_cvt_pk_bf16_f32 v153, v154, v155
    v_cvt_pk_bf16_f32 v154, v184, v185
    v_cvt_pk_bf16_f32 v155, v186, v187
    v_accvgpr_read_b32 v232, a172
    v_accvgpr_read_b32 v233, a173
    v_accvgpr_read_b32 v234, a174
    v_accvgpr_read_b32 v235, a175
    v_max_f32 v156, 0, v156
    v_max_f32 v157, 0, v157
    v_max_f32 v158, 0, v158
    v_max_f32 v159, 0, v159
    v_pk_mul_f32 v[156:157], v[156:157], v[232:233]
    v_pk_mul_f32 v[158:159], v[158:159], v[234:235]
    v_accvgpr_read_b32 v236, a204
    v_accvgpr_read_b32 v237, a205
    v_accvgpr_read_b32 v238, a206
    v_accvgpr_read_b32 v239, a207
    v_max_f32 v188, 0, v188
    v_max_f32 v189, 0, v189
    v_max_f32 v190, 0, v190
    v_max_f32 v191, 0, v191
    v_pk_mul_f32 v[188:189], v[188:189], v[236:237]
    v_pk_mul_f32 v[190:191], v[190:191], v[238:239]
    v_cvt_pk_bf16_f32 v156, v156, v157
    v_cvt_pk_bf16_f32 v157, v158, v159
    v_cvt_pk_bf16_f32 v158, v188, v189
    v_cvt_pk_bf16_f32 v159, v190, v191
    v_accvgpr_read_b32 v208, a176
    v_accvgpr_read_b32 v209, a177
    v_accvgpr_read_b32 v210, a178
    v_accvgpr_read_b32 v211, a179
    v_max_f32 v160, 0, v160
    v_max_f32 v161, 0, v161
    v_max_f32 v162, 0, v162
    v_max_f32 v163, 0, v163
    v_pk_mul_f32 v[160:161], v[160:161], v[208:209]
    v_pk_mul_f32 v[162:163], v[162:163], v[210:211]
    v_accvgpr_read_b32 v212, a208
    v_accvgpr_read_b32 v213, a209
    v_accvgpr_read_b32 v214, a210
    v_accvgpr_read_b32 v215, a211
    v_max_f32 v192, 0, v192
    v_max_f32 v193, 0, v193
    v_max_f32 v194, 0, v194
    v_max_f32 v195, 0, v195
    v_pk_mul_f32 v[192:193], v[192:193], v[212:213]
    v_pk_mul_f32 v[194:195], v[194:195], v[214:215]
    v_cvt_pk_bf16_f32 v160, v160, v161
    v_cvt_pk_bf16_f32 v161, v162, v163
    v_cvt_pk_bf16_f32 v162, v192, v193
    v_cvt_pk_bf16_f32 v163, v194, v195
    v_accvgpr_read_b32 v216, a180
    v_accvgpr_read_b32 v217, a181
    v_accvgpr_read_b32 v218, a182
    v_accvgpr_read_b32 v219, a183
    v_max_f32 v164, 0, v164
    v_max_f32 v165, 0, v165
    v_max_f32 v166, 0, v166
    v_max_f32 v167, 0, v167
    v_pk_mul_f32 v[164:165], v[164:165], v[216:217]
    v_pk_mul_f32 v[166:167], v[166:167], v[218:219]
    v_accvgpr_read_b32 v220, a212
    v_accvgpr_read_b32 v221, a213
    v_accvgpr_read_b32 v222, a214
    v_accvgpr_read_b32 v223, a215
    v_max_f32 v196, 0, v196
    v_max_f32 v197, 0, v197
    v_max_f32 v198, 0, v198
    v_max_f32 v199, 0, v199
    v_pk_mul_f32 v[196:197], v[196:197], v[220:221]
    v_pk_mul_f32 v[198:199], v[198:199], v[222:223]
    v_cvt_pk_bf16_f32 v164, v164, v165
    v_cvt_pk_bf16_f32 v165, v166, v167
    v_cvt_pk_bf16_f32 v166, v196, v197
    v_cvt_pk_bf16_f32 v167, v198, v199
    v_accvgpr_read_b32 v224, a184
    v_accvgpr_read_b32 v225, a185
    v_accvgpr_read_b32 v226, a186
    v_accvgpr_read_b32 v227, a187
    v_max_f32 v168, 0, v168
    v_max_f32 v169, 0, v169
    v_max_f32 v170, 0, v170
    v_max_f32 v171, 0, v171
    v_pk_mul_f32 v[168:169], v[168:169], v[224:225]
    v_pk_mul_f32 v[170:171], v[170:171], v[226:227]
    v_accvgpr_read_b32 v228, a216
    v_accvgpr_read_b32 v229, a217
    v_accvgpr_read_b32 v230, a218
    v_accvgpr_read_b32 v231, a219
    v_max_f32 v200, 0, v200
    v_max_f32 v201, 0, v201
    v_max_f32 v202, 0, v202
    v_max_f32 v203, 0, v203
    v_pk_mul_f32 v[200:201], v[200:201], v[228:229]
    v_pk_mul_f32 v[202:203], v[202:203], v[230:231]
    v_cvt_pk_bf16_f32 v168, v168, v169
    v_cvt_pk_bf16_f32 v169, v170, v171
    v_cvt_pk_bf16_f32 v170, v200, v201
    v_cvt_pk_bf16_f32 v171, v202, v203
    v_accvgpr_read_b32 v232, a188
    v_accvgpr_read_b32 v233, a189
    v_accvgpr_read_b32 v234, a190
    v_accvgpr_read_b32 v235, a191
    v_max_f32 v172, 0, v172
    v_max_f32 v173, 0, v173
    v_max_f32 v174, 0, v174
    v_max_f32 v175, 0, v175
    v_pk_mul_f32 v[172:173], v[172:173], v[232:233]
    v_pk_mul_f32 v[174:175], v[174:175], v[234:235]
    v_accvgpr_read_b32 v236, a220
    v_accvgpr_read_b32 v237, a221
    v_accvgpr_read_b32 v238, a222
    v_accvgpr_read_b32 v239, a223
    v_max_f32 v204, 0, v204
    v_max_f32 v205, 0, v205
    v_max_f32 v206, 0, v206
    v_max_f32 v207, 0, v207
    v_pk_mul_f32 v[204:205], v[204:205], v[236:237]
    v_pk_mul_f32 v[206:207], v[206:207], v[238:239]
    v_cvt_pk_bf16_f32 v172, v172, v173
    v_cvt_pk_bf16_f32 v173, v174, v175
    v_cvt_pk_bf16_f32 v174, v204, v205
    v_cvt_pk_bf16_f32 v175, v206, v207
    v_accvgpr_write_b32 a0, v80
    v_accvgpr_write_b32 a1, v81
    v_accvgpr_write_b32 a2, v82
    v_accvgpr_write_b32 a3, v83
    v_accvgpr_write_b32 a4, v84
    v_accvgpr_write_b32 a5, v85
    v_accvgpr_write_b32 a6, v86
    v_accvgpr_write_b32 a7, v87
    v_accvgpr_write_b32 a8, v88
    v_accvgpr_write_b32 a9, v89
    v_accvgpr_write_b32 a10, v90
    v_accvgpr_write_b32 a11, v91
    v_accvgpr_write_b32 a12, v92
    v_accvgpr_write_b32 a13, v93
    v_accvgpr_write_b32 a14, v94
    v_accvgpr_write_b32 a15, v95
    v_accvgpr_write_b32 a16, v96
    v_accvgpr_write_b32 a17, v97
    v_accvgpr_write_b32 a18, v98
    v_accvgpr_write_b32 a19, v99
    v_accvgpr_write_b32 a20, v100
    v_accvgpr_write_b32 a21, v101
    v_accvgpr_write_b32 a22, v102
    v_accvgpr_write_b32 a23, v103
    v_accvgpr_write_b32 a24, v104
    v_accvgpr_write_b32 a25, v105
    v_accvgpr_write_b32 a26, v106
    v_accvgpr_write_b32 a27, v107
    v_accvgpr_write_b32 a28, v108
    v_accvgpr_write_b32 a29, v109
    v_accvgpr_write_b32 a30, v110
    v_accvgpr_write_b32 a31, v111
    s_add_u32 s52, s51, s49
    s_add_u32 s52, s52, 8
    s_lshl_b32 s76, s47, 1
    s_add_u32 s76, s76, s48
    s_mul_i32 s76, s76, 112
    s_add_u32 s76, s76, s52
    s_lshl_b32 s76, s76, 13
    s_mov_b32 s70, s76
    v_accvgpr_write_b32 a192, v144
    v_accvgpr_write_b32 a193, v145
    v_accvgpr_write_b32 a194, v146
    v_accvgpr_write_b32 a195, v147
    v_accvgpr_write_b32 a196, v148
    v_accvgpr_write_b32 a197, v149
    v_accvgpr_write_b32 a198, v150
    v_accvgpr_write_b32 a199, v151
    v_accvgpr_write_b32 a200, v152
    v_accvgpr_write_b32 a201, v153
    v_accvgpr_write_b32 a202, v154
    v_accvgpr_write_b32 a203, v155
    v_accvgpr_write_b32 a204, v156
    v_accvgpr_write_b32 a205, v157
    v_accvgpr_write_b32 a206, v158
    v_accvgpr_write_b32 a207, v159
    v_accvgpr_write_b32 a208, v160
    v_accvgpr_write_b32 a209, v161
    v_accvgpr_write_b32 a210, v162
    v_accvgpr_write_b32 a211, v163
    v_accvgpr_write_b32 a212, v164
    v_accvgpr_write_b32 a213, v165
    v_accvgpr_write_b32 a214, v166
    v_accvgpr_write_b32 a215, v167
    v_accvgpr_write_b32 a216, v168
    v_accvgpr_write_b32 a217, v169
    v_accvgpr_write_b32 a218, v170
    v_accvgpr_write_b32 a219, v171
    v_accvgpr_write_b32 a220, v172
    v_accvgpr_write_b32 a221, v173
    v_accvgpr_write_b32 a222, v174
    v_accvgpr_write_b32 a223, v175
    s_add_u32 s52, s51, s49
    s_add_u32 s52, s52, 56
    s_lshl_b32 s76, s47, 1
    s_add_u32 s76, s76, s48
    s_mul_i32 s76, s76, 112
    s_add_u32 s76, s76, s52
    s_lshl_b32 s76, s76, 13
    s_mov_b32 s71, s76
    s_mov_b32 s14, s47
    s_branch L_p2_entry
L_g1_tailB:
    s_waitcnt vmcnt(20) lgkmcnt(0)
    s_barrier
    v_mfma_f32_16x16x32_bf16 v[80:83], a[72:75], a[0:3], v[80:83]
    ds_read_b128 a[32:35], v1 offset:8192
    v_mfma_f32_16x16x32_bf16 v[84:87], a[72:75], a[4:7], v[84:87]
    ds_read_b128 a[36:39], v1 offset:9216
    v_mfma_f32_16x16x32_bf16 v[88:91], a[72:75], a[8:11], v[88:91]
    ds_read_b128 a[40:43], v1 offset:10240
    v_mfma_f32_16x16x32_bf16 v[92:95], a[72:75], a[12:15], v[92:95]
    ds_read_b128 a[44:47], v1 offset:11264
    v_mfma_f32_16x16x32_bf16 v[96:99], a[72:75], a[16:19], v[96:99]
    ds_read_b128 a[48:51], v1 offset:12288
    v_mfma_f32_16x16x32_bf16 v[100:103], a[72:75], a[20:23], v[100:103]
    ds_read_b128 a[52:55], v1 offset:13312
    v_mfma_f32_16x16x32_bf16 v[104:107], a[72:75], a[24:27], v[104:107]
    ds_read_b128 a[56:59], v1 offset:14336
    v_mfma_f32_16x16x32_bf16 v[108:111], a[72:75], a[28:31], v[108:111]
    ds_read_b128 a[60:63], v1 offset:15360
    v_mfma_f32_16x16x32_bf16 v[140:143], a[76:79], a[28:31], v[140:143]
    ds_read_b64_tr_b16 a[112:113], v4 offset:4096
    v_mfma_f32_16x16x32_bf16 v[136:139], a[76:79], a[24:27], v[136:139]
    ds_read_b64_tr_b16 a[114:115], v4 offset:4608
    v_mfma_f32_16x16x32_bf16 v[132:135], a[76:79], a[20:23], v[132:135]
    ds_read_b64_tr_b16 a[116:117], v5 offset:4096
    v_mfma_f32_16x16x32_bf16 v[128:131], a[76:79], a[16:19], v[128:131]
    ds_read_b64_tr_b16 a[118:119], v5 offset:4608
    v_mfma_f32_16x16x32_bf16 v[124:127], a[76:79], a[12:15], v[124:127]
    ds_read_b64_tr_b16 a[120:121], v6 offset:4096
    v_mfma_f32_16x16x32_bf16 v[120:123], a[76:79], a[8:11], v[120:123]
    ds_read_b64_tr_b16 a[122:123], v6 offset:4608
    v_mfma_f32_16x16x32_bf16 v[116:119], a[76:79], a[4:7], v[116:119]
    ds_read_b64_tr_b16 a[124:125], v7 offset:4096
    v_mfma_f32_16x16x32_bf16 v[112:115], a[76:79], a[0:3], v[112:115]
    ds_read_b64_tr_b16 a[126:127], v7 offset:4608
    v_mfma_f32_16x16x32_bf16 v[144:147], a[80:83], a[0:3], v[144:147]
    v_mfma_f32_16x16x32_bf16 v[148:151], a[80:83], a[4:7], v[148:151]
    v_mfma_f32_16x16x32_bf16 v[152:155], a[80:83], a[8:11], v[152:155]
    v_mfma_f32_16x16x32_bf16 v[156:159], a[80:83], a[12:15], v[156:159]
    v_mfma_f32_16x16x32_bf16 v[160:163], a[80:83], a[16:19], v[160:163]
    v_mfma_f32_16x16x32_bf16 v[164:167], a[80:83], a[20:23], v[164:167]
    v_mfma_f32_16x16x32_bf16 v[168:171], a[80:83], a[24:27], v[168:171]
    v_mfma_f32_16x16x32_bf16 v[172:175], a[80:83], a[28:31], v[172:175]
    v_mfma_f32_16x16x32_bf16 v[204:207], a[84:87], a[28:31], v[204:207]
    v_mfma_f32_16x16x32_bf16 v[200:203], a[84:87], a[24:27], v[200:203]
    v_mfma_f32_16x16x32_bf16 v[196:199], a[84:87], a[20:23], v[196:199]
    v_mfma_f32_16x16x32_bf16 v[192:195], a[84:87], a[16:19], v[192:195]
    v_mfma_f32_16x16x32_bf16 v[188:191], a[84:87], a[12:15], v[188:191]
    v_mfma_f32_16x16x32_bf16 v[184:187], a[84:87], a[8:11], v[184:187]
    v_mfma_f32_16x16x32_bf16 v[180:183], a[84:87], a[4:7], v[180:183]
    v_mfma_f32_16x16x32_bf16 v[176:179], a[84:87], a[0:3], v[176:179]
    s_waitcnt vmcnt(10) lgkmcnt(0)
    s_barrier
    v_mfma_f32_16x16x32_bf16 v[80:83], a[112:115], a[32:35], v[80:83]
    ds_read_b128 a[0:3], v1 offset:16384
    v_mfma_f32_16x16x32_bf16 v[84:87], a[112:115], a[36:39], v[84:87]
    ds_read_b128 a[4:7], v1 offset:17408
    v_mfma_f32_16x16x32_bf16 v[88:91], a[112:115], a[40:43], v[88:91]
    ds_read_b128 a[8:11], v1 offset:18432
    v_mfma_f32_16x16x32_bf16 v[92:95], a[112:115], a[44:47], v[92:95]
    ds_read_b128 a[12:15], v1 offset:19456
    v_mfma_f32_16x16x32_bf16 v[96:99], a[112:115], a[48:51], v[96:99]
    ds_read_b128 a[16:19], v1 offset:20480
    v_mfma_f32_16x16x32_bf16 v[100:103], a[112:115], a[52:55], v[100:103]
    ds_read_b128 a[20:23], v1 offset:21504
    v_mfma_f32_16x16x32_bf16 v[104:107], a[112:115], a[56:59], v[104:107]
    ds_read_b128 a[24:27], v1 offset:22528
    v_mfma_f32_16x16x32_bf16 v[108:111], a[112:115], a[60:63], v[108:111]
    ds_read_b128 a[28:31], v1 offset:23552
    v_mfma_f32_16x16x32_bf16 v[140:143], a[116:119], a[60:63], v[140:143]
    ds_read_b64_tr_b16 a[72:73], v4 offset:8192
    v_mfma_f32_16x16x32_bf16 v[136:139], a[116:119], a[56:59], v[136:139]
    ds_read_b64_tr_b16 a[74:75], v4 offset:8704
    v_mfma_f32_16x16x32_bf16 v[132:135], a[116:119], a[52:55], v[132:135]
    ds_read_b64_tr_b16 a[76:77], v5 offset:8192
    v_mfma_f32_16x16x32_bf16 v[128:131], a[116:119], a[48:51], v[128:131]
    ds_read_b64_tr_b16 a[78:79], v5 offset:8704
    v_mfma_f32_16x16x32_bf16 v[124:127], a[116:119], a[44:47], v[124:127]
    ds_read_b64_tr_b16 a[80:81], v6 offset:8192
    v_mfma_f32_16x16x32_bf16 v[120:123], a[116:119], a[40:43], v[120:123]
    ds_read_b64_tr_b16 a[82:83], v6 offset:8704
    v_mfma_f32_16x16x32_bf16 v[116:119], a[116:119], a[36:39], v[116:119]
    ds_read_b64_tr_b16 a[84:85], v7 offset:8192
    v_mfma_f32_16x16x32_bf16 v[112:115], a[116:119], a[32:35], v[112:115]
    ds_read_b64_tr_b16 a[86:87], v7 offset:8704
    v_mfma_f32_16x16x32_bf16 v[144:147], a[120:123], a[32:35], v[144:147]
    v_mfma_f32_16x16x32_bf16 v[148:151], a[120:123], a[36:39], v[148:151]
    v_mfma_f32_16x16x32_bf16 v[152:155], a[120:123], a[40:43], v[152:155]
    v_mfma_f32_16x16x32_bf16 v[156:159], a[120:123], a[44:47], v[156:159]
    v_mfma_f32_16x16x32_bf16 v[160:163], a[120:123], a[48:51], v[160:163]
    v_mfma_f32_16x16x32_bf16 v[164:167], a[120:123], a[52:55], v[164:167]
    v_mfma_f32_16x16x32_bf16 v[168:171], a[120:123], a[56:59], v[168:171]
    v_mfma_f32_16x16x32_bf16 v[172:175], a[120:123], a[60:63], v[172:175]
    v_mfma_f32_16x16x32_bf16 v[204:207], a[124:127], a[60:63], v[204:207]
    v_mfma_f32_16x16x32_bf16 v[200:203], a[124:127], a[56:59], v[200:203]
    v_mfma_f32_16x16x32_bf16 v[196:199], a[124:127], a[52:55], v[196:199]
    v_mfma_f32_16x16x32_bf16 v[192:195], a[124:127], a[48:51], v[192:195]
    v_mfma_f32_16x16x32_bf16 v[188:191], a[124:127], a[44:47], v[188:191]
    v_mfma_f32_16x16x32_bf16 v[184:187], a[124:127], a[40:43], v[184:187]
    v_mfma_f32_16x16x32_bf16 v[180:183], a[124:127], a[36:39], v[180:183]
    v_mfma_f32_16x16x32_bf16 v[176:179], a[124:127], a[32:35], v[176:179]
    s_waitcnt vmcnt(0) lgkmcnt(0)
    s_barrier
    v_mfma_f32_16x16x32_bf16 v[80:83], a[72:75], a[0:3], v[80:83]
    ds_read_b128 a[32:35], v1 offset:24576
    v_mfma_f32_16x16x32_bf16 v[84:87], a[72:75], a[4:7], v[84:87]
    ds_read_b128 a[36:39], v1 offset:25600
    v_mfma_f32_16x16x32_bf16 v[88:91], a[72:75], a[8:11], v[88:91]
    ds_read_b128 a[40:43], v1 offset:26624
    v_mfma_f32_16x16x32_bf16 v[92:95], a[72:75], a[12:15], v[92:95]
    ds_read_b128 a[44:47], v1 offset:27648
    v_mfma_f32_16x16x32_bf16 v[96:99], a[72:75], a[16:19], v[96:99]
    ds_read_b128 a[48:51], v1 offset:28672
    v_mfma_f32_16x16x32_bf16 v[100:103], a[72:75], a[20:23], v[100:103]
    ds_read_b128 a[52:55], v1 offset:29696
    v_mfma_f32_16x16x32_bf16 v[104:107], a[72:75], a[24:27], v[104:107]
    ds_read_b128 a[56:59], v1 offset:30720
    v_mfma_f32_16x16x32_bf16 v[108:111], a[72:75], a[28:31], v[108:111]
    ds_read_b128 a[60:63], v1 offset:31744
    v_mfma_f32_16x16x32_bf16 v[140:143], a[76:79], a[28:31], v[140:143]
    ds_read_b64_tr_b16 a[112:113], v4 offset:12288
    v_mfma_f32_16x16x32_bf16 v[136:139], a[76:79], a[24:27], v[136:139]
    ds_read_b64_tr_b16 a[114:115], v4 offset:12800
    v_mfma_f32_16x16x32_bf16 v[132:135], a[76:79], a[20:23], v[132:135]
    ds_read_b64_tr_b16 a[116:117], v5 offset:12288
    v_mfma_f32_16x16x32_bf16 v[128:131], a[76:79], a[16:19], v[128:131]
    ds_read_b64_tr_b16 a[118:119], v5 offset:12800
    v_mfma_f32_16x16x32_bf16 v[124:127], a[76:79], a[12:15], v[124:127]
    ds_read_b64_tr_b16 a[120:121], v6 offset:12288
    v_mfma_f32_16x16x32_bf16 v[120:123], a[76:79], a[8:11], v[120:123]
    ds_read_b64_tr_b16 a[122:123], v6 offset:12800
    v_mfma_f32_16x16x32_bf16 v[116:119], a[76:79], a[4:7], v[116:119]
    ds_read_b64_tr_b16 a[124:125], v7 offset:12288
    v_mfma_f32_16x16x32_bf16 v[112:115], a[76:79], a[0:3], v[112:115]
    ds_read_b64_tr_b16 a[126:127], v7 offset:12800
    v_mfma_f32_16x16x32_bf16 v[144:147], a[80:83], a[0:3], v[144:147]
    v_mfma_f32_16x16x32_bf16 v[148:151], a[80:83], a[4:7], v[148:151]
    v_mfma_f32_16x16x32_bf16 v[152:155], a[80:83], a[8:11], v[152:155]
    v_mfma_f32_16x16x32_bf16 v[156:159], a[80:83], a[12:15], v[156:159]
    v_mfma_f32_16x16x32_bf16 v[160:163], a[80:83], a[16:19], v[160:163]
    v_mfma_f32_16x16x32_bf16 v[164:167], a[80:83], a[20:23], v[164:167]
    v_mfma_f32_16x16x32_bf16 v[168:171], a[80:83], a[24:27], v[168:171]
    v_mfma_f32_16x16x32_bf16 v[172:175], a[80:83], a[28:31], v[172:175]
    v_mfma_f32_16x16x32_bf16 v[204:207], a[84:87], a[28:31], v[204:207]
    v_mfma_f32_16x16x32_bf16 v[200:203], a[84:87], a[24:27], v[200:203]
    v_mfma_f32_16x16x32_bf16 v[196:199], a[84:87], a[20:23], v[196:199]
    v_mfma_f32_16x16x32_bf16 v[192:195], a[84:87], a[16:19], v[192:195]
    v_mfma_f32_16x16x32_bf16 v[188:191], a[84:87], a[12:15], v[188:191]
    v_mfma_f32_16x16x32_bf16 v[184:187], a[84:87], a[8:11], v[184:187]
    v_mfma_f32_16x16x32_bf16 v[180:183], a[84:87], a[4:7], v[180:183]
    v_mfma_f32_16x16x32_bf16 v[176:179], a[84:87], a[0:3], v[176:179]
    s_waitcnt lgkmcnt(0)
    v_mfma_f32_16x16x32_bf16 v[80:83], a[112:115], a[32:35], v[80:83]
    ds_read_b128 a[0:3], v1 offset:0
    s_getpc_b64 s[96:97]
L_pc_fb:
    v_mfma_f32_16x16x32_bf16 v[84:87], a[112:115], a[36:39], v[84:87]
    ds_read_b128 a[4:7], v1 offset:1024
    s_add_u32 s96, s96, L_p2_entry - L_pc_fb
    v_mfma_f32_16x16x32_bf16 v[88:91], a[112:115], a[40:43], v[88:91]
    ds_read_b128 a[8:11], v1 offset:2048
    s_addc_u32 s97, s97, 0
    v_mfma_f32_16x16x32_bf16 v[92:95], a[112:115], a[44:47], v[92:95]
    ds_read_b128 a[12:15], v1 offset:3072
    s_mov_b32 s98, L_g1_done - L_p2_entry
    v_mfma_f32_16x16x32_bf16 v[96:99], a[112:115], a[48:51], v[96:99]
    ds_read_b128 a[16:19], v1 offset:4096
    s_mov_b32 s99, 0x00020000
    v_mfma_f32_16x16x32_bf16 v[100:103], a[112:115], a[52:55], v[100:103]
    ds_read_b128 a[20:23], v1 offset:5120
    s_lshr_b32 s52, s2, 3
    v_mfma_f32_16x16x32_bf16 v[104:107], a[112:115], a[56:59], v[104:107]
    ds_read_b128 a[24:27], v1 offset:6144
    s_lshl_b32 s52, s52, 2
    v_mfma_f32_16x16x32_bf16 v[108:111], a[112:115], a[60:63], v[108:111]
    ds_read_b128 a[28:31], v1 offset:7168
    s_add_u32 s52, s52, s36
    v_mfma_f32_16x16x32_bf16 v[140:143], a[116:119], a[60:63], v[140:143]
    ds_read_b64_tr_b16 a[64:65], v2 offset:0
    s_mul_i32 s52, s52, 384
    v_mfma_f32_16x16x32_bf16 v[136:139], a[116:119], a[56:59], v[136:139]
    ds_read_b64_tr_b16 a[66:67], v2 offset:512
    v_lshlrev_b32 v15, 7, v0
    v_mfma_f32_16x16x32_bf16 v[132:135], a[116:119], a[52:55], v[132:135]
    ds_read_b64_tr_b16 a[68:69], v3 offset:0
    s_mov_b64 exec, 7
    buffer_load_dword a226, v15, s[96:99], s52 offen
    s_mov_b64 exec, -1
    v_mfma_f32_16x16x32_bf16 v[128:131], a[116:119], a[48:51], v[128:131]
    ds_read_b64_tr_b16 a[70:71], v3 offset:512
    v_mfma_f32_16x16x32_bf16 v[124:127], a[116:119], a[44:47], v[124:127]
    v_mfma_f32_16x16x32_bf16 v[120:123], a[116:119], a[40:43], v[120:123]
    v_mfma_f32_16x16x32_bf16 v[116:119], a[116:119], a[36:39], v[116:119]
    v_mfma_f32_16x16x32_bf16 v[112:115], a[116:119], a[32:35], v[112:115]
    v_mfma_f32_16x16x32_bf16 v[144:147], a[120:123], a[32:35], v[144:147]
    v_mfma_f32_16x16x32_bf16 v[148:151], a[120:123], a[36:39], v[148:151]
    v_mfma_f32_16x16x32_bf16 v[152:155], a[120:123], a[40:43], v[152:155]
    v_mfma_f32_16x16x32_bf16 v[156:159], a[120:123], a[44:47], v[156:159]
    v_mfma_f32_16x16x32_bf16 v[160:163], a[120:123], a[48:51], v[160:163]
    v_mfma_f32_16x16x32_bf16 v[164:167], a[120:123], a[52:55], v[164:167]
    v_mfma_f32_16x16x32_bf16 v[168:171], a[120:123], a[56:59], v[168:171]
    v_mfma_f32_16x16x32_bf16 v[172:175], a[120:123], a[60:63], v[172:175]
    v_mfma_f32_16x16x32_bf16 v[204:207], a[124:127], a[60:63], v[204:207]
    v_mfma_f32_16x16x32_bf16 v[200:203], a[124:127], a[56:59], v[200:203]
    v_mfma_f32_16x16x32_bf16 v[196:199], a[124:127], a[52:55], v[196:199]
    v_mfma_f32_16x16x32_bf16 v[192:195], a[124:127], a[48:51], v[192:195]
    v_mfma_f32_16x16x32_bf16 v[188:191], a[124:127], a[44:47], v[188:191]
    v_mfma_f32_16x16x32_bf16 v[184:187], a[124:127], a[40:43], v[184:187]
    v_mfma_f32_16x16x32_bf16 v[180:183], a[124:127], a[36:39], v[180:183]
    v_mfma_f32_16x16x32_bf16 v[176:179], a[124:127], a[32:35], v[176:179]
    s_waitcnt lgkmcnt(0)
    v_mfma_f32_16x16x32_bf16 v[16:19], a[64:67], a[0:3], v[16:19]
    ds_read_b128 a[32:35], v1 offset:8192
    v_mfma_f32_16x16x32_bf16 v[20:23], a[64:67], a[4:7], v[20:23]
    ds_read_b128 a[36:39], v1 offset:9216
    v_mfma_f32_16x16x32_bf16 v[24:27], a[64:67], a[8:11], v[24:27]
    ds_read_b128 a[40:43], v1 offset:10240
    v_mfma_f32_16x16x32_bf16 v[28:31], a[64:67], a[12:15], v[28:31]
    ds_read_b128 a[44:47], v1 offset:11264
    v_mfma_f32_16x16x32_bf16 v[32:35], a[64:67], a[16:19], v[32:35]
    ds_read_b128 a[48:51], v1 offset:12288
    v_mfma_f32_16x16x32_bf16 v[36:39], a[64:67], a[20:23], v[36:39]
    ds_read_b128 a[52:55], v1 offset:13312
    v_mfma_f32_16x16x32_bf16 v[40:43], a[64:67], a[24:27], v[40:43]
    ds_read_b128 a[56:59], v1 offset:14336
    v_mfma_f32_16x16x32_bf16 v[44:47], a[64:67], a[28:31], v[44:47]
    ds_read_b128 a[60:63], v1 offset:15360
    v_mfma_f32_16x16x32_bf16 v[76:79], a[68:71], a[28:31], v[76:79]
    ds_read_b64_tr_b16 a[104:105], v2 offset:4096
    v_mfma_f32_16x16x32_bf16 v[72:75], a[68:71], a[24:27], v[72:75]
    ds_read_b64_tr_b16 a[106:107], v2 offset:4608
    v_mfma_f32_16x16x32_bf16 v[68:71], a[68:71], a[20:23], v[68:71]
    ds_read_b64_tr_b16 a[108:109], v3 offset:4096
    v_mfma_f32_16x16x32_bf16 v[64:67], a[68:71], a[16:19], v[64:67]
    ds_read_b64_tr_b16 a[110:111], v3 offset:4608
    v_mfma_f32_16x16x32_bf16 v[60:63], a[68:71], a[12:15], v[60:63]
    s_lshl_b32 s52, s49, 1
    s_add_u32 s52, s52, s50
    v_mfma_f32_16x16x32_bf16 v[56:59], a[68:71], a[8:11], v[56:59]
    s_sub_u32 s52, s52, 1
    s_lshl_b32 s52, s52, 1
    v_mfma_f32_16x16x32_bf16 v[52:55], a[68:71], a[4:7], v[52:55]
    s_add_u32 s52, s52, 0
    s_cmp_lt_u32 s52, 32
    v_mfma_f32_16x16x32_bf16 v[48:51], a[68:71], a[0:3], v[48:51]
    s_cselect_b32 s58, 0x3e8293ee, 1.0
    s_mov_b32 s59, s58
    s_waitcnt lgkmcnt(0)
    v_mfma_f32_16x16x32_bf16 v[16:19], a[104:107], a[32:35], v[16:19]
    ds_read_b128 a[0:3], v1 offset:16384
    s_lshl_b32 s76, s52, 17
    v_mfma_f32_16x16x32_bf16 v[20:23], a[104:107], a[36:39], v[20:23]
    ds_read_b128 a[4:7], v1 offset:17408
    s_lshl_b32 s53, s47, 14
    v_mfma_f32_16x16x32_bf16 v[24:27], a[104:107], a[40:43], v[24:27]
    ds_read_b128 a[8:11], v1 offset:18432
    s_add_u32 s76, s76, s53
    v_mfma_f32_16x16x32_bf16 v[28:31], a[104:107], a[44:47], v[28:31]
    ds_read_b128 a[12:15], v1 offset:19456
    s_lshl_b32 s53, s48, 13
    v_mfma_f32_16x16x32_bf16 v[32:35], a[104:107], a[48:51], v[32:35]
    ds_read_b128 a[16:19], v1 offset:20480
    s_add_u32 s76, s76, s53
    v_mfma_f32_16x16x32_bf16 v[36:39], a[104:107], a[52:55], v[36:39]
    ds_read_b128 a[20:23], v1 offset:21504
    v_mul_f32 v80, s58, v80
    v_mfma_f32_16x16x32_bf16 v[40:43], a[104:107], a[56:59], v[40:43]
    ds_read_b128 a[24:27], v1 offset:22528
    v_mul_f32 v81, s58, v81
    v_mfma_f32_16x16x32_bf16 v[44:47], a[104:107], a[60:63], v[44:47]
    ds_read_b128 a[28:31], v1 offset:23552
    v_mul_f32 v82, s58, v82
    v_mfma_f32_16x16x32_bf16 v[76:79], a[108:111], a[60:63], v[76:79]
    ds_read_b64_tr_b16 a[64:65], v2 offset:8192
    v_mul_f32 v83, s58, v83
    v_mfma_f32_16x16x32_bf16 v[72:75], a[108:111], a[56:59], v[72:75]
    ds_read_b64_tr_b16 a[66:67], v2 offset:8704
    v_mul_f32 v112, s58, v112
    v_mfma_f32_16x16x32_bf16 v[68:71], a[108:111], a[52:55], v[68:71]
    ds_read_b64_tr_b16 a[68:69], v3 offset:8192
    v_mul_f32 v113, s58, v113
    v_mfma_f32_16x16x32_bf16 v[64:67], a[108:111], a[48:51], v[64:67]
    ds_read_b64_tr_b16 a[70:71], v3 offset:8704
    v_mul_f32 v114, s58, v114
    v_mfma_f32_16x16x32_bf16 v[60:63], a[108:111], a[44:47], v[60:63]
    v_mul_f32 v115, s58, v115
    v_cvt_pk_bf16_f32 v80, v80, v81
    v_mfma_f32_16x16x32_bf16 v[56:59], a[108:111], a[40:43], v[56:59]
    v_cvt_pk_bf16_f32 v81, v82, v83
    v_cvt_pk_bf16_f32 v82, v112, v113
    v_mfma_f32_16x16x32_bf16 v[52:55], a[108:111], a[36:39], v[52:55]
    v_cvt_pk_bf16_f32 v83, v114, v115
    buffer_store_dwordx4 v[80:83], v13, s[68:71], s76 offen offset:0 sc1
    v_mfma_f32_16x16x32_bf16 v[48:51], a[108:111], a[32:35], v[48:51]
    v_mul_f32 v84, s58, v84
    v_mul_f32 v85, s58, v85
    s_waitcnt lgkmcnt(0)
    v_mfma_f32_16x16x32_bf16 v[16:19], a[64:67], a[0:3], v[16:19]
    ds_read_b128 a[32:35], v1 offset:24576
    v_mul_f32 v86, s58, v86
    v_mfma_f32_16x16x32_bf16 v[20:23], a[64:67], a[4:7], v[20:23]
    ds_read_b128 a[36:39], v1 offset:25600
    v_mul_f32 v87, s58, v87
    v_mfma_f32_16x16x32_bf16 v[24:27], a[64:67], a[8:11], v[24:27]
    ds_read_b128 a[40:43], v1 offset:26624
    v_mul_f32 v116, s58, v116
    v_mfma_f32_16x16x32_bf16 v[28:31], a[64:67], a[12:15], v[28:31]
    ds_read_b128 a[44:47], v1 offset:27648
    v_mul_f32 v117, s58, v117
    v_mfma_f32_16x16x32_bf16 v[32:35], a[64:67], a[16:19], v[32:35]
    ds_read_b128 a[48:51], v1 offset:28672
    v_mul_f32 v118, s58, v118
    v_mfma_f32_16x16x32_bf16 v[36:39], a[64:67], a[20:23], v[36:39]
    ds_read_b128 a[52:55], v1 offset:29696
    v_mul_f32 v119, s58, v119
    v_mfma_f32_16x16x32_bf16 v[40:43], a[64:67], a[24:27], v[40:43]
    ds_read_b128 a[56:59], v1 offset:30720
    v_cvt_pk_bf16_f32 v84, v84, v85
    v_mfma_f32_16x16x32_bf16 v[44:47], a[64:67], a[28:31], v[44:47]
    ds_read_b128 a[60:63], v1 offset:31744
    v_cvt_pk_bf16_f32 v85, v86, v87
    v_mfma_f32_16x16x32_bf16 v[76:79], a[68:71], a[28:31], v[76:79]
    ds_read_b64_tr_b16 a[104:105], v2 offset:12288
    v_cvt_pk_bf16_f32 v86, v116, v117
    v_mfma_f32_16x16x32_bf16 v[72:75], a[68:71], a[24:27], v[72:75]
    ds_read_b64_tr_b16 a[106:107], v2 offset:12800
    v_cvt_pk_bf16_f32 v87, v118, v119
    v_mfma_f32_16x16x32_bf16 v[68:71], a[68:71], a[20:23], v[68:71]
    ds_read_b64_tr_b16 a[108:109], v3 offset:12288
    buffer_store_dwordx4 v[84:87], v13, s[68:71], s76 offen offset:128 sc1
    v_mfma_f32_16x16x32_bf16 v[64:67], a[68:71], a[16:19], v[64:67]
    ds_read_b64_tr_b16 a[110:111], v3 offset:12800
    v_mul_f32 v88, s58, v88
    v_mfma_f32_16x16x32_bf16 v[60:63], a[68:71], a[12:15], v[60:63]
    v_mul_f32 v89, s58, v89
    v_mul_f32 v90, s58, v90
    v_mfma_f32_16x16x32_bf16 v[56:59], a[68:71], a[8:11], v[56:59]
    v_mul_f32 v91, s58, v91
    v_mul_f32 v120, s58, v120
    v_mfma_f32_16x16x32_bf16 v[52:55], a[68:71], a[4:7], v[52:55]
    v_mul_f32 v121, s58, v121
    v_mul_f32 v122, s58, v122
    v_mfma_f32_16x16x32_bf16 v[48:51], a[68:71], a[0:3], v[48:51]
    v_mul_f32 v123, s58, v123
    v_cvt_pk_bf16_f32 v88, v88, v89
    s_waitcnt lgkmcnt(0)
    v_mfma_f32_16x16x32_bf16 v[16:19], a[104:107], a[32:35], v[16:19]
    ds_read_b128 a[0:3], v1 offset:0
    v_cvt_pk_bf16_f32 v89, v90, v91
    v_mfma_f32_16x16x32_bf16 v[20:23], a[104:107], a[36:39], v[20:23]
    ds_read_b128 a[4:7], v1 offset:1024
    v_cvt_pk_bf16_f32 v90, v120, v121
    v_mfma_f32_16x16x32_bf16 v[24:27], a[104:107], a[40:43], v[24:27]
    ds_read_b128 a[8:11], v1 offset:2048
    v_cvt_pk_bf16_f32 v91, v122, v123
    v_mfma_f32_16x16x32_bf16 v[28:31], a[104:107], a[44:47], v[28:31]
    ds_read_b128 a[12:15], v1 offset:3072
    buffer_store_dwordx4 v[88:91], v13, s[68:71], s76 offen offset:2048 sc1
    v_mfma_f32_16x16x32_bf16 v[32:35], a[104:107], a[48:51], v[32:35]
    ds_read_b128 a[16:19], v1 offset:4096
    v_mul_f32 v92, s58, v92
    v_mfma_f32_16x16x32_bf16 v[36:39], a[104:107], a[52:55], v[36:39]
    ds_read_b128 a[20:23], v1 offset:5120
    v_mul_f32 v93, s58, v93
    v_mfma_f32_16x16x32_bf16 v[40:43], a[104:107], a[56:59], v[40:43]
    ds_read_b128 a[24:27], v1 offset:6144
    v_mul_f32 v94, s58, v94
    v_mfma_f32_16x16x32_bf16 v[44:47], a[104:107], a[60:63], v[44:47]
    ds_read_b128 a[28:31], v1 offset:7168
    v_mul_f32 v95, s58, v95
    v_mfma_f32_16x16x32_bf16 v[76:79], a[108:111], a[60:63], v[76:79]
    ds_read_b64_tr_b16 a[88:89], v8 offset:0
    v_mul_f32 v124, s58, v124
    v_mfma_f32_16x16x32_bf16 v[72:75], a[108:111], a[56:59], v[72:75]
    ds_read_b64_tr_b16 a[90:91], v8 offset:512
    v_mul_f32 v125, s58, v125
    v_mfma_f32_16x16x32_bf16 v[68:71], a[108:111], a[52:55], v[68:71]
    ds_read_b64_tr_b16 a[92:93], v9 offset:0
    v_mul_f32 v126, s58, v126
    v_mfma_f32_16x16x32_bf16 v[64:67], a[108:111], a[48:51], v[64:67]
    ds_read_b64_tr_b16 a[94:95], v9 offset:512
    v_mul_f32 v127, s58, v127
    v_mfma_f32_16x16x32_bf16 v[60:63], a[108:111], a[44:47], v[60:63]
    ds_read_b64_tr_b16 a[96:97], v10 offset:0
    v_cvt_pk_bf16_f32 v92, v92, v93
    v_mfma_f32_16x16x32_bf16 v[56:59], a[108:111], a[40:43], v[56:59]
    ds_read_b64_tr_b16 a[98:99], v10 offset:512
    v_cvt_pk_bf16_f32 v93, v94, v95
    v_mfma_f32_16x16x32_bf16 v[52:55], a[108:111], a[36:39], v[52:55]
    ds_read_b64_tr_b16 a[100:101], v11 offset:0
    v_cvt_pk_bf16_f32 v94, v124, v125
    v_mfma_f32_16x16x32_bf16 v[48:51], a[108:111], a[32:35], v[48:51]
    ds_read_b64_tr_b16 a[102:103], v11 offset:512
    v_cvt_pk_bf16_f32 v95, v126, v127
    s_waitcnt lgkmcnt(0)
    v_mfma_f32_16x16x32_bf16 v[208:211], a[88:91], a[0:3], v[208:211]
    ds_read_b128 a[32:35], v1 offset:8192
    v_mfma_f32_16x16x32_bf16 v[212:215], a[88:91], a[4:7], v[212:215]
    ds_read_b128 a[36:39], v1 offset:9216
    v_mfma_f32_16x16x32_bf16 v[216:219], a[88:91], a[8:11], v[216:219]
    ds_read_b128 a[40:43], v1 offset:10240
    v_mfma_f32_16x16x32_bf16 v[220:223], a[88:91], a[12:15], v[220:223]
    ds_read_b128 a[44:47], v1 offset:11264
    v_mfma_f32_16x16x32_bf16 v[224:227], a[88:91], a[16:19], v[224:227]
    ds_read_b128 a[48:51], v1 offset:12288
    v_mfma_f32_16x16x32_bf16 v[228:231], a[88:91], a[20:23], v[228:231]
    ds_read_b128 a[52:55], v1 offset:13312
    v_mfma_f32_16x16x32_bf16 v[232:235], a[88:91], a[24:27], v[232:235]
    ds_read_b128 a[56:59], v1 offset:14336
    v_mfma_f32_16x16x32_bf16 v[236:239], a[88:91], a[28:31], v[236:239]
    ds_read_b128 a[60:63], v1 offset:15360
    v_mfma_f32_16x16x32_bf16 a[156:159], a[92:95], a[28:31], a[156:159]
    ds_read_b64_tr_b16 a[128:129], v8 offset:4096
    v_mfma_f32_16x16x32_bf16 a[152:155], a[92:95], a[24:27], a[152:155]
    ds_read_b64_tr_b16 a[130:131], v8 offset:4608
    v_mfma_f32_16x16x32_bf16 a[148:151], a[92:95], a[20:23], a[148:151]
    ds_read_b64_tr_b16 a[132:133], v9 offset:4096
    v_mfma_f32_16x16x32_bf16 a[144:147], a[92:95], a[16:19], a[144:147]
    ds_read_b64_tr_b16 a[134:135], v9 offset:4608
    v_mfma_f32_16x16x32_bf16 v[252:255], a[92:95], a[12:15], v[252:255]
    ds_read_b64_tr_b16 a[136:137], v10 offset:4096
    v_mfma_f32_16x16x32_bf16 v[248:251], a[92:95], a[8:11], v[248:251]
    ds_read_b64_tr_b16 a[138:139], v10 offset:4608
    v_mfma_f32_16x16x32_bf16 v[244:247], a[92:95], a[4:7], v[244:247]
    ds_read_b64_tr_b16 a[140:141], v11 offset:4096
    v_mfma_f32_16x16x32_bf16 v[240:243], a[92:95], a[0:3], v[240:243]
    ds_read_b64_tr_b16 a[142:143], v11 offset:4608
    v_mfma_f32_16x16x32_bf16 a[160:163], a[96:99], a[0:3], a[160:163]
    buffer_store_dwordx4 v[92:95], v13, s[68:71], s76 offen offset:2176 sc1
    v_mul_f32 v96, s58, v96
    v_mfma_f32_16x16x32_bf16 a[164:167], a[96:99], a[4:7], a[164:167]
    v_mul_f32 v97, s58, v97
    v_mul_f32 v98, s58, v98
    v_mfma_f32_16x16x32_bf16 a[168:171], a[96:99], a[8:11], a[168:171]
    v_mul_f32 v99, s58, v99
    v_mul_f32 v128, s58, v128
    v_mfma_f32_16x16x32_bf16 a[172:175], a[96:99], a[12:15], a[172:175]
    v_mul_f32 v129, s58, v129
    v_mul_f32 v130, s58, v130
    v_mfma_f32_16x16x32_bf16 a[176:179], a[96:99], a[16:19], a[176:179]
    v_mul_f32 v131, s58, v131
    v_cvt_pk_bf16_f32 v96, v96, v97
    v_mfma_f32_16x16x32_bf16 a[180:183], a[96:99], a[20:23], a[180:183]
    v_cvt_pk_bf16_f32 v97, v98, v99
    v_cvt_pk_bf16_f32 v98, v128, v129
    v_mfma_f32_16x16x32_bf16 a[184:187], a[96:99], a[24:27], a[184:187]
    v_cvt_pk_bf16_f32 v99, v130, v131
    s_add_u32 s76, s76, 4096
    v_mfma_f32_16x16x32_bf16 a[188:191], a[96:99], a[28:31], a[188:191]
    buffer_store_dwordx4 v[96:99], v13, s[68:71], s76 offen offset:0 sc1
    v_mul_f32 v100, s58, v100
    v_mfma_f32_16x16x32_bf16 a[220:223], a[100:103], a[28:31], a[220:223]
    v_mul_f32 v101, s58, v101
    v_mul_f32 v102, s58, v102
    v_mfma_f32_16x16x32_bf16 a[216:219], a[100:103], a[24:27], a[216:219]
    v_mul_f32 v103, s58, v103
    v_mul_f32 v132, s58, v132
    v_mfma_f32_16x16x32_bf16 a[212:215], a[100:103], a[20:23], a[212:215]
    v_mul_f32 v133, s58, v133
    v_mul_f32 v134, s58, v134
    v_mfma_f32_16x16x32_bf16 a[208:211], a[100:103], a[16:19], a[208:211]
    v_mul_f32 v135, s58, v135
    v_cvt_pk_bf16_f32 v100, v100, v101
    v_mfma_f32_16x16x32_bf16 a[204:207], a[100:103], a[12:15], a[204:207]
    v_cvt_pk_bf16_f32 v101, v102, v103
    v_cvt_pk_bf16_f32 v102, v132, v133
    v_mfma_f32_16x16x32_bf16 a[200:203], a[100:103], a[8:11], a[200:203]
    v_cvt_pk_bf16_f32 v103, v134, v135
    buffer_store_dwordx4 v[100:103], v13, s[68:71], s76 offen offset:128 sc1
    v_mfma_f32_16x16x32_bf16 a[196:199], a[100:103], a[4:7], a[196:199]
    v_mul_f32 v104, s58, v104
    v_mul_f32 v105, s58, v105
    v_mfma_f32_16x16x32_bf16 a[192:195], a[100:103], a[0:3], a[192:195]
    v_mul_f32 v106, s58, v106
    v_mul_f32 v107, s58, v107
    s_waitcnt lgkmcnt(0)
    v_mfma_f32_16x16x32_bf16 v[208:211], a[128:131], a[32:35], v[208:211]
    ds_read_b128 a[0:3], v1 offset:16384
    v_mul_f32 v136, s58, v136
    v_mfma_f32_16x16x32_bf16 v[212:215], a[128:131], a[36:39], v[212:215]
    ds_read_b128 a[4:7], v1 offset:17408
    v_mul_f32 v137, s58, v137
    v_mfma_f32_16x16x32_bf16 v[216:219], a[128:131], a[40:43], v[216:219]
    ds_read_b128 a[8:11], v1 offset:18432
    v_mul_f32 v138, s58, v138
    v_mfma_f32_16x16x32_bf16 v[220:223], a[128:131], a[44:47], v[220:223]
    ds_read_b128 a[12:15], v1 offset:19456
    v_mul_f32 v139, s58, v139
    v_mfma_f32_16x16x32_bf16 v[224:227], a[128:131], a[48:51], v[224:227]
    ds_read_b128 a[16:19], v1 offset:20480
    v_cvt_pk_bf16_f32 v104, v104, v105
    v_mfma_f32_16x16x32_bf16 v[228:231], a[128:131], a[52:55], v[228:231]
    ds_read_b128 a[20:23], v1 offset:21504
    v_cvt_pk_bf16_f32 v105, v106, v107
    v_mfma_f32_16x16x32_bf16 v[232:235], a[128:131], a[56:59], v[232:235]
    ds_read_b128 a[24:27], v1 offset:22528
    v_cvt_pk_bf16_f32 v106, v136, v137
    v_mfma_f32_16x16x32_bf16 v[236:239], a[128:131], a[60:63], v[236:239]
    ds_read_b128 a[28:31], v1 offset:23552
    v_cvt_pk_bf16_f32 v107, v138, v139
    v_mfma_f32_16x16x32_bf16 a[156:159], a[132:135], a[60:63], a[156:159]
    ds_read_b64_tr_b16 a[88:89], v8 offset:8192
    buffer_store_dwordx4 v[104:107], v13, s[68:71], s76 offen offset:2048 sc1
    v_mfma_f32_16x16x32_bf16 a[152:155], a[132:135], a[56:59], a[152:155]
    ds_read_b64_tr_b16 a[90:91], v8 offset:8704
    v_mul_f32 v108, s58, v108
    v_mfma_f32_16x16x32_bf16 a[148:151], a[132:135], a[52:55], a[148:151]
    ds_read_b64_tr_b16 a[92:93], v9 offset:8192
    v_mul_f32 v109, s58, v109
    v_mfma_f32_16x16x32_bf16 a[144:147], a[132:135], a[48:51], a[144:147]
    ds_read_b64_tr_b16 a[94:95], v9 offset:8704
    v_mul_f32 v110, s58, v110
    v_mfma_f32_16x16x32_bf16 v[252:255], a[132:135], a[44:47], v[252:255]
    ds_read_b64_tr_b16 a[96:97], v10 offset:8192
    v_mul_f32 v111, s58, v111
    v_mfma_f32_16x16x32_bf16 v[248:251], a[132:135], a[40:43], v[248:251]
    ds_read_b64_tr_b16 a[98:99], v10 offset:8704
    v_mul_f32 v140, s58, v140
    v_mfma_f32_16x16x32_bf16 v[244:247], a[132:135], a[36:39], v[244:247]
    ds_read_b64_tr_b16 a[100:101], v11 offset:8192
    v_mul_f32 v141, s58, v141
    v_mfma_f32_16x16x32_bf16 v[240:243], a[132:135], a[32:35], v[240:243]
    ds_read_b64_tr_b16 a[102:103], v11 offset:8704
    v_mul_f32 v142, s58, v142
    v_mfma_f32_16x16x32_bf16 a[160:163], a[136:139], a[32:35], a[160:163]
    v_mul_f32 v143, s58, v143
    v_cvt_pk_bf16_f32 v108, v108, v109
    v_mfma_f32_16x16x32_bf16 a[164:167], a[136:139], a[36:39], a[164:167]
    v_cvt_pk_bf16_f32 v109, v110, v111
    v_cvt_pk_bf16_f32 v110, v140, v141
    v_mfma_f32_16x16x32_bf16 a[168:171], a[136:139], a[40:43], a[168:171]
    v_cvt_pk_bf16_f32 v111, v142, v143
    buffer_store_dwordx4 v[108:111], v13, s[68:71], s76 offen offset:2176 sc1
    v_mfma_f32_16x16x32_bf16 a[172:175], a[136:139], a[44:47], a[172:175]
    s_lshl_b32 s52, s49, 1
    s_add_u32 s52, s52, s50
    v_mfma_f32_16x16x32_bf16 a[176:179], a[136:139], a[48:51], a[176:179]
    s_sub_u32 s52, s52, 1
    s_lshl_b32 s52, s52, 1
    v_mfma_f32_16x16x32_bf16 a[180:183], a[136:139], a[52:55], a[180:183]
    s_add_u32 s52, s52, 1
    s_cmp_lt_u32 s52, 32
    v_mfma_f32_16x16x32_bf16 a[184:187], a[136:139], a[56:59], a[184:187]
    s_cselect_b32 s58, 0x3e8293ee, 1.0
    s_mov_b32 s59, s58
    v_mfma_f32_16x16x32_bf16 a[188:191], a[136:139], a[60:63], a[188:191]
    s_lshl_b32 s76, s52, 17
    s_lshl_b32 s53, s47, 14
    v_mfma_f32_16x16x32_bf16 a[220:223], a[140:143], a[60:63], a[220:223]
    s_add_u32 s76, s76, s53
    s_lshl_b32 s53, s48, 13
    v_mfma_f32_16x16x32_bf16 a[216:219], a[140:143], a[56:59], a[216:219]
    s_add_u32 s76, s76, s53
    v_mul_f32 v144, s58, v144
    v_mfma_f32_16x16x32_bf16 a[212:215], a[140:143], a[52:55], a[212:215]
    v_mul_f32 v145, s58, v145
    v_mul_f32 v146, s58, v146
    v_mfma_f32_16x16x32_bf16 a[208:211], a[140:143], a[48:51], a[208:211]
    v_mul_f32 v147, s58, v147
    v_mul_f32 v176, s58, v176
    v_mfma_f32_16x16x32_bf16 a[204:207], a[140:143], a[44:47], a[204:207]
    v_mul_f32 v177, s58, v177
    v_mul_f32 v178, s58, v178
    v_mfma_f32_16x16x32_bf16 a[200:203], a[140:143], a[40:43], a[200:203]
    v_mul_f32 v179, s58, v179
    v_cvt_pk_bf16_f32 v144, v144, v145
    v_mfma_f32_16x16x32_bf16 a[196:199], a[140:143], a[36:39], a[196:199]
    v_cvt_pk_bf16_f32 v145, v146, v147
    v_cvt_pk_bf16_f32 v146, v176, v177
    v_mfma_f32_16x16x32_bf16 a[192:195], a[140:143], a[32:35], a[192:195]
    v_cvt_pk_bf16_f32 v147, v178, v179
    buffer_store_dwordx4 v[144:147], v13, s[68:71], s76 offen offset:0 sc1
    s_waitcnt lgkmcnt(0)
    v_mfma_f32_16x16x32_bf16 v[208:211], a[88:91], a[0:3], v[208:211]
    ds_read_b128 a[32:35], v1 offset:24576
    v_mul_f32 v148, s58, v148
    v_mfma_f32_16x16x32_bf16 v[212:215], a[88:91], a[4:7], v[212:215]
    ds_read_b128 a[36:39], v1 offset:25600
    v_mul_f32 v149, s58, v149
    v_mfma_f32_16x16x32_bf16 v[216:219], a[88:91], a[8:11], v[216:219]
    ds_read_b128 a[40:43], v1 offset:26624
    v_mul_f32 v150, s58, v150
    v_mfma_f32_16x16x32_bf16 v[220:223], a[88:91], a[12:15], v[220:223]
    ds_read_b128 a[44:47], v1 offset:27648
    v_mul_f32 v151, s58, v151
    v_mfma_f32_16x16x32_bf16 v[224:227], a[88:91], a[16:19], v[224:227]
    ds_read_b128 a[48:51], v1 offset:28672
    v_mul_f32 v180, s58, v180
    v_mfma_f32_16x16x32_bf16 v[228:231], a[88:91], a[20:23], v[228:231]
    ds_read_b128 a[52:55], v1 offset:29696
    v_mul_f32 v181, s58, v181
    v_mfma_f32_16x16x32_bf16 v[232:235], a[88:91], a[24:27], v[232:235]
    ds_read_b128 a[56:59], v1 offset:30720
    v_mul_f32 v182, s58, v182
    v_mfma_f32_16x16x32_bf16 v[236:239], a[88:91], a[28:31], v[236:239]
    ds_read_b128 a[60:63], v1 offset:31744
    v_mul_f32 v183, s58, v183
    v_mfma_f32_16x16x32_bf16 a[156:159], a[92:95], a[28:31], a[156:159]
    ds_read_b64_tr_b16 a[128:129], v8 offset:12288
    v_cvt_pk_bf16_f32 v148, v148, v149
    v_mfma_f32_16x16x32_bf16 a[152:155], a[92:95], a[24:27], a[152:155]
    ds_read_b64_tr_b16 a[130:131], v8 offset:12800
    v_cvt_pk_bf16_f32 v149, v150, v151
    v_mfma_f32_16x16x32_bf16 a[148:151], a[92:95], a[20:23], a[148:151]
    ds_read_b64_tr_b16 a[132:133], v9 offset:12288
    v_cvt_pk_bf16_f32 v150, v180, v181
    v_mfma_f32_16x16x32_bf16 a[144:147], a[92:95], a[16:19], a[144:147]
    ds_read_b64_tr_b16 a[134:135], v9 offset:12800
    v_cvt_pk_bf16_f32 v151, v182, v183
    v_mfma_f32_16x16x32_bf16 v[252:255], a[92:95], a[12:15], v[252:255]
    ds_read_b64_tr_b16 a[136:137], v10 offset:12288
    buffer_store_dwordx4 v[148:151], v13, s[68:71], s76 offen offset:128 sc1
    v_mfma_f32_16x16x32_bf16 v[248:251], a[92:95], a[8:11], v[248:251]
    ds_read_b64_tr_b16 a[138:139], v10 offset:12800
    v_mul_f32 v152, s58, v152
    v_mfma_f32_16x16x32_bf16 v[244:247], a[92:95], a[4:7], v[244:247]
    ds_read_b64_tr_b16 a[140:141], v11 offset:12288
    v_mul_f32 v153, s58, v153
    v_mfma_f32_16x16x32_bf16 v[240:243], a[92:95], a[0:3], v[240:243]
    ds_read_b64_tr_b16 a[142:143], v11 offset:12800
    v_mul_f32 v154, s58, v154
    v_mfma_f32_16x16x32_bf16 a[160:163], a[96:99], a[0:3], a[160:163]
    v_mul_f32 v155, s58, v155
    v_mul_f32 v184, s58, v184
    v_mfma_f32_16x16x32_bf16 a[164:167], a[96:99], a[4:7], a[164:167]
    v_mul_f32 v185, s58, v185
    v_mul_f32 v186, s58, v186
    v_mfma_f32_16x16x32_bf16 a[168:171], a[96:99], a[8:11], a[168:171]
    v_mul_f32 v187, s58, v187
    v_cvt_pk_bf16_f32 v152, v152, v153
    v_mfma_f32_16x16x32_bf16 a[172:175], a[96:99], a[12:15], a[172:175]
    v_cvt_pk_bf16_f32 v153, v154, v155
    v_cvt_pk_bf16_f32 v154, v184, v185
    v_mfma_f32_16x16x32_bf16 a[176:179], a[96:99], a[16:19], a[176:179]
    v_cvt_pk_bf16_f32 v155, v186, v187
    buffer_store_dwordx4 v[152:155], v13, s[68:71], s76 offen offset:2048 sc1
    v_mfma_f32_16x16x32_bf16 a[180:183], a[96:99], a[20:23], a[180:183]
    v_mul_f32 v156, s58, v156
    v_mul_f32 v157, s58, v157
    v_mfma_f32_16x16x32_bf16 a[184:187], a[96:99], a[24:27], a[184:187]
    v_mul_f32 v158, s58, v158
    v_mul_f32 v159, s58, v159
    v_mfma_f32_16x16x32_bf16 a[188:191], a[96:99], a[28:31], a[188:191]
    v_mul_f32 v188, s58, v188
    v_mul_f32 v189, s58, v189
    v_mfma_f32_16x16x32_bf16 a[220:223], a[100:103], a[28:31], a[220:223]
    v_mul_f32 v190, s58, v190
    v_mul_f32 v191, s58, v191
    v_mfma_f32_16x16x32_bf16 a[216:219], a[100:103], a[24:27], a[216:219]
    v_cvt_pk_bf16_f32 v156, v156, v157
    v_cvt_pk_bf16_f32 v157, v158, v159
    v_mfma_f32_16x16x32_bf16 a[212:215], a[100:103], a[20:23], a[212:215]
    v_cvt_pk_bf16_f32 v158, v188, v189
    v_cvt_pk_bf16_f32 v159, v190, v191
    v_mfma_f32_16x16x32_bf16 a[208:211], a[100:103], a[16:19], a[208:211]
    buffer_store_dwordx4 v[156:159], v13, s[68:71], s76 offen offset:2176 sc1
    v_mul_f32 v160, s58, v160
    v_mfma_f32_16x16x32_bf16 a[204:207], a[100:103], a[12:15], a[204:207]
    v_mul_f32 v161, s58, v161
    v_mul_f32 v162, s58, v162
    v_mfma_f32_16x16x32_bf16 a[200:203], a[100:103], a[8:11], a[200:203]
    v_mul_f32 v163, s58, v163
    v_mul_f32 v192, s58, v192
    v_mfma_f32_16x16x32_bf16 a[196:199], a[100:103], a[4:7], a[196:199]
    v_mul_f32 v193, s58, v193
    v_mul_f32 v194, s58, v194
    v_mfma_f32_16x16x32_bf16 a[192:195], a[100:103], a[0:3], a[192:195]
    v_mul_f32 v195, s58, v195
    v_cvt_pk_bf16_f32 v160, v160, v161
    s_waitcnt lgkmcnt(0)
    v_mfma_f32_16x16x32_bf16 v[208:211], a[128:131], a[32:35], v[208:211]
    v_cvt_pk_bf16_f32 v161, v162, v163
    v_cvt_pk_bf16_f32 v162, v192, v193
    v_mfma_f32_16x16x32_bf16 v[212:215], a[128:131], a[36:39], v[212:215]
    v_cvt_pk_bf16_f32 v163, v194, v195
    s_add_u32 s76, s76, 4096
    v_mfma_f32_16x16x32_bf16 v[216:219], a[128:131], a[40:43], v[216:219]
    buffer_store_dwordx4 v[160:163], v13, s[68:71], s76 offen offset:0 sc1
    v_mul_f32 v164, s58, v164
    v_mfma_f32_16x16x32_bf16 v[220:223], a[128:131], a[44:47], v[220:223]
    v_mul_f32 v165, s58, v165
    v_mul_f32 v166, s58, v166
    v_mfma_f32_16x16x32_bf16 v[224:227], a[128:131], a[48:51], v[224:227]
    v_mul_f32 v167, s58, v167
    v_mul_f32 v196, s58, v196
    v_mfma_f32_16x16x32_bf16 v[228:231], a[128:131], a[52:55], v[228:231]
    v_mul_f32 v197, s58, v197
    v_mul_f32 v198, s58, v198
    v_mfma_f32_16x16x32_bf16 v[232:235], a[128:131], a[56:59], v[232:235]
    v_mul_f32 v199, s58, v199
    v_cvt_pk_bf16_f32 v164, v164, v165
    v_mfma_f32_16x16x32_bf16 v[236:239], a[128:131], a[60:63], v[236:239]
    v_cvt_pk_bf16_f32 v165, v166, v167
    v_cvt_pk_bf16_f32 v166, v196, v197
    v_mfma_f32_16x16x32_bf16 a[156:159], a[132:135], a[60:63], a[156:159]
    v_cvt_pk_bf16_f32 v167, v198, v199
    buffer_store_dwordx4 v[164:167], v13, s[68:71], s76 offen offset:128 sc1
    v_mfma_f32_16x16x32_bf16 a[152:155], a[132:135], a[56:59], a[152:155]
    v_mul_f32 v168, s58, v168
    v_mul_f32 v169, s58, v169
    v_mfma_f32_16x16x32_bf16 a[148:151], a[132:135], a[52:55], a[148:151]
    v_mul_f32 v170, s58, v170
    v_mul_f32 v171, s58, v171
    v_mfma_f32_16x16x32_bf16 a[144:147], a[132:135], a[48:51], a[144:147]
    v_mul_f32 v200, s58, v200
    v_mul_f32 v201, s58, v201
    v_mfma_f32_16x16x32_bf16 v[252:255], a[132:135], a[44:47], v[252:255]
    v_mul_f32 v202, s58, v202
    v_mul_f32 v203, s58, v203
    v_mfma_f32_16x16x32_bf16 v[248:251], a[132:135], a[40:43], v[248:251]
    v_cvt_pk_bf16_f32 v168, v168, v169
    v_cvt_pk_bf16_f32 v169, v170, v171
    v_mfma_f32_16x16x32_bf16 v[244:247], a[132:135], a[36:39], v[244:247]
    v_cvt_pk_bf16_f32 v170, v200, v201
    v_cvt_pk_bf16_f32 v171, v202, v203
    v_mfma_f32_16x16x32_bf16 v[240:243], a[132:135], a[32:35], v[240:243]
    buffer_store_dwordx4 v[168:171], v13, s[68:71], s76 offen offset:2048 sc1
    v_mul_f32 v172, s58, v172
    v_mfma_f32_16x16x32_bf16 a[160:163], a[136:139], a[32:35], a[160:163]
    v_mul_f32 v173, s58, v173
    v_mul_f32 v174, s58, v174
    v_mfma_f32_16x16x32_bf16 a[164:167], a[136:139], a[36:39], a[164:167]
    v_mul_f32 v175, s58, v175
    v_mul_f32 v204, s58, v204
    v_mfma_f32_16x16x32_bf16 a[168:171], a[136:139], a[40:43], a[168:171]
    v_mul_f32 v205, s58, v205
    v_mul_f32 v206, s58, v206
    v_mfma_f32_16x16x32_bf16 a[172:175], a[136:139], a[44:47], a[172:175]
    v_mul_f32 v207, s58, v207
    v_cvt_pk_bf16_f32 v172, v172, v173
    v_mfma_f32_16x16x32_bf16 a[176:179], a[136:139], a[48:51], a[176:179]
    v_cvt_pk_bf16_f32 v173, v174, v175
    v_cvt_pk_bf16_f32 v174, v204, v205
    v_mfma_f32_16x16x32_bf16 a[180:183], a[136:139], a[52:55], a[180:183]
    v_cvt_pk_bf16_f32 v175, v206, v207
    buffer_store_dwordx4 v[172:175], v13, s[68:71], s76 offen offset:2176 sc1
    v_mfma_f32_16x16x32_bf16 a[184:187], a[136:139], a[56:59], a[184:187]
    s_lshl_b32 s52, s50, 1
    s_add_u32 s52, s52, s49
    v_mfma_f32_16x16x32_bf16 a[188:191], a[136:139], a[60:63], a[188:191]
    s_cmp_lt_u32 s52, 32
    s_cselect_b32 s58, 0x3e8293ee, 1.0
    v_mfma_f32_16x16x32_bf16 a[220:223], a[140:143], a[60:63], a[220:223]
    s_mov_b32 s59, s58
    s_lshl_b32 s76, s52, 17
    v_mfma_f32_16x16x32_bf16 a[216:219], a[140:143], a[56:59], a[216:219]
    s_lshl_b32 s53, s47, 14
    s_add_u32 s76, s76, s53
    v_mfma_f32_16x16x32_bf16 a[212:215], a[140:143], a[52:55], a[212:215]
    s_lshl_b32 s53, s48, 13
    s_add_u32 s76, s76, s53
    v_mfma_f32_16x16x32_bf16 a[208:211], a[140:143], a[48:51], a[208:211]
    v_mul_f32 v16, s58, v16
    v_mul_f32 v17, s58, v17
    v_mfma_f32_16x16x32_bf16 a[204:207], a[140:143], a[44:47], a[204:207]
    v_mul_f32 v18, s58, v18
    v_mul_f32 v19, s58, v19
    v_mfma_f32_16x16x32_bf16 a[200:203], a[140:143], a[40:43], a[200:203]
    v_mul_f32 v48, s58, v48
    v_mul_f32 v49, s58, v49
    v_mfma_f32_16x16x32_bf16 a[196:199], a[140:143], a[36:39], a[196:199]
    v_mul_f32 v50, s58, v50
    v_mul_f32 v51, s58, v51
    v_mfma_f32_16x16x32_bf16 a[192:195], a[140:143], a[32:35], a[192:195]
    v_cvt_pk_bf16_f32 v16, v16, v17
    v_cvt_pk_bf16_f32 v17, v18, v19
    v_cvt_pk_bf16_f32 v18, v48, v49
    v_cvt_pk_bf16_f32 v19, v50, v51
    buffer_store_dwordx4 v[16:19], v13, s[68:71], s76 offen offset:0 sc1
    v_mul_f32 v20, s58, v20
    v_mul_f32 v21, s58, v21
    v_mul_f32 v22, s58, v22
    v_mul_f32 v23, s58, v23
    v_mul_f32 v52, s58, v52
    v_mul_f32 v53, s58, v53
    v_mul_f32 v54, s58, v54
    v_mul_f32 v55, s58, v55
    v_cvt_pk_bf16_f32 v20, v20, v21
    v_cvt_pk_bf16_f32 v21, v22, v23
    v_cvt_pk_bf16_f32 v22, v52, v53
    v_cvt_pk_bf16_f32 v23, v54, v55
    buffer_store_dwordx4 v[20:23], v13, s[68:71], s76 offen offset:128 sc1
    v_mul_f32 v24, s58, v24
    v_mul_f32 v25, s58, v25
    v_mul_f32 v26, s58, v26
    v_mul_f32 v27, s58, v27
    v_mul_f32 v56, s58, v56
    v_mul_f32 v57, s58, v57
    v_mul_f32 v58, s58, v58
    v_mul_f32 v59, s58, v59
    v_cvt_pk_bf16_f32 v24, v24, v25
    v_cvt_pk_bf16_f32 v25, v26, v27
    v_cvt_pk_bf16_f32 v26, v56, v57
    v_cvt_pk_bf16_f32 v27, v58, v59
    buffer_store_dwordx4 v[24:27], v13, s[68:71], s76 offen offset:2048 sc1
    v_mul_f32 v28, s58, v28
    v_mul_f32 v29, s58, v29
    v_mul_f32 v30, s58, v30
    v_mul_f32 v31, s58, v31
    v_mul_f32 v60, s58, v60
    v_mul_f32 v61, s58, v61
    v_mul_f32 v62, s58, v62
    v_mul_f32 v63, s58, v63
    v_cvt_pk_bf16_f32 v28, v28, v29
    v_cvt_pk_bf16_f32 v29, v30, v31
    v_cvt_pk_bf16_f32 v30, v60, v61
    v_cvt_pk_bf16_f32 v31, v62, v63
    buffer_store_dwordx4 v[28:31], v13, s[68:71], s76 offen offset:2176 sc1
    v_mul_f32 v32, s58, v32
    v_mul_f32 v33, s58, v33
    v_mul_f32 v34, s58, v34
    v_mul_f32 v35, s58, v35
    v_mul_f32 v64, s58, v64
    v_mul_f32 v65, s58, v65
    v_mul_f32 v66, s58, v66
    v_mul_f32 v67, s58, v67
    v_cvt_pk_bf16_f32 v32, v32, v33
    v_cvt_pk_bf16_f32 v33, v34, v35
    v_cvt_pk_bf16_f32 v34, v64, v65
    v_cvt_pk_bf16_f32 v35, v66, v67
    s_add_u32 s76, s76, 4096
    buffer_store_dwordx4 v[32:35], v13, s[68:71], s76 offen offset:0 sc1
    v_mul_f32 v36, s58, v36
    v_mul_f32 v37, s58, v37
    v_mul_f32 v38, s58, v38
    v_mul_f32 v39, s58, v39
    v_mul_f32 v68, s58, v68
    v_mul_f32 v69, s58, v69
    v_mul_f32 v70, s58, v70
    v_mul_f32 v71, s58, v71
    v_cvt_pk_bf16_f32 v36, v36, v37
    v_cvt_pk_bf16_f32 v37, v38, v39
    v_cvt_pk_bf16_f32 v38, v68, v69
    v_cvt_pk_bf16_f32 v39, v70, v71
    buffer_store_dwordx4 v[36:39], v13, s[68:71], s76 offen offset:128 sc1
    v_mul_f32 v40, s58, v40
    v_mul_f32 v41, s58, v41
    v_mul_f32 v42, s58, v42
    v_mul_f32 v43, s58, v43
    v_mul_f32 v72, s58, v72
    v_mul_f32 v73, s58, v73
    v_mul_f32 v74, s58, v74
    v_mul_f32 v75, s58, v75
    v_cvt_pk_bf16_f32 v40, v40, v41
    v_cvt_pk_bf16_f32 v41, v42, v43
    v_cvt_pk_bf16_f32 v42, v72, v73
    v_cvt_pk_bf16_f32 v43, v74, v75
    buffer_store_dwordx4 v[40:43], v13, s[68:71], s76 offen offset:2048 sc1
    v_mul_f32 v44, s58, v44
    v_mul_f32 v45, s58, v45
    v_mul_f32 v46, s58, v46
    v_mul_f32 v47, s58, v47
    v_mul_f32 v76, s58, v76
    v_mul_f32 v77, s58, v77
    v_mul_f32 v78, s58, v78
    v_mul_f32 v79, s58, v79
    v_cvt_pk_bf16_f32 v44, v44, v45
    v_cvt_pk_bf16_f32 v45, v46, v47
    v_cvt_pk_bf16_f32 v46, v76, v77
    v_cvt_pk_bf16_f32 v47, v78, v79
    buffer_store_dwordx4 v[44:47], v13, s[68:71], s76 offen offset:2176 sc1
    s_waitcnt vmcnt(0)
    s_barrier
    s_cmp_lg_u32 s36, 3
    s_cbranch_scc1 L_g1_noq_b
    s_add_u32 s96, s4, 20971520
    s_addc_u32 s97, s5, 0
    s_mov_b32 s98, 40960
    s_mov_b32 s99, 0x00020000
    s_lshl_b32 s52, s45, 3
    s_add_u32 s52, s52, s46
    s_lshl_b32 s52, s52, 9
    s_add_u32 s52, s52, 16384
    v_mov_b32 v1, 1
    v_lshlrev_b32 v2, 7, v0
    s_mov_b64 exec, 15
    buffer_atomic_add v1, v2, s[96:99], s52 offen sc1
    s_mov_b64 exec, -1
L_g1_noq_b:
    s_nop 3
    v_accvgpr_read_b32 v112, a160
    v_accvgpr_read_b32 v113, a161
    v_accvgpr_read_b32 v114, a162
    v_accvgpr_read_b32 v115, a163
    v_max_f32 v208, 0, v208
    v_max_f32 v209, 0, v209
    v_max_f32 v210, 0, v210
    v_max_f32 v211, 0, v211
    v_pk_mul_f32 v[208:209], v[208:209], v[112:113]
    v_pk_mul_f32 v[210:211], v[210:211], v[114:115]
    v_accvgpr_read_b32 v116, a192
    v_accvgpr_read_b32 v117, a193
    v_accvgpr_read_b32 v118, a194
    v_accvgpr_read_b32 v119, a195
    v_max_f32 v240, 0, v240
    v_max_f32 v241, 0, v241
    v_max_f32 v242, 0, v242
    v_max_f32 v243, 0, v243
    v_pk_mul_f32 v[240:241], v[240:241], v[116:117]
    v_pk_mul_f32 v[242:243], v[242:243], v[118:119]
    v_cvt_pk_bf16_f32 v208, v208, v209
    v_cvt_pk_bf16_f32 v209, v210, v211
    v_cvt_pk_bf16_f32 v210, v240, v241
    v_cvt_pk_bf16_f32 v211, v242, v243
    v_accvgpr_read_b32 v120, a164
    v_accvgpr_read_b32 v121, a165
    v_accvgpr_read_b32 v122, a166
    v_accvgpr_read_b32 v123, a167
    v_max_f32 v212, 0, v212
    v_max_f32 v213, 0, v213
    v_max_f32 v214, 0, v214
    v_max_f32 v215, 0, v215
    v_pk_mul_f32 v[212:213], v[212:213], v[120:121]
    v_pk_mul_f32 v[214:215], v[214:215], v[122:123]
    v_accvgpr_read_b32 v124, a196
    v_accvgpr_read_b32 v125, a197
    v_accvgpr_read_b32 v126, a198
    v_accvgpr_read_b32 v127, a199
    v_max_f32 v244, 0, v244
    v_max_f32 v245, 0, v245
    v_max_f32 v246, 0, v246
    v_max_f32 v247, 0, v247
    v_pk_mul_f32 v[244:245], v[244:245], v[124:125]
    v_pk_mul_f32 v[246:247], v[246:247], v[126:127]
    v_cvt_pk_bf16_f32 v212, v212, v213
    v_cvt_pk_bf16_f32 v213, v214, v215
    v_cvt_pk_bf16_f32 v214, v244, v245
    v_cvt_pk_bf16_f32 v215, v246, v247
    v_accvgpr_read_b32 v128, a168
    v_accvgpr_read_b32 v129, a169
    v_accvgpr_read_b32 v130, a170
    v_accvgpr_read_b32 v131, a171
    v_max_f32 v216, 0, v216
    v_max_f32 v217, 0, v217
    v_max_f32 v218, 0, v218
    v_max_f32 v219, 0, v219
    v_pk_mul_f32 v[216:217], v[216:217], v[128:129]
    v_pk_mul_f32 v[218:219], v[218:219], v[130:131]
    v_accvgpr_read_b32 v132, a200
    v_accvgpr_read_b32 v133, a201
    v_accvgpr_read_b32 v134, a202
    v_accvgpr_read_b32 v135, a203
    v_max_f32 v248, 0, v248
    v_max_f32 v249, 0, v249
    v_max_f32 v250, 0, v250
    v_max_f32 v251, 0, v251
    v_pk_mul_f32 v[248:249], v[248:249], v[132:133]
    v_pk_mul_f32 v[250:251], v[250:251], v[134:135]
    v_cvt_pk_bf16_f32 v216, v216, v217
    v_cvt_pk_bf16_f32 v217, v218, v219
    v_cvt_pk_bf16_f32 v218, v248, v249
    v_cvt_pk_bf16_f32 v219, v250, v251
    v_accvgpr_read_b32 v136, a172
    v_accvgpr_read_b32 v137, a173
    v_accvgpr_read_b32 v138, a174
    v_accvgpr_read_b32 v139, a175
    v_max_f32 v220, 0, v220
    v_max_f32 v221, 0, v221
    v_max_f32 v222, 0, v222
    v_max_f32 v223, 0, v223
    v_pk_mul_f32 v[220:221], v[220:221], v[136:137]
    v_pk_mul_f32 v[222:223], v[222:223], v[138:139]
    v_accvgpr_read_b32 v140, a204
    v_accvgpr_read_b32 v141, a205
    v_accvgpr_read_b32 v142, a206
    v_accvgpr_read_b32 v143, a207
    v_max_f32 v252, 0, v252
    v_max_f32 v253, 0, v253
    v_max_f32 v254, 0, v254
    v_max_f32 v255, 0, v255
    v_pk_mul_f32 v[252:253], v[252:253], v[140:141]
    v_pk_mul_f32 v[254:255], v[254:255], v[142:143]
    v_cvt_pk_bf16_f32 v220, v220, v221
    v_cvt_pk_bf16_f32 v221, v222, v223
    v_cvt_pk_bf16_f32 v222, v252, v253
    v_cvt_pk_bf16_f32 v223, v254, v255
    v_accvgpr_read_b32 v112, a176
    v_accvgpr_read_b32 v113, a177
    v_accvgpr_read_b32 v114, a178
    v_accvgpr_read_b32 v115, a179
    v_max_f32 v224, 0, v224
    v_max_f32 v225, 0, v225
    v_max_f32 v226, 0, v226
    v_max_f32 v227, 0, v227
    v_pk_mul_f32 v[224:225], v[224:225], v[112:113]
    v_pk_mul_f32 v[226:227], v[226:227], v[114:115]
    v_accvgpr_read_b32 v116, a144
    v_accvgpr_read_b32 v117, a145
    v_accvgpr_read_b32 v118, a146
    v_accvgpr_read_b32 v119, a147
    v_accvgpr_read_b32 v120, a208
    v_accvgpr_read_b32 v121, a209
    v_accvgpr_read_b32 v122, a210
    v_accvgpr_read_b32 v123, a211
    v_max_f32 v116, 0, v116
    v_max_f32 v117, 0, v117
    v_max_f32 v118, 0, v118
    v_max_f32 v119, 0, v119
    v_pk_mul_f32 v[116:117], v[116:117], v[120:121]
    v_pk_mul_f32 v[118:119], v[118:119], v[122:123]
    v_cvt_pk_bf16_f32 v224, v224, v225
    v_cvt_pk_bf16_f32 v225, v226, v227
    v_cvt_pk_bf16_f32 v226, v116, v117
    v_cvt_pk_bf16_f32 v227, v118, v119
    v_accvgpr_read_b32 v124, a180
    v_accvgpr_read_b32 v125, a181
    v_accvgpr_read_b32 v126, a182
    v_accvgpr_read_b32 v127, a183
    v_max_f32 v228, 0, v228
    v_max_f32 v229, 0, v229
    v_max_f32 v230, 0, v230
    v_max_f32 v231, 0, v231
    v_pk_mul_f32 v[228:229], v[228:229], v[124:125]
    v_pk_mul_f32 v[230:231], v[230:231], v[126:127]
    v_accvgpr_read_b32 v128, a148
    v_accvgpr_read_b32 v129, a149
    v_accvgpr_read_b32 v130, a150
    v_accvgpr_read_b32 v131, a151
    v_accvgpr_read_b32 v132, a212
    v_accvgpr_read_b32 v133, a213
    v_accvgpr_read_b32 v134, a214
    v_accvgpr_read_b32 v135, a215
    v_max_f32 v128, 0, v128
    v_max_f32 v129, 0, v129
    v_max_f32 v130, 0, v130
    v_max_f32 v131, 0, v131
    v_pk_mul_f32 v[128:129], v[128:129], v[132:133]
    v_pk_mul_f32 v[130:131], v[130:131], v[134:135]
    v_cvt_pk_bf16_f32 v228, v228, v229
    v_cvt_pk_bf16_f32 v229, v230, v231
    v_cvt_pk_bf16_f32 v230, v128, v129
    v_cvt_pk_bf16_f32 v231, v130, v131
    v_accvgpr_read_b32 v136, a184
    v_accvgpr_read_b32 v137, a185
    v_accvgpr_read_b32 v138, a186
    v_accvgpr_read_b32 v139, a187
    v_max_f32 v232, 0, v232
    v_max_f32 v233, 0, v233
    v_max_f32 v234, 0, v234
    v_max_f32 v235, 0, v235
    v_pk_mul_f32 v[232:233], v[232:233], v[136:137]
    v_pk_mul_f32 v[234:235], v[234:235], v[138:139]
    v_accvgpr_read_b32 v140, a152
    v_accvgpr_read_b32 v141, a153
    v_accvgpr_read_b32 v142, a154
    v_accvgpr_read_b32 v143, a155
    v_accvgpr_read_b32 v112, a216
    v_accvgpr_read_b32 v113, a217
    v_accvgpr_read_b32 v114, a218
    v_accvgpr_read_b32 v115, a219
    v_max_f32 v140, 0, v140
    v_max_f32 v141, 0, v141
    v_max_f32 v142, 0, v142
    v_max_f32 v143, 0, v143
    v_pk_mul_f32 v[140:141], v[140:141], v[112:113]
    v_pk_mul_f32 v[142:143], v[142:143], v[114:115]
    v_cvt_pk_bf16_f32 v232, v232, v233
    v_cvt_pk_bf16_f32 v233, v234, v235
    v_cvt_pk_bf16_f32 v234, v140, v141
    v_cvt_pk_bf16_f32 v235, v142, v143
    v_accvgpr_read_b32 v116, a188
    v_accvgpr_read_b32 v117, a189
    v_accvgpr_read_b32 v118, a190
    v_accvgpr_read_b32 v119, a191
    v_max_f32 v236, 0, v236
    v_max_f32 v237, 0, v237
    v_max_f32 v238, 0, v238
    v_max_f32 v239, 0, v239
    v_pk_mul_f32 v[236:237], v[236:237], v[116:117]
    v_pk_mul_f32 v[238:239], v[238:239], v[118:119]
    v_accvgpr_read_b32 v120, a156
    v_accvgpr_read_b32 v121, a157
    v_accvgpr_read_b32 v122, a158
    v_accvgpr_read_b32 v123, a159
    v_accvgpr_read_b32 v124, a220
    v_accvgpr_read_b32 v125, a221
    v_accvgpr_read_b32 v126, a222
    v_accvgpr_read_b32 v127, a223
    v_max_f32 v120, 0, v120
    v_max_f32 v121, 0, v121
    v_max_f32 v122, 0, v122
    v_max_f32 v123, 0, v123
    v_pk_mul_f32 v[120:121], v[120:121], v[124:125]
    v_pk_mul_f32 v[122:123], v[122:123], v[126:127]
    v_cvt_pk_bf16_f32 v236, v236, v237
    v_cvt_pk_bf16_f32 v237, v238, v239
    v_cvt_pk_bf16_f32 v238, v120, v121
    v_cvt_pk_bf16_f32 v239, v122, v123
    v_accvgpr_write_b32 a0, v208
    v_accvgpr_write_b32 a1, v209
    v_accvgpr_write_b32 a2, v210
    v_accvgpr_write_b32 a3, v211
    v_accvgpr_write_b32 a4, v212
    v_accvgpr_write_b32 a5, v213
    v_accvgpr_write_b32 a6, v214
    v_accvgpr_write_b32 a7, v215
    v_accvgpr_write_b32 a8, v216
    v_accvgpr_write_b32 a9, v217
    v_accvgpr_write_b32 a10, v218
    v_accvgpr_write_b32 a11, v219
    v_accvgpr_write_b32 a12, v220
    v_accvgpr_write_b32 a13, v221
    v_accvgpr_write_b32 a14, v222
    v_accvgpr_write_b32 a15, v223
    v_accvgpr_write_b32 a16, v224
    v_accvgpr_write_b32 a17, v225
    v_accvgpr_write_b32 a18, v226
    v_accvgpr_write_b32 a19, v227
    v_accvgpr_write_b32 a20, v228
    v_accvgpr_write_b32 a21, v229
    v_accvgpr_write_b32 a22, v230
    v_accvgpr_write_b32 a23, v231
    v_accvgpr_write_b32 a24, v232
    v_accvgpr_write_b32 a25, v233
    v_accvgpr_write_b32 a26, v234
    v_accvgpr_write_b32 a27, v235
    v_accvgpr_write_b32 a28, v236
    v_accvgpr_write_b32 a29, v237
    v_accvgpr_write_b32 a30, v238
    v_accvgpr_write_b32 a31, v239
    s_lshl_b32 s52, s51, 1
    s_add_u32 s52, s52, s49
    s_lshl_b32 s76, s47, 1
    s_add_u32 s76, s76, s48
    s_mul_i32 s76, s76, 112
    s_add_u32 s76, s76, s52
    s_lshl_b32 s76, s76, 13
    s_mov_b32 s70, s76
    s_mov_b32 s71, 0x40000000
    s_mov_b32 s14, s47
    s_branch L_p2_entry
L_g1_head_v:
    s_waitcnt vmcnt(0) lgkmcnt(0)
    s_barrier
    v_mfma_f32_16x16x32_bf16 v[16:19], a[0:3], a[64:67], v[16:19]
    ds_read_b128 a[32:35], v1 offset:8192
    v_mfma_f32_16x16x32_bf16 v[20:23], a[4:7], a[64:67], v[20:23]
    ds_read_b128 a[36:39], v1 offset:9216
    v_mfma_f32_16x16x32_bf16 v[24:27], a[8:11], a[64:67], v[24:27]
    s_add_u32 m0, s42, 16384
    v_mfma_f32_16x16x32_bf16 v[28:31], a[12:15], a[64:67], v[28:31]
    buffer_load_dwordx4 v12, s[12:15], s37 offen offset:0 lds
    v_mfma_f32_16x16x32_bf16 v[32:35], a[16:19], a[64:67], v[32:35]
    ds_read_b128 a[40:43], v1 offset:10240
    v_mfma_f32_16x16x32_bf16 v[36:39], a[20:23], a[64:67], v[36:39]
    ds_read_b128 a[44:47], v1 offset:11264
    v_mfma_f32_16x16x32_bf16 v[40:43], a[24:27], a[64:67], v[40:43]
    ds_read_b128 a[48:51], v1 offset:12288
    v_mfma_f32_16x16x32_bf16 v[44:47], a[28:31], a[64:67], v[44:47]
    buffer_load_dwordx4 v12, s[12:15], s37 offen offset:1024 lds
    v_mfma_f32_16x16x32_bf16 v[76:79], a[28:31], a[68:71], v[76:79]
    ds_read_b128 a[52:55], v1 offset:13312
    v_mfma_f32_16x16x32_bf16 v[72:75], a[24:27], a[68:71], v[72:75]
    ds_read_b128 a[56:59], v1 offset:14336
    v_mfma_f32_16x16x32_bf16 v[68:71], a[20:23], a[68:71], v[68:71]
    ds_read_b128 a[60:63], v1 offset:15360
    v_mfma_f32_16x16x32_bf16 v[64:67], a[16:19], a[68:71], v[64:67]
    buffer_load_dwordx4 v12, s[12:15], s37 offen offset:2048 lds
    v_mfma_f32_16x16x32_bf16 v[60:63], a[12:15], a[68:71], v[60:63]
    ds_read_b64_tr_b16 a[104:105], v2 offset:4096
    v_mfma_f32_16x16x32_bf16 v[56:59], a[8:11], a[68:71], v[56:59]
    ds_read_b64_tr_b16 a[106:107], v2 offset:4608
    v_mfma_f32_16x16x32_bf16 v[52:55], a[4:7], a[68:71], v[52:55]
    ds_read_b64_tr_b16 a[108:109], v3 offset:4096
    v_mfma_f32_16x16x32_bf16 v[48:51], a[0:3], a[68:71], v[48:51]
    buffer_load_dwordx4 v12, s[12:15], s37 offen offset:3072 lds
    v_mfma_f32_16x16x32_bf16 v[80:83], a[72:75], a[0:3], v[80:83]
    ds_read_b64_tr_b16 a[110:111], v3 offset:4608
    v_mfma_f32_16x16x32_bf16 v[84:87], a[72:75], a[4:7], v[84:87]
    ds_read_b64_tr_b16 a[112:113], v4 offset:4096
    v_mfma_f32_16x16x32_bf16 v[88:91], a[72:75], a[8:11], v[88:91]
    s_add_u32 s37, s37, 0x4000
    s_add_u32 m0, s43, 8192
    v_mfma_f32_16x16x32_bf16 v[92:95], a[72:75], a[12:15], v[92:95]
    buffer_load_dwordx4 v13, s[16:19], s38 offen lds
    v_mfma_f32_16x16x32_bf16 v[96:99], a[72:75], a[16:19], v[96:99]
    ds_read_b64_tr_b16 a[114:115], v4 offset:4608
    v_mfma_f32_16x16x32_bf16 v[100:103], a[72:75], a[20:23], v[100:103]
    ds_read_b64_tr_b16 a[116:117], v5 offset:4096
    v_mfma_f32_16x16x32_bf16 v[104:107], a[72:75], a[24:27], v[104:107]
    s_add_u32 m0, s43, 24576
    v_mfma_f32_16x16x32_bf16 v[108:111], a[72:75], a[28:31], v[108:111]
    buffer_load_dwordx4 v14, s[20:23], s39 offen lds
    v_mfma_f32_16x16x32_bf16 v[140:143], a[76:79], a[28:31], v[140:143]
    ds_read_b64_tr_b16 a[118:119], v5 offset:4608
    v_mfma_f32_16x16x32_bf16 v[136:139], a[76:79], a[24:27], v[136:139]
    ds_read_b64_tr_b16 a[120:121], v6 offset:4096
    v_mfma_f32_16x16x32_bf16 v[132:135], a[76:79], a[20:23], v[132:135]
    s_add_u32 m0, s43, 40960
    v_mfma_f32_16x16x32_bf16 v[128:131], a[76:79], a[16:19], v[128:131]
    buffer_load_dwordx4 v15, s[24:27], s40 offen lds
    v_mfma_f32_16x16x32_bf16 v[124:127], a[76:79], a[12:15], v[124:127]
    ds_read_b64_tr_b16 a[122:123], v6 offset:4608
    v_mfma_f32_16x16x32_bf16 v[120:123], a[76:79], a[8:11], v[120:123]
    ds_read_b64_tr_b16 a[124:125], v7 offset:4096
    v_mfma_f32_16x16x32_bf16 v[116:119], a[76:79], a[4:7], v[116:119]
    s_add_u32 m0, s43, 57344
    v_mfma_f32_16x16x32_bf16 v[112:115], a[76:79], a[0:3], v[112:115]
    buffer_load_dwordx4 v14, s[28:31], s39 offen lds
    v_mfma_f32_16x16x32_bf16 v[144:147], a[80:83], a[0:3], v[144:147]
    ds_read_b64_tr_b16 a[126:127], v7 offset:4608
    v_mfma_f32_16x16x32_bf16 v[148:151], a[80:83], a[4:7], v[148:151]
    ds_read_b64_tr_b16 a[128:129], v8 offset:4096
    v_mfma_f32_16x16x32_bf16 v[152:155], a[80:83], a[8:11], v[152:155]
    s_add_u32 m0, s43, 73728
    v_mfma_f32_16x16x32_bf16 v[156:159], a[80:83], a[12:15], v[156:159]
    buffer_load_dwordx4 v15, s[32:35], s40 offen lds
    v_mfma_f32_16x16x32_bf16 v[160:163], a[80:83], a[16:19], v[160:163]
    ds_read_b64_tr_b16 a[130:131], v8 offset:4608
    v_mfma_f32_16x16x32_bf16 v[164:167], a[80:83], a[20:23], v[164:167]
    s_add_u32 s38, s38, 196608
    s_add_u32 s39, s39, s41
    v_mfma_f32_16x16x32_bf16 v[168:171], a[80:83], a[24:27], v[168:171]
    s_add_u32 s40, s40, 229376
    s_add_u32 m0, s42, 24576
    v_mfma_f32_16x16x32_bf16 v[172:175], a[80:83], a[28:31], v[172:175]
    buffer_load_dwordx4 v12, s[12:15], s37 offen offset:0 lds
    v_mfma_f32_16x16x32_bf16 v[204:207], a[84:87], a[28:31], v[204:207]
    ds_read_b64_tr_b16 a[132:133], v9 offset:4096
    v_mfma_f32_16x16x32_bf16 v[200:203], a[84:87], a[24:27], v[200:203]
    ds_read_b64_tr_b16 a[134:135], v9 offset:4608
    v_mfma_f32_16x16x32_bf16 v[196:199], a[84:87], a[20:23], v[196:199]
    ds_read_b64_tr_b16 a[136:137], v10 offset:4096
    v_mfma_f32_16x16x32_bf16 v[192:195], a[84:87], a[16:19], v[192:195]
    buffer_load_dwordx4 v12, s[12:15], s37 offen offset:1024 lds
    v_mfma_f32_16x16x32_bf16 v[188:191], a[84:87], a[12:15], v[188:191]
    ds_read_b64_tr_b16 a[138:139], v10 offset:4608
    v_mfma_f32_16x16x32_bf16 v[184:187], a[84:87], a[8:11], v[184:187]
    ds_read_b64_tr_b16 a[140:141], v11 offset:4096
    v_mfma_f32_16x16x32_bf16 v[180:183], a[84:87], a[4:7], v[180:183]
    ds_read_b64_tr_b16 a[142:143], v11 offset:4608
    v_mfma_f32_16x16x32_bf16 v[176:179], a[84:87], a[0:3], v[176:179]
    buffer_load_dwordx4 v12, s[12:15], s37 offen offset:2048 lds
    v_mfma_f32_16x16x32_bf16 v[208:211], a[88:91], a[0:3], v[208:211]
    v_mfma_f32_16x16x32_bf16 v[212:215], a[88:91], a[4:7], v[212:215]
    v_mfma_f32_16x16x32_bf16 v[216:219], a[88:91], a[8:11], v[216:219]
    v_mfma_f32_16x16x32_bf16 v[220:223], a[88:91], a[12:15], v[220:223]
    buffer_load_dwordx4 v12, s[12:15], s37 offen offset:3072 lds
    v_mfma_f32_16x16x32_bf16 v[224:227], a[88:91], a[16:19], v[224:227]
    v_mfma_f32_16x16x32_bf16 v[228:231], a[88:91], a[20:23], v[228:231]
    v_mfma_f32_16x16x32_bf16 v[232:235], a[88:91], a[24:27], v[232:235]
    s_add_u32 s37, s37, 0x4000
    s_add_u32 m0, s43, 12288
    v_mfma_f32_16x16x32_bf16 v[236:239], a[88:91], a[28:31], v[236:239]
    buffer_load_dwordx4 v13, s[16:19], s38 offen lds
    v_mfma_f32_16x16x32_bf16 a[156:159], a[92:95], a[28:31], a[156:159]
    v_mfma_f32_16x16x32_bf16 a[152:155], a[92:95], a[24:27], a[152:155]
    v_mfma_f32_16x16x32_bf16 a[148:151], a[92:95], a[20:23], a[148:151]
    s_add_u32 m0, s43, 28672
    v_mfma_f32_16x16x32_bf16 a[144:147], a[92:95], a[16:19], a[144:147]
    buffer_load_dwordx4 v14, s[20:23], s39 offen lds
    v_mfma_f32_16x16x32_bf16 v[252:255], a[92:95], a[12:15], v[252:255]
    v_mfma_f32_16x16x32_bf16 v[248:251], a[92:95], a[8:11], v[248:251]
    v_mfma_f32_16x16x32_bf16 v[244:247], a[92:95], a[4:7], v[244:247]
    s_add_u32 m0, s43, 45056
    v_mfma_f32_16x16x32_bf16 v[240:243], a[92:95], a[0:3], v[240:243]
    buffer_load_dwordx4 v15, s[24:27], s40 offen lds
    v_mfma_f32_16x16x32_bf16 a[160:163], a[96:99], a[0:3], a[160:163]
    v_mfma_f32_16x16x32_bf16 a[164:167], a[96:99], a[4:7], a[164:167]
    v_mfma_f32_16x16x32_bf16 a[168:171], a[96:99], a[8:11], a[168:171]
    s_add_u32 m0, s43, 61440
    v_mfma_f32_16x16x32_bf16 a[172:175], a[96:99], a[12:15], a[172:175]
    buffer_load_dwordx4 v14, s[28:31], s39 offen lds
    v_mfma_f32_16x16x32_bf16 a[176:179], a[96:99], a[16:19], a[176:179]
    v_mfma_f32_16x16x32_bf16 a[180:183], a[96:99], a[20:23], a[180:183]
    v_mfma_f32_16x16x32_bf16 a[184:187], a[96:99], a[24:27], a[184:187]
    s_add_u32 m0, s43, 77824
    v_mfma_f32_16x16x32_bf16 a[188:191], a[96:99], a[28:31], a[188:191]
    buffer_load_dwordx4 v15, s[32:35], s40 offen lds
    v_mfma_f32_16x16x32_bf16 a[220:223], a[100:103], a[28:31], a[220:223]
    s_add_u32 s38, s38, 196608
    v_mfma_f32_16x16x32_bf16 a[216:219], a[100:103], a[24:27], a[216:219]
    s_add_u32 s39, s39, s41
    v_mfma_f32_16x16x32_bf16 a[212:215], a[100:103], a[20:23], a[212:215]
    s_add_u32 s40, s40, 229376
    v_mfma_f32_16x16x32_bf16 a[208:211], a[100:103], a[16:19], a[208:211]
    v_mfma_f32_16x16x32_bf16 a[204:207], a[100:103], a[12:15], a[204:207]
    v_mfma_f32_16x16x32_bf16 a[200:203], a[100:103], a[8:11], a[200:203]
    v_mfma_f32_16x16x32_bf16 a[196:199], a[100:103], a[4:7], a[196:199]
    v_mfma_f32_16x16x32_bf16 a[192:195], a[100:103], a[0:3], a[192:195]
    s_waitcnt vmcnt(9) lgkmcnt(0)
    s_barrier
    v_mfma_f32_16x16x32_bf16 v[16:19], a[32:35], a[104:107], v[16:19]
    ds_read_b128 a[0:3], v1 offset:16384
    v_mfma_f32_16x16x32_bf16 v[20:23], a[36:39], a[104:107], v[20:23]
    ds_read_b128 a[4:7], v1 offset:17408
    v_mfma_f32_16x16x32_bf16 v[24:27], a[40:43], a[104:107], v[24:27]
    s_add_u32 m0, s42, 0
    v_mfma_f32_16x16x32_bf16 v[28:31], a[44:47], a[104:107], v[28:31]
    buffer_load_dwordx4 v12, s[12:15], s37 offen offset:0 lds
    v_mfma_f32_16x16x32_bf16 v[32:35], a[48:51], a[104:107], v[32:35]
    ds_read_b128 a[8:11], v1 offset:18432
    v_mfma_f32_16x16x32_bf16 v[36:39], a[52:55], a[104:107], v[36:39]
    ds_read_b128 a[12:15], v1 offset:19456
    v_mfma_f32_16x16x32_bf16 v[40:43], a[56:59], a[104:107], v[40:43]
    ds_read_b128 a[16:19], v1 offset:20480
    v_mfma_f32_16x16x32_bf16 v[44:47], a[60:63], a[104:107], v[44:47]
    buffer_load_dwordx4 v12, s[12:15], s37 offen offset:1024 lds
    v_mfma_f32_16x16x32_bf16 v[76:79], a[60:63], a[108:111], v[76:79]
    ds_read_b128 a[20:23], v1 offset:21504
    v_mfma_f32_16x16x32_bf16 v[72:75], a[56:59], a[108:111], v[72:75]
    ds_read_b128 a[24:27], v1 offset:22528
    v_mfma_f32_16x16x32_bf16 v[68:71], a[52:55], a[108:111], v[68:71]
    ds_read_b128 a[28:31], v1 offset:23552
    v_mfma_f32_16x16x32_bf16 v[64:67], a[48:51], a[108:111], v[64:67]
    buffer_load_dwordx4 v12, s[12:15], s37 offen offset:2048 lds
    v_mfma_f32_16x16x32_bf16 v[60:63], a[44:47], a[108:111], v[60:63]
    ds_read_b64_tr_b16 a[64:65], v2 offset:8192
    v_mfma_f32_16x16x32_bf16 v[56:59], a[40:43], a[108:111], v[56:59]
    ds_read_b64_tr_b16 a[66:67], v2 offset:8704
    v_mfma_f32_16x16x32_bf16 v[52:55], a[36:39], a[108:111], v[52:55]
    ds_read_b64_tr_b16 a[68:69], v3 offset:8192
    v_mfma_f32_16x16x32_bf16 v[48:51], a[32:35], a[108:111], v[48:51]
    buffer_load_dwordx4 v12, s[12:15], s37 offen offset:3072 lds
    v_mfma_f32_16x16x32_bf16 v[80:83], a[112:115], a[32:35], v[80:83]
    ds_read_b64_tr_b16 a[70:71], v3 offset:8704
    v_mfma_f32_16x16x32_bf16 v[84:87], a[112:115], a[36:39], v[84:87]
    ds_read_b64_tr_b16 a[72:73], v4 offset:8192
    v_mfma_f32_16x16x32_bf16 v[88:91], a[112:115], a[40:43], v[88:91]
    s_add_u32 s37, s37, 0x4000
    s_add_u32 m0, s43, 0
    v_mfma_f32_16x16x32_bf16 v[92:95], a[112:115], a[44:47], v[92:95]
    buffer_load_dwordx4 v13, s[16:19], s38 offen lds
    v_mfma_f32_16x16x32_bf16 v[96:99], a[112:115], a[48:51], v[96:99]
    ds_read_b64_tr_b16 a[74:75], v4 offset:8704
    v_mfma_f32_16x16x32_bf16 v[100:103], a[112:115], a[52:55], v[100:103]
    ds_read_b64_tr_b16 a[76:77], v5 offset:8192
    v_mfma_f32_16x16x32_bf16 v[104:107], a[112:115], a[56:59], v[104:107]
    s_add_u32 m0, s43, 16384
    v_mfma_f32_16x16x32_bf16 v[108:111], a[112:115], a[60:63], v[108:111]
    buffer_load_dwordx4 v14, s[20:23], s39 offen lds
    v_mfma_f32_16x16x32_bf16 v[140:143], a[116:119], a[60:63], v[140:143]
    ds_read_b64_tr_b16 a[78:79], v5 offset:8704
    v_mfma_f32_16x16x32_bf16 v[136:139], a[116:119], a[56:59], v[136:139]
    ds_read_b64_tr_b16 a[80:81], v6 offset:8192
    v_mfma_f32_16x16x32_bf16 v[132:135], a[116:119], a[52:55], v[132:135]
    s_add_u32 m0, s43, 32768
    v_mfma_f32_16x16x32_bf16 v[128:131], a[116:119], a[48:51], v[128:131]
    buffer_load_dwordx4 v15, s[24:27], s40 offen lds
    v_mfma_f32_16x16x32_bf16 v[124:127], a[116:119], a[44:47], v[124:127]
    ds_read_b64_tr_b16 a[82:83], v6 offset:8704
    v_mfma_f32_16x16x32_bf16 v[120:123], a[116:119], a[40:43], v[120:123]
    ds_read_b64_tr_b16 a[84:85], v7 offset:8192
    v_mfma_f32_16x16x32_bf16 v[116:119], a[116:119], a[36:39], v[116:119]
    s_add_u32 m0, s43, 49152
    v_mfma_f32_16x16x32_bf16 v[112:115], a[116:119], a[32:35], v[112:115]
    buffer_load_dwordx4 v14, s[28:31], s39 offen lds
    v_mfma_f32_16x16x32_bf16 v[144:147], a[120:123], a[32:35], v[144:147]
    ds_read_b64_tr_b16 a[86:87], v7 offset:8704
    v_mfma_f32_16x16x32_bf16 v[148:151], a[120:123], a[36:39], v[148:151]
    ds_read_b64_tr_b16 a[88:89], v8 offset:8192
    v_mfma_f32_16x16x32_bf16 v[152:155], a[120:123], a[40:43], v[152:155]
    s_add_u32 m0, s43, 65536
    v_mfma_f32_16x16x32_bf16 v[156:159], a[120:123], a[44:47], v[156:159]
    buffer_load_dwordx4 v15, s[32:35], s40 offen lds
    v_mfma_f32_16x16x32_bf16 v[160:163], a[120:123], a[48:51], v[160:163]
    ds_read_b64_tr_b16 a[90:91], v8 offset:8704
    v_mfma_f32_16x16x32_bf16 v[164:167], a[120:123], a[52:55], v[164:167]
    s_add_u32 s38, s38, 196608
    s_add_u32 s39, s39, s41
    v_mfma_f32_16x16x32_bf16 v[168:171], a[120:123], a[56:59], v[168:171]
    s_add_u32 s40, s40, 229376
    s_add_u32 m0, s42, 8192
    v_mfma_f32_16x16x32_bf16 v[172:175], a[120:123], a[60:63], v[172:175]
    buffer_load_dwordx4 v12, s[12:15], s37 offen offset:0 lds
    v_mfma_f32_16x16x32_bf16 v[204:207], a[124:127], a[60:63], v[204:207]
    ds_read_b64_tr_b16 a[92:93], v9 offset:8192
    v_mfma_f32_16x16x32_bf16 v[200:203], a[124:127], a[56:59], v[200:203]
    ds_read_b64_tr_b16 a[94:95], v9 offset:8704
    v_mfma_f32_16x16x32_bf16 v[196:199], a[124:127], a[52:55], v[196:199]
    ds_read_b64_tr_b16 a[96:97], v10 offset:8192
    v_mfma_f32_16x16x32_bf16 v[192:195], a[124:127], a[48:51], v[192:195]
    buffer_load_dwordx4 v12, s[12:15], s37 offen offset:1024 lds
    v_mfma_f32_16x16x32_bf16 v[188:191], a[124:127], a[44:47], v[188:191]
    ds_read_b64_tr_b16 a[98:99], v10 offset:8704
    v_mfma_f32_16x16x32_bf16 v[184:187], a[124:127], a[40:43], v[184:187]
    ds_read_b64_tr_b16 a[100:101], v11 offset:8192
    v_mfma_f32_16x16x32_bf16 v[180:183], a[124:127], a[36:39], v[180:183]
    ds_read_b64_tr_b16 a[102:103], v11 offset:8704
    v_mfma_f32_16x16x32_bf16 v[176:179], a[124:127], a[32:35], v[176:179]
    buffer_load_dwordx4 v12, s[12:15], s37 offen offset:2048 lds
    v_mfma_f32_16x16x32_bf16 v[208:211], a[128:131], a[32:35], v[208:211]
    v_mfma_f32_16x16x32_bf16 v[212:215], a[128:131], a[36:39], v[212:215]
    v_mfma_f32_16x16x32_bf16 v[216:219], a[128:131], a[40:43], v[216:219]
    v_mfma_f32_16x16x32_bf16 v[220:223], a[128:131], a[44:47], v[220:223]
    buffer_load_dwordx4 v12, s[12:15], s37 offen offset:3072 lds
    v_mfma_f32_16x16x32_bf16 v[224:227], a[128:131], a[48:51], v[224:227]
    v_mfma_f32_16x16x32_bf16 v[228:231], a[128:131], a[52:55], v[228:231]
    v_mfma_f32_16x16x32_bf16 v[232:235], a[128:131], a[56:59], v[232:235]
    s_add_u32 s37, s37, 0x4000
    s_add_u32 m0, s43, 4096
    v_mfma_f32_16x16x32_bf16 v[236:239], a[128:131], a[60:63], v[236:239]
    buffer_load_dwordx4 v13, s[16:19], s38 offen lds
    v_mfma_f32_16x16x32_bf16 a[156:159], a[132:135], a[60:63], a[156:159]
    v_mfma_f32_16x16x32_bf16 a[152:155], a[132:135], a[56:59], a[152:155]
    v_mfma_f32_16x16x32_bf16 a[148:151], a[132:135], a[52:55], a[148:151]
    s_add_u32 m0, s43, 20480
    v_mfma_f32_16x16x32_bf16 a[144:147], a[132:135], a[48:51], a[144:147]
    buffer_load_dwordx4 v14, s[20:23], s39 offen lds
    v_mfma_f32_16x16x32_bf16 v[252:255], a[132:135], a[44:47], v[252:255]
    v_mfma_f32_16x16x32_bf16 v[248:251], a[132:135], a[40:43], v[248:251]
    v_mfma_f32_16x16x32_bf16 v[244:247], a[132:135], a[36:39], v[244:247]
    s_add_u32 m0, s43, 36864
    v_mfma_f32_16x16x32_bf16 v[240:243], a[132:135], a[32:35], v[240:243]
    buffer_load_dwordx4 v15, s[24:27], s40 offen lds
    v_mfma_f32_16x16x32_bf16 a[160:163], a[136:139], a[32:35], a[160:163]
    v_mfma_f32_16x16x32_bf16 a[164:167], a[136:139], a[36:39], a[164:167]
    v_mfma_f32_16x16x32_bf16 a[168:171], a[136:139], a[40:43], a[168:171]
    s_add_u32 m0, s43, 53248
    v_mfma_f32_16x16x32_bf16 a[172:175], a[136:139], a[44:47], a[172:175]
    buffer_load_dwordx4 v14, s[28:31], s39 offen lds
    v_mfma_f32_16x16x32_bf16 a[176:179], a[136:139], a[48:51], a[176:179]
    v_mfma_f32_16x16x32_bf16 a[180:183], a[136:139], a[52:55], a[180:183]
    v_mfma_f32_16x16x32_bf16 a[184:187], a[136:139], a[56:59], a[184:187]
    s_add_u32 m0, s43, 69632
    v_mfma_f32_16x16x32_bf16 a[188:191], a[136:139], a[60:63], a[188:191]
    buffer_load_dwordx4 v15, s[32:35], s40 offen lds
    v_mfma_f32_16x16x32_bf16 a[220:223], a[140:143], a[60:63], a[220:223]
    s_add_u32 s38, s38, 196608
    v_mfma_f32_16x16x32_bf16 a[216:219], a[140:143], a[56:59], a[216:219]
    s_add_u32 s39, s39, s41
    v_mfma_f32_16x16x32_bf16 a[212:215], a[140:143], a[52:55], a[212:215]
    s_add_u32 s40, s40, 229376
    v_mfma_f32_16x16x32_bf16 a[208:211], a[140:143], a[48:51], a[208:211]
    v_mfma_f32_16x16x32_bf16 a[204:207], a[140:143], a[44:47], a[204:207]
    v_mfma_f32_16x16x32_bf16 a[200:203], a[140:143], a[40:43], a[200:203]
    v_mfma_f32_16x16x32_bf16 a[196:199], a[140:143], a[36:39], a[196:199]
    v_mfma_f32_16x16x32_bf16 a[192:195], a[140:143], a[32:35], a[192:195]
    v_cmp_gt_u32 vcc, s3, v0
    v_lshlrev_b32 v0, 7, v0
    s_andn2_b64 exec, exec, vcc
    v_mov_b32 v0, 0x40000000
    s_mov_b64 exec, -1
    s_waitcnt vmcnt(18) lgkmcnt(0)
    s_barrier
    v_mfma_f32_16x16x32_bf16 v[16:19], a[0:3], a[64:67], v[16:19]
    ds_read_b128 a[32:35], v1 offset:24576
    v_mfma_f32_16x16x32_bf16 v[20:23], a[4:7], a[64:67], v[20:23]
    ds_read_b128 a[36:39], v1 offset:25600
    v_mfma_f32_16x16x32_bf16 v[24:27], a[8:11], a[64:67], v[24:27]
    ds_read_b128 a[40:43], v1 offset:26624
    v_mfma_f32_16x16x32_bf16 v[28:31], a[12:15], a[64:67], v[28:31]
    buffer_load_dword a226, v0, s[88:91], s78 offen
    v_mfma_f32_16x16x32_bf16 v[32:35], a[16:19], a[64:67], v[32:35]
    ds_read_b128 a[44:47], v1 offset:27648
    v_mfma_f32_16x16x32_bf16 v[36:39], a[20:23], a[64:67], v[36:39]
    ds_read_b128 a[48:51], v1 offset:28672
    v_mfma_f32_16x16x32_bf16 v[40:43], a[24:27], a[64:67], v[40:43]
    ds_read_b128 a[52:55], v1 offset:29696
    v_mfma_f32_16x16x32_bf16 v[44:47], a[28:31], a[64:67], v[44:47]
    ds_read_b128 a[56:59], v1 offset:30720
    v_mfma_f32_16x16x32_bf16 v[76:79], a[28:31], a[68:71], v[76:79]
    ds_read_b128 a[60:63], v1 offset:31744
    v_mfma_f32_16x16x32_bf16 v[72:75], a[24:27], a[68:71], v[72:75]
    s_add_u32 s78, s78, s100
    s_add_u32 m0, s42, 16384
    v_mfma_f32_16x16x32_bf16 v[68:71], a[20:23], a[68:71], v[68:71]
    buffer_load_dwordx4 v12, s[12:15], s37 offen offset:0 lds
    v_mfma_f32_16x16x32_bf16 v[64:67], a[16:19], a[68:71], v[64:67]
    ds_read_b64_tr_b16 a[104:105], v2 offset:12288
    v_mfma_f32_16x16x32_bf16 v[60:63], a[12:15], a[68:71], v[60:63]
    ds_read_b64_tr_b16 a[106:107], v2 offset:12800
    v_mfma_f32_16x16x32_bf16 v[56:59], a[8:11], a[68:71], v[56:59]
    ds_read_b64_tr_b16 a[108:109], v3 offset:12288
    v_mfma_f32_16x16x32_bf16 v[52:55], a[4:7], a[68:71], v[52:55]
    ds_read_b64_tr_b16 a[110:111], v3 offset:12800
    v_mfma_f32_16x16x32_bf16 v[48:51], a[0:3], a[68:71], v[48:51]
    ds_read_b64_tr_b16 a[112:113], v4 offset:12288
    v_mfma_f32_16x16x32_bf16 v[80:83], a[72:75], a[0:3], v[80:83]
    ds_read_b64_tr_b16 a[114:115], v4 offset:12800
    v_mfma_f32_16x16x32_bf16 v[84:87], a[72:75], a[4:7], v[84:87]
    buffer_load_dwordx4 v12, s[12:15], s37 offen offset:1024 lds
    v_mfma_f32_16x16x32_bf16 v[88:91], a[72:75], a[8:11], v[88:91]
    ds_read_b64_tr_b16 a[116:117], v5 offset:12288
    v_mfma_f32_16x16x32_bf16 v[92:95], a[72:75], a[12:15], v[92:95]
    ds_read_b64_tr_b16 a[118:119], v5 offset:12800
    v_mfma_f32_16x16x32_bf16 v[96:99], a[72:75], a[16:19], v[96:99]
    ds_read_b64_tr_b16 a[120:121], v6 offset:12288
    v_mfma_f32_16x16x32_bf16 v[100:103], a[72:75], a[20:23], v[100:103]
    ds_read_b64_tr_b16 a[122:123], v6 offset:12800
    v_mfma_f32_16x16x32_bf16 v[104:107], a[72:75], a[24:27], v[104:107]
    ds_read_b64_tr_b16 a[124:125], v7 offset:12288
    v_mfma_f32_16x16x32_bf16 v[108:111], a[72:75], a[28:31], v[108:111]
    ds_read_b64_tr_b16 a[126:127], v7 offset:12800
    v_mfma_f32_16x16x32_bf16 v[140:143], a[76:79], a[28:31], v[140:143]
    buffer_load_dwordx4 v12, s[12:15], s37 offen offset:2048 lds
    v_mfma_f32_16x16x32_bf16 v[136:139], a[76:79], a[24:27], v[136:139]
    ds_read_b64_tr_b16 a[128:129], v8 offset:12288
    v_mfma_f32_16x16x32_bf16 v[132:135], a[76:79], a[20:23], v[132:135]
    ds_read_b64_tr_b16 a[130:131], v8 offset:12800
    v_mfma_f32_16x16x32_bf16 v[128:131], a[76:79], a[16:19], v[128:131]
    ds_read_b64_tr_b16 a[132:133], v9 offset:12288
    v_mfma_f32_16x16x32_bf16 v[124:127], a[76:79], a[12:15], v[124:127]
    ds_read_b64_tr_b16 a[134:135], v9 offset:12800
    v_mfma_f32_16x16x32_bf16 v[120:123], a[76:79], a[8:11], v[120:123]
    ds_read_b64_tr_b16 a[136:137], v10 offset:12288
    v_mfma_f32_16x16x32_bf16 v[116:119], a[76:79], a[4:7], v[116:119]
    ds_read_b64_tr_b16 a[138:139], v10 offset:12800
    v_mfma_f32_16x16x32_bf16 v[112:115], a[76:79], a[0:3], v[112:115]
    buffer_load_dwordx4 v12, s[12:15], s37 offen offset:3072 lds
    v_mfma_f32_16x16x32_bf16 v[144:147], a[80:83], a[0:3], v[144:147]
    ds_read_b64_tr_b16 a[140:141], v11 offset:12288
    v_mfma_f32_16x16x32_bf16 v[148:151], a[80:83], a[4:7], v[148:151]
    ds_read_b64_tr_b16 a[142:143], v11 offset:12800
    v_mfma_f32_16x16x32_bf16 v[152:155], a[80:83], a[8:11], v[152:155]
    v_mfma_f32_16x16x32_bf16 v[156:159], a[80:83], a[12:15], v[156:159]
    v_mfma_f32_16x16x32_bf16 v[160:163], a[80:83], a[16:19], v[160:163]
    v_mfma_f32_16x16x32_bf16 v[164:167], a[80:83], a[20:23], v[164:167]
    s_add_u32 s37, s37, 0x4000
    s_add_u32 m0, s43, 8192
    v_mfma_f32_16x16x32_bf16 v[168:171], a[80:83], a[24:27], v[168:171]
    buffer_load_dwordx4 v13, s[16:19], s38 offen lds
    v_mfma_f32_16x16x32_bf16 v[172:175], a[80:83], a[28:31], v[172:175]
    v_mfma_f32_16x16x32_bf16 v[204:207], a[84:87], a[28:31], v[204:207]
    v_mfma_f32_16x16x32_bf16 v[200:203], a[84:87], a[24:27], v[200:203]
    v_mfma_f32_16x16x32_bf16 v[196:199], a[84:87], a[20:23], v[196:199]
    v_mfma_f32_16x16x32_bf16 v[192:195], a[84:87], a[16:19], v[192:195]
    v_mfma_f32_16x16x32_bf16 v[188:191], a[84:87], a[12:15], v[188:191]
    s_add_u32 m0, s43, 24576
    v_mfma_f32_16x16x32_bf16 v[184:187], a[84:87], a[8:11], v[184:187]
    buffer_load_dwordx4 v14, s[20:23], s39 offen lds
    v_mfma_f32_16x16x32_bf16 v[180:183], a[84:87], a[4:7], v[180:183]
    v_mfma_f32_16x16x32_bf16 v[176:179], a[84:87], a[0:3], v[176:179]
    v_mfma_f32_16x16x32_bf16 v[208:211], a[88:91], a[0:3], v[208:211]
    v_mfma_f32_16x16x32_bf16 v[212:215], a[88:91], a[4:7], v[212:215]
    v_mfma_f32_16x16x32_bf16 v[216:219], a[88:91], a[8:11], v[216:219]
    v_mfma_f32_16x16x32_bf16 v[220:223], a[88:91], a[12:15], v[220:223]
    s_add_u32 m0, s43, 40960
    v_mfma_f32_16x16x32_bf16 v[224:227], a[88:91], a[16:19], v[224:227]
    buffer_load_dwordx4 v15, s[24:27], s40 offen lds
    v_mfma_f32_16x16x32_bf16 v[228:231], a[88:91], a[20:23], v[228:231]
    v_mfma_f32_16x16x32_bf16 v[232:235], a[88:91], a[24:27], v[232:235]
    v_mfma_f32_16x16x32_bf16 v[236:239], a[88:91], a[28:31], v[236:239]
    v_mfma_f32_16x16x32_bf16 a[156:159], a[92:95], a[28:31], a[156:159]
    v_mfma_f32_16x16x32_bf16 a[152:155], a[92:95], a[24:27], a[152:155]
    v_mfma_f32_16x16x32_bf16 a[148:151], a[92:95], a[20:23], a[148:151]
    s_add_u32 m0, s43, 57344
    v_mfma_f32_16x16x32_bf16 a[144:147], a[92:95], a[16:19], a[144:147]
    buffer_load_dwordx4 v14, s[28:31], s39 offen lds
    v_mfma_f32_16x16x32_bf16 v[252:255], a[92:95], a[12:15], v[252:255]
    v_mfma_f32_16x16x32_bf16 v[248:251], a[92:95], a[8:11], v[248:251]
    v_mfma_f32_16x16x32_bf16 v[244:247], a[92:95], a[4:7], v[244:247]
    v_mfma_f32_16x16x32_bf16 v[240:243], a[92:95], a[0:3], v[240:243]
    v_mfma_f32_16x16x32_bf16 a[160:163], a[96:99], a[0:3], a[160:163]
    v_mfma_f32_16x16x32_bf16 a[164:167], a[96:99], a[4:7], a[164:167]
    s_add_u32 m0, s43, 73728
    v_mfma_f32_16x16x32_bf16 a[168:171], a[96:99], a[8:11], a[168:171]
    buffer_load_dwordx4 v15, s[32:35], s40 offen lds
    v_mfma_f32_16x16x32_bf16 a[172:175], a[96:99], a[12:15], a[172:175]
    s_add_u32 s38, s38, 196608
    v_mfma_f32_16x16x32_bf16 a[176:179], a[96:99], a[16:19], a[176:179]
    s_add_u32 s39, s39, s41
    v_mfma_f32_16x16x32_bf16 a[180:183], a[96:99], a[20:23], a[180:183]
    s_add_u32 s40, s40, 229376
    v_mfma_f32_16x16x32_bf16 a[184:187], a[96:99], a[24:27], a[184:187]
    v_mfma_f32_16x16x32_bf16 a[188:191], a[96:99], a[28:31], a[188:191]
    v_mfma_f32_16x16x32_bf16 a[220:223], a[100:103], a[28:31], a[220:223]
    v_mfma_f32_16x16x32_bf16 a[216:219], a[100:103], a[24:27], a[216:219]
    v_mfma_f32_16x16x32_bf16 a[212:215], a[100:103], a[20:23], a[212:215]
    v_mfma_f32_16x16x32_bf16 a[208:211], a[100:103], a[16:19], a[208:211]
    v_mfma_f32_16x16x32_bf16 a[204:207], a[100:103], a[12:15], a[204:207]
    v_mfma_f32_16x16x32_bf16 a[200:203], a[100:103], a[8:11], a[200:203]
    v_mfma_f32_16x16x32_bf16 a[196:199], a[100:103], a[4:7], a[196:199]
    v_mfma_f32_16x16x32_bf16 a[192:195], a[100:103], a[0:3], a[192:195]
    s_waitcnt vmcnt(18) lgkmcnt(0)
    s_barrier
    v_mfma_f32_16x16x32_bf16 v[16:19], a[32:35], a[104:107], v[16:19]
    ds_read_b128 a[0:3], v1 offset:0
    v_mfma_f32_16x16x32_bf16 v[20:23], a[36:39], a[104:107], v[20:23]
    ds_read_b128 a[4:7], v1 offset:1024
    v_mfma_f32_16x16x32_bf16 v[24:27], a[40:43], a[104:107], v[24:27]
    ds_read_b128 a[8:11], v1 offset:2048
    v_mfma_f32_16x16x32_bf16 v[28:31], a[44:47], a[104:107], v[28:31]
    buffer_load_dword a226, v0, s[88:91], s78 offen
    v_mfma_f32_16x16x32_bf16 v[32:35], a[48:51], a[104:107], v[32:35]
    ds_read_b128 a[12:15], v1 offset:3072
    v_mfma_f32_16x16x32_bf16 v[36:39], a[52:55], a[104:107], v[36:39]
    ds_read_b128 a[16:19], v1 offset:4096
    v_mfma_f32_16x16x32_bf16 v[40:43], a[56:59], a[104:107], v[40:43]
    ds_read_b128 a[20:23], v1 offset:5120
    v_mfma_f32_16x16x32_bf16 v[44:47], a[60:63], a[104:107], v[44:47]
    ds_read_b128 a[24:27], v1 offset:6144
    v_mfma_f32_16x16x32_bf16 v[76:79], a[60:63], a[108:111], v[76:79]
    ds_read_b128 a[28:31], v1 offset:7168
    v_mfma_f32_16x16x32_bf16 v[72:75], a[56:59], a[108:111], v[72:75]
    s_add_u32 s78, s78, s100
    s_add_u32 m0, s42, 24576
    v_mfma_f32_16x16x32_bf16 v[68:71], a[52:55], a[108:111], v[68:71]
    buffer_load_dwordx4 v12, s[12:15], s37 offen offset:0 lds
    v_mfma_f32_16x16x32_bf16 v[64:67], a[48:51], a[108:111], v[64:67]
    ds_read_b64_tr_b16 a[64:65], v2 offset:0
    v_mfma_f32_16x16x32_bf16 v[60:63], a[44:47], a[108:111], v[60:63]
    ds_read_b64_tr_b16 a[66:67], v2 offset:512
    v_mfma_f32_16x16x32_bf16 v[56:59], a[40:43], a[108:111], v[56:59]
    ds_read_b64_tr_b16 a[68:69], v3 offset:0
    v_mfma_f32_16x16x32_bf16 v[52:55], a[36:39], a[108:111], v[52:55]
    ds_read_b64_tr_b16 a[70:71], v3 offset:512
    v_mfma_f32_16x16x32_bf16 v[48:51], a[32:35], a[108:111], v[48:51]
    ds_read_b64_tr_b16 a[72:73], v4 offset:0
    v_mfma_f32_16x16x32_bf16 v[80:83], a[112:115], a[32:35], v[80:83]
    ds_read_b64_tr_b16 a[74:75], v4 offset:512
    v_mfma_f32_16x16x32_bf16 v[84:87], a[112:115], a[36:39], v[84:87]
    buffer_load_dwordx4 v12, s[12:15], s37 offen offset:1024 lds
    v_mfma_f32_16x16x32_bf16 v[88:91], a[112:115], a[40:43], v[88:91]
    ds_read_b64_tr_b16 a[76:77], v5 offset:0
    v_mfma_f32_16x16x32_bf16 v[92:95], a[112:115], a[44:47], v[92:95]
    ds_read_b64_tr_b16 a[78:79], v5 offset:512
    v_mfma_f32_16x16x32_bf16 v[96:99], a[112:115], a[48:51], v[96:99]
    ds_read_b64_tr_b16 a[80:81], v6 offset:0
    v_mfma_f32_16x16x32_bf16 v[100:103], a[112:115], a[52:55], v[100:103]
    ds_read_b64_tr_b16 a[82:83], v6 offset:512
    v_mfma_f32_16x16x32_bf16 v[104:107], a[112:115], a[56:59], v[104:107]
    ds_read_b64_tr_b16 a[84:85], v7 offset:0
    v_mfma_f32_16x16x32_bf16 v[108:111], a[112:115], a[60:63], v[108:111]
    ds_read_b64_tr_b16 a[86:87], v7 offset:512
    v_mfma_f32_16x16x32_bf16 v[140:143], a[116:119], a[60:63], v[140:143]
    buffer_load_dwordx4 v12, s[12:15], s37 offen offset:2048 lds
    v_mfma_f32_16x16x32_bf16 v[136:139], a[116:119], a[56:59], v[136:139]
    ds_read_b64_tr_b16 a[88:89], v8 offset:0
    v_mfma_f32_16x16x32_bf16 v[132:135], a[116:119], a[52:55], v[132:135]
    ds_read_b64_tr_b16 a[90:91], v8 offset:512
    v_mfma_f32_16x16x32_bf16 v[128:131], a[116:119], a[48:51], v[128:131]
    ds_read_b64_tr_b16 a[92:93], v9 offset:0
    v_mfma_f32_16x16x32_bf16 v[124:127], a[116:119], a[44:47], v[124:127]
    ds_read_b64_tr_b16 a[94:95], v9 offset:512
    v_mfma_f32_16x16x32_bf16 v[120:123], a[116:119], a[40:43], v[120:123]
    ds_read_b64_tr_b16 a[96:97], v10 offset:0
    v_mfma_f32_16x16x32_bf16 v[116:119], a[116:119], a[36:39], v[116:119]
    ds_read_b64_tr_b16 a[98:99], v10 offset:512
    v_mfma_f32_16x16x32_bf16 v[112:115], a[116:119], a[32:35], v[112:115]
    buffer_load_dwordx4 v12, s[12:15], s37 offen offset:3072 lds
    v_mfma_f32_16x16x32_bf16 v[144:147], a[120:123], a[32:35], v[144:147]
    ds_read_b64_tr_b16 a[100:101], v11 offset:0
    v_mfma_f32_16x16x32_bf16 v[148:151], a[120:123], a[36:39], v[148:151]
    ds_read_b64_tr_b16 a[102:103], v11 offset:512
    v_mfma_f32_16x16x32_bf16 v[152:155], a[120:123], a[40:43], v[152:155]
    v_mfma_f32_16x16x32_bf16 v[156:159], a[120:123], a[44:47], v[156:159]
    v_mfma_f32_16x16x32_bf16 v[160:163], a[120:123], a[48:51], v[160:163]
    v_mfma_f32_16x16x32_bf16 v[164:167], a[120:123], a[52:55], v[164:167]
    s_add_u32 s37, s37, 0x4000
    s_add_u32 m0, s43, 12288
    v_mfma_f32_16x16x32_bf16 v[168:171], a[120:123], a[56:59], v[168:171]
    buffer_load_dwordx4 v13, s[16:19], s38 offen lds
    v_mfma_f32_16x16x32_bf16 v[172:175], a[120:123], a[60:63], v[172:175]
    v_mfma_f32_16x16x32_bf16 v[204:207], a[124:127], a[60:63], v[204:207]
    v_mfma_f32_16x16x32_bf16 v[200:203], a[124:127], a[56:59], v[200:203]
    v_mfma_f32_16x16x32_bf16 v[196:199], a[124:127], a[52:55], v[196:199]
    v_mfma_f32_16x16x32_bf16 v[192:195], a[124:127], a[48:51], v[192:195]
    v_mfma_f32_16x16x32_bf16 v[188:191], a[124:127], a[44:47], v[188:191]
    s_add_u32 m0, s43, 28672
    v_mfma_f32_16x16x32_bf16 v[184:187], a[124:127], a[40:43], v[184:187]
    buffer_load_dwordx4 v14, s[20:23], s39 offen lds
    v_mfma_f32_16x16x32_bf16 v[180:183], a[124:127], a[36:39], v[180:183]
    v_mfma_f32_16x16x32_bf16 v[176:179], a[124:127], a[32:35], v[176:179]
    v_mfma_f32_16x16x32_bf16 v[208:211], a[128:131], a[32:35], v[208:211]
    v_mfma_f32_16x16x32_bf16 v[212:215], a[128:131], a[36:39], v[212:215]
    v_mfma_f32_16x16x32_bf16 v[216:219], a[128:131], a[40:43], v[216:219]
    v_mfma_f32_16x16x32_bf16 v[220:223], a[128:131], a[44:47], v[220:223]
    s_add_u32 m0, s43, 45056
    v_mfma_f32_16x16x32_bf16 v[224:227], a[128:131], a[48:51], v[224:227]
    buffer_load_dwordx4 v15, s[24:27], s40 offen lds
    v_mfma_f32_16x16x32_bf16 v[228:231], a[128:131], a[52:55], v[228:231]
    v_mfma_f32_16x16x32_bf16 v[232:235], a[128:131], a[56:59], v[232:235]
    v_mfma_f32_16x16x32_bf16 v[236:239], a[128:131], a[60:63], v[236:239]
    v_mfma_f32_16x16x32_bf16 a[156:159], a[132:135], a[60:63], a[156:159]
    v_mfma_f32_16x16x32_bf16 a[152:155], a[132:135], a[56:59], a[152:155]
    v_mfma_f32_16x16x32_bf16 a[148:151], a[132:135], a[52:55], a[148:151]
    s_add_u32 m0, s43, 61440
    v_mfma_f32_16x16x32_bf16 a[144:147], a[132:135], a[48:51], a[144:147]
    buffer_load_dwordx4 v14, s[28:31], s39 offen lds
    v_mfma_f32_16x16x32_bf16 v[252:255], a[132:135], a[44:47], v[252:255]
    v_mfma_f32_16x16x32_bf16 v[248:251], a[132:135], a[40:43], v[248:251]
    v_mfma_f32_16x16x32_bf16 v[244:247], a[132:135], a[36:39], v[244:247]
    v_mfma_f32_16x16x32_bf16 v[240:243], a[132:135], a[32:35], v[240:243]
    v_mfma_f32_16x16x32_bf16 a[160:163], a[136:139], a[32:35], a[160:163]
    v_mfma_f32_16x16x32_bf16 a[164:167], a[136:139], a[36:39], a[164:167]
    s_add_u32 m0, s43, 77824
    v_mfma_f32_16x16x32_bf16 a[168:171], a[136:139], a[40:43], a[168:171]
    buffer_load_dwordx4 v15, s[32:35], s40 offen lds
    v_mfma_f32_16x16x32_bf16 a[172:175], a[136:139], a[44:47], a[172:175]
    s_add_u32 s38, s38, 196608
    v_mfma_f32_16x16x32_bf16 a[176:179], a[136:139], a[48:51], a[176:179]
    s_add_u32 s39, s39, s41
    v_mfma_f32_16x16x32_bf16 a[180:183], a[136:139], a[52:55], a[180:183]
    s_add_u32 s40, s40, 229376
    v_mfma_f32_16x16x32_bf16 a[184:187], a[136:139], a[56:59], a[184:187]
    v_mfma_f32_16x16x32_bf16 a[188:191], a[136:139], a[60:63], a[188:191]
    v_mfma_f32_16x16x32_bf16 a[220:223], a[140:143], a[60:63], a[220:223]
    v_mfma_f32_16x16x32_bf16 a[216:219], a[140:143], a[56:59], a[216:219]
    v_mfma_f32_16x16x32_bf16 a[212:215], a[140:143], a[52:55], a[212:215]
    v_mfma_f32_16x16x32_bf16 a[208:211], a[140:143], a[48:51], a[208:211]
    v_mfma_f32_16x16x32_bf16 a[204:207], a[140:143], a[44:47], a[204:207]
    v_mfma_f32_16x16x32_bf16 a[200:203], a[140:143], a[40:43], a[200:203]
    v_mfma_f32_16x16x32_bf16 a[196:199], a[140:143], a[36:39], a[196:199]
    v_mfma_f32_16x16x32_bf16 a[192:195], a[140:143], a[32:35], a[192:195]
.p2align 6
L_g1_loop_v:
    s_waitcnt vmcnt(20) lgkmcnt(0)
    s_barrier
    v_mfma_f32_16x16x32_bf16 v[16:19], a[0:3], a[64:67], v[16:19]
    ds_read_b128 a[32:35], v1 offset:8192
    v_mfma_f32_16x16x32_bf16 v[20:23], a[4:7], a[64:67], v[20:23]
    ds_read_b128 a[36:39], v1 offset:9216
    v_mfma_f32_16x16x32_bf16 v[24:27], a[8:11], a[64:67], v[24:27]
    ds_read_b128 a[40:43], v1 offset:10240
    v_mfma_f32_16x16x32_bf16 v[28:31], a[12:15], a[64:67], v[28:31]
    buffer_load_dword a226, v0, s[88:91], s78 offen
    v_mfma_f32_16x16x32_bf16 v[32:35], a[16:19], a[64:67], v[32:35]
    ds_read_b128 a[44:47], v1 offset:11264
    v_mfma_f32_16x16x32_bf16 v[36:39], a[20:23], a[64:67], v[36:39]
    ds_read_b128 a[48:51], v1 offset:12288
    v_mfma_f32_16x16x32_bf16 v[40:43], a[24:27], a[64:67], v[40:43]
    ds_read_b128 a[52:55], v1 offset:13312
    v_mfma_f32_16x16x32_bf16 v[44:47], a[28:31], a[64:67], v[44:47]
    ds_read_b128 a[56:59], v1 offset:14336
    v_mfma_f32_16x16x32_bf16 v[76:79], a[28:31], a[68:71], v[76:79]
    ds_read_b128 a[60:63], v1 offset:15360
    v_mfma_f32_16x16x32_bf16 v[72:75], a[24:27], a[68:71], v[72:75]
    s_add_u32 s78, s78, s100
    s_add_u32 m0, s42, 0
    v_mfma_f32_16x16x32_bf16 v[68:71], a[20:23], a[68:71], v[68:71]
    buffer_load_dwordx4 v12, s[12:15], s37 offen offset:0 lds
    v_mfma_f32_16x16x32_bf16 v[64:67], a[16:19], a[68:71], v[64:67]
    ds_read_b64_tr_b16 a[104:105], v2 offset:4096
    v_mfma_f32_16x16x32_bf16 v[60:63], a[12:15], a[68:71], v[60:63]
    ds_read_b64_tr_b16 a[106:107], v2 offset:4608
    v_mfma_f32_16x16x32_bf16 v[56:59], a[8:11], a[68:71], v[56:59]
    ds_read_b64_tr_b16 a[108:109], v3 offset:4096
    v_mfma_f32_16x16x32_bf16 v[52:55], a[4:7], a[68:71], v[52:55]
    ds_read_b64_tr_b16 a[110:111], v3 offset:4608
    v_mfma_f32_16x16x32_bf16 v[48:51], a[0:3], a[68:71], v[48:51]
    ds_read_b64_tr_b16 a[112:113], v4 offset:4096
    v_mfma_f32_16x16x32_bf16 v[80:83], a[72:75], a[0:3], v[80:83]
    ds_read_b64_tr_b16 a[114:115], v4 offset:4608
    v_mfma_f32_16x16x32_bf16 v[84:87], a[72:75], a[4:7], v[84:87]
    buffer_load_dwordx4 v12, s[12:15], s37 offen offset:1024 lds
    v_mfma_f32_16x16x32_bf16 v[88:91], a[72:75], a[8:11], v[88:91]
    ds_read_b64_tr_b16 a[116:117], v5 offset:4096
    v_mfma_f32_16x16x32_bf16 v[92:95], a[72:75], a[12:15], v[92:95]
    ds_read_b64_tr_b16 a[118:119], v5 offset:4608
    v_mfma_f32_16x16x32_bf16 v[96:99], a[72:75], a[16:19], v[96:99]
    ds_read_b64_tr_b16 a[120:121], v6 offset:4096
    v_mfma_f32_16x16x32_bf16 v[100:103], a[72:75], a[20:23], v[100:103]
    ds_read_b64_tr_b16 a[122:123], v6 offset:4608
    v_mfma_f32_16x16x32_bf16 v[104:107], a[72:75], a[24:27], v[104:107]
    ds_read_b64_tr_b16 a[124:125], v7 offset:4096
    v_mfma_f32_16x16x32_bf16 v[108:111], a[72:75], a[28:31], v[108:111]
    ds_read_b64_tr_b16 a[126:127], v7 offset:4608
    v_mfma_f32_16x16x32_bf16 v[140:143], a[76:79], a[28:31], v[140:143]
    buffer_load_dwordx4 v12, s[12:15], s37 offen offset:2048 lds
    v_mfma_f32_16x16x32_bf16 v[136:139], a[76:79], a[24:27], v[136:139]
    ds_read_b64_tr_b16 a[128:129], v8 offset:4096
    v_mfma_f32_16x16x32_bf16 v[132:135], a[76:79], a[20:23], v[132:135]
    ds_read_b64_tr_b16 a[130:131], v8 offset:4608
    v_mfma_f32_16x16x32_bf16 v[128:131], a[76:79], a[16:19], v[128:131]
    ds_read_b64_tr_b16 a[132:133], v9 offset:4096
    v_mfma_f32_16x16x32_bf16 v[124:127], a[76:79], a[12:15], v[124:127]
    ds_read_b64_tr_b16 a[134:135], v9 offset:4608
    v_mfma_f32_16x16x32_bf16 v[120:123], a[76:79], a[8:11], v[120:123]
    ds_read_b64_tr_b16 a[136:137], v10 offset:4096
    v_mfma_f32_16x16x32_bf16 v[116:119], a[76:79], a[4:7], v[116:119]
    ds_read_b64_tr_b16 a[138:139], v10 offset:4608
    v_mfma_f32_16x16x32_bf16 v[112:115], a[76:79], a[0:3], v[112:115]
    buffer_load_dwordx4 v12, s[12:15], s37 offen offset:3072 lds
    v_mfma_f32_16x16x32_bf16 v[144:147], a[80:83], a[0:3], v[144:147]
    ds_read_b64_tr_b16 a[140:141], v11 offset:4096
    v_mfma_f32_16x16x32_bf16 v[148:151], a[80:83], a[4:7], v[148:151]
    ds_read_b64_tr_b16 a[142:143], v11 offset:4608
    v_mfma_f32_16x16x32_bf16 v[152:155], a[80:83], a[8:11], v[152:155]
    v_mfma_f32_16x16x32_bf16 v[156:159], a[80:83], a[12:15], v[156:159]
    v_mfma_f32_16x16x32_bf16 v[160:163], a[80:83], a[16:19], v[160:163]
    v_mfma_f32_16x16x32_bf16 v[164:167], a[80:83], a[20:23], v[164:167]
    s_add_u32 s37, s37, 0x4000
    s_add_u32 m0, s43, 0
    v_mfma_f32_16x16x32_bf16 v[168:171], a[80:83], a[24:27], v[168:171]
    buffer_load_dwordx4 v13, s[16:19], s38 offen lds
    v_mfma_f32_16x16x32_bf16 v[172:175], a[80:83], a[28:31], v[172:175]
    v_mfma_f32_16x16x32_bf16 v[204:207], a[84:87], a[28:31], v[204:207]
    v_mfma_f32_16x16x32_bf16 v[200:203], a[84:87], a[24:27], v[200:203]
    v_mfma_f32_16x16x32_bf16 v[196:199], a[84:87], a[20:23], v[196:199]
    v_mfma_f32_16x16x32_bf16 v[192:195], a[84:87], a[16:19], v[192:195]
    v_mfma_f32_16x16x32_bf16 v[188:191], a[84:87], a[12:15], v[188:191]
    s_add_u32 m0, s43, 16384
    v_mfma_f32_16x16x32_bf16 v[184:187], a[84:87], a[8:11], v[184:187]
    buffer_load_dwordx4 v14, s[20:23], s39 offen lds
    v_mfma_f32_16x16x32_bf16 v[180:183], a[84:87], a[4:7], v[180:183]
    v_mfma_f32_16x16x32_bf16 v[176:179], a[84:87], a[0:3], v[176:179]
    v_mfma_f32_16x16x32_bf16 v[208:211], a[88:91], a[0:3], v[208:211]
    v_mfma_f32_16x16x32_bf16 v[212:215], a[88:91], a[4:7], v[212:215]
    v_mfma_f32_16x16x32_bf16 v[216:219], a[88:91], a[8:11], v[216:219]
    v_mfma_f32_16x16x32_bf16 v[220:223], a[88:91], a[12:15], v[220:223]
    s_add_u32 m0, s43, 32768
    v_mfma_f32_16x16x32_bf16 v[224:227], a[88:91], a[16:19], v[224:227]
    buffer_load_dwordx4 v15, s[24:27], s40 offen lds
    v_mfma_f32_16x16x32_bf16 v[228:231], a[88:91], a[20:23], v[228:231]
    v_mfma_f32_16x16x32_bf16 v[232:235], a[88:91], a[24:27], v[232:235]
    v_mfma_f32_16x16x32_bf16 v[236:239], a[88:91], a[28:31], v[236:239]
    v_mfma_f32_16x16x32_bf16 a[156:159], a[92:95], a[28:31], a[156:159]
    v_mfma_f32_16x16x32_bf16 a[152:155], a[92:95], a[24:27], a[152:155]
    v_mfma_f32_16x16x32_bf16 a[148:151], a[92:95], a[20:23], a[148:151]
    s_add_u32 m0, s43, 49152
    v_mfma_f32_16x16x32_bf16 a[144:147], a[92:95], a[16:19], a[144:147]
    buffer_load_dwordx4 v14, s[28:31], s39 offen lds
    v_mfma_f32_16x16x32_bf16 v[252:255], a[92:95], a[12:15], v[252:255]
    v_mfma_f32_16x16x32_bf16 v[248:251], a[92:95], a[8:11], v[248:251]
    v_mfma_f32_16x16x32_bf16 v[244:247], a[92:95], a[4:7], v[244:247]
    v_mfma_f32_16x16x32_bf16 v[240:243], a[92:95], a[0:3], v[240:243]
    v_mfma_f32_16x16x32_bf16 a[160:163], a[96:99], a[0:3], a[160:163]
    v_mfma_f32_16x16x32_bf16 a[164:167], a[96:99], a[4:7], a[164:167]
    s_add_u32 m0, s43, 65536
    v_mfma_f32_16x16x32_bf16 a[168:171], a[96:99], a[8:11], a[168:171]
    buffer_load_dwordx4 v15, s[32:35], s40 offen lds
    v_mfma_f32_16x16x32_bf16 a[172:175], a[96:99], a[12:15], a[172:175]
    s_add_u32 s38, s38, 196608
    v_mfma_f32_16x16x32_bf16 a[176:179], a[96:99], a[16:19], a[176:179]
    s_add_u32 s39, s39, s41
    v_mfma_f32_16x16x32_bf16 a[180:183], a[96:99], a[20:23], a[180:183]
    s_add_u32 s40, s40, 229376
    v_mfma_f32_16x16x32_bf16 a[184:187], a[96:99], a[24:27], a[184:187]
    v_mfma_f32_16x16x32_bf16 a[188:191], a[96:99], a[28:31], a[188:191]
    v_mfma_f32_16x16x32_bf16 a[220:223], a[100:103], a[28:31], a[220:223]
    v_mfma_f32_16x16x32_bf16 a[216:219], a[100:103], a[24:27], a[216:219]
    v_mfma_f32_16x16x32_bf16 a[212:215], a[100:103], a[20:23], a[212:215]
    v_mfma_f32_16x16x32_bf16 a[208:211], a[100:103], a[16:19], a[208:211]
    v_mfma_f32_16x16x32_bf16 a[204:207], a[100:103], a[12:15], a[204:207]
    v_mfma_f32_16x16x32_bf16 a[200:203], a[100:103], a[8:11], a[200:203]
    v_mfma_f32_16x16x32_bf16 a[196:199], a[100:103], a[4:7], a[196:199]
    v_mfma_f32_16x16x32_bf16 a[192:195], a[100:103], a[0:3], a[192:195]
    s_waitcnt vmcnt(20) lgkmcnt(0)
    s_barrier
    v_mfma_f32_16x16x32_bf16 v[16:19], a[32:35], a[104:107], v[16:19]
    ds_read_b128 a[0:3], v1 offset:16384
    v_mfma_f32_16x16x32_bf16 v[20:23], a[36:39], a[104:107], v[20:23]
    ds_read_b128 a[4:7], v1 offset:17408
    v_mfma_f32_16x16x32_bf16 v[24:27], a[40:43], a[104:107], v[24:27]
    ds_read_b128 a[8:11], v1 offset:18432
    v_mfma_f32_16x16x32_bf16 v[28:31], a[44:47], a[104:107], v[28:31]
    buffer_load_dword a226, v0, s[88:91], s78 offen
    v_mfma_f32_16x16x32_bf16 v[32:35], a[48:51], a[104:107], v[32:35]
    ds_read_b128 a[12:15], v1 offset:19456
    v_mfma_f32_16x16x32_bf16 v[36:39], a[52:55], a[104:107], v[36:39]
    ds_read_b128 a[16:19], v1 offset:20480
    v_mfma_f32_16x16x32_bf16 v[40:43], a[56:59], a[104:107], v[40:43]
    ds_read_b128 a[20:23], v1 offset:21504
    v_mfma_f32_16x16x32_bf16 v[44:47], a[60:63], a[104:107], v[44:47]
    ds_read_b128 a[24:27], v1 offset:22528
    v_mfma_f32_16x16x32_bf16 v[76:79], a[60:63], a[108:111], v[76:79]
    ds_read_b128 a[28:31], v1 offset:23552
    v_mfma_f32_16x16x32_bf16 v[72:75], a[56:59], a[108:111], v[72:75]
    s_add_u32 s78, s78, s100
    s_add_u32 m0, s42, 8192
    v_mfma_f32_16x16x32_bf16 v[68:71], a[52:55], a[108:111], v[68:71]
    buffer_load_dwordx4 v12, s[12:15], s37 offen offset:0 lds
    v_mfma_f32_16x16x32_bf16 v[64:67], a[48:51], a[108:111], v[64:67]
    ds_read_b64_tr_b16 a[64:65], v2 offset:8192
    v_mfma_f32_16x16x32_bf16 v[60:63], a[44:47], a[108:111], v[60:63]
    ds_read_b64_tr_b16 a[66:67], v2 offset:8704
    v_mfma_f32_16x16x32_bf16 v[56:59], a[40:43], a[108:111], v[56:59]
    ds_read_b64_tr_b16 a[68:69], v3 offset:8192
    v_mfma_f32_16x16x32_bf16 v[52:55], a[36:39], a[108:111], v[52:55]
    ds_read_b64_tr_b16 a[70:71], v3 offset:8704
    v_mfma_f32_16x16x32_bf16 v[48:51], a[32:35], a[108:111], v[48:51]
    ds_read_b64_tr_b16 a[72:73], v4 offset:8192
    v_mfma_f32_16x16x32_bf16 v[80:83], a[112:115], a[32:35], v[80:83]
    ds_read_b64_tr_b16 a[74:75], v4 offset:8704
    v_mfma_f32_16x16x32_bf16 v[84:87], a[112:115], a[36:39], v[84:87]
    buffer_load_dwordx4 v12, s[12:15], s37 offen offset:1024 lds
    v_mfma_f32_16x16x32_bf16 v[88:91], a[112:115], a[40:43], v[88:91]
    ds_read_b64_tr_b16 a[76:77], v5 offset:8192
    v_mfma_f32_16x16x32_bf16 v[92:95], a[112:115], a[44:47], v[92:95]
    ds_read_b64_tr_b16 a[78:79], v5 offset:8704
    v_mfma_f32_16x16x32_bf16 v[96:99], a[112:115], a[48:51], v[96:99]
    ds_read_b64_tr_b16 a[80:81], v6 offset:8192
    v_mfma_f32_16x16x32_bf16 v[100:103], a[112:115], a[52:55], v[100:103]
    ds_read_b64_tr_b16 a[82:83], v6 offset:8704
    v_mfma_f32_16x16x32_bf16 v[104:107], a[112:115], a[56:59], v[104:107]
    ds_read_b64_tr_b16 a[84:85], v7 offset:8192
    v_mfma_f32_16x16x32_bf16 v[108:111], a[112:115], a[60:63], v[108:111]
    ds_read_b64_tr_b16 a[86:87], v7 offset:8704
    v_mfma_f32_16x16x32_bf16 v[140:143], a[116:119], a[60:63], v[140:143]
    buffer_load_dwordx4 v12, s[12:15], s37 offen offset:2048 lds
    v_mfma_f32_16x16x32_bf16 v[136:139], a[116:119], a[56:59], v[136:139]
    ds_read_b64_tr_b16 a[88:89], v8 offset:8192
    v_mfma_f32_16x16x32_bf16 v[132:135], a[116:119], a[52:55], v[132:135]
    ds_read_b64_tr_b16 a[90:91], v8 offset:8704
    v_mfma_f32_16x16x32_bf16 v[128:131], a[116:119], a[48:51], v[128:131]
    ds_read_b64_tr_b16 a[92:93], v9 offset:8192
    v_mfma_f32_16x16x32_bf16 v[124:127], a[116:119], a[44:47], v[124:127]
    ds_read_b64_tr_b16 a[94:95], v9 offset:8704
    v_mfma_f32_16x16x32_bf16 v[120:123], a[116:119], a[40:43], v[120:123]
    ds_read_b64_tr_b16 a[96:97], v10 offset:8192
    v_mfma_f32_16x16x32_bf16 v[116:119], a[116:119], a[36:39], v[116:119]
    ds_read_b64_tr_b16 a[98:99], v10 offset:8704
    v_mfma_f32_16x16x32_bf16 v[112:115], a[116:119], a[32:35], v[112:115]
    buffer_load_dwordx4 v12, s[12:15], s37 offen offset:3072 lds
    v_mfma_f32_16x16x32_bf16 v[144:147], a[120:123], a[32:35], v[144:147]
    ds_read_b64_tr_b16 a[100:101], v11 offset:8192
    v_mfma_f32_16x16x32_bf16 v[148:151], a[120:123], a[36:39], v[148:151]
    ds_read_b64_tr_b16 a[102:103], v11 offset:8704
    v_mfma_f32_16x16x32_bf16 v[152:155], a[120:123], a[40:43], v[152:155]
    v_mfma_f32_16x16x32_bf16 v[156:159], a[120:123], a[44:47], v[156:159]
    v_mfma_f32_16x16x32_bf16 v[160:163], a[120:123], a[48:51], v[160:163]
    v_mfma_f32_16x16x32_bf16 v[164:167], a[120:123], a[52:55], v[164:167]
    s_add_u32 s37, s37, 0x4000
    s_add_u32 m0, s43, 4096
    v_mfma_f32_16x16x32_bf16 v[168:171], a[120:123], a[56:59], v[168:171]
    buffer_load_dwordx4 v13, s[16:19], s38 offen lds
    v_mfma_f32_16x16x32_bf16 v[172:175], a[120:123], a[60:63], v[172:175]
    v_mfma_f32_16x16x32_bf16 v[204:207], a[124:127], a[60:63], v[204:207]
    v_mfma_f32_16x16x32_bf16 v[200:203], a[124:127], a[56:59], v[200:203]
    v_mfma_f32_16x16x32_bf16 v[196:199], a[124:127], a[52:55], v[196:199]
    v_mfma_f32_16x16x32_bf16 v[192:195], a[124:127], a[48:51], v[192:195]
    v_mfma_f32_16x16x32_bf16 v[188:191], a[124:127], a[44:47], v[188:191]
    s_add_u32 m0, s43, 20480
    v_mfma_f32_16x16x32_bf16 v[184:187], a[124:127], a[40:43], v[184:187]
    buffer_load_dwordx4 v14, s[20:23], s39 offen lds
    v_mfma_f32_16x16x32_bf16 v[180:183], a[124:127], a[36:39], v[180:183]
    v_mfma_f32_16x16x32_bf16 v[176:179], a[124:127], a[32:35], v[176:179]
    v_mfma_f32_16x16x32_bf16 v[208:211], a[128:131], a[32:35], v[208:211]
    v_mfma_f32_16x16x32_bf16 v[212:215], a[128:131], a[36:39], v[212:215]
    v_mfma_f32_16x16x32_bf16 v[216:219], a[128:131], a[40:43], v[216:219]
    v_mfma_f32_16x16x32_bf16 v[220:223], a[128:131], a[44:47], v[220:223]
    s_add_u32 m0, s43, 36864
    v_mfma_f32_16x16x32_bf16 v[224:227], a[128:131], a[48:51], v[224:227]
    buffer_load_dwordx4 v15, s[24:27], s40 offen lds
    v_mfma_f32_16x16x32_bf16 v[228:231], a[128:131], a[52:55], v[228:231]
    v_mfma_f32_16x16x32_bf16 v[232:235], a[128:131], a[56:59], v[232:235]
    v_mfma_f32_16x16x32_bf16 v[236:239], a[128:131], a[60:63], v[236:239]
    v_mfma_f32_16x16x32_bf16 a[156:159], a[132:135], a[60:63], a[156:159]
    v_mfma_f32_16x16x32_bf16 a[152:155], a[132:135], a[56:59], a[152:155]
    v_mfma_f32_16x16x32_bf16 a[148:151], a[132:135], a[52:55], a[148:151]
    s_add_u32 m0, s43, 53248
    v_mfma_f32_16x16x32_bf16 a[144:147], a[132:135], a[48:51], a[144:147]
    buffer_load_dwordx4 v14, s[28:31], s39 offen lds
    v_mfma_f32_16x16x32_bf16 v[252:255], a[132:135], a[44:47], v[252:255]
    v_mfma_f32_16x16x32_bf16 v[248:251], a[132:135], a[40:43], v[248:251]
    v_mfma_f32_16x16x32_bf16 v[244:247], a[132:135], a[36:39], v[244:247]
    v_mfma_f32_16x16x32_bf16 v[240:243], a[132:135], a[32:35], v[240:243]
    v_mfma_f32_16x16x32_bf16 a[160:163], a[136:139], a[32:35], a[160:163]
    v_mfma_f32_16x16x32_bf16 a[164:167], a[136:139], a[36:39], a[164:167]
    s_add_u32 m0, s43, 69632
    v_mfma_f32_16x16x32_bf16 a[168:171], a[136:139], a[40:43], a[168:171]
    buffer_load_dwordx4 v15, s[32:35], s40 offen lds
    v_mfma_f32_16x16x32_bf16 a[172:175], a[136:139], a[44:47], a[172:175]
    s_add_u32 s38, s38, 196608
    v_mfma_f32_16x16x32_bf16 a[176:179], a[136:139], a[48:51], a[176:179]
    s_add_u32 s39, s39, s41
    v_mfma_f32_16x16x32_bf16 a[180:183], a[136:139], a[52:55], a[180:183]
    s_add_u32 s40, s40, 229376
    v_mfma_f32_16x16x32_bf16 a[184:187], a[136:139], a[56:59], a[184:187]
    v_mfma_f32_16x16x32_bf16 a[188:191], a[136:139], a[60:63], a[188:191]
    v_mfma_f32_16x16x32_bf16 a[220:223], a[140:143], a[60:63], a[220:223]
    v_mfma_f32_16x16x32_bf16 a[216:219], a[140:143], a[56:59], a[216:219]
    v_mfma_f32_16x16x32_bf16 a[212:215], a[140:143], a[52:55], a[212:215]
    v_mfma_f32_16x16x32_bf16 a[208:211], a[140:143], a[48:51], a[208:211]
    v_mfma_f32_16x16x32_bf16 a[204:207], a[140:143], a[44:47], a[204:207]
    v_mfma_f32_16x16x32_bf16 a[200:203], a[140:143], a[40:43], a[200:203]
    v_mfma_f32_16x16x32_bf16 a[196:199], a[140:143], a[36:39], a[196:199]
    v_mfma_f32_16x16x32_bf16 a[192:195], a[140:143], a[32:35], a[192:195]
    s_waitcnt vmcnt(20) lgkmcnt(0)
    s_barrier
    v_mfma_f32_16x16x32_bf16 v[16:19], a[0:3], a[64:67], v[16:19]
    ds_read_b128 a[32:35], v1 offset:24576
    v_mfma_f32_16x16x32_bf16 v[20:23], a[4:7], a[64:67], v[20:23]
    ds_read_b128 a[36:39], v1 offset:25600
    v_mfma_f32_16x16x32_bf16 v[24:27], a[8:11], a[64:67], v[24:27]
    ds_read_b128 a[40:43], v1 offset:26624
    v_mfma_f32_16x16x32_bf16 v[28:31], a[12:15], a[64:67], v[28:31]
    buffer_load_dword a226, v0, s[88:91], s78 offen
    v_mfma_f32_16x16x32_bf16 v[32:35], a[16:19], a[64:67], v[32:35]
    ds_read_b128 a[44:47], v1 offset:27648
    v_mfma_f32_16x16x32_bf16 v[36:39], a[20:23], a[64:67], v[36:39]
    ds_read_b128 a[48:51], v1 offset:28672
    v_mfma_f32_16x16x32_bf16 v[40:43], a[24:27], a[64:67], v[40:43]
    ds_read_b128 a[52:55], v1 offset:29696
    v_mfma_f32_16x16x32_bf16 v[44:47], a[28:31], a[64:67], v[44:47]
    ds_read_b128 a[56:59], v1 offset:30720
    v_mfma_f32_16x16x32_bf16 v[76:79], a[28:31], a[68:71], v[76:79]
    ds_read_b128 a[60:63], v1 offset:31744
    v_mfma_f32_16x16x32_bf16 v[72:75], a[24:27], a[68:71], v[72:75]
    s_add_u32 s78, s78, s100
    s_add_u32 m0, s42, 16384
    v_mfma_f32_16x16x32_bf16 v[68:71], a[20:23], a[68:71], v[68:71]
    buffer_load_dwordx4 v12, s[12:15], s37 offen offset:0 lds
    v_mfma_f32_16x16x32_bf16 v[64:67], a[16:19], a[68:71], v[64:67]
    ds_read_b64_tr_b16 a[104:105], v2 offset:12288
    v_mfma_f32_16x16x32_bf16 v[60:63], a[12:15], a[68:71], v[60:63]
    ds_read_b64_tr_b16 a[106:107], v2 offset:12800
    v_mfma_f32_16x16x32_bf16 v[56:59], a[8:11], a[68:71], v[56:59]
    ds_read_b64_tr_b16 a[108:109], v3 offset:12288
    v_mfma_f32_16x16x32_bf16 v[52:55], a[4:7], a[68:71], v[52:55]
    ds_read_b64_tr_b16 a[110:111], v3 offset:12800
    v_mfma_f32_16x16x32_bf16 v[48:51], a[0:3], a[68:71], v[48:51]
    ds_read_b64_tr_b16 a[112:113], v4 offset:12288
    v_mfma_f32_16x16x32_bf16 v[80:83], a[72:75], a[0:3], v[80:83]
    ds_read_b64_tr_b16 a[114:115], v4 offset:12800
    v_mfma_f32_16x16x32_bf16 v[84:87], a[72:75], a[4:7], v[84:87]
    buffer_load_dwordx4 v12, s[12:15], s37 offen offset:1024 lds
    v_mfma_f32_16x16x32_bf16 v[88:91], a[72:75], a[8:11], v[88:91]
    ds_read_b64_tr_b16 a[116:117], v5 offset:12288
    v_mfma_f32_16x16x32_bf16 v[92:95], a[72:75], a[12:15], v[92:95]
    ds_read_b64_tr_b16 a[118:119], v5 offset:12800
    v_mfma_f32_16x16x32_bf16 v[96:99], a[72:75], a[16:19], v[96:99]
    ds_read_b64_tr_b16 a[120:121], v6 offset:12288
    v_mfma_f32_16x16x32_bf16 v[100:103], a[72:75], a[20:23], v[100:103]
    ds_read_b64_tr_b16 a[122:123], v6 offset:12800
    v_mfma_f32_16x16x32_bf16 v[104:107], a[72:75], a[24:27], v[104:107]
    ds_read_b64_tr_b16 a[124:125], v7 offset:12288
    v_mfma_f32_16x16x32_bf16 v[108:111], a[72:75], a[28:31], v[108:111]
    ds_read_b64_tr_b16 a[126:127], v7 offset:12800
    v_mfma_f32_16x16x32_bf16 v[140:143], a[76:79], a[28:31], v[140:143]
    buffer_load_dwordx4 v12, s[12:15], s37 offen offset:2048 lds
    v_mfma_f32_16x16x32_bf16 v[136:139], a[76:79], a[24:27], v[136:139]
    ds_read_b64_tr_b16 a[128:129], v8 offset:12288
    v_mfma_f32_16x16x32_bf16 v[132:135], a[76:79], a[20:23], v[132:135]
    ds_read_b64_tr_b16 a[130:131], v8 offset:12800
    v_mfma_f32_16x16x32_bf16 v[128:131], a[76:79], a[16:19], v[128:131]
    ds_read_b64_tr_b16 a[132:133], v9 offset:12288
    v_mfma_f32_16x16x32_bf16 v[124:127], a[76:79], a[12:15], v[124:127]
    ds_read_b64_tr_b16 a[134:135], v9 offset:12800
    v_mfma_f32_16x16x32_bf16 v[120:123], a[76:79], a[8:11], v[120:123]
    ds_read_b64_tr_b16 a[136:137], v10 offset:12288
    v_mfma_f32_16x16x32_bf16 v[116:119], a[76:79], a[4:7], v[116:119]
    ds_read_b64_tr_b16 a[138:139], v10 offset:12800
    v_mfma_f32_16x16x32_bf16 v[112:115], a[76:79], a[0:3], v[112:115]
    buffer_load_dwordx4 v12, s[12:15], s37 offen offset:3072 lds
    v_mfma_f32_16x16x32_bf16 v[144:147], a[80:83], a[0:3], v[144:147]
    ds_read_b64_tr_b16 a[140:141], v11 offset:12288
    v_mfma_f32_16x16x32_bf16 v[148:151], a[80:83], a[4:7], v[148:151]
    ds_read_b64_tr_b16 a[142:143], v11 offset:12800
    v_mfma_f32_16x16x32_bf16 v[152:155], a[80:83], a[8:11], v[152:155]
    v_mfma_f32_16x16x32_bf16 v[156:159], a[80:83], a[12:15], v[156:159]
    v_mfma_f32_16x16x32_bf16 v[160:163], a[80:83], a[16:19], v[160:163]
    v_mfma_f32_16x16x32_bf16 v[164:167], a[80:83], a[20:23], v[164:167]
    s_add_u32 s37, s37, 0x4000
    s_add_u32 m0, s43, 8192
    v_mfma_f32_16x16x32_bf16 v[168:171], a[80:83], a[24:27], v[168:171]
    buffer_load_dwordx4 v13, s[16:19], s38 offen lds
    v_mfma_f32_16x16x32_bf16 v[172:175], a[80:83], a[28:31], v[172:175]
    v_mfma_f32_16x16x32_bf16 v[204:207], a[84:87], a[28:31], v[204:207]
    v_mfma_f32_16x16x32_bf16 v[200:203], a[84:87], a[24:27], v[200:203]
    v_mfma_f32_16x16x32_bf16 v[196:199], a[84:87], a[20:23], v[196:199]
    v_mfma_f32_16x16x32_bf16 v[192:195], a[84:87], a[16:19], v[192:195]
    v_mfma_f32_16x16x32_bf16 v[188:191], a[84:87], a[12:15], v[188:191]
    s_add_u32 m0, s43, 24576
    v_mfma_f32_16x16x32_bf16 v[184:187], a[84:87], a[8:11], v[184:187]
    buffer_load_dwordx4 v14, s[20:23], s39 offen lds
    v_mfma_f32_16x16x32_bf16 v[180:183], a[84:87], a[4:7], v[180:183]
    v_mfma_f32_16x16x32_bf16 v[176:179], a[84:87], a[0:3], v[176:179]
    v_mfma_f32_16x16x32_bf16 v[208:211], a[88:91], a[0:3], v[208:211]
    v_mfma_f32_16x16x32_bf16 v[212:215], a[88:91], a[4:7], v[212:215]
    v_mfma_f32_16x16x32_bf16 v[216:219], a[88:91], a[8:11], v[216:219]
    v_mfma_f32_16x16x32_bf16 v[220:223], a[88:91], a[12:15], v[220:223]
    s_add_u32 m0, s43, 40960
    v_mfma_f32_16x16x32_bf16 v[224:227], a[88:91], a[16:19], v[224:227]
    buffer_load_dwordx4 v15, s[24:27], s40 offen lds
    v_mfma_f32_16x16x32_bf16 v[228:231], a[88:91], a[20:23], v[228:231]
    v_mfma_f32_16x16x32_bf16 v[232:235], a[88:91], a[24:27], v[232:235]
    v_mfma_f32_16x16x32_bf16 v[236:239], a[88:91], a[28:31], v[236:239]
    v_mfma_f32_16x16x32_bf16 a[156:159], a[92:95], a[28:31], a[156:159]
    v_mfma_f32_16x16x32_bf16 a[152:155], a[92:95], a[24:27], a[152:155]
    v_mfma_f32_16x16x32_bf16 a[148:151], a[92:95], a[20:23], a[148:151]
    s_add_u32 m0, s43, 57344
    v_mfma_f32_16x16x32_bf16 a[144:147], a[92:95], a[16:19], a[144:147]
    buffer_load_dwordx4 v14, s[28:31], s39 offen lds
    v_mfma_f32_16x16x32_bf16 v[252:255], a[92:95], a[12:15], v[252:255]
    v_mfma_f32_16x16x32_bf16 v[248:251], a[92:95], a[8:11], v[248:251]
    v_mfma_f32_16x16x32_bf16 v[244:247], a[92:95], a[4:7], v[244:247]
    v_mfma_f32_16x16x32_bf16 v[240:243], a[92:95], a[0:3], v[240:243]
    v_mfma_f32_16x16x32_bf16 a[160:163], a[96:99], a[0:3], a[160:163]
    v_mfma_f32_16x16x32_bf16 a[164:167], a[96:99], a[4:7], a[164:167]
    s_add_u32 m0, s43, 73728
    v_mfma_f32_16x16x32_bf16 a[168:171], a[96:99], a[8:11], a[168:171]
    buffer_load_dwordx4 v15, s[32:35], s40 offen lds
    v_mfma_f32_16x16x32_bf16 a[172:175], a[96:99], a[12:15], a[172:175]
    s_add_u32 s38, s38, 196608
    v_mfma_f32_16x16x32_bf16 a[176:179], a[96:99], a[16:19], a[176:179]
    s_add_u32 s39, s39, s41
    v_mfma_f32_16x16x32_bf16 a[180:183], a[96:99], a[20:23], a[180:183]
    s_add_u32 s40, s40, 229376
    v_mfma_f32_16x16x32_bf16 a[184:187], a[96:99], a[24:27], a[184:187]
    v_mfma_f32_16x16x32_bf16 a[188:191], a[96:99], a[28:31], a[188:191]
    v_mfma_f32_16x16x32_bf16 a[220:223], a[100:103], a[28:31], a[220:223]
    v_mfma_f32_16x16x32_bf16 a[216:219], a[100:103], a[24:27], a[216:219]
    v_mfma_f32_16x16x32_bf16 a[212:215], a[100:103], a[20:23], a[212:215]
    v_mfma_f32_16x16x32_bf16 a[208:211], a[100:103], a[16:19], a[208:211]
    v_mfma_f32_16x16x32_bf16 a[204:207], a[100:103], a[12:15], a[204:207]
    v_mfma_f32_16x16x32_bf16 a[200:203], a[100:103], a[8:11], a[200:203]
    v_mfma_f32_16x16x32_bf16 a[196:199], a[100:103], a[4:7], a[196:199]
    v_mfma_f32_16x16x32_bf16 a[192:195], a[100:103], a[0:3], a[192:195]
    s_waitcnt vmcnt(20) lgkmcnt(0)
    s_barrier
    v_mfma_f32_16x16x32_bf16 v[16:19], a[32:35], a[104:107], v[16:19]
    ds_read_b128 a[0:3], v1 offset:0
    v_mfma_f32_16x16x32_bf16 v[20:23], a[36:39], a[104:107], v[20:23]
    ds_read_b128 a[4:7], v1 offset:1024
    v_mfma_f32_16x16x32_bf16 v[24:27], a[40:43], a[104:107], v[24:27]
    ds_read_b128 a[8:11], v1 offset:2048
    v_mfma_f32_16x16x32_bf16 v[28:31], a[44:47], a[104:107], v[28:31]
    buffer_load_dword a226, v0, s[88:91], s78 offen
    v_mfma_f32_16x16x32_bf16 v[32:35], a[48:51], a[104:107], v[32:35]
    ds_read_b128 a[12:15], v1 offset:3072
    v_mfma_f32_16x16x32_bf16 v[36:39], a[52:55], a[104:107], v[36:39]
    ds_read_b128 a[16:19], v1 offset:4096
    v_mfma_f32_16x16x32_bf16 v[40:43], a[56:59], a[104:107], v[40:43]
    ds_read_b128 a[20:23], v1 offset:5120
    v_mfma_f32_16x16x32_bf16 v[44:47], a[60:63], a[104:107], v[44:47]
    ds_read_b128 a[24:27], v1 offset:6144
    v_mfma_f32_16x16x32_bf16 v[76:79], a[60:63], a[108:111], v[76:79]
    ds_read_b128 a[28:31], v1 offset:7168
    v_mfma_f32_16x16x32_bf16 v[72:75], a[56:59], a[108:111], v[72:75]
    s_add_u32 s78, s78, s100
    s_add_u32 m0, s42, 24576
    v_mfma_f32_16x16x32_bf16 v[68:71], a[52:55], a[108:111], v[68:71]
    buffer_load_dwordx4 v12, s[12:15], s37 offen offset:0 lds
    v_mfma_f32_16x16x32_bf16 v[64:67], a[48:51], a[108:111], v[64:67]
    ds_read_b64_tr_b16 a[64:65], v2 offset:0
    v_mfma_f32_16x16x32_bf16 v[60:63], a[44:47], a[108:111], v[60:63]
    ds_read_b64_tr_b16 a[66:67], v2 offset:512
    v_mfma_f32_16x16x32_bf16 v[56:59], a[40:43], a[108:111], v[56:59]
    ds_read_b64_tr_b16 a[68:69], v3 offset:0
    v_mfma_f32_16x16x32_bf16 v[52:55], a[36:39], a[108:111], v[52:55]
    ds_read_b64_tr_b16 a[70:71], v3 offset:512
    v_mfma_f32_16x16x32_bf16 v[48:51], a[32:35], a[108:111], v[48:51]
    ds_read_b64_tr_b16 a[72:73], v4 offset:0
    v_mfma_f32_16x16x32_bf16 v[80:83], a[112:115], a[32:35], v[80:83]
    ds_read_b64_tr_b16 a[74:75], v4 offset:512
    v_mfma_f32_16x16x32_bf16 v[84:87], a[112:115], a[36:39], v[84:87]
    buffer_load_dwordx4 v12, s[12:15], s37 offen offset:1024 lds
    v_mfma_f32_16x16x32_bf16 v[88:91], a[112:115], a[40:43], v[88:91]
    ds_read_b64_tr_b16 a[76:77], v5 offset:0
    v_mfma_f32_16x16x32_bf16 v[92:95], a[112:115], a[44:47], v[92:95]
    ds_read_b64_tr_b16 a[78:79], v5 offset:512
    v_mfma_f32_16x16x32_bf16 v[96:99], a[112:115], a[48:51], v[96:99]
    ds_read_b64_tr_b16 a[80:81], v6 offset:0
    v_mfma_f32_16x16x32_bf16 v[100:103], a[112:115], a[52:55], v[100:103]
    ds_read_b64_tr_b16 a[82:83], v6 offset:512
    v_mfma_f32_16x16x32_bf16 v[104:107], a[112:115], a[56:59], v[104:107]
    ds_read_b64_tr_b16 a[84:85], v7 offset:0
    v_mfma_f32_16x16x32_bf16 v[108:111], a[112:115], a[60:63], v[108:111]
    ds_read_b64_tr_b16 a[86:87], v7 offset:512
    v_mfma_f32_16x16x32_bf16 v[140:143], a[116:119], a[60:63], v[140:143]
    buffer_load_dwordx4 v12, s[12:15], s37 offen offset:2048 lds
    v_mfma_f32_16x16x32_bf16 v[136:139], a[116:119], a[56:59], v[136:139]
    ds_read_b64_tr_b16 a[88:89], v8 offset:0
    v_mfma_f32_16x16x32_bf16 v[132:135], a[116:119], a[52:55], v[132:135]
    ds_read_b64_tr_b16 a[90:91], v8 offset:512
    v_mfma_f32_16x16x32_bf16 v[128:131], a[116:119], a[48:51], v[128:131]
    ds_read_b64_tr_b16 a[92:93], v9 offset:0
    v_mfma_f32_16x16x32_bf16 v[124:127], a[116:119], a[44:47], v[124:127]
    ds_read_b64_tr_b16 a[94:95], v9 offset:512
    v_mfma_f32_16x16x32_bf16 v[120:123], a[116:119], a[40:43], v[120:123]
    ds_read_b64_tr_b16 a[96:97], v10 offset:0
    v_mfma_f32_16x16x32_bf16 v[116:119], a[116:119], a[36:39], v[116:119]
    ds_read_b64_tr_b16 a[98:99], v10 offset:512
    v_mfma_f32_16x16x32_bf16 v[112:115], a[116:119], a[32:35], v[112:115]
    buffer_load_dwordx4 v12, s[12:15], s37 offen offset:3072 lds
    v_mfma_f32_16x16x32_bf16 v[144:147], a[120:123], a[32:35], v[144:147]
    ds_read_b64_tr_b16 a[100:101], v11 offset:0
    v_mfma_f32_16x16x32_bf16 v[148:151], a[120:123], a[36:39], v[148:151]
    ds_read_b64_tr_b16 a[102:103], v11 offset:512
    v_mfma_f32_16x16x32_bf16 v[152:155], a[120:123], a[40:43], v[152:155]
    v_mfma_f32_16x16x32_bf16 v[156:159], a[120:123], a[44:47], v[156:159]
    v_mfma_f32_16x16x32_bf16 v[160:163], a[120:123], a[48:51], v[160:163]
    v_mfma_f32_16x16x32_bf16 v[164:167], a[120:123], a[52:55], v[164:167]
    s_add_u32 s37, s37, 0x4000
    s_add_u32 m0, s43, 12288
    v_mfma_f32_16x16x32_bf16 v[168:171], a[120:123], a[56:59], v[168:171]
    buffer_load_dwordx4 v13, s[16:19], s38 offen lds
    v_mfma_f32_16x16x32_bf16 v[172:175], a[120:123], a[60:63], v[172:175]
    v_mfma_f32_16x16x32_bf16 v[204:207], a[124:127], a[60:63], v[204:207]
    v_mfma_f32_16x16x32_bf16 v[200:203], a[124:127], a[56:59], v[200:203]
    v_mfma_f32_16x16x32_bf16 v[196:199], a[124:127], a[52:55], v[196:199]
    v_mfma_f32_16x16x32_bf16 v[192:195], a[124:127], a[48:51], v[192:195]
    v_mfma_f32_16x16x32_bf16 v[188:191], a[124:127], a[44:47], v[188:191]
    s_add_u32 m0, s43, 28672
    v_mfma_f32_16x16x32_bf16 v[184:187], a[124:127], a[40:43], v[184:187]
    buffer_load_dwordx4 v14, s[20:23], s39 offen lds
    v_mfma_f32_16x16x32_bf16 v[180:183], a[124:127], a[36:39], v[180:183]
    v_mfma_f32_16x16x32_bf16 v[176:179], a[124:127], a[32:35], v[176:179]
    v_mfma_f32_16x16x32_bf16 v[208:211], a[128:131], a[32:35], v[208:211]
    v_mfma_f32_16x16x32_bf16 v[212:215], a[128:131], a[36:39], v[212:215]
    v_mfma_f32_16x16x32_bf16 v[216:219], a[128:131], a[40:43], v[216:219]
    v_mfma_f32_16x16x32_bf16 v[220:223], a[128:131], a[44:47], v[220:223]
    s_add_u32 m0, s43, 45056
    v_mfma_f32_16x16x32_bf16 v[224:227], a[128:131], a[48:51], v[224:227]
    buffer_load_dwordx4 v15, s[24:27], s40 offen lds
    v_mfma_f32_16x16x32_bf16 v[228:231], a[128:131], a[52:55], v[228:231]
    v_mfma_f32_16x16x32_bf16 v[232:235], a[128:131], a[56:59], v[232:235]
    v_mfma_f32_16x16x32_bf16 v[236:239], a[128:131], a[60:63], v[236:239]
    v_mfma_f32_16x16x32_bf16 a[156:159], a[132:135], a[60:63], a[156:159]
    v_mfma_f32_16x16x32_bf16 a[152:155], a[132:135], a[56:59], a[152:155]
    v_mfma_f32_16x16x32_bf16 a[148:151], a[132:135], a[52:55], a[148:151]
    s_add_u32 m0, s43, 61440
    v_mfma_f32_16x16x32_bf16 a[144:147], a[132:135], a[48:51], a[144:147]
    buffer_load_dwordx4 v14, s[28:31], s39 offen lds
    v_mfma_f32_16x16x32_bf16 v[252:255], a[132:135], a[44:47], v[252:255]
    v_mfma_f32_16x16x32_bf16 v[248:251], a[132:135], a[40:43], v[248:251]
    v_mfma_f32_16x16x32_bf16 v[244:247], a[132:135], a[36:39], v[244:247]
    v_mfma_f32_16x16x32_bf16 v[240:243], a[132:135], a[32:35], v[240:243]
    v_mfma_f32_16x16x32_bf16 a[160:163], a[136:139], a[32:35], a[160:163]
    v_mfma_f32_16x16x32_bf16 a[164:167], a[136:139], a[36:39], a[164:167]
    s_add_u32 m0, s43, 77824
    v_mfma_f32_16x16x32_bf16 a[168:171], a[136:139], a[40:43], a[168:171]
    buffer_load_dwordx4 v15, s[32:35], s40 offen lds
    v_mfma_f32_16x16x32_bf16 a[172:175], a[136:139], a[44:47], a[172:175]
    s_add_u32 s38, s38, 196608
    v_mfma_f32_16x16x32_bf16 a[176:179], a[136:139], a[48:51], a[176:179]
    s_add_u32 s39, s39, s41
    v_mfma_f32_16x16x32_bf16 a[180:183], a[136:139], a[52:55], a[180:183]
    s_add_u32 s40, s40, 229376
    v_mfma_f32_16x16x32_bf16 a[184:187], a[136:139], a[56:59], a[184:187]
    v_mfma_f32_16x16x32_bf16 a[188:191], a[136:139], a[60:63], a[188:191]
    s_sub_u32 s44, s44, 1
    v_mfma_f32_16x16x32_bf16 a[220:223], a[140:143], a[60:63], a[220:223]
    s_cmp_eq_u32 s44, s101
    v_mfma_f32_16x16x32_bf16 a[216:219], a[140:143], a[56:59], a[216:219]
    s_cselect_b32 s88, s92, s88
    v_mfma_f32_16x16x32_bf16 a[212:215], a[140:143], a[52:55], a[212:215]
    s_cselect_b32 s89, s93, s89
    v_mfma_f32_16x16x32_bf16 a[208:211], a[140:143], a[48:51], a[208:211]
    s_cselect_b32 s90, s94, s90
    v_mfma_f32_16x16x32_bf16 a[204:207], a[140:143], a[44:47], a[204:207]
    s_cselect_b32 s78, s79, s78
    v_mfma_f32_16x16x32_bf16 a[200:203], a[140:143], a[40:43], a[200:203]
    s_cmp_lg_u32 s44, 0
    v_mfma_f32_16x16x32_bf16 a[196:199], a[140:143], a[36:39], a[196:199]
    v_mfma_f32_16x16x32_bf16 a[192:195], a[140:143], a[32:35], a[192:195]
    s_cbranch_scc1 L_g1_loop_v
    v_mbcnt_lo_u32_b32 v0, -1, 0
    v_mbcnt_hi_u32_b32 v0, -1, v0
    s_load_dwordx2 s[6:7], s[0:1], 48
    s_load_dwordx2 s[8:9], s[0:1], 16
    s_load_dwordx2 s[10:11], s[0:1], 0
    s_load_dwordx2 s[12:13], s[0:1], 56
    v_lshrrev_b32 v13, 4, v0
    v_lshlrev_b32 v13, 9, v13
    v_and_b32 v14, 15, v0
    v_lshl_add_u32 v13, v14, 4, v13
    s_waitcnt vmcnt(20) lgkmcnt(0)
    s_barrier
    v_mfma_f32_16x16x32_bf16 v[16:19], a[0:3], a[64:67], v[16:19]
    ds_read_b128 a[32:35], v1 offset:8192
    v_mfma_f32_16x16x32_bf16 v[20:23], a[4:7], a[64:67], v[20:23]
    ds_read_b128 a[36:39], v1 offset:9216
    v_mfma_f32_16x16x32_bf16 v[24:27], a[8:11], a[64:67], v[24:27]
    ds_read_b128 a[40:43], v1 offset:10240
    v_mfma_f32_16x16x32_bf16 v[28:31], a[12:15], a[64:67], v[28:31]
    ds_read_b128 a[44:47], v1 offset:11264
    v_mfma_f32_16x16x32_bf16 v[32:35], a[16:19], a[64:67], v[32:35]
    ds_read_b128 a[48:51], v1 offset:12288
    v_mfma_f32_16x16x32_bf16 v[36:39], a[20:23], a[64:67], v[36:39]
    ds_read_b128 a[52:55], v1 offset:13312
    v_mfma_f32_16x16x32_bf16 v[40:43], a[24:27], a[64:67], v[40:43]
    ds_read_b128 a[56:59], v1 offset:14336
    v_mfma_f32_16x16x32_bf16 v[44:47], a[28:31], a[64:67], v[44:47]
    ds_read_b128 a[60:63], v1 offset:15360
    v_mfma_f32_16x16x32_bf16 v[76:79], a[28:31], a[68:71], v[76:79]
    ds_read_b64_tr_b16 a[104:105], v2 offset:4096
    v_mfma_f32_16x16x32_bf16 v[72:75], a[24:27], a[68:71], v[72:75]
    ds_read_b64_tr_b16 a[106:107], v2 offset:4608
    v_mfma_f32_16x16x32_bf16 v[68:71], a[20:23], a[68:71], v[68:71]
    ds_read_b64_tr_b16 a[108:109], v3 offset:4096
    v_mfma_f32_16x16x32_bf16 v[64:67], a[16:19], a[68:71], v[64:67]
    ds_read_b64_tr_b16 a[110:111], v3 offset:4608
    v_mfma_f32_16x16x32_bf16 v[60:63], a[12:15], a[68:71], v[60:63]
    ds_read_b64_tr_b16 a[112:113], v4 offset:4096
    v_mfma_f32_16x16x32_bf16 v[56:59], a[8:11], a[68:71], v[56:59]
    ds_read_b64_tr_b16 a[114:115], v4 offset:4608
    v_mfma_f32_16x16x32_bf16 v[52:55], a[4:7], a[68:71], v[52:55]
    ds_read_b64_tr_b16 a[128:129], v8 offset:4096
    v_mfma_f32_16x16x32_bf16 v[48:51], a[0:3], a[68:71], v[48:51]
    ds_read_b64_tr_b16 a[130:131], v8 offset:4608
    v_mfma_f32_16x16x32_bf16 v[80:83], a[72:75], a[0:3], v[80:83]
    v_mfma_f32_16x16x32_bf16 v[84:87], a[72:75], a[4:7], v[84:87]
    v_mfma_f32_16x16x32_bf16 v[88:91], a[72:75], a[8:11], v[88:91]
    v_mfma_f32_16x16x32_bf16 v[92:95], a[72:75], a[12:15], v[92:95]
    v_mfma_f32_16x16x32_bf16 v[96:99], a[72:75], a[16:19], v[96:99]
    v_mfma_f32_16x16x32_bf16 v[100:103], a[72:75], a[20:23], v[100:103]
    v_mfma_f32_16x16x32_bf16 v[104:107], a[72:75], a[24:27], v[104:107]
    v_mfma_f32_16x16x32_bf16 v[108:111], a[72:75], a[28:31], v[108:111]
    v_mfma_f32_16x16x32_bf16 v[208:211], a[88:91], a[0:3], v[208:211]
    v_mfma_f32_16x16x32_bf16 v[212:215], a[88:91], a[4:7], v[212:215]
    v_mfma_f32_16x16x32_bf16 v[216:219], a[88:91], a[8:11], v[216:219]
    v_mfma_f32_16x16x32_bf16 v[220:223], a[88:91], a[12:15], v[220:223]
    v_mfma_f32_16x16x32_bf16 v[224:227], a[88:91], a[16:19], v[224:227]
    v_mfma_f32_16x16x32_bf16 v[228:231], a[88:91], a[20:23], v[228:231]
    v_mfma_f32_16x16x32_bf16 v[232:235], a[88:91], a[24:27], v[232:235]
    v_mfma_f32_16x16x32_bf16 v[236:239], a[88:91], a[28:31], v[236:239]
    s_waitcnt vmcnt(10) lgkmcnt(0)
    s_barrier
    v_mfma_f32_16x16x32_bf16 v[16:19], a[32:35], a[104:107], v[16:19]
    ds_read_b128 a[0:3], v1 offset:16384
    v_mfma_f32_16x16x32_bf16 v[20:23], a[36:39], a[104:107], v[20:23]
    ds_read_b128 a[4:7], v1 offset:17408
    v_mfma_f32_16x16x32_bf16 v[24:27], a[40:43], a[104:107], v[24:27]
    ds_read_b128 a[8:11], v1 offset:18432
    v_mfma_f32_16x16x32_bf16 v[28:31], a[44:47], a[104:107], v[28:31]
    ds_read_b128 a[12:15], v1 offset:19456
    v_mfma_f32_16x16x32_bf16 v[32:35], a[48:51], a[104:107], v[32:35]
    ds_read_b128 a[16:19], v1 offset:20480
    v_mfma_f32_16x16x32_bf16 v[36:39], a[52:55], a[104:107], v[36:39]
    ds_read_b128 a[20:23], v1 offset:21504
    v_mfma_f32_16x16x32_bf16 v[40:43], a[56:59], a[104:107], v[40:43]
    ds_read_b128 a[24:27], v1 offset:22528
    v_mfma_f32_16x16x32_bf16 v[44:47], a[60:63], a[104:107], v[44:47]
    ds_read_b128 a[28:31], v1 offset:23552
    v_mfma_f32_16x16x32_bf16 v[76:79], a[60:63], a[108:111], v[76:79]
    ds_read_b64_tr_b16 a[64:65], v2 offset:8192
    v_mfma_f32_16x16x32_bf16 v[72:75], a[56:59], a[108:111], v[72:75]
    ds_read_b64_tr_b16 a[66:67], v2 offset:8704
    v_mfma_f32_16x16x32_bf16 v[68:71], a[52:55], a[108:111], v[68:71]
    ds_read_b64_tr_b16 a[68:69], v3 offset:8192
    v_mfma_f32_16x16x32_bf16 v[64:67], a[48:51], a[108:111], v[64:67]
    ds_read_b64_tr_b16 a[70:71], v3 offset:8704
    v_mfma_f32_16x16x32_bf16 v[60:63], a[44:47], a[108:111], v[60:63]
    ds_read_b64_tr_b16 a[72:73], v4 offset:8192
    v_mfma_f32_16x16x32_bf16 v[56:59], a[40:43], a[108:111], v[56:59]
    ds_read_b64_tr_b16 a[74:75], v4 offset:8704
    v_mfma_f32_16x16x32_bf16 v[52:55], a[36:39], a[108:111], v[52:55]
    ds_read_b64_tr_b16 a[88:89], v8 offset:8192
    v_mfma_f32_16x16x32_bf16 v[48:51], a[32:35], a[108:111], v[48:51]
    ds_read_b64_tr_b16 a[90:91], v8 offset:8704
    v_mfma_f32_16x16x32_bf16 v[80:83], a[112:115], a[32:35], v[80:83]
    v_mfma_f32_16x16x32_bf16 v[84:87], a[112:115], a[36:39], v[84:87]
    v_mfma_f32_16x16x32_bf16 v[88:91], a[112:115], a[40:43], v[88:91]
    v_mfma_f32_16x16x32_bf16 v[92:95], a[112:115], a[44:47], v[92:95]
    v_mfma_f32_16x16x32_bf16 v[96:99], a[112:115], a[48:51], v[96:99]
    v_mfma_f32_16x16x32_bf16 v[100:103], a[112:115], a[52:55], v[100:103]
    v_mfma_f32_16x16x32_bf16 v[104:107], a[112:115], a[56:59], v[104:107]
    v_mfma_f32_16x16x32_bf16 v[108:111], a[112:115], a[60:63], v[108:111]
    v_mfma_f32_16x16x32_bf16 v[208:211], a[128:131], a[32:35], v[208:211]
    v_mfma_f32_16x16x32_bf16 v[212:215], a[128:131], a[36:39], v[212:215]
    v_mfma_f32_16x16x32_bf16 v[216:219], a[128:131], a[40:43], v[216:219]
    v_mfma_f32_16x16x32_bf16 v[220:223], a[128:131], a[44:47], v[220:223]
    v_mfma_f32_16x16x32_bf16 v[224:227], a[128:131], a[48:51], v[224:227]
    v_mfma_f32_16x16x32_bf16 v[228:231], a[128:131], a[52:55], v[228:231]
    v_mfma_f32_16x16x32_bf16 v[232:235], a[128:131], a[56:59], v[232:235]
    v_mfma_f32_16x16x32_bf16 v[236:239], a[128:131], a[60:63], v[236:239]
    s_waitcnt vmcnt(0) lgkmcnt(0)
    s_barrier
    v_mfma_f32_16x16x32_bf16 v[16:19], a[0:3], a[64:67], v[16:19]
    ds_read_b128 a[32:35], v1 offset:24576
    v_mfma_f32_16x16x32_bf16 v[20:23], a[4:7], a[64:67], v[20:23]
    ds_read_b128 a[36:39], v1 offset:25600
    v_mfma_f32_16x16x32_bf16 v[24:27], a[8:11], a[64:67], v[24:27]
    ds_read_b128 a[40:43], v1 offset:26624
    v_mfma_f32_16x16x32_bf16 v[28:31], a[12:15], a[64:67], v[28:31]
    ds_read_b128 a[44:47], v1 offset:27648
    v_mfma_f32_16x16x32_bf16 v[32:35], a[16:19], a[64:67], v[32:35]
    ds_read_b128 a[48:51], v1 offset:28672
    v_mfma_f32_16x16x32_bf16 v[36:39], a[20:23], a[64:67], v[36:39]
    ds_read_b128 a[52:55], v1 offset:29696
    v_mfma_f32_16x16x32_bf16 v[40:43], a[24:27], a[64:67], v[40:43]
    ds_read_b128 a[56:59], v1 offset:30720
    v_mfma_f32_16x16x32_bf16 v[44:47], a[28:31], a[64:67], v[44:47]
    ds_read_b128 a[60:63], v1 offset:31744
    v_mfma_f32_16x16x32_bf16 v[76:79], a[28:31], a[68:71], v[76:79]
    ds_read_b64_tr_b16 a[104:105], v2 offset:12288
    v_mfma_f32_16x16x32_bf16 v[72:75], a[24:27], a[68:71], v[72:75]
    ds_read_b64_tr_b16 a[106:107], v2 offset:12800
    v_mfma_f32_16x16x32_bf16 v[68:71], a[20:23], a[68:71], v[68:71]
    ds_read_b64_tr_b16 a[108:109], v3 offset:12288
    v_mfma_f32_16x16x32_bf16 v[64:67], a[16:19], a[68:71], v[64:67]
    ds_read_b64_tr_b16 a[110:111], v3 offset:12800
    v_mfma_f32_16x16x32_bf16 v[60:63], a[12:15], a[68:71], v[60:63]
    ds_read_b64_tr_b16 a[112:113], v4 offset:12288
    v_mfma_f32_16x16x32_bf16 v[56:59], a[8:11], a[68:71], v[56:59]
    ds_read_b64_tr_b16 a[114:115], v4 offset:12800
    v_mfma_f32_16x16x32_bf16 v[52:55], a[4:7], a[68:71], v[52:55]
    ds_read_b64_tr_b16 a[128:129], v8 offset:12288
    v_mfma_f32_16x16x32_bf16 v[48:51], a[0:3], a[68:71], v[48:51]
    ds_read_b64_tr_b16 a[130:131], v8 offset:12800
    v_mfma_f32_16x16x32_bf16 v[80:83], a[72:75], a[0:3], v[80:83]
    v_mfma_f32_16x16x32_bf16 v[84:87], a[72:75], a[4:7], v[84:87]
    v_mfma_f32_16x16x32_bf16 v[88:91], a[72:75], a[8:11], v[88:91]
    v_mfma_f32_16x16x32_bf16 v[92:95], a[72:75], a[12:15], v[92:95]
    v_mfma_f32_16x16x32_bf16 v[96:99], a[72:75], a[16:19], v[96:99]
    v_mfma_f32_16x16x32_bf16 v[100:103], a[72:75], a[20:23], v[100:103]
    v_mfma_f32_16x16x32_bf16 v[104:107], a[72:75], a[24:27], v[104:107]
    v_mfma_f32_16x16x32_bf16 v[108:111], a[72:75], a[28:31], v[108:111]
    v_mfma_f32_16x16x32_bf16 v[208:211], a[88:91], a[0:3], v[208:211]
    v_mfma_f32_16x16x32_bf16 v[212:215], a[88:91], a[4:7], v[212:215]
    v_mfma_f32_16x16x32_bf16 v[216:219], a[88:91], a[8:11], v[216:219]
    v_mfma_f32_16x16x32_bf16 v[220:223], a[88:91], a[12:15], v[220:223]
    v_mfma_f32_16x16x32_bf16 v[224:227], a[88:91], a[16:19], v[224:227]
    v_mfma_f32_16x16x32_bf16 v[228:231], a[88:91], a[20:23], v[228:231]
    v_mfma_f32_16x16x32_bf16 v[232:235], a[88:91], a[24:27], v[232:235]
    v_mfma_f32_16x16x32_bf16 v[236:239], a[88:91], a[28:31], v[236:239]
    s_waitcnt lgkmcnt(0)
    v_mfma_f32_16x16x32_bf16 v[16:19], a[32:35], a[104:107], v[16:19]
    ds_read_b128 a[0:3], v1 offset:0
    s_getpc_b64 s[96:97]
L_pc_fv:
    v_mfma_f32_16x16x32_bf16 v[20:23], a[36:39], a[104:107], v[20:23]
    ds_read_b128 a[4:7], v1 offset:1024
    s_add_u32 s96, s96, L_p2_entry - L_pc_fv
    v_mfma_f32_16x16x32_bf16 v[24:27], a[40:43], a[104:107], v[24:27]
    ds_read_b128 a[8:11], v1 offset:2048
    s_addc_u32 s97, s97, 0
    v_mfma_f32_16x16x32_bf16 v[28:31], a[44:47], a[104:107], v[28:31]
    ds_read_b128 a[12:15], v1 offset:3072
    s_mov_b32 s98, L_g1_done - L_p2_entry
    v_mfma_f32_16x16x32_bf16 v[32:35], a[48:51], a[104:107], v[32:35]
    ds_read_b128 a[16:19], v1 offset:4096
    s_mov_b32 s99, 0x00020000
    v_mfma_f32_16x16x32_bf16 v[36:39], a[52:55], a[104:107], v[36:39]
    ds_read_b128 a[20:23], v1 offset:5120
    s_lshr_b32 s52, s2, 3
    v_mfma_f32_16x16x32_bf16 v[40:43], a[56:59], a[104:107], v[40:43]
    ds_read_b128 a[24:27], v1 offset:6144
    s_lshl_b32 s52, s52, 2
    v_mfma_f32_16x16x32_bf16 v[44:47], a[60:63], a[104:107], v[44:47]
    ds_read_b128 a[28:31], v1 offset:7168
    s_add_u32 s52, s52, s36
    v_mfma_f32_16x16x32_bf16 v[76:79], a[60:63], a[108:111], v[76:79]
    ds_read_b64_tr_b16 a[76:77], v5 offset:0
    s_mul_i32 s52, s52, 384
    v_mfma_f32_16x16x32_bf16 v[72:75], a[56:59], a[108:111], v[72:75]
    ds_read_b64_tr_b16 a[78:79], v5 offset:512
    v_lshlrev_b32 v15, 7, v0
    v_mfma_f32_16x16x32_bf16 v[68:71], a[52:55], a[108:111], v[68:71]
    ds_read_b64_tr_b16 a[92:93], v9 offset:0
    s_mov_b64 exec, 7
    buffer_load_dword a226, v15, s[96:99], s52 offen
    s_mov_b64 exec, -1
    v_mfma_f32_16x16x32_bf16 v[64:67], a[48:51], a[108:111], v[64:67]
    ds_read_b64_tr_b16 a[94:95], v9 offset:512
    v_mfma_f32_16x16x32_bf16 v[60:63], a[44:47], a[108:111], v[60:63]
    v_mfma_f32_16x16x32_bf16 v[56:59], a[40:43], a[108:111], v[56:59]
    v_mfma_f32_16x16x32_bf16 v[52:55], a[36:39], a[108:111], v[52:55]
    v_mfma_f32_16x16x32_bf16 v[48:51], a[32:35], a[108:111], v[48:51]
    v_mfma_f32_16x16x32_bf16 v[80:83], a[112:115], a[32:35], v[80:83]
    v_mfma_f32_16x16x32_bf16 v[84:87], a[112:115], a[36:39], v[84:87]
    v_mfma_f32_16x16x32_bf16 v[88:91], a[112:115], a[40:43], v[88:91]
    v_mfma_f32_16x16x32_bf16 v[92:95], a[112:115], a[44:47], v[92:95]
    v_mfma_f32_16x16x32_bf16 v[96:99], a[112:115], a[48:51], v[96:99]
    v_mfma_f32_16x16x32_bf16 v[100:103], a[112:115], a[52:55], v[100:103]
    v_mfma_f32_16x16x32_bf16 v[104:107], a[112:115], a[56:59], v[104:107]
    v_mfma_f32_16x16x32_bf16 v[108:111], a[112:115], a[60:63], v[108:111]
    v_mfma_f32_16x16x32_bf16 v[208:211], a[128:131], a[32:35], v[208:211]
    v_mfma_f32_16x16x32_bf16 v[212:215], a[128:131], a[36:39], v[212:215]
    v_mfma_f32_16x16x32_bf16 v[216:219], a[128:131], a[40:43], v[216:219]
    v_mfma_f32_16x16x32_bf16 v[220:223], a[128:131], a[44:47], v[220:223]
    v_mfma_f32_16x16x32_bf16 v[224:227], a[128:131], a[48:51], v[224:227]
    v_mfma_f32_16x16x32_bf16 v[228:231], a[128:131], a[52:55], v[228:231]
    v_mfma_f32_16x16x32_bf16 v[232:235], a[128:131], a[56:59], v[232:235]
    v_mfma_f32_16x16x32_bf16 v[236:239], a[128:131], a[60:63], v[236:239]
    s_waitcnt lgkmcnt(0)
    v_mfma_f32_16x16x32_bf16 v[140:143], a[76:79], a[28:31], v[140:143]
    ds_read_b128 a[32:35], v1 offset:8192
    v_mfma_f32_16x16x32_bf16 v[136:139], a[76:79], a[24:27], v[136:139]
    ds_read_b128 a[36:39], v1 offset:9216
    v_mfma_f32_16x16x32_bf16 v[132:135], a[76:79], a[20:23], v[132:135]
    ds_read_b128 a[40:43], v1 offset:10240
    v_mfma_f32_16x16x32_bf16 v[128:131], a[76:79], a[16:19], v[128:131]
    ds_read_b128 a[44:47], v1 offset:11264
    v_mfma_f32_16x16x32_bf16 v[124:127], a[76:79], a[12:15], v[124:127]
    ds_read_b128 a[48:51], v1 offset:12288
    v_mfma_f32_16x16x32_bf16 v[120:123], a[76:79], a[8:11], v[120:123]
    ds_read_b128 a[52:55], v1 offset:13312
    v_mfma_f32_16x16x32_bf16 v[116:119], a[76:79], a[4:7], v[116:119]
    ds_read_b128 a[56:59], v1 offset:14336
    v_mfma_f32_16x16x32_bf16 v[112:115], a[76:79], a[0:3], v[112:115]
    ds_read_b128 a[60:63], v1 offset:15360
    v_mfma_f32_16x16x32_bf16 a[156:159], a[92:95], a[28:31], a[156:159]
    ds_read_b64_tr_b16 a[116:117], v5 offset:4096
    v_mfma_f32_16x16x32_bf16 a[152:155], a[92:95], a[24:27], a[152:155]
    ds_read_b64_tr_b16 a[118:119], v5 offset:4608
    v_mfma_f32_16x16x32_bf16 a[148:151], a[92:95], a[20:23], a[148:151]
    ds_read_b64_tr_b16 a[132:133], v9 offset:4096
    v_mfma_f32_16x16x32_bf16 a[144:147], a[92:95], a[16:19], a[144:147]
    ds_read_b64_tr_b16 a[134:135], v9 offset:4608
    v_mfma_f32_16x16x32_bf16 v[252:255], a[92:95], a[12:15], v[252:255]
    s_sub_u32 s52, s50, 32
    s_lshl_b32 s52, s52, 1
    v_mfma_f32_16x16x32_bf16 v[248:251], a[92:95], a[8:11], v[248:251]
    s_add_u32 s52, s52, s49
    s_lshl_b32 s76, s52, 17
    v_mfma_f32_16x16x32_bf16 v[244:247], a[92:95], a[4:7], v[244:247]
    s_lshl_b32 s53, s47, 14
    s_add_u32 s76, s76, s53
    v_mfma_f32_16x16x32_bf16 v[240:243], a[92:95], a[0:3], v[240:243]
    s_lshl_b32 s53, s48, 13
    s_add_u32 s76, s76, s53
    s_waitcnt lgkmcnt(0)
    v_mfma_f32_16x16x32_bf16 v[140:143], a[116:119], a[60:63], v[140:143]
    ds_read_b128 a[0:3], v1 offset:16384
    v_cvt_pk_bf16_f32 v16, v16, v17
    v_mfma_f32_16x16x32_bf16 v[136:139], a[116:119], a[56:59], v[136:139]
    ds_read_b128 a[4:7], v1 offset:17408
    v_cvt_pk_bf16_f32 v17, v18, v19
    v_mfma_f32_16x16x32_bf16 v[132:135], a[116:119], a[52:55], v[132:135]
    ds_read_b128 a[8:11], v1 offset:18432
    v_cvt_pk_bf16_f32 v18, v20, v21
    v_mfma_f32_16x16x32_bf16 v[128:131], a[116:119], a[48:51], v[128:131]
    ds_read_b128 a[12:15], v1 offset:19456
    v_cvt_pk_bf16_f32 v19, v22, v23
    v_mfma_f32_16x16x32_bf16 v[124:127], a[116:119], a[44:47], v[124:127]
    ds_read_b128 a[16:19], v1 offset:20480
    buffer_store_dwordx4 v[16:19], v13, s[72:75], s76 offen offset:0 sc1
    v_mfma_f32_16x16x32_bf16 v[120:123], a[116:119], a[40:43], v[120:123]
    ds_read_b128 a[20:23], v1 offset:21504
    v_cvt_pk_bf16_f32 v48, v48, v49
    v_mfma_f32_16x16x32_bf16 v[116:119], a[116:119], a[36:39], v[116:119]
    ds_read_b128 a[24:27], v1 offset:22528
    v_cvt_pk_bf16_f32 v49, v50, v51
    v_mfma_f32_16x16x32_bf16 v[112:115], a[116:119], a[32:35], v[112:115]
    ds_read_b128 a[28:31], v1 offset:23552
    v_cvt_pk_bf16_f32 v50, v52, v53
    v_mfma_f32_16x16x32_bf16 a[156:159], a[132:135], a[60:63], a[156:159]
    ds_read_b64_tr_b16 a[76:77], v5 offset:8192
    v_cvt_pk_bf16_f32 v51, v54, v55
    v_mfma_f32_16x16x32_bf16 a[152:155], a[132:135], a[56:59], a[152:155]
    ds_read_b64_tr_b16 a[78:79], v5 offset:8704
    buffer_store_dwordx4 v[48:51], v13, s[72:75], s76 offen offset:256 sc1
    v_mfma_f32_16x16x32_bf16 a[148:151], a[132:135], a[52:55], a[148:151]
    ds_read_b64_tr_b16 a[92:93], v9 offset:8192
    v_cvt_pk_bf16_f32 v24, v24, v25
    v_mfma_f32_16x16x32_bf16 a[144:147], a[132:135], a[48:51], a[144:147]
    ds_read_b64_tr_b16 a[94:95], v9 offset:8704
    v_cvt_pk_bf16_f32 v25, v26, v27
    v_mfma_f32_16x16x32_bf16 v[252:255], a[132:135], a[44:47], v[252:255]
    v_cvt_pk_bf16_f32 v26, v28, v29
    v_cvt_pk_bf16_f32 v27, v30, v31
    v_mfma_f32_16x16x32_bf16 v[248:251], a[132:135], a[40:43], v[248:251]
    buffer_store_dwordx4 v[24:27], v13, s[72:75], s76 offen offset:2048 sc1
    v_cvt_pk_bf16_f32 v56, v56, v57
    v_mfma_f32_16x16x32_bf16 v[244:247], a[132:135], a[36:39], v[244:247]
    v_cvt_pk_bf16_f32 v57, v58, v59
    v_cvt_pk_bf16_f32 v58, v60, v61
    v_mfma_f32_16x16x32_bf16 v[240:243], a[132:135], a[32:35], v[240:243]
    v_cvt_pk_bf16_f32 v59, v62, v63
    buffer_store_dwordx4 v[56:59], v13, s[72:75], s76 offen offset:2304 sc1
    s_waitcnt lgkmcnt(0)
    v_mfma_f32_16x16x32_bf16 v[140:143], a[76:79], a[28:31], v[140:143]
    ds_read_b128 a[32:35], v1 offset:24576
    s_add_u32 s76, s76, 4096
    v_mfma_f32_16x16x32_bf16 v[136:139], a[76:79], a[24:27], v[136:139]
    ds_read_b128 a[36:39], v1 offset:25600
    v_cvt_pk_bf16_f32 v32, v32, v33
    v_mfma_f32_16x16x32_bf16 v[132:135], a[76:79], a[20:23], v[132:135]
    ds_read_b128 a[40:43], v1 offset:26624
    v_cvt_pk_bf16_f32 v33, v34, v35
    v_mfma_f32_16x16x32_bf16 v[128:131], a[76:79], a[16:19], v[128:131]
    ds_read_b128 a[44:47], v1 offset:27648
    v_cvt_pk_bf16_f32 v34, v36, v37
    v_mfma_f32_16x16x32_bf16 v[124:127], a[76:79], a[12:15], v[124:127]
    ds_read_b128 a[48:51], v1 offset:28672
    v_cvt_pk_bf16_f32 v35, v38, v39
    v_mfma_f32_16x16x32_bf16 v[120:123], a[76:79], a[8:11], v[120:123]
    ds_read_b128 a[52:55], v1 offset:29696
    buffer_store_dwordx4 v[32:35], v13, s[72:75], s76 offen offset:0 sc1
    v_mfma_f32_16x16x32_bf16 v[116:119], a[76:79], a[4:7], v[116:119]
    ds_read_b128 a[56:59], v1 offset:30720
    v_cvt_pk_bf16_f32 v64, v64, v65
    v_mfma_f32_16x16x32_bf16 v[112:115], a[76:79], a[0:3], v[112:115]
    ds_read_b128 a[60:63], v1 offset:31744
    v_cvt_pk_bf16_f32 v65, v66, v67
    v_mfma_f32_16x16x32_bf16 a[156:159], a[92:95], a[28:31], a[156:159]
    ds_read_b64_tr_b16 a[116:117], v5 offset:12288
    v_cvt_pk_bf16_f32 v66, v68, v69
    v_mfma_f32_16x16x32_bf16 a[152:155], a[92:95], a[24:27], a[152:155]
    ds_read_b64_tr_b16 a[118:119], v5 offset:12800
    v_cvt_pk_bf16_f32 v67, v70, v71
    v_mfma_f32_16x16x32_bf16 a[148:151], a[92:95], a[20:23], a[148:151]
    ds_read_b64_tr_b16 a[132:133], v9 offset:12288
    buffer_store_dwordx4 v[64:67], v13, s[72:75], s76 offen offset:256 sc1
    v_mfma_f32_16x16x32_bf16 a[144:147], a[92:95], a[16:19], a[144:147]
    ds_read_b64_tr_b16 a[134:135], v9 offset:12800
    v_cvt_pk_bf16_f32 v40, v40, v41
    v_mfma_f32_16x16x32_bf16 v[252:255], a[92:95], a[12:15], v[252:255]
    v_cvt_pk_bf16_f32 v41, v42, v43
    v_cvt_pk_bf16_f32 v42, v44, v45
    v_mfma_f32_16x16x32_bf16 v[248:251], a[92:95], a[8:11], v[248:251]
    v_cvt_pk_bf16_f32 v43, v46, v47
    buffer_store_dwordx4 v[40:43], v13, s[72:75], s76 offen offset:2048 sc1
    v_mfma_f32_16x16x32_bf16 v[244:247], a[92:95], a[4:7], v[244:247]
    v_cvt_pk_bf16_f32 v72, v72, v73
    v_cvt_pk_bf16_f32 v73, v74, v75
    v_mfma_f32_16x16x32_bf16 v[240:243], a[92:95], a[0:3], v[240:243]
    v_cvt_pk_bf16_f32 v74, v76, v77
    v_cvt_pk_bf16_f32 v75, v78, v79
    s_waitcnt lgkmcnt(0)
    v_mfma_f32_16x16x32_bf16 v[140:143], a[116:119], a[60:63], v[140:143]
    ds_read_b128 a[0:3], v1 offset:0
    buffer_store_dwordx4 v[72:75], v13, s[72:75], s76 offen offset:2304 sc1
    v_mfma_f32_16x16x32_bf16 v[136:139], a[116:119], a[56:59], v[136:139]
    ds_read_b128 a[4:7], v1 offset:1024
    v_mfma_f32_16x16x32_bf16 v[132:135], a[116:119], a[52:55], v[132:135]
    ds_read_b128 a[8:11], v1 offset:2048
    v_mfma_f32_16x16x32_bf16 v[128:131], a[116:119], a[48:51], v[128:131]
    ds_read_b128 a[12:15], v1 offset:3072
    v_mfma_f32_16x16x32_bf16 v[124:127], a[116:119], a[44:47], v[124:127]
    ds_read_b128 a[16:19], v1 offset:4096
    v_mfma_f32_16x16x32_bf16 v[120:123], a[116:119], a[40:43], v[120:123]
    ds_read_b128 a[20:23], v1 offset:5120
    v_mfma_f32_16x16x32_bf16 v[116:119], a[116:119], a[36:39], v[116:119]
    ds_read_b128 a[24:27], v1 offset:6144
    v_mfma_f32_16x16x32_bf16 v[112:115], a[116:119], a[32:35], v[112:115]
    ds_read_b128 a[28:31], v1 offset:7168
    v_mfma_f32_16x16x32_bf16 a[156:159], a[132:135], a[60:63], a[156:159]
    ds_read_b64_tr_b16 a[80:81], v6 offset:0
    v_mfma_f32_16x16x32_bf16 a[152:155], a[132:135], a[56:59], a[152:155]
    ds_read_b64_tr_b16 a[82:83], v6 offset:512
    v_mfma_f32_16x16x32_bf16 a[148:151], a[132:135], a[52:55], a[148:151]
    ds_read_b64_tr_b16 a[84:85], v7 offset:0
    v_mfma_f32_16x16x32_bf16 a[144:147], a[132:135], a[48:51], a[144:147]
    ds_read_b64_tr_b16 a[86:87], v7 offset:512
    v_mfma_f32_16x16x32_bf16 v[252:255], a[132:135], a[44:47], v[252:255]
    ds_read_b64_tr_b16 a[96:97], v10 offset:0
    v_mfma_f32_16x16x32_bf16 v[248:251], a[132:135], a[40:43], v[248:251]
    ds_read_b64_tr_b16 a[98:99], v10 offset:512
    v_mfma_f32_16x16x32_bf16 v[244:247], a[132:135], a[36:39], v[244:247]
    ds_read_b64_tr_b16 a[100:101], v11 offset:0
    v_mfma_f32_16x16x32_bf16 v[240:243], a[132:135], a[32:35], v[240:243]
    ds_read_b64_tr_b16 a[102:103], v11 offset:512
    s_waitcnt lgkmcnt(0)
    v_mfma_f32_16x16x32_bf16 v[144:147], a[80:83], a[0:3], v[144:147]
    ds_read_b128 a[32:35], v1 offset:8192
    v_mfma_f32_16x16x32_bf16 v[148:151], a[80:83], a[4:7], v[148:151]
    ds_read_b128 a[36:39], v1 offset:9216
    v_mfma_f32_16x16x32_bf16 v[152:155], a[80:83], a[8:11], v[152:155]
    ds_read_b128 a[40:43], v1 offset:10240
    v_mfma_f32_16x16x32_bf16 v[156:159], a[80:83], a[12:15], v[156:159]
    ds_read_b128 a[44:47], v1 offset:11264
    v_mfma_f32_16x16x32_bf16 v[160:163], a[80:83], a[16:19], v[160:163]
    ds_read_b128 a[48:51], v1 offset:12288
    v_mfma_f32_16x16x32_bf16 v[164:167], a[80:83], a[20:23], v[164:167]
    ds_read_b128 a[52:55], v1 offset:13312
    v_mfma_f32_16x16x32_bf16 v[168:171], a[80:83], a[24:27], v[168:171]
    ds_read_b128 a[56:59], v1 offset:14336
    v_mfma_f32_16x16x32_bf16 v[172:175], a[80:83], a[28:31], v[172:175]
    ds_read_b128 a[60:63], v1 offset:15360
    v_mfma_f32_16x16x32_bf16 v[204:207], a[84:87], a[28:31], v[204:207]
    ds_read_b64_tr_b16 a[120:121], v6 offset:4096
    v_mfma_f32_16x16x32_bf16 v[200:203], a[84:87], a[24:27], v[200:203]
    ds_read_b64_tr_b16 a[122:123], v6 offset:4608
    v_mfma_f32_16x16x32_bf16 v[196:199], a[84:87], a[20:23], v[196:199]
    ds_read_b64_tr_b16 a[124:125], v7 offset:4096
    v_mfma_f32_16x16x32_bf16 v[192:195], a[84:87], a[16:19], v[192:195]
    ds_read_b64_tr_b16 a[126:127], v7 offset:4608
    v_mfma_f32_16x16x32_bf16 v[188:191], a[84:87], a[12:15], v[188:191]
    ds_read_b64_tr_b16 a[136:137], v10 offset:4096
    v_mfma_f32_16x16x32_bf16 v[184:187], a[84:87], a[8:11], v[184:187]
    ds_read_b64_tr_b16 a[138:139], v10 offset:4608
    v_mfma_f32_16x16x32_bf16 v[180:183], a[84:87], a[4:7], v[180:183]
    ds_read_b64_tr_b16 a[140:141], v11 offset:4096
    v_mfma_f32_16x16x32_bf16 v[176:179], a[84:87], a[0:3], v[176:179]
    ds_read_b64_tr_b16 a[142:143], v11 offset:4608
    v_mfma_f32_16x16x32_bf16 a[160:163], a[96:99], a[0:3], a[160:163]
    v_max_f32 v80, 0, v80
    v_max_f32 v81, 0, v81
    v_mfma_f32_16x16x32_bf16 a[164:167], a[96:99], a[4:7], a[164:167]
    v_max_f32 v82, 0, v82
    v_max_f32 v83, 0, v83
    v_mfma_f32_16x16x32_bf16 a[168:171], a[96:99], a[8:11], a[168:171]
    v_mul_f32 v80, v80, v208
    v_mul_f32 v81, v81, v209
    v_mfma_f32_16x16x32_bf16 a[172:175], a[96:99], a[12:15], a[172:175]
    v_mul_f32 v82, v82, v210
    v_mul_f32 v83, v83, v211
    v_mfma_f32_16x16x32_bf16 a[176:179], a[96:99], a[16:19], a[176:179]
    v_max_f32 v112, 0, v112
    v_max_f32 v113, 0, v113
    v_mfma_f32_16x16x32_bf16 a[180:183], a[96:99], a[20:23], a[180:183]
    v_max_f32 v114, 0, v114
    v_max_f32 v115, 0, v115
    v_mfma_f32_16x16x32_bf16 a[184:187], a[96:99], a[24:27], a[184:187]
    v_mul_f32 v112, v112, v240
    v_mul_f32 v113, v113, v241
    v_mfma_f32_16x16x32_bf16 a[188:191], a[96:99], a[28:31], a[188:191]
    v_mul_f32 v114, v114, v242
    v_mul_f32 v115, v115, v243
    v_mfma_f32_16x16x32_bf16 a[220:223], a[100:103], a[28:31], a[220:223]
    v_cvt_pk_bf16_f32 v80, v80, v81
    v_cvt_pk_bf16_f32 v81, v82, v83
    v_mfma_f32_16x16x32_bf16 a[216:219], a[100:103], a[24:27], a[216:219]
    v_cvt_pk_bf16_f32 v82, v112, v113
    v_cvt_pk_bf16_f32 v83, v114, v115
    v_mfma_f32_16x16x32_bf16 a[212:215], a[100:103], a[20:23], a[212:215]
    v_max_f32 v84, 0, v84
    v_max_f32 v85, 0, v85
    v_mfma_f32_16x16x32_bf16 a[208:211], a[100:103], a[16:19], a[208:211]
    v_max_f32 v86, 0, v86
    v_max_f32 v87, 0, v87
    v_mfma_f32_16x16x32_bf16 a[204:207], a[100:103], a[12:15], a[204:207]
    v_mul_f32 v84, v84, v212
    v_mul_f32 v85, v85, v213
    v_mfma_f32_16x16x32_bf16 a[200:203], a[100:103], a[8:11], a[200:203]
    v_mul_f32 v86, v86, v214
    v_mul_f32 v87, v87, v215
    v_mfma_f32_16x16x32_bf16 a[196:199], a[100:103], a[4:7], a[196:199]
    v_max_f32 v116, 0, v116
    v_max_f32 v117, 0, v117
    v_mfma_f32_16x16x32_bf16 a[192:195], a[100:103], a[0:3], a[192:195]
    v_max_f32 v118, 0, v118
    v_max_f32 v119, 0, v119
    s_waitcnt lgkmcnt(0)
    v_mfma_f32_16x16x32_bf16 v[144:147], a[120:123], a[32:35], v[144:147]
    ds_read_b128 a[0:3], v1 offset:16384
    v_mul_f32 v116, v116, v244
    v_mfma_f32_16x16x32_bf16 v[148:151], a[120:123], a[36:39], v[148:151]
    ds_read_b128 a[4:7], v1 offset:17408
    v_mul_f32 v117, v117, v245
    v_mfma_f32_16x16x32_bf16 v[152:155], a[120:123], a[40:43], v[152:155]
    ds_read_b128 a[8:11], v1 offset:18432
    v_mul_f32 v118, v118, v246
    v_mfma_f32_16x16x32_bf16 v[156:159], a[120:123], a[44:47], v[156:159]
    ds_read_b128 a[12:15], v1 offset:19456
    v_mul_f32 v119, v119, v247
    v_mfma_f32_16x16x32_bf16 v[160:163], a[120:123], a[48:51], v[160:163]
    ds_read_b128 a[16:19], v1 offset:20480
    v_cvt_pk_bf16_f32 v84, v84, v85
    v_mfma_f32_16x16x32_bf16 v[164:167], a[120:123], a[52:55], v[164:167]
    ds_read_b128 a[20:23], v1 offset:21504
    v_cvt_pk_bf16_f32 v85, v86, v87
    v_mfma_f32_16x16x32_bf16 v[168:171], a[120:123], a[56:59], v[168:171]
    ds_read_b128 a[24:27], v1 offset:22528
    v_cvt_pk_bf16_f32 v86, v116, v117
    v_mfma_f32_16x16x32_bf16 v[172:175], a[120:123], a[60:63], v[172:175]
    ds_read_b128 a[28:31], v1 offset:23552
    v_cvt_pk_bf16_f32 v87, v118, v119
    v_mfma_f32_16x16x32_bf16 v[204:207], a[124:127], a[60:63], v[204:207]
    ds_read_b64_tr_b16 a[80:81], v6 offset:8192
    v_max_f32 v88, 0, v88
    v_mfma_f32_16x16x32_bf16 v[200:203], a[124:127], a[56:59], v[200:203]
    ds_read_b64_tr_b16 a[82:83], v6 offset:8704
    v_max_f32 v89, 0, v89
    v_mfma_f32_16x16x32_bf16 v[196:199], a[124:127], a[52:55], v[196:199]
    ds_read_b64_tr_b16 a[84:85], v7 offset:8192
    v_max_f32 v90, 0, v90
    v_mfma_f32_16x16x32_bf16 v[192:195], a[124:127], a[48:51], v[192:195]
    ds_read_b64_tr_b16 a[86:87], v7 offset:8704
    v_max_f32 v91, 0, v91
    v_mfma_f32_16x16x32_bf16 v[188:191], a[124:127], a[44:47], v[188:191]
    ds_read_b64_tr_b16 a[96:97], v10 offset:8192
    v_mul_f32 v88, v88, v216
    v_mfma_f32_16x16x32_bf16 v[184:187], a[124:127], a[40:43], v[184:187]
    ds_read_b64_tr_b16 a[98:99], v10 offset:8704
    v_mul_f32 v89, v89, v217
    v_mfma_f32_16x16x32_bf16 v[180:183], a[124:127], a[36:39], v[180:183]
    ds_read_b64_tr_b16 a[100:101], v11 offset:8192
    v_mul_f32 v90, v90, v218
    v_mfma_f32_16x16x32_bf16 v[176:179], a[124:127], a[32:35], v[176:179]
    ds_read_b64_tr_b16 a[102:103], v11 offset:8704
    v_mul_f32 v91, v91, v219
    v_mfma_f32_16x16x32_bf16 a[160:163], a[136:139], a[32:35], a[160:163]
    v_max_f32 v120, 0, v120
    v_max_f32 v121, 0, v121
    v_mfma_f32_16x16x32_bf16 a[164:167], a[136:139], a[36:39], a[164:167]
    v_max_f32 v122, 0, v122
    v_max_f32 v123, 0, v123
    v_mfma_f32_16x16x32_bf16 a[168:171], a[136:139], a[40:43], a[168:171]
    v_mul_f32 v120, v120, v248
    v_mul_f32 v121, v121, v249
    v_mfma_f32_16x16x32_bf16 a[172:175], a[136:139], a[44:47], a[172:175]
    v_mul_f32 v122, v122, v250
    v_mul_f32 v123, v123, v251
    v_mfma_f32_16x16x32_bf16 a[176:179], a[136:139], a[48:51], a[176:179]
    v_cvt_pk_bf16_f32 v88, v88, v89
    v_cvt_pk_bf16_f32 v89, v90, v91
    v_mfma_f32_16x16x32_bf16 a[180:183], a[136:139], a[52:55], a[180:183]
    v_cvt_pk_bf16_f32 v90, v120, v121
    v_cvt_pk_bf16_f32 v91, v122, v123
    v_mfma_f32_16x16x32_bf16 a[184:187], a[136:139], a[56:59], a[184:187]
    v_max_f32 v92, 0, v92
    v_max_f32 v93, 0, v93
    v_mfma_f32_16x16x32_bf16 a[188:191], a[136:139], a[60:63], a[188:191]
    v_max_f32 v94, 0, v94
    v_max_f32 v95, 0, v95
    v_mfma_f32_16x16x32_bf16 a[220:223], a[140:143], a[60:63], a[220:223]
    v_mul_f32 v92, v92, v220
    v_mul_f32 v93, v93, v221
    v_mfma_f32_16x16x32_bf16 a[216:219], a[140:143], a[56:59], a[216:219]
    v_mul_f32 v94, v94, v222
    v_mul_f32 v95, v95, v223
    v_mfma_f32_16x16x32_bf16 a[212:215], a[140:143], a[52:55], a[212:215]
    v_max_f32 v124, 0, v124
    v_max_f32 v125, 0, v125
    v_mfma_f32_16x16x32_bf16 a[208:211], a[140:143], a[48:51], a[208:211]
    v_max_f32 v126, 0, v126
    v_max_f32 v127, 0, v127
    v_mfma_f32_16x16x32_bf16 a[204:207], a[140:143], a[44:47], a[204:207]
    v_mul_f32 v124, v124, v252
    v_mul_f32 v125, v125, v253
    v_mfma_f32_16x16x32_bf16 a[200:203], a[140:143], a[40:43], a[200:203]
    v_mul_f32 v126, v126, v254
    v_mul_f32 v127, v127, v255
    v_mfma_f32_16x16x32_bf16 a[196:199], a[140:143], a[36:39], a[196:199]
    v_cvt_pk_bf16_f32 v92, v92, v93
    v_cvt_pk_bf16_f32 v93, v94, v95
    v_mfma_f32_16x16x32_bf16 a[192:195], a[140:143], a[32:35], a[192:195]
    v_cvt_pk_bf16_f32 v94, v124, v125
    v_cvt_pk_bf16_f32 v95, v126, v127
    s_waitcnt lgkmcnt(0)
    v_mfma_f32_16x16x32_bf16 v[144:147], a[80:83], a[0:3], v[144:147]
    ds_read_b128 a[32:35], v1 offset:24576
    v_max_f32 v96, 0, v96
    v_mfma_f32_16x16x32_bf16 v[148:151], a[80:83], a[4:7], v[148:151]
    ds_read_b128 a[36:39], v1 offset:25600
    v_max_f32 v97, 0, v97
    v_mfma_f32_16x16x32_bf16 v[152:155], a[80:83], a[8:11], v[152:155]
    ds_read_b128 a[40:43], v1 offset:26624
    v_max_f32 v98, 0, v98
    v_mfma_f32_16x16x32_bf16 v[156:159], a[80:83], a[12:15], v[156:159]
    ds_read_b128 a[44:47], v1 offset:27648
    v_max_f32 v99, 0, v99
    v_mfma_f32_16x16x32_bf16 v[160:163], a[80:83], a[16:19], v[160:163]
    ds_read_b128 a[48:51], v1 offset:28672
    v_mul_f32 v96, v96, v224
    v_mfma_f32_16x16x32_bf16 v[164:167], a[80:83], a[20:23], v[164:167]
    ds_read_b128 a[52:55], v1 offset:29696
    v_mul_f32 v97, v97, v225
    v_mfma_f32_16x16x32_bf16 v[168:171], a[80:83], a[24:27], v[168:171]
    ds_read_b128 a[56:59], v1 offset:30720
    v_mul_f32 v98, v98, v226
    v_mfma_f32_16x16x32_bf16 v[172:175], a[80:83], a[28:31], v[172:175]
    ds_read_b128 a[60:63], v1 offset:31744
    v_mul_f32 v99, v99, v227
    v_mfma_f32_16x16x32_bf16 v[204:207], a[84:87], a[28:31], v[204:207]
    ds_read_b64_tr_b16 a[120:121], v6 offset:12288
    v_accvgpr_read_b32 v208, a144
    v_mfma_f32_16x16x32_bf16 v[200:203], a[84:87], a[24:27], v[200:203]
    ds_read_b64_tr_b16 a[122:123], v6 offset:12800
    v_accvgpr_read_b32 v209, a145
    v_mfma_f32_16x16x32_bf16 v[196:199], a[84:87], a[20:23], v[196:199]
    ds_read_b64_tr_b16 a[124:125], v7 offset:12288
    v_accvgpr_read_b32 v210, a146
    v_mfma_f32_16x16x32_bf16 v[192:195], a[84:87], a[16:19], v[192:195]
    ds_read_b64_tr_b16 a[126:127], v7 offset:12800
    v_accvgpr_read_b32 v211, a147
    v_mfma_f32_16x16x32_bf16 v[188:191], a[84:87], a[12:15], v[188:191]
    ds_read_b64_tr_b16 a[136:137], v10 offset:12288
    v_max_f32 v128, 0, v128
    v_mfma_f32_16x16x32_bf16 v[184:187], a[84:87], a[8:11], v[184:187]
    ds_read_b64_tr_b16 a[138:139], v10 offset:12800
    v_max_f32 v129, 0, v129
    v_mfma_f32_16x16x32_bf16 v[180:183], a[84:87], a[4:7], v[180:183]
    ds_read_b64_tr_b16 a[140:141], v11 offset:12288
    v_max_f32 v130, 0, v130
    v_mfma_f32_16x16x32_bf16 v[176:179], a[84:87], a[0:3], v[176:179]
    ds_read_b64_tr_b16 a[142:143], v11 offset:12800
    v_max_f32 v131, 0, v131
    v_mfma_f32_16x16x32_bf16 a[160:163], a[96:99], a[0:3], a[160:163]
    v_mul_f32 v128, v128, v208
    v_mul_f32 v129, v129, v209
    v_mfma_f32_16x16x32_bf16 a[164:167], a[96:99], a[4:7], a[164:167]
    v_mul_f32 v130, v130, v210
    v_mul_f32 v131, v131, v211
    v_mfma_f32_16x16x32_bf16 a[168:171], a[96:99], a[8:11], a[168:171]
    v_cvt_pk_bf16_f32 v96, v96, v97
    v_cvt_pk_bf16_f32 v97, v98, v99
    v_mfma_f32_16x16x32_bf16 a[172:175], a[96:99], a[12:15], a[172:175]
    v_cvt_pk_bf16_f32 v98, v128, v129
    v_cvt_pk_bf16_f32 v99, v130, v131
    v_mfma_f32_16x16x32_bf16 a[176:179], a[96:99], a[16:19], a[176:179]
    v_max_f32 v100, 0, v100
    v_max_f32 v101, 0, v101
    v_mfma_f32_16x16x32_bf16 a[180:183], a[96:99], a[20:23], a[180:183]
    v_max_f32 v102, 0, v102
    v_max_f32 v103, 0, v103
    v_mfma_f32_16x16x32_bf16 a[184:187], a[96:99], a[24:27], a[184:187]
    v_mul_f32 v100, v100, v228
    v_mul_f32 v101, v101, v229
    v_mfma_f32_16x16x32_bf16 a[188:191], a[96:99], a[28:31], a[188:191]
    v_mul_f32 v102, v102, v230
    v_mul_f32 v103, v103, v231
    v_mfma_f32_16x16x32_bf16 a[220:223], a[100:103], a[28:31], a[220:223]
    v_accvgpr_read_b32 v212, a148
    v_accvgpr_read_b32 v213, a149
    v_mfma_f32_16x16x32_bf16 a[216:219], a[100:103], a[24:27], a[216:219]
    v_accvgpr_read_b32 v214, a150
    v_accvgpr_read_b32 v215, a151
    v_mfma_f32_16x16x32_bf16 a[212:215], a[100:103], a[20:23], a[212:215]
    v_max_f32 v132, 0, v132
    v_max_f32 v133, 0, v133
    v_mfma_f32_16x16x32_bf16 a[208:211], a[100:103], a[16:19], a[208:211]
    v_max_f32 v134, 0, v134
    v_max_f32 v135, 0, v135
    v_mfma_f32_16x16x32_bf16 a[204:207], a[100:103], a[12:15], a[204:207]
    v_mul_f32 v132, v132, v212
    v_mul_f32 v133, v133, v213
    v_mfma_f32_16x16x32_bf16 a[200:203], a[100:103], a[8:11], a[200:203]
    v_mul_f32 v134, v134, v214
    v_mul_f32 v135, v135, v215
    v_mfma_f32_16x16x32_bf16 a[196:199], a[100:103], a[4:7], a[196:199]
    v_cvt_pk_bf16_f32 v100, v100, v101
    v_cvt_pk_bf16_f32 v101, v102, v103
    v_mfma_f32_16x16x32_bf16 a[192:195], a[100:103], a[0:3], a[192:195]
    v_cvt_pk_bf16_f32 v102, v132, v133
    v_cvt_pk_bf16_f32 v103, v134, v135
    s_waitcnt lgkmcnt(0)
    v_mfma_f32_16x16x32_bf16 v[144:147], a[120:123], a[32:35], v[144:147]
    v_max_f32 v104, 0, v104
    v_max_f32 v105, 0, v105
    v_mfma_f32_16x16x32_bf16 v[148:151], a[120:123], a[36:39], v[148:151]
    v_max_f32 v106, 0, v106
    v_max_f32 v107, 0, v107
    v_mfma_f32_16x16x32_bf16 v[152:155], a[120:123], a[40:43], v[152:155]
    v_mul_f32 v104, v104, v232
    v_mul_f32 v105, v105, v233
    v_mfma_f32_16x16x32_bf16 v[156:159], a[120:123], a[44:47], v[156:159]
    v_mul_f32 v106, v106, v234
    v_mul_f32 v107, v107, v235
    v_mfma_f32_16x16x32_bf16 v[160:163], a[120:123], a[48:51], v[160:163]
    v_accvgpr_read_b32 v208, a152
    v_accvgpr_read_b32 v209, a153
    v_mfma_f32_16x16x32_bf16 v[164:167], a[120:123], a[52:55], v[164:167]
    v_accvgpr_read_b32 v210, a154
    v_accvgpr_read_b32 v211, a155
    v_mfma_f32_16x16x32_bf16 v[168:171], a[120:123], a[56:59], v[168:171]
    v_max_f32 v136, 0, v136
    v_max_f32 v137, 0, v137
    v_mfma_f32_16x16x32_bf16 v[172:175], a[120:123], a[60:63], v[172:175]
    v_max_f32 v138, 0, v138
    v_max_f32 v139, 0, v139
    v_mfma_f32_16x16x32_bf16 v[204:207], a[124:127], a[60:63], v[204:207]
    v_mul_f32 v136, v136, v208
    v_mul_f32 v137, v137, v209
    v_mfma_f32_16x16x32_bf16 v[200:203], a[124:127], a[56:59], v[200:203]
    v_mul_f32 v138, v138, v210
    v_mul_f32 v139, v139, v211
    v_mfma_f32_16x16x32_bf16 v[196:199], a[124:127], a[52:55], v[196:199]
    v_cvt_pk_bf16_f32 v104, v104, v105
    v_cvt_pk_bf16_f32 v105, v106, v107
    v_mfma_f32_16x16x32_bf16 v[192:195], a[124:127], a[48:51], v[192:195]
    v_cvt_pk_bf16_f32 v106, v136, v137
    v_cvt_pk_bf16_f32 v107, v138, v139
    v_mfma_f32_16x16x32_bf16 v[188:191], a[124:127], a[44:47], v[188:191]
    v_max_f32 v108, 0, v108
    v_max_f32 v109, 0, v109
    v_mfma_f32_16x16x32_bf16 v[184:187], a[124:127], a[40:43], v[184:187]
    v_max_f32 v110, 0, v110
    v_max_f32 v111, 0, v111
    v_mfma_f32_16x16x32_bf16 v[180:183], a[124:127], a[36:39], v[180:183]
    v_mul_f32 v108, v108, v236
    v_mul_f32 v109, v109, v237
    v_mfma_f32_16x16x32_bf16 v[176:179], a[124:127], a[32:35], v[176:179]
    v_mul_f32 v110, v110, v238
    v_mul_f32 v111, v111, v239
    v_mfma_f32_16x16x32_bf16 a[160:163], a[136:139], a[32:35], a[160:163]
    v_accvgpr_read_b32 v212, a156
    v_accvgpr_read_b32 v213, a157
    v_mfma_f32_16x16x32_bf16 a[164:167], a[136:139], a[36:39], a[164:167]
    v_accvgpr_read_b32 v214, a158
    v_accvgpr_read_b32 v215, a159
    v_mfma_f32_16x16x32_bf16 a[168:171], a[136:139], a[40:43], a[168:171]
    v_max_f32 v140, 0, v140
    v_max_f32 v141, 0, v141
    v_mfma_f32_16x16x32_bf16 a[172:175], a[136:139], a[44:47], a[172:175]
    v_max_f32 v142, 0, v142
    v_max_f32 v143, 0, v143
    v_mfma_f32_16x16x32_bf16 a[176:179], a[136:139], a[48:51], a[176:179]
    v_mul_f32 v140, v140, v212
    v_mul_f32 v141, v141, v213
    v_mfma_f32_16x16x32_bf16 a[180:183], a[136:139], a[52:55], a[180:183]
    v_mul_f32 v142, v142, v214
    v_mul_f32 v143, v143, v215
    v_mfma_f32_16x16x32_bf16 a[184:187], a[136:139], a[56:59], a[184:187]
    v_cvt_pk_bf16_f32 v108, v108, v109
    v_cvt_pk_bf16_f32 v109, v110, v111
    v_mfma_f32_16x16x32_bf16 a[188:191], a[136:139], a[60:63], a[188:191]
    v_cvt_pk_bf16_f32 v110, v140, v141
    v_cvt_pk_bf16_f32 v111, v142, v143
    v_mfma_f32_16x16x32_bf16 a[220:223], a[140:143], a[60:63], a[220:223]
    v_mfma_f32_16x16x32_bf16 a[216:219], a[140:143], a[56:59], a[216:219]
    v_mfma_f32_16x16x32_bf16 a[212:215], a[140:143], a[52:55], a[212:215]
    v_mfma_f32_16x16x32_bf16 a[208:211], a[140:143], a[48:51], a[208:211]
    v_mfma_f32_16x16x32_bf16 a[204:207], a[140:143], a[44:47], a[204:207]
    v_mfma_f32_16x16x32_bf16 a[200:203], a[140:143], a[40:43], a[200:203]
    v_mfma_f32_16x16x32_bf16 a[196:199], a[140:143], a[36:39], a[196:199]
    v_mfma_f32_16x16x32_bf16 a[192:195], a[140:143], a[32:35], a[192:195]
    s_waitcnt vmcnt(0)
    s_barrier
    s_cmp_lg_u32 s36, 3
    s_cbranch_scc1 L_g1_noq_v
    s_add_u32 s96, s4, 20971520
    s_addc_u32 s97, s5, 0
    s_mov_b32 s98, 40960
    s_mov_b32 s99, 0x00020000
    s_lshl_b32 s52, s45, 3
    s_add_u32 s52, s52, s46
    s_lshl_b32 s52, s52, 9
    s_add_u32 s52, s52, 16384
    v_mov_b32 v1, 1
    v_lshlrev_b32 v2, 7, v0
    s_mov_b64 exec, 15
    buffer_atomic_add v1, v2, s[96:99], s52 offen sc1
    s_mov_b64 exec, -1
L_g1_noq_v:
    s_nop 3
    v_accvgpr_read_b32 v208, a160
    v_accvgpr_read_b32 v209, a161
    v_accvgpr_read_b32 v210, a162
    v_accvgpr_read_b32 v211, a163
    v_max_f32 v144, 0, v144
    v_max_f32 v145, 0, v145
    v_max_f32 v146, 0, v146
    v_max_f32 v147, 0, v147
    v_pk_mul_f32 v[144:145], v[144:145], v[208:209]
    v_pk_mul_f32 v[146:147], v[146:147], v[210:211]
    v_accvgpr_read_b32 v212, a192
    v_accvgpr_read_b32 v213, a193
    v_accvgpr_read_b32 v214, a194
    v_accvgpr_read_b32 v215, a195
    v_max_f32 v176, 0, v176
    v_max_f32 v177, 0, v177
    v_max_f32 v178, 0, v178
    v_max_f32 v179, 0, v179
    v_pk_mul_f32 v[176:177], v[176:177], v[212:213]
    v_pk_mul_f32 v[178:179], v[178:179], v[214:215]
    v_cvt_pk_bf16_f32 v144, v144, v145
    v_cvt_pk_bf16_f32 v145, v146, v147
    v_cvt_pk_bf16_f32 v146, v176, v177
    v_cvt_pk_bf16_f32 v147, v178, v179
    v_accvgpr_read_b32 v216, a164
    v_accvgpr_read_b32 v217, a165
    v_accvgpr_read_b32 v218, a166
    v_accvgpr_read_b32 v219, a167
    v_max_f32 v148, 0, v148
    v_max_f32 v149, 0, v149
    v_max_f32 v150, 0, v150
    v_max_f32 v151, 0, v151
    v_pk_mul_f32 v[148:149], v[148:149], v[216:217]
    v_pk_mul_f32 v[150:151], v[150:151], v[218:219]
    v_accvgpr_read_b32 v220, a196
    v_accvgpr_read_b32 v221, a197
    v_accvgpr_read_b32 v222, a198
    v_accvgpr_read_b32 v223, a199
    v_max_f32 v180, 0, v180
    v_max_f32 v181, 0, v181
    v_max_f32 v182, 0, v182
    v_max_f32 v183, 0, v183
    v_pk_mul_f32 v[180:181], v[180:181], v[220:221]
    v_pk_mul_f32 v[182:183], v[182:183], v[222:223]
    v_cvt_pk_bf16_f32 v148, v148, v149
    v_cvt_pk_bf16_f32 v149, v150, v151
    v_cvt_pk_bf16_f32 v150, v180, v181
    v_cvt_pk_bf16_f32 v151, v182, v183
    v_accvgpr_read_b32 v224, a168
    v_accvgpr_read_b32 v225, a169
    v_accvgpr_read_b32 v226, a170
    v_accvgpr_read_b32 v227, a171
    v_max_f32 v152, 0, v152
    v_max_f32 v153, 0, v153
    v_max_f32 v154, 0, v154
    v_max_f32 v155, 0, v155
    v_pk_mul_f32 v[152:153], v[152:153], v[224:225]
    v_pk_mul_f32 v[154:155], v[154:155], v[226:227]
    v_accvgpr_read_b32 v228, a200
    v_accvgpr_read_b32 v229, a201
    v_accvgpr_read_b32 v230, a202
    v_accvgpr_read_b32 v231, a203
    v_max_f32 v184, 0, v184
    v_max_f32 v185, 0, v185
    v_max_f32 v186, 0, v186
    v_max_f32 v187, 0, v187
    v_pk_mul_f32 v[184:185], v[184:185], v[228:229]
    v_pk_mul_f32 v[186:187], v[186:187], v[230:231]
    v_cvt_pk_bf16_f32 v152, v152, v153
    v_cvt_pk_bf16_f32 v153, v154, v155
    v_cvt_pk_bf16_f32 v154, v184, v185
    v_cvt_pk_bf16_f32 v155, v186, v187
    v_accvgpr_read_b32 v232, a172
    v_accvgpr_read_b32 v233, a173
    v_accvgpr_read_b32 v234, a174
    v_accvgpr_read_b32 v235, a175
    v_max_f32 v156, 0, v156
    v_max_f32 v157, 0, v157
    v_max_f32 v158, 0, v158
    v_max_f32 v159, 0, v159
    v_pk_mul_f32 v[156:157], v[156:157], v[232:233]
    v_pk_mul_f32 v[158:159], v[158:159], v[234:235]
    v_accvgpr_read_b32 v236, a204
    v_accvgpr_read_b32 v237, a205
    v_accvgpr_read_b32 v238, a206
    v_accvgpr_read_b32 v239, a207
    v_max_f32 v188, 0, v188
    v_max_f32 v189, 0, v189
    v_max_f32 v190, 0, v190
    v_max_f32 v191, 0, v191
    v_pk_mul_f32 v[188:189], v[188:189], v[236:237]
    v_pk_mul_f32 v[190:191], v[190:191], v[238:239]
    v_cvt_pk_bf16_f32 v156, v156, v157
    v_cvt_pk_bf16_f32 v157, v158, v159
    v_cvt_pk_bf16_f32 v158, v188, v189
    v_cvt_pk_bf16_f32 v159, v190, v191
    v_accvgpr_read_b32 v208, a176
    v_accvgpr_read_b32 v209, a177
    v_accvgpr_read_b32 v210, a178
    v_accvgpr_read_b32 v211, a179
    v_max_f32 v160, 0, v160
    v_max_f32 v161, 0, v161
    v_max_f32 v162, 0, v162
    v_max_f32 v163, 0, v163
    v_pk_mul_f32 v[160:161], v[160:161], v[208:209]
    v_pk_mul_f32 v[162:163], v[162:163], v[210:211]
    v_accvgpr_read_b32 v212, a208
    v_accvgpr_read_b32 v213, a209
    v_accvgpr_read_b32 v214, a210
    v_accvgpr_read_b32 v215, a211
    v_max_f32 v192, 0, v192
    v_max_f32 v193, 0, v193
    v_max_f32 v194, 0, v194
    v_max_f32 v195, 0, v195
    v_pk_mul_f32 v[192:193], v[192:193], v[212:213]
    v_pk_mul_f32 v[194:195], v[194:195], v[214:215]
    v_cvt_pk_bf16_f32 v160, v160, v161
    v_cvt_pk_bf16_f32 v161, v162, v163
    v_cvt_pk_bf16_f32 v162, v192, v193
    v_cvt_pk_bf16_f32 v163, v194, v195
    v_accvgpr_read_b32 v216, a180
    v_accvgpr_read_b32 v217, a181
    v_accvgpr_read_b32 v218, a182
    v_accvgpr_read_b32 v219, a183
    v_max_f32 v164, 0, v164
    v_max_f32 v165, 0, v165
    v_max_f32 v166, 0, v166
    v_max_f32 v167, 0, v167
    v_pk_mul_f32 v[164:165], v[164:165], v[216:217]
    v_pk_mul_f32 v[166:167], v[166:167], v[218:219]
    v_accvgpr_read_b32 v220, a212
    v_accvgpr_read_b32 v221, a213
    v_accvgpr_read_b32 v222, a214
    v_accvgpr_read_b32 v223, a215
    v_max_f32 v196, 0, v196
    v_max_f32 v197, 0, v197
    v_max_f32 v198, 0, v198
    v_max_f32 v199, 0, v199
    v_pk_mul_f32 v[196:197], v[196:197], v[220:221]
    v_pk_mul_f32 v[198:199], v[198:199], v[222:223]
    v_cvt_pk_bf16_f32 v164, v164, v165
    v_cvt_pk_bf16_f32 v165, v166, v167
    v_cvt_pk_bf16_f32 v166, v196, v197
    v_cvt_pk_bf16_f32 v167, v198, v199
    v_accvgpr_read_b32 v224, a184
    v_accvgpr_read_b32 v225, a185
    v_accvgpr_read_b32 v226, a186
    v_accvgpr_read_b32 v227, a187
    v_max_f32 v168, 0, v168
    v_max_f32 v169, 0, v169
    v_max_f32 v170, 0, v170
    v_max_f32 v171, 0, v171
    v_pk_mul_f32 v[168:169], v[168:169], v[224:225]
    v_pk_mul_f32 v[170:171], v[170:171], v[226:227]
    v_accvgpr_read_b32 v228, a216
    v_accvgpr_read_b32 v229, a217
    v_accvgpr_read_b32 v230, a218
    v_accvgpr_read_b32 v231, a219
    v_max_f32 v200, 0, v200
    v_max_f32 v201, 0, v201
    v_max_f32 v202, 0, v202
    v_max_f32 v203, 0, v203
    v_pk_mul_f32 v[200:201], v[200:201], v[228:229]
    v_pk_mul_f32 v[202:203], v[202:203], v[230:231]
    v_cvt_pk_bf16_f32 v168, v168, v169
    v_cvt_pk_bf16_f32 v169, v170, v171
    v_cvt_pk_bf16_f32 v170, v200, v201
    v_cvt_pk_bf16_f32 v171, v202, v203
    v_accvgpr_read_b32 v232, a188
    v_accvgpr_read_b32 v233, a189
    v_accvgpr_read_b32 v234, a190
    v_accvgpr_read_b32 v235, a191
    v_max_f32 v172, 0, v172
    v_max_f32 v173, 0, v173
    v_max_f32 v174, 0, v174
    v_max_f32 v175, 0, v175
    v_pk_mul_f32 v[172:173], v[172:173], v[232:233]
    v_pk_mul_f32 v[174:175], v[174:175], v[234:235]
    v_accvgpr_read_b32 v236, a220
    v_accvgpr_read_b32 v237, a221
    v_accvgpr_read_b32 v238, a222
    v_accvgpr_read_b32 v239, a223
    v_max_f32 v204, 0, v204
    v_max_f32 v205, 0, v205
    v_max_f32 v206, 0, v206
    v_max_f32 v207, 0, v207
    v_pk_mul_f32 v[204:205], v[204:205], v[236:237]
    v_pk_mul_f32 v[206:207], v[206:207], v[238:239]
    v_cvt_pk_bf16_f32 v172, v172, v173
    v_cvt_pk_bf16_f32 v173, v174, v175
    v_cvt_pk_bf16_f32 v174, v204, v205
    v_cvt_pk_bf16_f32 v175, v206, v207
    v_accvgpr_write_b32 a0, v80
    v_accvgpr_write_b32 a1, v81
    v_accvgpr_write_b32 a2, v82
    v_accvgpr_write_b32 a3, v83
    v_accvgpr_write_b32 a4, v84
    v_accvgpr_write_b32 a5, v85
    v_accvgpr_write_b32 a6, v86
    v_accvgpr_write_b32 a7, v87
    v_accvgpr_write_b32 a8, v88
    v_accvgpr_write_b32 a9, v89
    v_accvgpr_write_b32 a10, v90
    v_accvgpr_write_b32 a11, v91
    v_accvgpr_write_b32 a12, v92
    v_accvgpr_write_b32 a13, v93
    v_accvgpr_write_b32 a14, v94
    v_accvgpr_write_b32 a15, v95
    v_accvgpr_write_b32 a16, v96
    v_accvgpr_write_b32 a17, v97
    v_accvgpr_write_b32 a18, v98
    v_accvgpr_write_b32 a19, v99
    v_accvgpr_write_b32 a20, v100
    v_accvgpr_write_b32 a21, v101
    v_accvgpr_write_b32 a22, v102
    v_accvgpr_write_b32 a23, v103
    v_accvgpr_write_b32 a24, v104
    v_accvgpr_write_b32 a25, v105
    v_accvgpr_write_b32 a26, v106
    v_accvgpr_write_b32 a27, v107
    v_accvgpr_write_b32 a28, v108
    v_accvgpr_write_b32 a29, v109
    v_accvgpr_write_b32 a30, v110
    v_accvgpr_write_b32 a31, v111
    s_add_u32 s52, s51, s49
    s_add_u32 s52, s52, 8
    s_lshl_b32 s76, s47, 1
    s_add_u32 s76, s76, s48
    s_mul_i32 s76, s76, 112
    s_add_u32 s76, s76, s52
    s_lshl_b32 s76, s76, 13
    s_mov_b32 s70, s76
    v_accvgpr_write_b32 a192, v144
    v_accvgpr_write_b32 a193, v145
    v_accvgpr_write_b32 a194, v146
    v_accvgpr_write_b32 a195, v147
    v_accvgpr_write_b32 a196, v148
    v_accvgpr_write_b32 a197, v149
    v_accvgpr_write_b32 a198, v150
    v_accvgpr_write_b32 a199, v151
    v_accvgpr_write_b32 a200, v152
    v_accvgpr_write_b32 a201, v153
    v_accvgpr_write_b32 a202, v154
    v_accvgpr_write_b32 a203, v155
    v_accvgpr_write_b32 a204, v156
    v_accvgpr_write_b32 a205, v157
    v_accvgpr_write_b32 a206, v158
    v_accvgpr_write_b32 a207, v159
    v_accvgpr_write_b32 a208, v160
    v_accvgpr_write_b32 a209, v161
    v_accvgpr_write_b32 a210, v162
    v_accvgpr_write_b32 a211, v163
    v_accvgpr_write_b32 a212, v164
    v_accvgpr_write_b32 a213, v165
    v_accvgpr_write_b32 a214, v166
    v_accvgpr_write_b32 a215, v167
    v_accvgpr_write_b32 a216, v168
    v_accvgpr_write_b32 a217, v169
    v_accvgpr_write_b32 a218, v170
    v_accvgpr_write_b32 a219, v171
    v_accvgpr_write_b32 a220, v172
    v_accvgpr_write_b32 a221, v173
    v_accvgpr_write_b32 a222, v174
    v_accvgpr_write_b32 a223, v175
    s_add_u32 s52, s51, s49
    s_add_u32 s52, s52, 56
    s_lshl_b32 s76, s47, 1
    s_add_u32 s76, s76, s48
    s_mul_i32 s76, s76, 112
    s_add_u32 s76, s76, s52
    s_lshl_b32 s76, s76, 13
    s_mov_b32 s71, s76
    s_mov_b32 s14, s47
    s_branch L_p2_entry
L_p2_entry:
    s_waitcnt lgkmcnt(0)
    s_and_b32 s37, s2, 31
    s_lshr_b32 s38, s2, 5
    s_and_b32 s74, s2, 7
    s_lshr_b32 s39, s74, 1
    s_lshl_b32 s39, s39, 2
    s_bfe_u32 s75, s2, 0x20003
    s_add_u32 s39, s39, s75
    s_and_b32 s56, s2, 1
    s_lshl_b32 s56, s56, 3
    s_lshr_b32 s75, s2, 5
    s_add_u32 s56, s56, s75
    v_lshlrev_b32 v200, 4, v0
    v_lshrrev_b32 v212, 5, v0
    v_bfe_u32 v213, v0, 2, 2
    v_lshl_add_u32 v212, v212, 2, v213
    v_lshlrev_b32 v212, 7, v212
    v_and_b32 v213, 3, v0
    v_lshl_add_u32 v212, v213, 3, v212
    v_bfe_u32 v213, v0, 4, 1
    v_lshl_add_u32 v212, v213, 5, v212
    v_bfe_u32 v213, v0, 3, 1
    v_lshl_add_u32 v202, v213, 6, v212
    v_xor_b32 v203, 64, v202
    v_bfe_u32 v212, v0, 4, 1
    v_lshlrev_b32 v212, 10, v212
    v_lshrrev_b32 v213, 5, v0
    v_lshl_add_u32 v212, v213, 8, v212
    v_and_b32 v213, 15, v0
    v_lshl_add_u32 v204, v213, 4, v212
    v_lshrrev_b32 v212, 3, v0
    v_lshlrev_b32 v212, 11, v212
    v_and_b32 v213, 7, v0
    v_lshl_add_u32 v212, v213, 4, v212
    v_bfe_u32 v213, v0, 4, 1
    v_lshlrev_b32 v213, 6, v213
    v_xor_b32 v206, v212, v213
    s_lshr_b32 s74, s36, 1
    s_lshl_b32 s74, s74, 12
    v_add_u32 v204, s74, v204
    v_add_u32 v205, 8192, v204
    v_add_u32 v207, 15360, v206
    v_add_u32 v208, 30720, v206
    v_add_u32 v209, 46080, v206
    s_lshl_b32 s60, s36, 12
    s_add_u32 s60, s60, 32768
    s_and_b32 s74, s36, 1
    s_lshl_b32 s57, s74, 14
    s_lshl_b32 s74, s74, 13
    s_add_u32 s74, s74, 32768
    v_add_u32 v202, s74, v202
    v_add_u32 v203, s74, v203
    s_lshl_b32 s74, s36, 10
    v_add_u32 v210, s74, v200
    s_lshl_b32 s61, s36, 11
    s_lshl_b32 s58, s36, 16
    s_mov_b32 s59, 0
    s_lshl_b32 s75, s37, 17
    s_add_u32 s74, s75, 8390656
    s_add_u32 s20, s4, s74
    s_addc_u32 s21, s5, 0
    s_mov_b32 s22, 131072
    s_mov_b32 s23, 0x00020000
    s_add_u32 s74, s75, 12581888
    s_add_u32 s24, s4, s74
    s_addc_u32 s25, s5, 0
    s_mov_b32 s26, 132096
    s_mov_b32 s27, 0x00020000
    s_add_u32 s16, s4, 4194304
    s_addc_u32 s17, s5, 0
    s_mov_b32 s18, 8388608
    s_mov_b32 s19, 0x00020000
    s_add_u32 s52, s4, 20971520
    s_addc_u32 s53, s5, 0
    s_mov_b32 s54, 40960
    s_mov_b32 s55, 0x00020000
    s_lshl_b32 s76, s38, 14
    s_lshl_b32 s77, s36, 12
    s_add_u32 s76, s76, s77
    s_add_u32 s76, s76, s75
    s_add_u32 s77, s75, 4194304
    s_cmp_lg_u32 s36, 3
    s_cbranch_scc1 L_p2_noqp
    s_lshr_b32 s74, s37, 1
    s_mul_i32 s75, s74, 43
    s_lshr_b32 s75, s75, 7
    s_add_u32 s78, s74, 16
    s_mul_i32 s78, s78, 43
    s_lshr_b32 s78, s78, 7
    s_cmp_lt_u32 s74, 8
    s_cselect_b32 s78, s78, s74
    s_and_b32 s79, s74, 1
    s_lshl_b32 s79, s79, 3
    s_lshr_b32 s74, s74, 1
    s_add_u32 s74, s74, s79
    s_add_u32 s74, s74, 16
    v_mov_b32 v213, s74
    v_writelane_b32 v213, s75, 0
    v_writelane_b32 v213, s78, 1
    s_and_b32 s74, s38, 3
    s_lshl_b32 s74, s74, 7
    s_add_u32 s74, s74, 16384
    v_lshl_add_u32 v213, v213, 9, s74
    s_waitcnt vmcnt(0)
    s_mov_b32 s74, 65536
L_p2_qpoll:
    buffer_load_dword v212, v213, s[52:55], 0 offen sc1
    s_sub_u32 s74, s74, 1
    s_cbranch_scc1 L_p2_qpoll_end
    s_waitcnt vmcnt(0)
    v_cmp_gt_u32 vcc, 8, v212
    s_cbranch_vccnz L_p2_qpoll
L_p2_qpoll_end:
L_p2_noqp:
    s_barrier
    buffer_load_dwordx4 v[16:19], v200, s[16:19], s76 offen offset:0
    buffer_load_dwordx4 v[20:23], v200, s[16:19], s76 offen offset:1024
    buffer_load_dwordx4 v[24:27], v200, s[16:19], s76 offen offset:2048
    buffer_load_dwordx4 v[28:31], v200, s[16:19], s76 offen offset:3072
    buffer_load_dwordx4 v[32:35], v200, s[16:19], s77 offen offset:0
    buffer_load_dwordx4 v[36:39], v200, s[16:19], s77 offen offset:1024
    buffer_load_dwordx4 v[40:43], v200, s[16:19], s77 offen offset:2048
    buffer_load_dwordx4 v[44:47], v200, s[16:19], s77 offen offset:3072
    s_add_u32 s77, s77, 4096
    buffer_load_dwordx4 v[160:163], v200, s[16:19], s77 offen offset:0
    buffer_load_dwordx4 v[164:167], v200, s[16:19], s77 offen offset:1024
    buffer_load_dwordx4 v[168:171], v200, s[16:19], s77 offen offset:2048
    buffer_load_dwordx4 v[172:175], v200, s[16:19], s77 offen offset:3072
    s_add_u32 m0, s61, 0
    s_nop 0
    buffer_load_dwordx4 v210, s[20:23], s59 offen lds
    buffer_load_dwordx4 v210, s[24:27], s59 offen offset:1024 lds
    s_add_u32 s59, s59, 4096
    s_add_u32 m0, s61, 8192
    s_nop 0
    buffer_load_dwordx4 v210, s[20:23], s59 offen lds
    buffer_load_dwordx4 v210, s[24:27], s59 offen offset:1024 lds
    s_add_u32 s59, s59, 4096
    s_add_u32 m0, s61, 16384
    s_nop 0
    buffer_load_dwordx4 v210, s[20:23], s59 offen lds
    buffer_load_dwordx4 v210, s[24:27], s59 offen offset:1024 lds
    s_add_u32 s59, s59, 4096
    s_add_u32 m0, s61, 24576
    s_nop 0
    buffer_load_dwordx4 v210, s[20:23], s59 offen lds
    buffer_load_dwordx4 v210, s[24:27], s59 offen offset:1024 lds
    s_add_u32 s59, s59, 4096
    buffer_store_dwordx4 a[0:3], v200, s[64:67], s70 offen offset:0 sc1
    buffer_store_dwordx4 a[4:7], v200, s[64:67], s70 offen offset:1024 sc1
    buffer_store_dwordx4 a[8:11], v200, s[64:67], s70 offen offset:2048 sc1
    buffer_store_dwordx4 a[12:15], v200, s[64:67], s70 offen offset:3072 sc1
    s_lshl_b32 s74, s56, 7
    s_add_u32 s32, s6, s74
    s_addc_u32 s33, s7, 0
    s_mov_b32 s34, 0
    s_mov_b32 s35, 0x00020000
    s_sub_u32 s34, 7340032, s74
    s_add_u32 s40, s8, s74
    s_addc_u32 s41, s9, 0
    s_mov_b32 s42, 0
    s_mov_b32 s43, 0x00020000
    s_sub_u32 s42, 2097152, s74
    s_lshl_b32 s69, s39, 18
    s_add_u32 s69, s69, s74
    s_lshl_b32 s74, s36, 16
    s_add_u32 s69, s69, s74
    s_mul_i32 s74, s39, 917504
    s_add_u32 s74, s74, 23068672
    s_add_u32 s28, s4, s74
    s_addc_u32 s29, s5, 0
    s_mov_b32 s30, 917504
    s_mov_b32 s31, 0x00020000
    s_mov_b32 s44, s10
    s_mov_b32 s45, s11
    s_mov_b32 s46, 4194304
    s_mov_b32 s47, 0x00020000
    s_mov_b32 s48, s12
    s_mov_b32 s49, s13
    s_mov_b32 s50, 4194304
    s_mov_b32 s51, 0x00020000
    v_and_b32 v8, 3, v0
    v_lshrrev_b32 v9, 2, v0
    v_lshrrev_b32 v10, 4, v0
    v_xor_b32 v9, v9, v10
    v_and_b32 v9, 1, v9
    v_or_b32 v8, v8, v9
    v_cmp_eq_u32 vcc, 0, v8
    v_mov_b32 v9, 0x3f803f80
    s_nop 0
    v_cndmask_b32 v4, 0, v9, vcc
    v_mov_b32 v5, v4
    v_mov_b32 v6, v4
    v_mov_b32 v7, v4
    v_bfe_u32 v8, v0, 3, 1
    v_lshlrev_b32 v8, 10, v8
    v_lshrrev_b32 v9, 5, v0
    v_lshl_add_u32 v8, v9, 8, v8
    v_bfe_u32 v9, v0, 4, 1
    v_lshl_add_u32 v8, v9, 7, v8
    v_and_b32 v9, 7, v0
    v_lshl_add_u32 v3, v9, 4, v8
    s_lshl_b32 s74, s38, 1
    s_lshr_b32 s75, s36, 1
    s_add_u32 s74, s74, s75
    s_lshl_b32 s74, s74, 18
    s_lshl_b32 s75, s37, 13
    s_add_u32 s74, s74, s75
    s_and_b32 s75, s36, 1
    s_lshl_b32 s75, s75, 12
    s_add_u32 s68, s74, s75
    s_mov_b32 s63, 0x6c800000
    v_and_b32 v211, 31, v0
    v_lshlrev_b32 v211, 11, v211
    v_lshrrev_b32 v9, 5, v0
    v_lshl_add_u32 v211, v9, 4, v211
    v_mov_b32 v56, 0
    v_mov_b32 v57, 0
    v_mov_b32 v58, 0
    v_mov_b32 v59, 0
    v_mov_b32 v60, 0
    v_mov_b32 v61, 0
    v_mov_b32 v62, 0
    v_mov_b32 v63, 0
    v_mov_b32 v64, 0
    v_mov_b32 v65, 0
    v_mov_b32 v66, 0
    v_mov_b32 v67, 0
    v_mov_b32 v68, 0
    v_mov_b32 v69, 0
    v_mov_b32 v70, 0
    v_mov_b32 v71, 0
    v_mov_b32 v72, 0
    v_mov_b32 v73, 0
    v_mov_b32 v74, 0
    v_mov_b32 v75, 0
    v_mov_b32 v76, 0
    v_mov_b32 v77, 0
    v_mov_b32 v78, 0
    v_mov_b32 v79, 0
    v_mov_b32 v80, 0
    v_mov_b32 v81, 0
    v_mov_b32 v82, 0
    v_mov_b32 v83, 0
    v_mov_b32 v84, 0
    v_mov_b32 v85, 0
    v_mov_b32 v86, 0
    v_mov_b32 v87, 0
    v_mov_b32 v88, 0
    v_mov_b32 v89, 0
    v_mov_b32 v90, 0
    v_mov_b32 v91, 0
    v_mov_b32 v92, 0
    v_mov_b32 v93, 0
    v_mov_b32 v94, 0
    v_mov_b32 v95, 0
    v_mov_b32 v216, 0
    v_mov_b32 v217, 0
    v_mov_b32 v218, 0
    v_mov_b32 v219, 0
    s_waitcnt vmcnt(18)
    v_mfma_f32_32x32x16_bf16 v[96:111], v[32:35], v[16:19], 0
    v_mfma_f32_32x32x16_bf16 v[96:111], v[36:39], v[20:23], v[96:111]
    v_mfma_f32_32x32x16_bf16 v[112:127], v[32:35], v[24:27], 0
    v_mfma_f32_32x32x16_bf16 v[112:127], v[36:39], v[28:31], v[112:127]
    s_waitcnt vmcnt(16)
    v_mfma_f32_32x32x16_bf16 v[128:143], v[40:43], v[16:19], 0
    v_mfma_f32_32x32x16_bf16 v[128:143], v[44:47], v[20:23], v[128:143]
    s_nop 7
    v_max3_f32 v192, v96, v97, v98
    v_max3_f32 v192, v192, v99, v100
    v_max3_f32 v192, v192, v101, v102
    v_max3_f32 v192, v192, v103, v104
    v_max3_f32 v192, v192, v105, v106
    v_max3_f32 v192, v192, v107, v108
    v_max3_f32 v192, v192, v109, v110
    v_max_f32 v192, v192, v111
    v_mfma_f32_32x32x16_bf16 v[144:159], v[40:43], v[24:27], 0
    v_max3_f32 v193, v112, v113, v114
    v_max3_f32 v193, v193, v115, v116
    v_max3_f32 v193, v193, v117, v118
    v_max3_f32 v193, v193, v119, v120
    v_mfma_f32_32x32x16_bf16 v[144:159], v[44:47], v[28:31], v[144:159]
    v_max3_f32 v193, v193, v121, v122
    v_max3_f32 v193, v193, v123, v124
    v_max3_f32 v193, v193, v125, v126
    v_max_f32 v193, v193, v127
    s_waitcnt vmcnt(14)
    v_mfma_f32_32x32x16_bf16 v[96:111], v[160:163], v[16:19], 0
    v_mfma_f32_32x32x16_bf16 v[96:111], v[164:167], v[20:23], v[96:111]
    v_max3_f32 v192, v192, v128, v129
    v_max3_f32 v192, v192, v130, v131
    v_max3_f32 v192, v192, v132, v133
    v_max3_f32 v192, v192, v134, v135
    v_max3_f32 v192, v192, v136, v137
    v_max3_f32 v192, v192, v138, v139
    v_max3_f32 v192, v192, v140, v141
    v_max3_f32 v192, v192, v142, v143
    v_mfma_f32_32x32x16_bf16 v[112:127], v[160:163], v[24:27], 0
    v_max3_f32 v193, v193, v144, v145
    v_max3_f32 v193, v193, v146, v147
    v_max3_f32 v193, v193, v148, v149
    v_max3_f32 v193, v193, v150, v151
    v_mfma_f32_32x32x16_bf16 v[112:127], v[164:167], v[28:31], v[112:127]
    v_max3_f32 v193, v193, v152, v153
    v_max3_f32 v193, v193, v154, v155
    v_max3_f32 v193, v193, v156, v157
    v_max3_f32 v193, v193, v158, v159
    s_waitcnt vmcnt(12)
    v_mfma_f32_32x32x16_bf16 v[128:143], v[168:171], v[16:19], 0
    v_mfma_f32_32x32x16_bf16 v[128:143], v[172:175], v[20:23], v[128:143]
    v_max3_f32 v192, v192, v96, v97
    v_max3_f32 v192, v192, v98, v99
    v_max3_f32 v192, v192, v100, v101
    v_max3_f32 v192, v192, v102, v103
    v_max3_f32 v192, v192, v104, v105
    v_max3_f32 v192, v192, v106, v107
    v_max3_f32 v192, v192, v108, v109
    v_max3_f32 v192, v192, v110, v111
    v_mfma_f32_32x32x16_bf16 v[144:159], v[168:171], v[24:27], 0
    v_max3_f32 v193, v193, v112, v113
    v_max3_f32 v193, v193, v114, v115
    v_max3_f32 v193, v193, v116, v117
    v_max3_f32 v193, v193, v118, v119
    v_mfma_f32_32x32x16_bf16 v[144:159], v[172:175], v[28:31], v[144:159]
    v_max3_f32 v193, v193, v120, v121
    v_max3_f32 v193, v193, v122, v123
    v_max3_f32 v193, v193, v124, v125
    v_max3_f32 v193, v193, v126, v127
    v_max3_f32 v192, v192, v128, v129
    v_max3_f32 v192, v192, v130, v131
    v_max3_f32 v192, v192, v132, v133
    v_max3_f32 v192, v192, v134, v135
    v_max3_f32 v192, v192, v136, v137
    v_max3_f32 v192, v192, v138, v139
    v_max3_f32 v192, v192, v140, v141
    v_max3_f32 v192, v192, v142, v143
    v_max3_f32 v193, v193, v144, v145
    v_max3_f32 v193, v193, v146, v147
    v_max3_f32 v193, v193, v148, v149
    v_max3_f32 v193, v193, v150, v151
    v_max3_f32 v193, v193, v152, v153
    v_max3_f32 v193, v193, v154, v155
    v_max3_f32 v193, v193, v156, v157
    v_max3_f32 v193, v193, v158, v159
    v_mov_b32 v194, v192
    v_mov_b32 v195, v193
    s_nop 1
    v_permlane32_swap_b32 v192, v194
    v_permlane32_swap_b32 v193, v195
    v_max_f32 v192, v192, v194
    v_add_f32 v192, 0x42800000, v192
    v_ceil_f32 v192, v192
    v_sub_f32 v128, 0, v192
    v_sub_f32 v129, 0, v192
    v_sub_f32 v130, 0, v192
    v_sub_f32 v131, 0, v192
    v_sub_f32 v132, 0, v192
    v_sub_f32 v133, 0, v192
    v_sub_f32 v134, 0, v192
    v_sub_f32 v135, 0, v192
    v_sub_f32 v136, 0, v192
    v_sub_f32 v137, 0, v192
    v_sub_f32 v138, 0, v192
    v_sub_f32 v139, 0, v192
    v_sub_f32 v140, 0, v192
    v_sub_f32 v141, 0, v192
    v_sub_f32 v142, 0, v192
    v_sub_f32 v143, 0, v192
    s_nop 1
    v_mfma_f32_32x32x16_bf16 v[96:111], v[32:35], v[16:19], v[128:143]
    v_mfma_f32_32x32x16_bf16 v[96:111], v[36:39], v[20:23], v[96:111]
    v_max_f32 v193, v193, v195
    v_add_f32 v193, 0x42800000, v193
    v_ceil_f32 v193, v193
    v_sub_f32 v144, 0, v193
    v_sub_f32 v145, 0, v193
    v_sub_f32 v146, 0, v193
    v_sub_f32 v147, 0, v193
    v_sub_f32 v148, 0, v193
    v_sub_f32 v149, 0, v193
    v_sub_f32 v150, 0, v193
    v_sub_f32 v151, 0, v193
    v_sub_f32 v152, 0, v193
    v_sub_f32 v153, 0, v193
    v_sub_f32 v154, 0, v193
    v_sub_f32 v155, 0, v193
    v_sub_f32 v156, 0, v193
    v_sub_f32 v157, 0, v193
    v_sub_f32 v158, 0, v193
    v_sub_f32 v159, 0, v193
    v_mov_b32 v160, 0
    v_mov_b32 v161, 0
    v_mov_b32 v162, 0
    v_mov_b32 v163, 0
    v_mov_b32 v164, 0
    v_mov_b32 v165, 0
    v_mov_b32 v166, 0
    v_mov_b32 v167, 0
    v_mov_b32 v168, 0
    v_mov_b32 v169, 0
    v_mov_b32 v170, 0
    v_mov_b32 v171, 0
    v_mov_b32 v172, 0
    v_mov_b32 v173, 0
    v_mov_b32 v174, 0
    v_mov_b32 v175, 0
    v_mov_b32 v176, 0
    v_mov_b32 v177, 0
    v_mov_b32 v178, 0
    v_mov_b32 v179, 0
    v_mov_b32 v180, 0
    v_mov_b32 v181, 0
    v_mov_b32 v182, 0
    v_mov_b32 v183, 0
    v_mov_b32 v184, 0
    v_mov_b32 v185, 0
    v_mov_b32 v186, 0
    v_mov_b32 v187, 0
    v_mov_b32 v188, 0
    v_mov_b32 v189, 0
    v_mov_b32 v190, 0
    v_mov_b32 v191, 0
    s_lshl_b32 s78, s36, 16
    s_add_u32 s78, s78, 1048576
    s_waitcnt vmcnt(10)
    s_barrier
    v_exp_f32 v8, v96
    v_exp_f32 v9, v97
    v_mfma_f32_16x16x32_bf16 v[92:95], v[4:7], v[76:79], v[92:95]
    v_exp_f32 v10, v98
    v_mfma_f32_32x32x16_bf16 v[160:175], v[60:63], v[68:71], v[160:175]
    ds_read_b128 v[40:43], v200 offset:0
    ds_read_b128 v[44:47], v200 offset:2048
    ds_read_b128 v[48:51], v200 offset:1024
    ds_read_b128 v[52:55], v200 offset:3072
    v_cvt_pk_bf16_f32 v64, v8, v9
    v_exp_f32 v11, v99
    v_exp_f32 v12, v100
    v_cvt_pk_bf16_f32 v65, v10, v11
    v_exp_f32 v13, v101
    v_exp_f32 v14, v102
    v_cmp_nge_f32 vcc, s63, v92
    v_cvt_pk_bf16_f32 v66, v12, v13
    v_exp_f32 v15, v103
    v_exp_f32 v8, v104
    s_cbranch_vccnz L_p2_s0_go
L_p2_s0_back:
    v_mfma_f32_32x32x16_bf16 v[112:127], v[32:35], v[24:27], v[144:159]
    s_add_u32 s70, s70, 4096
    buffer_store_dwordx4 a[16:19], v200, s[64:67], s70 offen offset:0 sc1
    v_cvt_pk_bf16_f32 v67, v14, v15
    v_exp_f32 v9, v105
    v_exp_f32 v10, v106
    v_cvt_pk_bf16_f32 v68, v8, v9
    v_mfma_f32_32x32x16_bf16 v[112:127], v[36:39], v[28:31], v[112:127]
    buffer_store_dwordx4 a[20:23], v200, s[64:67], s70 offen offset:1024 sc1
    v_exp_f32 v11, v107
    v_exp_f32 v12, v108
    v_cvt_pk_bf16_f32 v69, v10, v11
    v_exp_f32 v13, v109
    v_mfma_f32_32x32x16_bf16 v[176:191], v[56:59], v[72:75], v[176:191]
    buffer_store_dwordx4 a[24:27], v200, s[64:67], s70 offen offset:2048 sc1
    v_exp_f32 v14, v110
    v_cvt_pk_bf16_f32 v70, v12, v13
    v_exp_f32 v15, v111
    v_mfma_f32_16x16x32_bf16 v[80:83], v[4:7], v[64:67], v[84:87]
    v_cvt_pk_bf16_f32 v71, v14, v15
    v_exp_f32 v8, v112
    v_exp_f32 v9, v113
    v_mfma_f32_16x16x32_bf16 v[80:83], v[4:7], v[68:71], v[80:83]
    v_exp_f32 v10, v114
    v_mfma_f32_32x32x16_bf16 v[176:191], v[60:63], v[76:79], v[176:191]
    buffer_store_dwordx4 a[28:31], v200, s[64:67], s70 offen offset:3072 sc1
    v_cvt_pk_bf16_f32 v72, v8, v9
    v_exp_f32 v11, v115
    v_exp_f32 v12, v116
    v_cvt_pk_bf16_f32 v73, v10, v11
    v_exp_f32 v13, v117
    v_exp_f32 v14, v118
    v_cmp_nge_f32 vcc, s63, v80
    v_cvt_pk_bf16_f32 v74, v12, v13
    v_exp_f32 v15, v119
    v_exp_f32 v8, v120
    s_cbranch_vccnz L_p2_s1_go
L_p2_s1_back:
    s_waitcnt lgkmcnt(0)
    v_mfma_f32_32x32x16_bf16 v[96:111], v[40:43], v[16:19], v[128:143]
    s_add_u32 m0, s60, 0
    v_cvt_pk_bf16_f32 v75, v14, v15
    v_exp_f32 v9, v121
    v_exp_f32 v10, v122
    v_cvt_pk_bf16_f32 v76, v8, v9
    v_mfma_f32_32x32x16_bf16 v[96:111], v[44:47], v[20:23], v[96:111]
    buffer_load_dwordx4 v206, s[32:35], s58 offen offset:0 lds
    v_exp_f32 v11, v123
    v_exp_f32 v12, v124
    v_cvt_pk_bf16_f32 v77, v10, v11
    v_exp_f32 v13, v125
    v_mfma_f32_32x32x16_bf16 v[160:175], v[48:51], v[64:67], v[160:175]
    buffer_load_dwordx4 v207, s[32:35], s58 offen offset:1024 lds
    v_exp_f32 v14, v126
    v_cvt_pk_bf16_f32 v78, v12, v13
    v_exp_f32 v15, v127
    v_mfma_f32_16x16x32_bf16 v[88:91], v[4:7], v[72:75], v[92:95]
    v_cvt_pk_bf16_f32 v79, v14, v15
    v_exp_f32 v8, v96
    v_exp_f32 v9, v97
    v_mfma_f32_16x16x32_bf16 v[88:91], v[4:7], v[76:79], v[88:91]
    v_exp_f32 v10, v98
    v_mfma_f32_32x32x16_bf16 v[160:175], v[52:55], v[68:71], v[160:175]
    ds_read_b128 v[32:35], v200 offset:4096
    ds_read_b128 v[36:39], v200 offset:6144
    ds_read_b128 v[56:59], v200 offset:5120
    ds_read_b128 v[60:63], v200 offset:7168
    v_cvt_pk_bf16_f32 v64, v8, v9
    v_exp_f32 v11, v99
    v_exp_f32 v12, v100
    v_cvt_pk_bf16_f32 v65, v10, v11
    v_exp_f32 v13, v101
    v_exp_f32 v14, v102
    v_cmp_nge_f32 vcc, s63, v88
    v_cvt_pk_bf16_f32 v66, v12, v13
    v_exp_f32 v15, v103
    v_exp_f32 v8, v104
    s_cbranch_vccnz L_p2_s2_go
L_p2_s2_back:
    v_mfma_f32_32x32x16_bf16 v[112:127], v[40:43], v[24:27], v[144:159]
    buffer_load_dwordx4 v208, s[32:35], s58 offen offset:2048 lds
    v_cvt_pk_bf16_f32 v67, v14, v15
    v_exp_f32 v9, v105
    v_exp_f32 v10, v106
    v_cvt_pk_bf16_f32 v68, v8, v9
    v_mfma_f32_32x32x16_bf16 v[112:127], v[44:47], v[28:31], v[112:127]
    buffer_load_dwordx4 v209, s[32:35], s58 offen offset:3072 lds
    v_exp_f32 v11, v107
    v_exp_f32 v12, v108
    v_cvt_pk_bf16_f32 v69, v10, v11
    v_exp_f32 v13, v109
    v_mfma_f32_32x32x16_bf16 v[176:191], v[48:51], v[72:75], v[176:191]
    s_add_u32 s58, s58, 262144
    v_exp_f32 v14, v110
    v_cvt_pk_bf16_f32 v70, v12, v13
    v_exp_f32 v15, v111
    v_mfma_f32_16x16x32_bf16 v[84:87], v[4:7], v[64:67], v[80:83]
    v_cvt_pk_bf16_f32 v71, v14, v15
    v_exp_f32 v8, v112
    v_exp_f32 v9, v113
    v_mfma_f32_16x16x32_bf16 v[84:87], v[4:7], v[68:71], v[84:87]
    v_exp_f32 v10, v114
    v_mfma_f32_32x32x16_bf16 v[176:191], v[52:55], v[76:79], v[176:191]
    v_cvt_pk_bf16_f32 v72, v8, v9
    v_exp_f32 v11, v115
    v_exp_f32 v12, v116
    v_cvt_pk_bf16_f32 v73, v10, v11
    v_exp_f32 v13, v117
    v_exp_f32 v14, v118
    v_cmp_nge_f32 vcc, s63, v84
    v_cvt_pk_bf16_f32 v74, v12, v13
    v_exp_f32 v15, v119
    v_exp_f32 v8, v120
    s_cbranch_vccnz L_p2_s3_go
L_p2_s3_back:
    s_waitcnt lgkmcnt(0)
    v_mfma_f32_32x32x16_bf16 v[96:111], v[32:35], v[16:19], v[128:143]
    v_cvt_pk_bf16_f32 v75, v14, v15
    v_exp_f32 v9, v121
    v_exp_f32 v10, v122
    v_cvt_pk_bf16_f32 v76, v8, v9
    v_mfma_f32_32x32x16_bf16 v[96:111], v[36:39], v[20:23], v[96:111]
    v_exp_f32 v11, v123
    v_exp_f32 v12, v124
    v_cvt_pk_bf16_f32 v77, v10, v11
    v_exp_f32 v13, v125
    v_mfma_f32_32x32x16_bf16 v[160:175], v[56:59], v[64:67], v[160:175]
    v_exp_f32 v14, v126
    v_cvt_pk_bf16_f32 v78, v12, v13
    v_exp_f32 v15, v127
    v_mfma_f32_16x16x32_bf16 v[92:95], v[4:7], v[72:75], v[88:91]
    v_cvt_pk_bf16_f32 v79, v14, v15
    s_waitcnt vmcnt(16)
    s_barrier
    v_exp_f32 v8, v96
    v_exp_f32 v9, v97
    v_mfma_f32_16x16x32_bf16 v[92:95], v[4:7], v[76:79], v[92:95]
    v_exp_f32 v10, v98
    v_mfma_f32_32x32x16_bf16 v[160:175], v[60:63], v[68:71], v[160:175]
    ds_read_b128 v[40:43], v200 offset:8192
    ds_read_b128 v[44:47], v200 offset:10240
    ds_read_b128 v[48:51], v200 offset:9216
    ds_read_b128 v[52:55], v200 offset:11264
    v_cvt_pk_bf16_f32 v64, v8, v9
    v_exp_f32 v11, v99
    v_exp_f32 v12, v100
    v_cvt_pk_bf16_f32 v65, v10, v11
    v_exp_f32 v13, v101
    v_exp_f32 v14, v102
    v_cmp_nge_f32 vcc, s63, v92
    v_cvt_pk_bf16_f32 v66, v12, v13
    v_exp_f32 v15, v103
    v_exp_f32 v8, v104
    s_cbranch_vccnz L_p2_s4_go
L_p2_s4_back:
    v_mfma_f32_32x32x16_bf16 v[112:127], v[32:35], v[24:27], v[144:159]
    s_add_u32 m0, s61, 0
    v_cvt_pk_bf16_f32 v67, v14, v15
    v_exp_f32 v9, v105
    v_exp_f32 v10, v106
    v_cvt_pk_bf16_f32 v68, v8, v9
    v_mfma_f32_32x32x16_bf16 v[112:127], v[36:39], v[28:31], v[112:127]
    buffer_load_dwordx4 v210, s[20:23], s59 offen lds
    v_exp_f32 v11, v107
    v_exp_f32 v12, v108
    v_cvt_pk_bf16_f32 v69, v10, v11
    v_exp_f32 v13, v109
    v_mfma_f32_32x32x16_bf16 v[176:191], v[56:59], v[72:75], v[176:191]
    buffer_load_dwordx4 v210, s[24:27], s59 offen offset:1024 lds
    v_exp_f32 v14, v110
    v_cvt_pk_bf16_f32 v70, v12, v13
    v_exp_f32 v15, v111
    v_mfma_f32_16x16x32_bf16 v[80:83], v[4:7], v[64:67], v[84:87]
    v_cvt_pk_bf16_f32 v71, v14, v15
    v_exp_f32 v8, v112
    v_exp_f32 v9, v113
    v_mfma_f32_16x16x32_bf16 v[80:83], v[4:7], v[68:71], v[80:83]
    v_exp_f32 v10, v114
    v_mfma_f32_32x32x16_bf16 v[176:191], v[60:63], v[76:79], v[176:191]
    s_add_u32 s59, s59, 4096
    s_add_u32 m0, s60, 16384
    v_cvt_pk_bf16_f32 v72, v8, v9
    v_exp_f32 v11, v115
    v_exp_f32 v12, v116
    v_cvt_pk_bf16_f32 v73, v10, v11
    v_exp_f32 v13, v117
    v_exp_f32 v14, v118
    v_cmp_nge_f32 vcc, s63, v80
    v_cvt_pk_bf16_f32 v74, v12, v13
    v_exp_f32 v15, v119
    v_exp_f32 v8, v120
    s_cbranch_vccnz L_p2_s5_go
L_p2_s5_back:
    s_waitcnt lgkmcnt(0)
    v_mfma_f32_32x32x16_bf16 v[96:111], v[40:43], v[16:19], v[128:143]
    buffer_load_dwordx4 v206, s[32:35], s58 offen offset:0 lds
    v_cvt_pk_bf16_f32 v75, v14, v15
    v_exp_f32 v9, v121
    v_exp_f32 v10, v122
    v_cvt_pk_bf16_f32 v76, v8, v9
    v_mfma_f32_32x32x16_bf16 v[96:111], v[44:47], v[20:23], v[96:111]
    buffer_load_dwordx4 v207, s[32:35], s58 offen offset:1024 lds
    v_exp_f32 v11, v123
    v_exp_f32 v12, v124
    v_cvt_pk_bf16_f32 v77, v10, v11
    v_exp_f32 v13, v125
    v_mfma_f32_32x32x16_bf16 v[160:175], v[48:51], v[64:67], v[160:175]
    buffer_load_dwordx4 v208, s[32:35], s58 offen offset:2048 lds
    v_exp_f32 v14, v126
    v_cvt_pk_bf16_f32 v78, v12, v13
    v_exp_f32 v15, v127
    v_mfma_f32_16x16x32_bf16 v[88:91], v[4:7], v[72:75], v[92:95]
    v_cvt_pk_bf16_f32 v79, v14, v15
    v_exp_f32 v8, v96
    v_exp_f32 v9, v97
    v_mfma_f32_16x16x32_bf16 v[88:91], v[4:7], v[76:79], v[88:91]
    v_exp_f32 v10, v98
    v_mfma_f32_32x32x16_bf16 v[160:175], v[52:55], v[68:71], v[160:175]
    ds_read_b128 v[32:35], v200 offset:12288
    ds_read_b128 v[36:39], v200 offset:14336
    ds_read_b128 v[56:59], v200 offset:13312
    ds_read_b128 v[60:63], v200 offset:15360
    v_cvt_pk_bf16_f32 v64, v8, v9
    v_exp_f32 v11, v99
    v_exp_f32 v12, v100
    v_cvt_pk_bf16_f32 v65, v10, v11
    v_exp_f32 v13, v101
    v_exp_f32 v14, v102
    v_cmp_nge_f32 vcc, s63, v88
    v_cvt_pk_bf16_f32 v66, v12, v13
    v_exp_f32 v15, v103
    v_exp_f32 v8, v104
    s_cbranch_vccnz L_p2_s6_go
L_p2_s6_back:
    v_mfma_f32_32x32x16_bf16 v[112:127], v[40:43], v[24:27], v[144:159]
    buffer_load_dwordx4 v209, s[32:35], s58 offen offset:3072 lds
    v_cvt_pk_bf16_f32 v67, v14, v15
    v_exp_f32 v9, v105
    v_exp_f32 v10, v106
    v_cvt_pk_bf16_f32 v68, v8, v9
    v_mfma_f32_32x32x16_bf16 v[112:127], v[44:47], v[28:31], v[112:127]
    s_add_u32 s58, s58, 262144
    v_exp_f32 v11, v107
    v_exp_f32 v12, v108
    v_cvt_pk_bf16_f32 v69, v10, v11
    v_exp_f32 v13, v109
    v_mfma_f32_32x32x16_bf16 v[176:191], v[48:51], v[72:75], v[176:191]
    v_exp_f32 v14, v110
    v_cvt_pk_bf16_f32 v70, v12, v13
    v_exp_f32 v15, v111
    v_mfma_f32_16x16x32_bf16 v[84:87], v[4:7], v[64:67], v[80:83]
    v_cvt_pk_bf16_f32 v71, v14, v15
    v_exp_f32 v8, v112
    v_exp_f32 v9, v113
    v_mfma_f32_16x16x32_bf16 v[84:87], v[4:7], v[68:71], v[84:87]
    v_exp_f32 v10, v114
    v_mfma_f32_32x32x16_bf16 v[176:191], v[52:55], v[76:79], v[176:191]
    v_cvt_pk_bf16_f32 v72, v8, v9
    v_exp_f32 v11, v115
    v_exp_f32 v12, v116
    v_cvt_pk_bf16_f32 v73, v10, v11
    v_exp_f32 v13, v117
    v_exp_f32 v14, v118
    v_cmp_nge_f32 vcc, s63, v84
    v_cvt_pk_bf16_f32 v74, v12, v13
    v_exp_f32 v15, v119
    v_exp_f32 v8, v120
    s_cbranch_vccnz L_p2_s7_go
L_p2_s7_back:
    s_waitcnt lgkmcnt(0)
    v_mfma_f32_32x32x16_bf16 v[96:111], v[32:35], v[16:19], v[128:143]
    v_cvt_pk_bf16_f32 v75, v14, v15
    v_exp_f32 v9, v121
    v_exp_f32 v10, v122
    v_cvt_pk_bf16_f32 v76, v8, v9
    v_mfma_f32_32x32x16_bf16 v[96:111], v[36:39], v[20:23], v[96:111]
    v_exp_f32 v11, v123
    v_exp_f32 v12, v124
    v_cvt_pk_bf16_f32 v77, v10, v11
    v_exp_f32 v13, v125
    v_mfma_f32_32x32x16_bf16 v[160:175], v[56:59], v[64:67], v[160:175]
    v_exp_f32 v14, v126
    v_cvt_pk_bf16_f32 v78, v12, v13
    v_exp_f32 v15, v127
    v_mfma_f32_16x16x32_bf16 v[92:95], v[4:7], v[72:75], v[88:91]
    v_cvt_pk_bf16_f32 v79, v14, v15
    s_waitcnt vmcnt(0)
    s_barrier
    s_cmp_lg_u32 s36, 3
    s_cbranch_scc1 L_p2_noh
    s_lshl_b32 s74, s14, 10
    s_add_u32 s74, s74, 8192
    v_mov_b32 v212, 1
    v_lshlrev_b32 v213, 7, v0
    s_mov_b64 exec, 0xff
    buffer_atomic_add v212, v213, s[52:55], s74 offen sc1
    s_mov_b64 exec, -1
L_p2_noh:
    v_exp_f32 v8, v96
    v_exp_f32 v9, v97
    v_mfma_f32_16x16x32_bf16 v[92:95], v[4:7], v[76:79], v[92:95]
    v_exp_f32 v10, v98
    v_mfma_f32_32x32x16_bf16 v[160:175], v[60:63], v[68:71], v[160:175]
    ds_read_b128 v[40:43], v200 offset:16384
    ds_read_b128 v[44:47], v200 offset:18432
    ds_read_b128 v[48:51], v200 offset:17408
    ds_read_b128 v[52:55], v200 offset:19456
    v_cvt_pk_bf16_f32 v64, v8, v9
    v_exp_f32 v11, v99
    v_exp_f32 v12, v100
    v_cvt_pk_bf16_f32 v65, v10, v11
    v_exp_f32 v13, v101
    v_exp_f32 v14, v102
    v_cmp_nge_f32 vcc, s63, v92
    v_cvt_pk_bf16_f32 v66, v12, v13
    v_exp_f32 v15, v103
    v_exp_f32 v8, v104
    s_cbranch_vccnz L_p2_s8_go
L_p2_s8_back:
    v_mfma_f32_32x32x16_bf16 v[112:127], v[32:35], v[24:27], v[144:159]
    s_add_u32 m0, s61, 8192
    v_cvt_pk_bf16_f32 v67, v14, v15
    v_exp_f32 v9, v105
    v_exp_f32 v10, v106
    v_cvt_pk_bf16_f32 v68, v8, v9
    v_mfma_f32_32x32x16_bf16 v[112:127], v[36:39], v[28:31], v[112:127]
    buffer_load_dwordx4 v210, s[20:23], s59 offen lds
    v_exp_f32 v11, v107
    v_exp_f32 v12, v108
    v_cvt_pk_bf16_f32 v69, v10, v11
    v_exp_f32 v13, v109
    v_mfma_f32_32x32x16_bf16 v[176:191], v[56:59], v[72:75], v[176:191]
    buffer_load_dwordx4 v210, s[24:27], s59 offen offset:1024 lds
    v_exp_f32 v14, v110
    v_cvt_pk_bf16_f32 v70, v12, v13
    v_exp_f32 v15, v111
    v_mfma_f32_16x16x32_bf16 v[80:83], v[4:7], v[64:67], v[84:87]
    v_cvt_pk_bf16_f32 v71, v14, v15
    v_exp_f32 v8, v112
    v_exp_f32 v9, v113
    v_mfma_f32_16x16x32_bf16 v[80:83], v[4:7], v[68:71], v[80:83]
    v_exp_f32 v10, v114
    v_mfma_f32_32x32x16_bf16 v[176:191], v[60:63], v[76:79], v[176:191]
    s_add_u32 s59, s59, 4096
    s_add_u32 m0, s60, 32768
    v_cvt_pk_bf16_f32 v72, v8, v9
    v_exp_f32 v11, v115
    v_exp_f32 v12, v116
    v_cvt_pk_bf16_f32 v73, v10, v11
    v_exp_f32 v13, v117
    v_exp_f32 v14, v118
    v_cmp_nge_f32 vcc, s63, v80
    v_cvt_pk_bf16_f32 v74, v12, v13
    v_exp_f32 v15, v119
    v_exp_f32 v8, v120
    s_cbranch_vccnz L_p2_s9_go
L_p2_s9_back:
    s_waitcnt lgkmcnt(0)
    v_mfma_f32_32x32x16_bf16 v[96:111], v[40:43], v[16:19], v[128:143]
    buffer_load_dwordx4 v206, s[32:35], s58 offen offset:0 lds
    v_cvt_pk_bf16_f32 v75, v14, v15
    v_exp_f32 v9, v121
    v_exp_f32 v10, v122
    v_cvt_pk_bf16_f32 v76, v8, v9
    v_mfma_f32_32x32x16_bf16 v[96:111], v[44:47], v[20:23], v[96:111]
    buffer_load_dwordx4 v207, s[32:35], s58 offen offset:1024 lds
    v_exp_f32 v11, v123
    v_exp_f32 v12, v124
    v_cvt_pk_bf16_f32 v77, v10, v11
    v_exp_f32 v13, v125
    v_mfma_f32_32x32x16_bf16 v[160:175], v[48:51], v[64:67], v[160:175]
    buffer_load_dwordx4 v208, s[32:35], s58 offen offset:2048 lds
    v_exp_f32 v14, v126
    v_cvt_pk_bf16_f32 v78, v12, v13
    v_exp_f32 v15, v127
    v_mfma_f32_16x16x32_bf16 v[88:91], v[4:7], v[72:75], v[92:95]
    v_cvt_pk_bf16_f32 v79, v14, v15
    v_exp_f32 v8, v96
    v_exp_f32 v9, v97
    v_mfma_f32_16x16x32_bf16 v[88:91], v[4:7], v[76:79], v[88:91]
    v_exp_f32 v10, v98
    v_mfma_f32_32x32x16_bf16 v[160:175], v[52:55], v[68:71], v[160:175]
    ds_read_b128 v[32:35], v200 offset:20480
    ds_read_b128 v[36:39], v200 offset:22528
    ds_read_b128 v[56:59], v200 offset:21504
    ds_read_b128 v[60:63], v200 offset:23552
    v_cvt_pk_bf16_f32 v64, v8, v9
    v_exp_f32 v11, v99
    v_exp_f32 v12, v100
    v_cvt_pk_bf16_f32 v65, v10, v11
    v_exp_f32 v13, v101
    v_exp_f32 v14, v102
    v_cmp_nge_f32 vcc, s63, v88
    v_cvt_pk_bf16_f32 v66, v12, v13
    v_exp_f32 v15, v103
    v_exp_f32 v8, v104
    s_cbranch_vccnz L_p2_s10_go
L_p2_s10_back:
    v_mfma_f32_32x32x16_bf16 v[112:127], v[40:43], v[24:27], v[144:159]
    buffer_load_dwordx4 v209, s[32:35], s58 offen offset:3072 lds
    v_cvt_pk_bf16_f32 v67, v14, v15
    v_exp_f32 v9, v105
    v_exp_f32 v10, v106
    v_cvt_pk_bf16_f32 v68, v8, v9
    v_mfma_f32_32x32x16_bf16 v[112:127], v[44:47], v[28:31], v[112:127]
    s_add_u32 s58, s58, 262144
    buffer_load_dwordx4 v[220:223], v211, s[44:47], s69 offen offset:0
    v_exp_f32 v11, v107
    v_exp_f32 v12, v108
    v_cvt_pk_bf16_f32 v69, v10, v11
    v_exp_f32 v13, v109
    v_mfma_f32_32x32x16_bf16 v[176:191], v[48:51], v[72:75], v[176:191]
    buffer_load_dwordx4 v[224:227], v211, s[44:47], s69 offen offset:32
    v_exp_f32 v14, v110
    v_cvt_pk_bf16_f32 v70, v12, v13
    v_exp_f32 v15, v111
    v_mfma_f32_16x16x32_bf16 v[84:87], v[4:7], v[64:67], v[80:83]
    v_cvt_pk_bf16_f32 v71, v14, v15
    v_exp_f32 v8, v112
    v_exp_f32 v9, v113
    v_mfma_f32_16x16x32_bf16 v[84:87], v[4:7], v[68:71], v[84:87]
    v_exp_f32 v10, v114
    v_mfma_f32_32x32x16_bf16 v[176:191], v[52:55], v[76:79], v[176:191]
    v_cvt_pk_bf16_f32 v72, v8, v9
    v_exp_f32 v11, v115
    v_exp_f32 v12, v116
    v_cvt_pk_bf16_f32 v73, v10, v11
    v_exp_f32 v13, v117
    v_exp_f32 v14, v118
    v_cmp_nge_f32 vcc, s63, v84
    v_cvt_pk_bf16_f32 v74, v12, v13
    v_exp_f32 v15, v119
    v_exp_f32 v8, v120
    s_cbranch_vccnz L_p2_s11_go
L_p2_s11_back:
    s_waitcnt lgkmcnt(0)
    v_mfma_f32_32x32x16_bf16 v[96:111], v[32:35], v[16:19], v[128:143]
    v_cvt_pk_bf16_f32 v75, v14, v15
    v_exp_f32 v9, v121
    v_exp_f32 v10, v122
    v_cvt_pk_bf16_f32 v76, v8, v9
    v_mfma_f32_32x32x16_bf16 v[96:111], v[36:39], v[20:23], v[96:111]
    v_exp_f32 v11, v123
    v_exp_f32 v12, v124
    v_cvt_pk_bf16_f32 v77, v10, v11
    v_exp_f32 v13, v125
    v_mfma_f32_32x32x16_bf16 v[160:175], v[56:59], v[64:67], v[160:175]
    v_exp_f32 v14, v126
    v_cvt_pk_bf16_f32 v78, v12, v13
    v_exp_f32 v15, v127
    v_mfma_f32_16x16x32_bf16 v[92:95], v[4:7], v[72:75], v[88:91]
    v_cvt_pk_bf16_f32 v79, v14, v15
    s_lshr_b32 s76, s39, 1
    s_mul_i32 s76, s76, 8
    s_and_b32 s77, s56, 7
    s_add_u32 s76, s76, s77
    s_lshl_b32 s76, s76, 7
    s_add_u32 s76, s76, 8192
    v_mov_b32 v215, s76
    s_waitcnt vmcnt(26)
    s_barrier
    v_exp_f32 v8, v96
    v_exp_f32 v9, v97
    v_mfma_f32_16x16x32_bf16 v[92:95], v[4:7], v[76:79], v[92:95]
    v_exp_f32 v10, v98
    v_mfma_f32_32x32x16_bf16 v[160:175], v[60:63], v[68:71], v[160:175]
    ds_read_b128 v[40:43], v200 offset:24576
    ds_read_b128 v[44:47], v200 offset:26624
    ds_read_b128 v[48:51], v200 offset:25600
    ds_read_b128 v[52:55], v200 offset:27648
    v_cvt_pk_bf16_f32 v64, v8, v9
    v_exp_f32 v11, v99
    v_exp_f32 v12, v100
    v_cvt_pk_bf16_f32 v65, v10, v11
    v_exp_f32 v13, v101
    v_exp_f32 v14, v102
    v_cmp_nge_f32 vcc, s63, v92
    v_cvt_pk_bf16_f32 v66, v12, v13
    v_exp_f32 v15, v103
    v_exp_f32 v8, v104
    s_cbranch_vccnz L_p2_s12_go
L_p2_s12_back:
    v_mfma_f32_32x32x16_bf16 v[112:127], v[32:35], v[24:27], v[144:159]
    s_add_u32 m0, s61, 16384
    v_cvt_pk_bf16_f32 v67, v14, v15
    v_exp_f32 v9, v105
    v_exp_f32 v10, v106
    v_cvt_pk_bf16_f32 v68, v8, v9
    v_mfma_f32_32x32x16_bf16 v[112:127], v[36:39], v[28:31], v[112:127]
    buffer_load_dwordx4 v210, s[20:23], s59 offen lds
    v_exp_f32 v11, v107
    v_exp_f32 v12, v108
    v_cvt_pk_bf16_f32 v69, v10, v11
    v_exp_f32 v13, v109
    v_mfma_f32_32x32x16_bf16 v[176:191], v[56:59], v[72:75], v[176:191]
    buffer_load_dwordx4 v210, s[24:27], s59 offen offset:1024 lds
    v_exp_f32 v14, v110
    v_cvt_pk_bf16_f32 v70, v12, v13
    v_exp_f32 v15, v111
    v_mfma_f32_16x16x32_bf16 v[80:83], v[4:7], v[64:67], v[84:87]
    v_cvt_pk_bf16_f32 v71, v14, v15
    v_exp_f32 v8, v112
    v_exp_f32 v9, v113
    v_mfma_f32_16x16x32_bf16 v[80:83], v[4:7], v[68:71], v[80:83]
    v_exp_f32 v10, v114
    v_mfma_f32_32x32x16_bf16 v[176:191], v[60:63], v[76:79], v[176:191]
    s_add_u32 s59, s59, 4096
    s_add_u32 m0, s60, 49152
    v_cvt_pk_bf16_f32 v72, v8, v9
    v_exp_f32 v11, v115
    v_exp_f32 v12, v116
    v_cvt_pk_bf16_f32 v73, v10, v11
    v_exp_f32 v13, v117
    v_exp_f32 v14, v118
    v_cmp_nge_f32 vcc, s63, v80
    v_cvt_pk_bf16_f32 v74, v12, v13
    v_exp_f32 v15, v119
    v_exp_f32 v8, v120
    s_cbranch_vccnz L_p2_s13_go
L_p2_s13_back:
    s_waitcnt lgkmcnt(0)
    v_mfma_f32_32x32x16_bf16 v[96:111], v[40:43], v[16:19], v[128:143]
    buffer_load_dwordx4 v206, s[32:35], s58 offen offset:0 lds
    v_cvt_pk_bf16_f32 v75, v14, v15
    v_exp_f32 v9, v121
    v_exp_f32 v10, v122
    v_cvt_pk_bf16_f32 v76, v8, v9
    v_mfma_f32_32x32x16_bf16 v[96:111], v[44:47], v[20:23], v[96:111]
    buffer_load_dwordx4 v207, s[32:35], s58 offen offset:1024 lds
    v_exp_f32 v11, v123
    v_exp_f32 v12, v124
    v_cvt_pk_bf16_f32 v77, v10, v11
    v_exp_f32 v13, v125
    v_mfma_f32_32x32x16_bf16 v[160:175], v[48:51], v[64:67], v[160:175]
    buffer_load_dwordx4 v208, s[32:35], s58 offen offset:2048 lds
    v_exp_f32 v14, v126
    v_cvt_pk_bf16_f32 v78, v12, v13
    v_exp_f32 v15, v127
    v_mfma_f32_16x16x32_bf16 v[88:91], v[4:7], v[72:75], v[92:95]
    v_cvt_pk_bf16_f32 v79, v14, v15
    v_exp_f32 v8, v96
    v_exp_f32 v9, v97
    v_mfma_f32_16x16x32_bf16 v[88:91], v[4:7], v[76:79], v[88:91]
    v_exp_f32 v10, v98
    v_mfma_f32_32x32x16_bf16 v[160:175], v[52:55], v[68:71], v[160:175]
    ds_read_b128 v[32:35], v200 offset:28672
    ds_read_b128 v[36:39], v200 offset:30720
    ds_read_b128 v[56:59], v200 offset:29696
    ds_read_b128 v[60:63], v200 offset:31744
    v_cvt_pk_bf16_f32 v64, v8, v9
    v_exp_f32 v11, v99
    v_exp_f32 v12, v100
    v_cvt_pk_bf16_f32 v65, v10, v11
    v_exp_f32 v13, v101
    v_exp_f32 v14, v102
    v_cmp_nge_f32 vcc, s63, v88
    v_cvt_pk_bf16_f32 v66, v12, v13
    v_exp_f32 v15, v103
    v_exp_f32 v8, v104
    s_cbranch_vccnz L_p2_s14_go
L_p2_s14_back:
    v_mfma_f32_32x32x16_bf16 v[112:127], v[40:43], v[24:27], v[144:159]
    buffer_load_dwordx4 v209, s[32:35], s58 offen offset:3072 lds
    v_cvt_pk_bf16_f32 v67, v14, v15
    v_exp_f32 v9, v105
    v_exp_f32 v10, v106
    v_cvt_pk_bf16_f32 v68, v8, v9
    v_mfma_f32_32x32x16_bf16 v[112:127], v[44:47], v[28:31], v[112:127]
    buffer_load_dword v214, v215, s[52:55], 0 offen sc1
    v_exp_f32 v11, v107
    v_exp_f32 v12, v108
    v_cvt_pk_bf16_f32 v69, v10, v11
    v_exp_f32 v13, v109
    v_mfma_f32_32x32x16_bf16 v[176:191], v[48:51], v[72:75], v[176:191]
    s_add_u32 s58, s58, 262144
    buffer_load_dwordx4 v[228:231], v211, s[44:47], s69 offen offset:64
    v_exp_f32 v14, v110
    v_cvt_pk_bf16_f32 v70, v12, v13
    v_exp_f32 v15, v111
    v_mfma_f32_16x16x32_bf16 v[84:87], v[4:7], v[64:67], v[80:83]
    v_cvt_pk_bf16_f32 v71, v14, v15
    v_exp_f32 v8, v112
    v_exp_f32 v9, v113
    v_mfma_f32_16x16x32_bf16 v[84:87], v[4:7], v[68:71], v[84:87]
    v_exp_f32 v10, v114
    v_mfma_f32_32x32x16_bf16 v[176:191], v[52:55], v[76:79], v[176:191]
    buffer_load_dwordx4 v[232:235], v211, s[44:47], s69 offen offset:96
    v_cvt_pk_bf16_f32 v72, v8, v9
    v_exp_f32 v11, v115
    v_exp_f32 v12, v116
    v_cvt_pk_bf16_f32 v73, v10, v11
    v_exp_f32 v13, v117
    v_exp_f32 v14, v118
    v_cmp_nge_f32 vcc, s63, v84
    v_cvt_pk_bf16_f32 v74, v12, v13
    v_exp_f32 v15, v119
    v_exp_f32 v8, v120
    s_cbranch_vccnz L_p2_s15_go
L_p2_s15_back:
    s_waitcnt lgkmcnt(0)
    v_mfma_f32_32x32x16_bf16 v[96:111], v[32:35], v[16:19], v[128:143]
    v_cvt_pk_bf16_f32 v75, v14, v15
    v_exp_f32 v9, v121
    v_exp_f32 v10, v122
    v_cvt_pk_bf16_f32 v76, v8, v9
    v_mfma_f32_32x32x16_bf16 v[96:111], v[36:39], v[20:23], v[96:111]
    v_exp_f32 v11, v123
    v_exp_f32 v12, v124
    v_cvt_pk_bf16_f32 v77, v10, v11
    v_exp_f32 v13, v125
    v_mfma_f32_32x32x16_bf16 v[160:175], v[56:59], v[64:67], v[160:175]
    v_exp_f32 v14, v126
    v_cvt_pk_bf16_f32 v78, v12, v13
    v_exp_f32 v15, v127
    v_mfma_f32_16x16x32_bf16 v[92:95], v[4:7], v[72:75], v[88:91]
    v_cvt_pk_bf16_f32 v79, v14, v15
    s_waitcnt vmcnt(2)
    v_cmp_gt_u32 vcc, 32, v214
    s_cbranch_vccz L_p2_hpoll_end
    s_mov_b32 s74, 65536
L_p2_hpoll:
    buffer_load_dword v214, v215, s[52:55], 0 offen sc1
    s_sub_u32 s74, s74, 1
    s_cbranch_scc1 L_p2_hpoll_end
    s_waitcnt vmcnt(0)
    v_cmp_gt_u32 vcc, 32, v214
    s_cbranch_vccnz L_p2_hpoll
L_p2_hpoll_end:
    s_waitcnt vmcnt(21)
    s_barrier
    v_exp_f32 v8, v96
    v_exp_f32 v9, v97
    v_mfma_f32_16x16x32_bf16 v[92:95], v[4:7], v[76:79], v[92:95]
    v_exp_f32 v10, v98
    v_mfma_f32_32x32x16_bf16 v[160:175], v[60:63], v[68:71], v[160:175]
    ds_read_b128 v[40:43], v200 offset:0
    ds_read_b128 v[44:47], v200 offset:2048
    ds_read_b128 v[48:51], v200 offset:1024
    ds_read_b128 v[52:55], v200 offset:3072
    v_cvt_pk_bf16_f32 v64, v8, v9
    v_exp_f32 v11, v99
    v_exp_f32 v12, v100
    v_cvt_pk_bf16_f32 v65, v10, v11
    v_exp_f32 v13, v101
    v_exp_f32 v14, v102
    v_cmp_nge_f32 vcc, s63, v92
    v_cvt_pk_bf16_f32 v66, v12, v13
    v_exp_f32 v15, v103
    v_exp_f32 v8, v104
    s_cbranch_vccnz L_p2_s16_go
L_p2_s16_back:
    v_mfma_f32_32x32x16_bf16 v[112:127], v[32:35], v[24:27], v[144:159]
    s_add_u32 m0, s61, 24576
    v_cvt_pk_bf16_f32 v67, v14, v15
    v_exp_f32 v9, v105
    v_exp_f32 v10, v106
    v_cvt_pk_bf16_f32 v68, v8, v9
    v_mfma_f32_32x32x16_bf16 v[112:127], v[36:39], v[28:31], v[112:127]
    buffer_load_dwordx4 v210, s[20:23], s59 offen lds
    v_exp_f32 v11, v107
    v_exp_f32 v12, v108
    v_cvt_pk_bf16_f32 v69, v10, v11
    v_exp_f32 v13, v109
    v_mfma_f32_32x32x16_bf16 v[176:191], v[56:59], v[72:75], v[176:191]
    buffer_load_dwordx4 v210, s[24:27], s59 offen offset:1024 lds
    v_exp_f32 v14, v110
    v_cvt_pk_bf16_f32 v70, v12, v13
    v_exp_f32 v15, v111
    v_mfma_f32_16x16x32_bf16 v[80:83], v[4:7], v[64:67], v[84:87]
    v_cvt_pk_bf16_f32 v71, v14, v15
    v_exp_f32 v8, v112
    v_exp_f32 v9, v113
    v_mfma_f32_16x16x32_bf16 v[80:83], v[4:7], v[68:71], v[80:83]
    v_exp_f32 v10, v114
    v_mfma_f32_32x32x16_bf16 v[176:191], v[60:63], v[76:79], v[176:191]
    s_add_u32 s59, s59, 4096
    buffer_store_dwordx4 a[192:195], v200, s[64:67], s71 offen offset:0 sc1
    v_cvt_pk_bf16_f32 v72, v8, v9
    v_exp_f32 v11, v115
    v_exp_f32 v12, v116
    v_cvt_pk_bf16_f32 v73, v10, v11
    v_exp_f32 v13, v117
    v_exp_f32 v14, v118
    v_cmp_nge_f32 vcc, s63, v80
    v_cvt_pk_bf16_f32 v74, v12, v13
    v_exp_f32 v15, v119
    v_exp_f32 v8, v120
    s_cbranch_vccnz L_p2_s17_go
L_p2_s17_back:
    s_waitcnt lgkmcnt(0)
    v_mfma_f32_32x32x16_bf16 v[96:111], v[40:43], v[16:19], v[128:143]
    buffer_store_dwordx4 a[196:199], v200, s[64:67], s71 offen offset:1024 sc1
    v_cvt_pk_bf16_f32 v75, v14, v15
    v_exp_f32 v9, v121
    v_exp_f32 v10, v122
    v_cvt_pk_bf16_f32 v76, v8, v9
    v_mfma_f32_32x32x16_bf16 v[96:111], v[44:47], v[20:23], v[96:111]
    buffer_load_dwordx4 a[64:67], v204, s[28:31], s57 offen offset:0
    v_exp_f32 v11, v123
    v_exp_f32 v12, v124
    v_cvt_pk_bf16_f32 v77, v10, v11
    v_exp_f32 v13, v125
    v_mfma_f32_32x32x16_bf16 v[160:175], v[48:51], v[64:67], v[160:175]
    buffer_load_dwordx4 a[72:75], v204, s[28:31], s57 offen offset:2048
    v_exp_f32 v14, v126
    v_cvt_pk_bf16_f32 v78, v12, v13
    v_exp_f32 v15, v127
    v_mfma_f32_16x16x32_bf16 v[88:91], v[4:7], v[72:75], v[92:95]
    v_cvt_pk_bf16_f32 v79, v14, v15
    v_exp_f32 v8, v96
    v_exp_f32 v9, v97
    v_mfma_f32_16x16x32_bf16 v[88:91], v[4:7], v[76:79], v[88:91]
    v_exp_f32 v10, v98
    v_mfma_f32_32x32x16_bf16 v[160:175], v[52:55], v[68:71], v[160:175]
    ds_read_b128 v[32:35], v200 offset:4096
    ds_read_b128 v[36:39], v200 offset:6144
    ds_read_b128 v[56:59], v200 offset:5120
    ds_read_b128 v[60:63], v200 offset:7168
    v_cvt_pk_bf16_f32 v64, v8, v9
    v_exp_f32 v11, v99
    v_exp_f32 v12, v100
    v_cvt_pk_bf16_f32 v65, v10, v11
    v_exp_f32 v13, v101
    v_exp_f32 v14, v102
    v_cmp_nge_f32 vcc, s63, v88
    v_cvt_pk_bf16_f32 v66, v12, v13
    v_exp_f32 v15, v103
    v_exp_f32 v8, v104
    s_cbranch_vccnz L_p2_s18_go
L_p2_s18_back:
    v_mfma_f32_32x32x16_bf16 v[112:127], v[40:43], v[24:27], v[144:159]
    buffer_load_dwordx4 a[68:71], v204, s[28:31], s57 offen offset:512
    v_cvt_pk_bf16_f32 v67, v14, v15
    v_exp_f32 v9, v105
    v_exp_f32 v10, v106
    v_cvt_pk_bf16_f32 v68, v8, v9
    v_mfma_f32_32x32x16_bf16 v[112:127], v[44:47], v[28:31], v[112:127]
    buffer_load_dwordx4 a[76:79], v204, s[28:31], s57 offen offset:2560
    v_exp_f32 v11, v107
    v_exp_f32 v12, v108
    v_cvt_pk_bf16_f32 v69, v10, v11
    v_exp_f32 v13, v109
    v_mfma_f32_32x32x16_bf16 v[176:191], v[48:51], v[72:75], v[176:191]
    buffer_load_dwordx4 a[80:83], v205, s[28:31], s57 offen offset:0
    v_exp_f32 v14, v110
    v_cvt_pk_bf16_f32 v70, v12, v13
    v_exp_f32 v15, v111
    v_mfma_f32_16x16x32_bf16 v[84:87], v[4:7], v[64:67], v[80:83]
    v_cvt_pk_bf16_f32 v71, v14, v15
    v_exp_f32 v8, v112
    v_exp_f32 v9, v113
    v_mfma_f32_16x16x32_bf16 v[84:87], v[4:7], v[68:71], v[84:87]
    v_exp_f32 v10, v114
    v_mfma_f32_32x32x16_bf16 v[176:191], v[52:55], v[76:79], v[176:191]
    buffer_load_dwordx4 a[88:91], v205, s[28:31], s57 offen offset:2048
    v_cvt_pk_bf16_f32 v72, v8, v9
    v_exp_f32 v11, v115
    v_exp_f32 v12, v116
    v_cvt_pk_bf16_f32 v73, v10, v11
    v_exp_f32 v13, v117
    v_exp_f32 v14, v118
    v_cmp_nge_f32 vcc, s63, v84
    v_cvt_pk_bf16_f32 v74, v12, v13
    v_exp_f32 v15, v119
    v_exp_f32 v8, v120
    s_cbranch_vccnz L_p2_s19_go
L_p2_s19_back:
    s_waitcnt lgkmcnt(0)
    v_mfma_f32_32x32x16_bf16 v[96:111], v[32:35], v[16:19], v[128:143]
    buffer_load_dwordx4 a[84:87], v205, s[28:31], s57 offen offset:512
    v_cvt_pk_bf16_f32 v75, v14, v15
    v_exp_f32 v9, v121
    v_exp_f32 v10, v122
    v_cvt_pk_bf16_f32 v76, v8, v9
    v_mfma_f32_32x32x16_bf16 v[96:111], v[36:39], v[20:23], v[96:111]
    buffer_load_dwordx4 a[92:95], v205, s[28:31], s57 offen offset:2560
    v_exp_f32 v11, v123
    v_exp_f32 v12, v124
    v_cvt_pk_bf16_f32 v77, v10, v11
    v_exp_f32 v13, v125
    v_mfma_f32_32x32x16_bf16 v[160:175], v[56:59], v[64:67], v[160:175]
    s_add_u32 s57, s57, 0x8000
    v_exp_f32 v14, v126
    v_cvt_pk_bf16_f32 v78, v12, v13
    v_exp_f32 v15, v127
    v_mfma_f32_16x16x32_bf16 v[92:95], v[4:7], v[72:75], v[88:91]
    v_cvt_pk_bf16_f32 v79, v14, v15
    s_waitcnt vmcnt(27)
    s_barrier
    v_exp_f32 v8, v96
    v_exp_f32 v9, v97
    v_mfma_f32_16x16x32_bf16 v[92:95], v[4:7], v[76:79], v[92:95]
    v_exp_f32 v10, v98
    v_mfma_f32_32x32x16_bf16 v[160:175], v[60:63], v[68:71], v[160:175]
    ds_read_b128 v[40:43], v200 offset:8192
    ds_read_b128 v[44:47], v200 offset:10240
    ds_read_b128 v[48:51], v200 offset:9216
    ds_read_b128 v[52:55], v200 offset:11264
    v_cvt_pk_bf16_f32 v64, v8, v9
    v_exp_f32 v11, v99
    v_exp_f32 v12, v100
    s_add_u32 m0, s61, 0
    v_cvt_pk_bf16_f32 v65, v10, v11
    v_exp_f32 v13, v101
    v_exp_f32 v14, v102
    v_cmp_nge_f32 vcc, s63, v92
    v_cvt_pk_bf16_f32 v66, v12, v13
    v_exp_f32 v15, v103
    v_exp_f32 v8, v104
    s_cbranch_vccnz L_p2_s20_go
L_p2_s20_back:
    v_mfma_f32_32x32x16_bf16 v[112:127], v[32:35], v[24:27], v[144:159]
    buffer_load_dwordx4 v210, s[20:23], s59 offen lds
    v_cvt_pk_bf16_f32 v67, v14, v15
    v_exp_f32 v9, v105
    buffer_load_dwordx4 v210, s[24:27], s59 offen offset:1024 lds
    v_exp_f32 v10, v106
    v_cvt_pk_bf16_f32 v68, v8, v9
    v_mfma_f32_32x32x16_bf16 v[112:127], v[36:39], v[28:31], v[112:127]
    s_add_u32 s59, s59, 4096
    buffer_store_dwordx4 a[200:203], v200, s[64:67], s71 offen offset:2048 sc1
    ds_read_b64_tr_b16 a[128:129], v202 offset:0
    ds_read_b64_tr_b16 a[130:131], v202 offset:2048
    ds_read_b64_tr_b16 a[132:133], v203 offset:0
    ds_read_b64_tr_b16 a[134:135], v203 offset:2048
    v_exp_f32 v11, v107
    v_exp_f32 v12, v108
    buffer_store_dwordx4 a[204:207], v200, s[64:67], s71 offen offset:3072 sc1
    v_cvt_pk_bf16_f32 v69, v10, v11
    v_exp_f32 v13, v109
    v_mfma_f32_32x32x16_bf16 v[176:191], v[56:59], v[72:75], v[176:191]
    buffer_load_dwordx4 a[96:99], v204, s[28:31], s57 offen offset:0
    v_exp_f32 v14, v110
    v_cvt_pk_bf16_f32 v70, v12, v13
    v_exp_f32 v15, v111
    v_mfma_f32_16x16x32_bf16 v[80:83], v[4:7], v[64:67], v[84:87]
    v_cvt_pk_bf16_f32 v71, v14, v15
    buffer_load_dwordx4 a[104:107], v204, s[28:31], s57 offen offset:2048
    v_exp_f32 v8, v112
    v_exp_f32 v9, v113
    v_mfma_f32_16x16x32_bf16 v[80:83], v[4:7], v[68:71], v[80:83]
    v_exp_f32 v10, v114
    v_mfma_f32_32x32x16_bf16 v[176:191], v[60:63], v[76:79], v[176:191]
    v_cvt_pk_bf16_f32 v72, v8, v9
    v_exp_f32 v11, v115
    v_exp_f32 v12, v116
    buffer_load_dwordx4 a[100:103], v204, s[28:31], s57 offen offset:512
    v_cvt_pk_bf16_f32 v73, v10, v11
    v_exp_f32 v13, v117
    v_exp_f32 v14, v118
    v_cmp_nge_f32 vcc, s63, v80
    v_cvt_pk_bf16_f32 v74, v12, v13
    v_exp_f32 v15, v119
    v_exp_f32 v8, v120
    s_cbranch_vccnz L_p2_s21_go
L_p2_s21_back:
    s_waitcnt lgkmcnt(0)
    v_mfma_f32_32x32x16_bf16 v[96:111], v[40:43], v[16:19], v[128:143]
    buffer_load_dwordx4 a[108:111], v204, s[28:31], s57 offen offset:2560
    ds_read_b64_tr_b16 a[136:137], v202 offset:1024
    ds_read_b64_tr_b16 a[138:139], v202 offset:3072
    ds_read_b64_tr_b16 a[140:141], v203 offset:1024
    ds_read_b64_tr_b16 a[142:143], v203 offset:3072
    v_cvt_pk_bf16_f32 v75, v14, v15
    v_exp_f32 v9, v121
    buffer_load_dwordx4 a[112:115], v205, s[28:31], s57 offen offset:0
    v_exp_f32 v10, v122
    v_cvt_pk_bf16_f32 v76, v8, v9
    v_mfma_f32_32x32x16_bf16 v[96:111], v[44:47], v[20:23], v[96:111]
    buffer_load_dwordx4 a[120:123], v205, s[28:31], s57 offen offset:2048
    v_exp_f32 v11, v123
    v_exp_f32 v12, v124
    buffer_load_dwordx4 a[116:119], v205, s[28:31], s57 offen offset:512
    v_cvt_pk_bf16_f32 v77, v10, v11
    v_exp_f32 v13, v125
    v_mfma_f32_32x32x16_bf16 v[160:175], v[48:51], v[64:67], v[160:175]
    buffer_load_dwordx4 a[124:127], v205, s[28:31], s57 offen offset:2560
    ds_read_b64_tr_b16 a[144:145], v202 offset:4096
    ds_read_b64_tr_b16 a[146:147], v202 offset:6144
    ds_read_b64_tr_b16 a[148:149], v203 offset:4096
    ds_read_b64_tr_b16 a[150:151], v203 offset:6144
    v_exp_f32 v14, v126
    v_cvt_pk_bf16_f32 v78, v12, v13
    v_exp_f32 v15, v127
    v_mfma_f32_16x16x32_bf16 v[88:91], v[4:7], v[72:75], v[92:95]
    v_cvt_pk_bf16_f32 v79, v14, v15
    s_add_u32 s57, s57, 0x8000
    v_mfma_f32_32x32x16_bf16 a[0:15], v[216:219], v[216:219], 0
    v_exp_f32 v8, v96
    v_exp_f32 v9, v97
    v_mfma_f32_16x16x32_bf16 v[88:91], v[4:7], v[76:79], v[88:91]
    v_exp_f32 v10, v98
    v_mfma_f32_32x32x16_bf16 v[160:175], v[52:55], v[68:71], v[160:175]
    ds_read_b128 v[32:35], v200 offset:12288
    ds_read_b128 v[36:39], v200 offset:14336
    ds_read_b128 v[56:59], v200 offset:13312
    ds_read_b128 v[60:63], v200 offset:15360
    v_cvt_pk_bf16_f32 v64, v8, v9
    v_exp_f32 v11, v99
    v_exp_f32 v12, v100
    v_mfma_f32_32x32x16_bf16 a[16:31], v[216:219], v[216:219], 0
    v_cvt_pk_bf16_f32 v65, v10, v11
    v_exp_f32 v13, v101
    v_exp_f32 v14, v102
    v_cmp_nge_f32 vcc, s63, v88
    v_cvt_pk_bf16_f32 v66, v12, v13
    v_exp_f32 v15, v103
    v_exp_f32 v8, v104
    s_cbranch_vccnz L_p2_s22_go
L_p2_s22_back:
    v_mfma_f32_32x32x16_bf16 v[112:127], v[40:43], v[24:27], v[144:159]
    v_mfma_f32_32x32x16_bf16 a[32:47], v[216:219], v[216:219], 0
    ds_read_b64_tr_b16 a[152:153], v202 offset:5120
    ds_read_b64_tr_b16 a[154:155], v202 offset:7168
    ds_read_b64_tr_b16 a[156:157], v203 offset:5120
    ds_read_b64_tr_b16 a[158:159], v203 offset:7168
    v_cvt_pk_bf16_f32 v67, v14, v15
    v_exp_f32 v9, v105
    v_mfma_f32_32x32x16_bf16 a[48:63], v[216:219], v[216:219], 0
    v_exp_f32 v10, v106
    v_cvt_pk_bf16_f32 v68, v8, v9
    v_mfma_f32_32x32x16_bf16 v[112:127], v[44:47], v[28:31], v[112:127]
    v_exp_f32 v11, v107
    v_exp_f32 v12, v108
    v_cvt_pk_bf16_f32 v69, v10, v11
    v_exp_f32 v13, v109
    v_mfma_f32_32x32x16_bf16 v[176:191], v[48:51], v[72:75], v[176:191]
    v_exp_f32 v14, v110
    v_cvt_pk_bf16_f32 v70, v12, v13
    v_exp_f32 v15, v111
    v_mfma_f32_16x16x32_bf16 v[84:87], v[4:7], v[64:67], v[80:83]
    v_cvt_pk_bf16_f32 v71, v14, v15
    v_exp_f32 v8, v112
    v_exp_f32 v9, v113
    v_mfma_f32_16x16x32_bf16 v[84:87], v[4:7], v[68:71], v[84:87]
    v_exp_f32 v10, v114
    v_mfma_f32_32x32x16_bf16 v[176:191], v[52:55], v[76:79], v[176:191]
    v_cvt_pk_bf16_f32 v72, v8, v9
    v_exp_f32 v11, v115
    v_exp_f32 v12, v116
    v_cvt_pk_bf16_f32 v73, v10, v11
    v_exp_f32 v13, v117
    v_exp_f32 v14, v118
    v_cmp_nge_f32 vcc, s63, v84
    v_cvt_pk_bf16_f32 v74, v12, v13
    v_exp_f32 v15, v119
    v_exp_f32 v8, v120
    s_cbranch_vccnz L_p2_s23_go
L_p2_s23_back:
    s_waitcnt lgkmcnt(0)
    v_mfma_f32_32x32x16_bf16 v[96:111], v[32:35], v[16:19], v[128:143]
    v_cvt_pk_bf16_f32 v75, v14, v15
    v_exp_f32 v9, v121
    v_exp_f32 v10, v122
    v_cvt_pk_bf16_f32 v76, v8, v9
    v_mfma_f32_32x32x16_bf16 v[96:111], v[36:39], v[20:23], v[96:111]
    v_exp_f32 v11, v123
    v_exp_f32 v12, v124
    v_cvt_pk_bf16_f32 v77, v10, v11
    v_exp_f32 v13, v125
    v_mfma_f32_32x32x16_bf16 v[160:175], v[56:59], v[64:67], v[160:175]
    v_exp_f32 v14, v126
    v_cvt_pk_bf16_f32 v78, v12, v13
    v_exp_f32 v15, v127
    v_mfma_f32_16x16x32_bf16 v[92:95], v[4:7], v[72:75], v[88:91]
    v_cvt_pk_bf16_f32 v79, v14, v15
    s_lshl_b32 s58, s36, 17
    s_add_u32 s58, s58, 1048576
    s_add_u32 s15, s58, 65536
    s_mov_b32 s62, 5
    s_waitcnt vmcnt(12)
    s_barrier
    v_exp_f32 v8, v96
    v_exp_f32 v9, v97
    v_mfma_f32_16x16x32_bf16 v[92:95], v[4:7], v[76:79], v[92:95]
    v_exp_f32 v10, v98
    v_mfma_f32_32x32x16_bf16 v[160:175], v[60:63], v[68:71], v[160:175]
    ds_read_b128 v[40:43], v200 offset:16384
    ds_read_b128 v[44:47], v200 offset:18432
    ds_read_b128 v[48:51], v200 offset:17408
    ds_read_b128 v[52:55], v200 offset:19456
    v_cvt_pk_bf16_f32 v64, v8, v9
    v_exp_f32 v11, v99
    v_exp_f32 v12, v100
    v_mfma_f32_32x32x16_bf16 a[0:15], a[128:131], a[64:67], a[0:15]
    s_add_u32 m0, s61, 8192
    v_cvt_pk_bf16_f32 v65, v10, v11
    v_exp_f32 v13, v101
    v_exp_f32 v14, v102
    v_mfma_f32_32x32x16_bf16 a[16:31], a[132:135], a[64:67], a[16:31]
    v_cmp_nge_f32 vcc, s63, v92
    v_cvt_pk_bf16_f32 v66, v12, v13
    v_exp_f32 v15, v103
    s_cbranch_vccnz L_p2_s24_go
L_p2_s24_back:
    v_mfma_f32_32x32x16_bf16 v[112:127], v[32:35], v[24:27], v[144:159]
    buffer_load_dwordx4 a[64:67], v204, s[28:31], s57 offen offset:0
    v_exp_f32 v8, v104
    v_cvt_pk_bf16_f32 v67, v14, v15
    v_exp_f32 v9, v105
    v_mfma_f32_32x32x16_bf16 v[112:127], v[36:39], v[28:31], v[112:127]
    buffer_load_dwordx4 v210, s[20:23], s59 offen lds
    v_exp_f32 v10, v106
    v_cvt_pk_bf16_f32 v68, v8, v9
    v_exp_f32 v11, v107
    v_mfma_f32_32x32x16_bf16 a[32:47], a[128:131], a[72:75], a[32:47]
    buffer_load_dwordx4 v210, s[24:27], s59 offen offset:1024 lds
    s_add_u32 s59, s59, 4096
    v_exp_f32 v12, v108
    v_cvt_pk_bf16_f32 v69, v10, v11
    v_exp_f32 v13, v109
    v_mfma_f32_32x32x16_bf16 v[176:191], v[56:59], v[72:75], v[176:191]
    s_add_u32 m0, s60, 0
    ds_read_b64_tr_b16 a[160:161], v202 offset:16384
    ds_read_b64_tr_b16 a[162:163], v202 offset:18432
    v_exp_f32 v14, v110
    v_cvt_pk_bf16_f32 v70, v12, v13
    v_exp_f32 v15, v111
    v_mfma_f32_16x16x32_bf16 v[80:83], v[4:7], v[64:67], v[84:87]
    v_cvt_pk_bf16_f32 v71, v14, v15
    v_mfma_f32_32x32x16_bf16 a[48:63], a[132:135], a[72:75], a[48:63]
    buffer_load_dwordx4 a[72:75], v204, s[28:31], s57 offen offset:2048
    v_exp_f32 v8, v112
    v_exp_f32 v9, v113
    v_mfma_f32_16x16x32_bf16 v[80:83], v[4:7], v[68:71], v[80:83]
    v_exp_f32 v10, v114
    v_mfma_f32_32x32x16_bf16 v[176:191], v[60:63], v[76:79], v[176:191]
    buffer_load_dwordx4 v206, s[32:35], s58 offen offset:0 lds
    v_cvt_pk_bf16_f32 v72, v8, v9
    v_exp_f32 v11, v115
    v_exp_f32 v12, v116
    v_mfma_f32_32x32x16_bf16 a[0:15], a[136:139], a[68:71], a[0:15]
    buffer_load_dwordx4 v207, s[32:35], s58 offen offset:1024 lds
    v_cvt_pk_bf16_f32 v73, v10, v11
    v_exp_f32 v13, v117
    v_exp_f32 v14, v118
    v_mfma_f32_32x32x16_bf16 a[16:31], a[140:143], a[68:71], a[16:31]
    v_cmp_nge_f32 vcc, s63, v80
    v_cvt_pk_bf16_f32 v74, v12, v13
    v_exp_f32 v15, v119
    s_cbranch_vccnz L_p2_s25_go
L_p2_s25_back:
    s_waitcnt lgkmcnt(0)
    v_mfma_f32_32x32x16_bf16 v[96:111], v[40:43], v[16:19], v[128:143]
    buffer_load_dwordx4 a[68:71], v204, s[28:31], s57 offen offset:512
    v_exp_f32 v8, v120
    v_cvt_pk_bf16_f32 v75, v14, v15
    v_exp_f32 v9, v121
    v_mfma_f32_32x32x16_bf16 v[96:111], v[44:47], v[20:23], v[96:111]
    ds_read_b64_tr_b16 a[164:165], v203 offset:16384
    ds_read_b64_tr_b16 a[166:167], v203 offset:18432
    v_exp_f32 v10, v122
    v_cvt_pk_bf16_f32 v76, v8, v9
    v_exp_f32 v11, v123
    v_mfma_f32_32x32x16_bf16 a[32:47], a[136:139], a[76:79], a[32:47]
    ds_read_b64_tr_b16 a[168:169], v202 offset:17408
    ds_read_b64_tr_b16 a[170:171], v202 offset:19456
    v_exp_f32 v12, v124
    v_cvt_pk_bf16_f32 v77, v10, v11
    v_exp_f32 v13, v125
    v_mfma_f32_32x32x16_bf16 v[160:175], v[48:51], v[64:67], v[160:175]
    ds_read_b64_tr_b16 a[172:173], v203 offset:17408
    ds_read_b64_tr_b16 a[174:175], v203 offset:19456
    v_exp_f32 v14, v126
    v_cvt_pk_bf16_f32 v78, v12, v13
    v_exp_f32 v15, v127
    v_mfma_f32_16x16x32_bf16 v[88:91], v[4:7], v[72:75], v[92:95]
    v_cvt_pk_bf16_f32 v79, v14, v15
    v_mfma_f32_32x32x16_bf16 a[48:63], a[140:143], a[76:79], a[48:63]
    buffer_load_dwordx4 a[76:79], v204, s[28:31], s57 offen offset:2560
    v_exp_f32 v8, v96
    v_exp_f32 v9, v97
    v_mfma_f32_16x16x32_bf16 v[88:91], v[4:7], v[76:79], v[88:91]
    v_exp_f32 v10, v98
    v_mfma_f32_32x32x16_bf16 v[160:175], v[52:55], v[68:71], v[160:175]
    ds_read_b128 v[32:35], v200 offset:20480
    ds_read_b128 v[36:39], v200 offset:22528
    ds_read_b128 v[56:59], v200 offset:21504
    ds_read_b128 v[60:63], v200 offset:23552
    v_cvt_pk_bf16_f32 v64, v8, v9
    v_exp_f32 v11, v99
    v_exp_f32 v12, v100
    v_mfma_f32_32x32x16_bf16 a[0:15], a[144:147], a[80:83], a[0:15]
    ds_read_b64_tr_b16 a[176:177], v202 offset:20480
    ds_read_b64_tr_b16 a[178:179], v202 offset:22528
    v_cvt_pk_bf16_f32 v65, v10, v11
    v_exp_f32 v13, v101
    v_exp_f32 v14, v102
    v_mfma_f32_32x32x16_bf16 a[16:31], a[148:151], a[80:83], a[16:31]
    v_cmp_nge_f32 vcc, s63, v88
    v_cvt_pk_bf16_f32 v66, v12, v13
    v_exp_f32 v15, v103
    s_cbranch_vccnz L_p2_s26_go
L_p2_s26_back:
    v_mfma_f32_32x32x16_bf16 v[112:127], v[40:43], v[24:27], v[144:159]
    buffer_load_dwordx4 a[80:83], v205, s[28:31], s57 offen offset:0
    v_exp_f32 v8, v104
    v_cvt_pk_bf16_f32 v67, v14, v15
    v_exp_f32 v9, v105
    v_mfma_f32_32x32x16_bf16 v[112:127], v[44:47], v[28:31], v[112:127]
    ds_read_b64_tr_b16 a[180:181], v203 offset:20480
    ds_read_b64_tr_b16 a[182:183], v203 offset:22528
    v_exp_f32 v10, v106
    v_cvt_pk_bf16_f32 v68, v8, v9
    v_exp_f32 v11, v107
    v_mfma_f32_32x32x16_bf16 a[32:47], a[144:147], a[88:91], a[32:47]
    ds_read_b64_tr_b16 a[184:185], v202 offset:21504
    ds_read_b64_tr_b16 a[186:187], v202 offset:23552
    v_exp_f32 v12, v108
    v_cvt_pk_bf16_f32 v69, v10, v11
    v_exp_f32 v13, v109
    v_mfma_f32_32x32x16_bf16 v[176:191], v[48:51], v[72:75], v[176:191]
    ds_read_b64_tr_b16 a[188:189], v203 offset:21504
    ds_read_b64_tr_b16 a[190:191], v203 offset:23552
    v_exp_f32 v14, v110
    v_cvt_pk_bf16_f32 v70, v12, v13
    v_exp_f32 v15, v111
    v_mfma_f32_16x16x32_bf16 v[84:87], v[4:7], v[64:67], v[80:83]
    v_cvt_pk_bf16_f32 v71, v14, v15
    v_mfma_f32_32x32x16_bf16 a[48:63], a[148:151], a[88:91], a[48:63]
    buffer_load_dwordx4 a[88:91], v205, s[28:31], s57 offen offset:2048
    v_exp_f32 v8, v112
    v_exp_f32 v9, v113
    v_mfma_f32_16x16x32_bf16 v[84:87], v[4:7], v[68:71], v[84:87]
    v_exp_f32 v10, v114
    v_mfma_f32_32x32x16_bf16 v[176:191], v[52:55], v[76:79], v[176:191]
    buffer_load_dwordx4 v208, s[32:35], s58 offen offset:2048 lds
    v_cvt_pk_bf16_f32 v72, v8, v9
    v_exp_f32 v11, v115
    v_exp_f32 v12, v116
    v_mfma_f32_32x32x16_bf16 a[0:15], a[152:155], a[84:87], a[0:15]
    buffer_load_dwordx4 v209, s[32:35], s58 offen offset:3072 lds
    s_add_u32 s58, s58, 524288
    v_cvt_pk_bf16_f32 v73, v10, v11
    v_exp_f32 v13, v117
    v_exp_f32 v14, v118
    v_mfma_f32_32x32x16_bf16 a[16:31], a[156:159], a[84:87], a[16:31]
    v_cmp_nge_f32 vcc, s63, v84
    v_cvt_pk_bf16_f32 v74, v12, v13
    v_exp_f32 v15, v119
    s_cbranch_vccnz L_p2_s27_go
L_p2_s27_back:
    s_waitcnt lgkmcnt(0)
    v_mfma_f32_32x32x16_bf16 v[96:111], v[32:35], v[16:19], v[128:143]
    buffer_load_dwordx4 a[84:87], v205, s[28:31], s57 offen offset:512
    v_exp_f32 v8, v120
    v_cvt_pk_bf16_f32 v75, v14, v15
    v_exp_f32 v9, v121
    v_mfma_f32_32x32x16_bf16 v[96:111], v[36:39], v[20:23], v[96:111]
    s_add_u32 s71, s71, 4096
    buffer_store_dwordx4 a[208:211], v200, s[64:67], s71 offen offset:0 sc1
    v_exp_f32 v10, v122
    v_cvt_pk_bf16_f32 v76, v8, v9
    v_exp_f32 v11, v123
    v_mfma_f32_32x32x16_bf16 a[32:47], a[152:155], a[92:95], a[32:47]
    buffer_store_dwordx4 a[212:215], v200, s[64:67], s71 offen offset:1024 sc1
    v_exp_f32 v12, v124
    v_cvt_pk_bf16_f32 v77, v10, v11
    v_exp_f32 v13, v125
    v_mfma_f32_32x32x16_bf16 v[160:175], v[56:59], v[64:67], v[160:175]
    v_exp_f32 v14, v126
    v_cvt_pk_bf16_f32 v78, v12, v13
    v_exp_f32 v15, v127
    v_mfma_f32_16x16x32_bf16 v[92:95], v[4:7], v[72:75], v[88:91]
    v_cvt_pk_bf16_f32 v79, v14, v15
    v_mfma_f32_32x32x16_bf16 a[48:63], a[156:159], a[92:95], a[48:63]
    buffer_load_dwordx4 a[92:95], v205, s[28:31], s57 offen offset:2560
    s_add_u32 s57, s57, 0x8000
    s_waitcnt vmcnt(14)
    s_barrier
    v_exp_f32 v8, v96
    v_exp_f32 v9, v97
    v_mfma_f32_16x16x32_bf16 v[92:95], v[4:7], v[76:79], v[92:95]
    v_exp_f32 v10, v98
    v_mfma_f32_32x32x16_bf16 v[160:175], v[60:63], v[68:71], v[160:175]
    ds_read_b128 v[40:43], v200 offset:24576
    ds_read_b128 v[44:47], v200 offset:26624
    ds_read_b128 v[48:51], v200 offset:25600
    ds_read_b128 v[52:55], v200 offset:27648
    v_cvt_pk_bf16_f32 v64, v8, v9
    v_exp_f32 v11, v99
    v_exp_f32 v12, v100
    v_mfma_f32_32x32x16_bf16 a[0:15], a[160:163], a[96:99], a[0:15]
    s_add_u32 m0, s61, 16384
    v_cvt_pk_bf16_f32 v65, v10, v11
    v_exp_f32 v13, v101
    v_exp_f32 v14, v102
    v_mfma_f32_32x32x16_bf16 a[16:31], a[164:167], a[96:99], a[16:31]
    v_cmp_nge_f32 vcc, s63, v92
    v_cvt_pk_bf16_f32 v66, v12, v13
    v_exp_f32 v15, v103
    s_cbranch_vccnz L_p2_s28_go
L_p2_s28_back:
    v_mfma_f32_32x32x16_bf16 v[112:127], v[32:35], v[24:27], v[144:159]
    buffer_load_dwordx4 a[96:99], v204, s[28:31], s57 offen offset:0
    v_exp_f32 v8, v104
    v_cvt_pk_bf16_f32 v67, v14, v15
    v_exp_f32 v9, v105
    v_mfma_f32_32x32x16_bf16 v[112:127], v[36:39], v[28:31], v[112:127]
    buffer_load_dwordx4 v210, s[20:23], s59 offen lds
    v_exp_f32 v10, v106
    v_cvt_pk_bf16_f32 v68, v8, v9
    v_exp_f32 v11, v107
    v_mfma_f32_32x32x16_bf16 a[32:47], a[160:163], a[104:107], a[32:47]
    buffer_load_dwordx4 v210, s[24:27], s59 offen offset:1024 lds
    s_add_u32 s59, s59, 4096
    v_exp_f32 v12, v108
    v_cvt_pk_bf16_f32 v69, v10, v11
    v_exp_f32 v13, v109
    v_mfma_f32_32x32x16_bf16 v[176:191], v[56:59], v[72:75], v[176:191]
    s_add_u32 m0, s60, 16384
    ds_read_b64_tr_b16 a[128:129], v202 offset:32768
    ds_read_b64_tr_b16 a[130:131], v202 offset:34816
    v_exp_f32 v14, v110
    v_cvt_pk_bf16_f32 v70, v12, v13
    v_exp_f32 v15, v111
    v_mfma_f32_16x16x32_bf16 v[80:83], v[4:7], v[64:67], v[84:87]
    v_cvt_pk_bf16_f32 v71, v14, v15
    v_mfma_f32_32x32x16_bf16 a[48:63], a[164:167], a[104:107], a[48:63]
    buffer_load_dwordx4 a[104:107], v204, s[28:31], s57 offen offset:2048
    v_exp_f32 v8, v112
    v_exp_f32 v9, v113
    v_mfma_f32_16x16x32_bf16 v[80:83], v[4:7], v[68:71], v[80:83]
    v_exp_f32 v10, v114
    v_mfma_f32_32x32x16_bf16 v[176:191], v[60:63], v[76:79], v[176:191]
    buffer_load_dwordx4 v206, s[32:35], s58 offen offset:0 lds
    v_cvt_pk_bf16_f32 v72, v8, v9
    v_exp_f32 v11, v115
    v_exp_f32 v12, v116
    v_mfma_f32_32x32x16_bf16 a[0:15], a[168:171], a[100:103], a[0:15]
    buffer_load_dwordx4 v207, s[32:35], s58 offen offset:1024 lds
    v_cvt_pk_bf16_f32 v73, v10, v11
    v_exp_f32 v13, v117
    v_exp_f32 v14, v118
    v_mfma_f32_32x32x16_bf16 a[16:31], a[172:175], a[100:103], a[16:31]
    v_cmp_nge_f32 vcc, s63, v80
    v_cvt_pk_bf16_f32 v74, v12, v13
    v_exp_f32 v15, v119
    s_cbranch_vccnz L_p2_s29_go
L_p2_s29_back:
    s_waitcnt lgkmcnt(0)
    v_mfma_f32_32x32x16_bf16 v[96:111], v[40:43], v[16:19], v[128:143]
    buffer_load_dwordx4 a[100:103], v204, s[28:31], s57 offen offset:512
    v_exp_f32 v8, v120
    v_cvt_pk_bf16_f32 v75, v14, v15
    v_exp_f32 v9, v121
    v_mfma_f32_32x32x16_bf16 v[96:111], v[44:47], v[20:23], v[96:111]
    ds_read_b64_tr_b16 a[132:133], v203 offset:32768
    ds_read_b64_tr_b16 a[134:135], v203 offset:34816
    v_exp_f32 v10, v122
    v_cvt_pk_bf16_f32 v76, v8, v9
    v_exp_f32 v11, v123
    v_mfma_f32_32x32x16_bf16 a[32:47], a[168:171], a[108:111], a[32:47]
    ds_read_b64_tr_b16 a[136:137], v202 offset:33792
    ds_read_b64_tr_b16 a[138:139], v202 offset:35840
    v_exp_f32 v12, v124
    v_cvt_pk_bf16_f32 v77, v10, v11
    v_exp_f32 v13, v125
    v_mfma_f32_32x32x16_bf16 v[160:175], v[48:51], v[64:67], v[160:175]
    ds_read_b64_tr_b16 a[140:141], v203 offset:33792
    ds_read_b64_tr_b16 a[142:143], v203 offset:35840
    v_exp_f32 v14, v126
    v_cvt_pk_bf16_f32 v78, v12, v13
    v_exp_f32 v15, v127
    v_mfma_f32_16x16x32_bf16 v[88:91], v[4:7], v[72:75], v[92:95]
    v_cvt_pk_bf16_f32 v79, v14, v15
    v_mfma_f32_32x32x16_bf16 a[48:63], a[172:175], a[108:111], a[48:63]
    buffer_load_dwordx4 a[108:111], v204, s[28:31], s57 offen offset:2560
    v_exp_f32 v8, v96
    v_exp_f32 v9, v97
    v_mfma_f32_16x16x32_bf16 v[88:91], v[4:7], v[76:79], v[88:91]
    v_exp_f32 v10, v98
    v_mfma_f32_32x32x16_bf16 v[160:175], v[52:55], v[68:71], v[160:175]
    ds_read_b128 v[32:35], v200 offset:28672
    ds_read_b128 v[36:39], v200 offset:30720
    ds_read_b128 v[56:59], v200 offset:29696
    ds_read_b128 v[60:63], v200 offset:31744
    v_cvt_pk_bf16_f32 v64, v8, v9
    v_exp_f32 v11, v99
    v_exp_f32 v12, v100
    v_mfma_f32_32x32x16_bf16 a[0:15], a[176:179], a[112:115], a[0:15]
    ds_read_b64_tr_b16 a[144:145], v202 offset:36864
    ds_read_b64_tr_b16 a[146:147], v202 offset:38912
    v_cvt_pk_bf16_f32 v65, v10, v11
    v_exp_f32 v13, v101
    v_exp_f32 v14, v102
    v_mfma_f32_32x32x16_bf16 a[16:31], a[180:183], a[112:115], a[16:31]
    v_cmp_nge_f32 vcc, s63, v88
    v_cvt_pk_bf16_f32 v66, v12, v13
    v_exp_f32 v15, v103
    s_cbranch_vccnz L_p2_s30_go
L_p2_s30_back:
    v_mfma_f32_32x32x16_bf16 v[112:127], v[40:43], v[24:27], v[144:159]
    buffer_load_dwordx4 a[112:115], v205, s[28:31], s57 offen offset:0
    v_exp_f32 v8, v104
    v_cvt_pk_bf16_f32 v67, v14, v15
    v_exp_f32 v9, v105
    v_mfma_f32_32x32x16_bf16 v[112:127], v[44:47], v[28:31], v[112:127]
    ds_read_b64_tr_b16 a[148:149], v203 offset:36864
    ds_read_b64_tr_b16 a[150:151], v203 offset:38912
    v_exp_f32 v10, v106
    v_cvt_pk_bf16_f32 v68, v8, v9
    v_exp_f32 v11, v107
    v_mfma_f32_32x32x16_bf16 a[32:47], a[176:179], a[120:123], a[32:47]
    ds_read_b64_tr_b16 a[152:153], v202 offset:37888
    ds_read_b64_tr_b16 a[154:155], v202 offset:39936
    v_exp_f32 v12, v108
    v_cvt_pk_bf16_f32 v69, v10, v11
    v_exp_f32 v13, v109
    v_mfma_f32_32x32x16_bf16 v[176:191], v[48:51], v[72:75], v[176:191]
    ds_read_b64_tr_b16 a[156:157], v203 offset:37888
    ds_read_b64_tr_b16 a[158:159], v203 offset:39936
    v_exp_f32 v14, v110
    v_cvt_pk_bf16_f32 v70, v12, v13
    v_exp_f32 v15, v111
    v_mfma_f32_16x16x32_bf16 v[84:87], v[4:7], v[64:67], v[80:83]
    v_cvt_pk_bf16_f32 v71, v14, v15
    v_mfma_f32_32x32x16_bf16 a[48:63], a[180:183], a[120:123], a[48:63]
    buffer_load_dwordx4 a[120:123], v205, s[28:31], s57 offen offset:2048
    v_exp_f32 v8, v112
    v_exp_f32 v9, v113
    v_mfma_f32_16x16x32_bf16 v[84:87], v[4:7], v[68:71], v[84:87]
    v_exp_f32 v10, v114
    v_mfma_f32_32x32x16_bf16 v[176:191], v[52:55], v[76:79], v[176:191]
    buffer_load_dwordx4 v208, s[32:35], s58 offen offset:2048 lds
    v_cvt_pk_bf16_f32 v72, v8, v9
    v_exp_f32 v11, v115
    v_exp_f32 v12, v116
    v_mfma_f32_32x32x16_bf16 a[0:15], a[184:187], a[116:119], a[0:15]
    buffer_load_dwordx4 v209, s[32:35], s58 offen offset:3072 lds
    s_add_u32 s58, s58, 524288
    v_cvt_pk_bf16_f32 v73, v10, v11
    v_exp_f32 v13, v117
    v_exp_f32 v14, v118
    v_mfma_f32_32x32x16_bf16 a[16:31], a[188:191], a[116:119], a[16:31]
    v_cmp_nge_f32 vcc, s63, v84
    v_cvt_pk_bf16_f32 v74, v12, v13
    v_exp_f32 v15, v119
    s_cbranch_vccnz L_p2_s31_go
L_p2_s31_back:
    s_waitcnt lgkmcnt(0)
    v_mfma_f32_32x32x16_bf16 v[96:111], v[32:35], v[16:19], v[128:143]
    buffer_load_dwordx4 a[116:119], v205, s[28:31], s57 offen offset:512
    v_exp_f32 v8, v120
    v_cvt_pk_bf16_f32 v75, v14, v15
    v_exp_f32 v9, v121
    v_mfma_f32_32x32x16_bf16 v[96:111], v[36:39], v[20:23], v[96:111]
    buffer_store_dwordx4 a[216:219], v200, s[64:67], s71 offen offset:2048 sc1
    v_exp_f32 v10, v122
    v_cvt_pk_bf16_f32 v76, v8, v9
    v_exp_f32 v11, v123
    v_mfma_f32_32x32x16_bf16 a[32:47], a[184:187], a[124:127], a[32:47]
    buffer_store_dwordx4 a[220:223], v200, s[64:67], s71 offen offset:3072 sc1
    v_exp_f32 v12, v124
    v_cvt_pk_bf16_f32 v77, v10, v11
    v_exp_f32 v13, v125
    v_mfma_f32_32x32x16_bf16 v[160:175], v[56:59], v[64:67], v[160:175]
    v_exp_f32 v14, v126
    v_cvt_pk_bf16_f32 v78, v12, v13
    v_exp_f32 v15, v127
    v_mfma_f32_16x16x32_bf16 v[92:95], v[4:7], v[72:75], v[88:91]
    v_cvt_pk_bf16_f32 v79, v14, v15
    v_mfma_f32_32x32x16_bf16 a[48:63], a[188:191], a[124:127], a[48:63]
    buffer_load_dwordx4 a[124:127], v205, s[28:31], s57 offen offset:2560
    s_add_u32 s57, s57, 0x8000
.p2align 6
L_p2_loop:
    s_cmp_lg_u32 s62, 5
    s_cbranch_scc1 L_p2_h1
L_p2_h1_back:
    s_waitcnt vmcnt(14)
    s_barrier
    v_exp_f32 v8, v96
    v_exp_f32 v9, v97
    v_mfma_f32_16x16x32_bf16 v[92:95], v[4:7], v[76:79], v[92:95]
    v_exp_f32 v10, v98
    v_mfma_f32_32x32x16_bf16 v[160:175], v[60:63], v[68:71], v[160:175]
    ds_read_b128 v[40:43], v200 offset:0
    ds_read_b128 v[44:47], v200 offset:2048
    ds_read_b128 v[48:51], v200 offset:1024
    ds_read_b128 v[52:55], v200 offset:3072
    v_cvt_pk_bf16_f32 v64, v8, v9
    v_exp_f32 v11, v99
    v_exp_f32 v12, v100
    v_mfma_f32_32x32x16_bf16 a[0:15], a[128:131], a[64:67], a[0:15]
    s_add_u32 m0, s61, 24576
    v_cvt_pk_bf16_f32 v65, v10, v11
    v_exp_f32 v13, v101
    v_exp_f32 v14, v102
    v_mfma_f32_32x32x16_bf16 a[16:31], a[132:135], a[64:67], a[16:31]
    v_cmp_nge_f32 vcc, s63, v92
    v_cvt_pk_bf16_f32 v66, v12, v13
    v_exp_f32 v15, v103
    s_cbranch_vccnz L_p2_s32_go
L_p2_s32_back:
    v_mfma_f32_32x32x16_bf16 v[112:127], v[32:35], v[24:27], v[144:159]
    buffer_load_dwordx4 a[64:67], v204, s[28:31], s57 offen offset:0
    v_exp_f32 v8, v104
    v_cvt_pk_bf16_f32 v67, v14, v15
    v_exp_f32 v9, v105
    v_mfma_f32_32x32x16_bf16 v[112:127], v[36:39], v[28:31], v[112:127]
    buffer_load_dwordx4 v210, s[20:23], s59 offen lds
    v_exp_f32 v10, v106
    v_cvt_pk_bf16_f32 v68, v8, v9
    v_exp_f32 v11, v107
    v_mfma_f32_32x32x16_bf16 a[32:47], a[128:131], a[72:75], a[32:47]
    buffer_load_dwordx4 v210, s[24:27], s59 offen offset:1024 lds
    s_add_u32 s59, s59, 4096
    v_exp_f32 v12, v108
    v_cvt_pk_bf16_f32 v69, v10, v11
    v_exp_f32 v13, v109
    v_mfma_f32_32x32x16_bf16 v[176:191], v[56:59], v[72:75], v[176:191]
    s_add_u32 m0, s60, 32768
    ds_read_b64_tr_b16 a[160:161], v202 offset:49152
    ds_read_b64_tr_b16 a[162:163], v202 offset:51200
    v_exp_f32 v14, v110
    v_cvt_pk_bf16_f32 v70, v12, v13
    v_exp_f32 v15, v111
    v_mfma_f32_16x16x32_bf16 v[80:83], v[4:7], v[64:67], v[84:87]
    v_cvt_pk_bf16_f32 v71, v14, v15
    v_mfma_f32_32x32x16_bf16 a[48:63], a[132:135], a[72:75], a[48:63]
    buffer_load_dwordx4 a[72:75], v204, s[28:31], s57 offen offset:2048
    v_exp_f32 v8, v112
    v_exp_f32 v9, v113
    v_mfma_f32_16x16x32_bf16 v[80:83], v[4:7], v[68:71], v[80:83]
    v_exp_f32 v10, v114
    v_mfma_f32_32x32x16_bf16 v[176:191], v[60:63], v[76:79], v[176:191]
    buffer_load_dwordx4 v206, s[32:35], s58 offen offset:0 lds
    v_cvt_pk_bf16_f32 v72, v8, v9
    v_exp_f32 v11, v115
    v_exp_f32 v12, v116
    v_mfma_f32_32x32x16_bf16 a[0:15], a[136:139], a[68:71], a[0:15]
    buffer_load_dwordx4 v207, s[32:35], s58 offen offset:1024 lds
    v_cvt_pk_bf16_f32 v73, v10, v11
    v_exp_f32 v13, v117
    v_exp_f32 v14, v118
    v_mfma_f32_32x32x16_bf16 a[16:31], a[140:143], a[68:71], a[16:31]
    v_cmp_nge_f32 vcc, s63, v80
    v_cvt_pk_bf16_f32 v74, v12, v13
    v_exp_f32 v15, v119
    s_cbranch_vccnz L_p2_s33_go
L_p2_s33_back:
    s_waitcnt lgkmcnt(0)
    v_mfma_f32_32x32x16_bf16 v[96:111], v[40:43], v[16:19], v[128:143]
    buffer_load_dwordx4 a[68:71], v204, s[28:31], s57 offen offset:512
    v_exp_f32 v8, v120
    v_cvt_pk_bf16_f32 v75, v14, v15
    v_exp_f32 v9, v121
    v_mfma_f32_32x32x16_bf16 v[96:111], v[44:47], v[20:23], v[96:111]
    ds_read_b64_tr_b16 a[164:165], v203 offset:49152
    ds_read_b64_tr_b16 a[166:167], v203 offset:51200
    v_exp_f32 v10, v122
    v_cvt_pk_bf16_f32 v76, v8, v9
    v_exp_f32 v11, v123
    v_mfma_f32_32x32x16_bf16 a[32:47], a[136:139], a[76:79], a[32:47]
    ds_read_b64_tr_b16 a[168:169], v202 offset:50176
    ds_read_b64_tr_b16 a[170:171], v202 offset:52224
    v_exp_f32 v12, v124
    v_cvt_pk_bf16_f32 v77, v10, v11
    v_exp_f32 v13, v125
    v_mfma_f32_32x32x16_bf16 v[160:175], v[48:51], v[64:67], v[160:175]
    ds_read_b64_tr_b16 a[172:173], v203 offset:50176
    ds_read_b64_tr_b16 a[174:175], v203 offset:52224
    v_exp_f32 v14, v126
    v_cvt_pk_bf16_f32 v78, v12, v13
    v_exp_f32 v15, v127
    v_mfma_f32_16x16x32_bf16 v[88:91], v[4:7], v[72:75], v[92:95]
    v_cvt_pk_bf16_f32 v79, v14, v15
    v_mfma_f32_32x32x16_bf16 a[48:63], a[140:143], a[76:79], a[48:63]
    buffer_load_dwordx4 a[76:79], v204, s[28:31], s57 offen offset:2560
    v_exp_f32 v8, v96
    v_exp_f32 v9, v97
    v_mfma_f32_16x16x32_bf16 v[88:91], v[4:7], v[76:79], v[88:91]
    v_exp_f32 v10, v98
    v_mfma_f32_32x32x16_bf16 v[160:175], v[52:55], v[68:71], v[160:175]
    ds_read_b128 v[32:35], v200 offset:4096
    ds_read_b128 v[36:39], v200 offset:6144
    ds_read_b128 v[56:59], v200 offset:5120
    ds_read_b128 v[60:63], v200 offset:7168
    v_cvt_pk_bf16_f32 v64, v8, v9
    v_exp_f32 v11, v99
    v_exp_f32 v12, v100
    v_mfma_f32_32x32x16_bf16 a[0:15], a[144:147], a[80:83], a[0:15]
    ds_read_b64_tr_b16 a[176:177], v202 offset:53248
    ds_read_b64_tr_b16 a[178:179], v202 offset:55296
    v_cvt_pk_bf16_f32 v65, v10, v11
    v_exp_f32 v13, v101
    v_exp_f32 v14, v102
    v_mfma_f32_32x32x16_bf16 a[16:31], a[148:151], a[80:83], a[16:31]
    v_cmp_nge_f32 vcc, s63, v88
    v_cvt_pk_bf16_f32 v66, v12, v13
    v_exp_f32 v15, v103
    s_cbranch_vccnz L_p2_s34_go
L_p2_s34_back:
    v_mfma_f32_32x32x16_bf16 v[112:127], v[40:43], v[24:27], v[144:159]
    buffer_load_dwordx4 a[80:83], v205, s[28:31], s57 offen offset:0
    v_exp_f32 v8, v104
    v_cvt_pk_bf16_f32 v67, v14, v15
    v_exp_f32 v9, v105
    v_mfma_f32_32x32x16_bf16 v[112:127], v[44:47], v[28:31], v[112:127]
    ds_read_b64_tr_b16 a[180:181], v203 offset:53248
    ds_read_b64_tr_b16 a[182:183], v203 offset:55296
    v_exp_f32 v10, v106
    v_cvt_pk_bf16_f32 v68, v8, v9
    v_exp_f32 v11, v107
    v_mfma_f32_32x32x16_bf16 a[32:47], a[144:147], a[88:91], a[32:47]
    ds_read_b64_tr_b16 a[184:185], v202 offset:54272
    ds_read_b64_tr_b16 a[186:187], v202 offset:56320
    v_exp_f32 v12, v108
    v_cvt_pk_bf16_f32 v69, v10, v11
    v_exp_f32 v13, v109
    v_mfma_f32_32x32x16_bf16 v[176:191], v[48:51], v[72:75], v[176:191]
    ds_read_b64_tr_b16 a[188:189], v203 offset:54272
    ds_read_b64_tr_b16 a[190:191], v203 offset:56320
    v_exp_f32 v14, v110
    v_cvt_pk_bf16_f32 v70, v12, v13
    v_exp_f32 v15, v111
    v_mfma_f32_16x16x32_bf16 v[84:87], v[4:7], v[64:67], v[80:83]
    v_cvt_pk_bf16_f32 v71, v14, v15
    v_mfma_f32_32x32x16_bf16 a[48:63], a[148:151], a[88:91], a[48:63]
    buffer_load_dwordx4 a[88:91], v205, s[28:31], s57 offen offset:2048
    v_exp_f32 v8, v112
    v_exp_f32 v9, v113
    v_mfma_f32_16x16x32_bf16 v[84:87], v[4:7], v[68:71], v[84:87]
    v_exp_f32 v10, v114
    v_mfma_f32_32x32x16_bf16 v[176:191], v[52:55], v[76:79], v[176:191]
    buffer_load_dwordx4 v208, s[32:35], s58 offen offset:2048 lds
    v_cvt_pk_bf16_f32 v72, v8, v9
    v_exp_f32 v11, v115
    v_exp_f32 v12, v116
    v_mfma_f32_32x32x16_bf16 a[0:15], a[152:155], a[84:87], a[0:15]
    buffer_load_dwordx4 v209, s[32:35], s58 offen offset:3072 lds
    s_add_u32 s58, s58, 524288
    v_cvt_pk_bf16_f32 v73, v10, v11
    v_exp_f32 v13, v117
    v_exp_f32 v14, v118
    v_mfma_f32_32x32x16_bf16 a[16:31], a[156:159], a[84:87], a[16:31]
    v_cmp_nge_f32 vcc, s63, v84
    v_cvt_pk_bf16_f32 v74, v12, v13
    v_exp_f32 v15, v119
    s_cbranch_vccnz L_p2_s35_go
L_p2_s35_back:
    s_waitcnt lgkmcnt(0)
    v_mfma_f32_32x32x16_bf16 v[96:111], v[32:35], v[16:19], v[128:143]
    buffer_load_dwordx4 a[84:87], v205, s[28:31], s57 offen offset:512
    v_exp_f32 v8, v120
    v_cvt_pk_bf16_f32 v75, v14, v15
    v_exp_f32 v9, v121
    v_mfma_f32_32x32x16_bf16 v[96:111], v[36:39], v[20:23], v[96:111]
    v_exp_f32 v10, v122
    v_cvt_pk_bf16_f32 v76, v8, v9
    v_exp_f32 v11, v123
    v_mfma_f32_32x32x16_bf16 a[32:47], a[152:155], a[92:95], a[32:47]
    v_exp_f32 v12, v124
    v_cvt_pk_bf16_f32 v77, v10, v11
    v_exp_f32 v13, v125
    v_mfma_f32_32x32x16_bf16 v[160:175], v[56:59], v[64:67], v[160:175]
    v_exp_f32 v14, v126
    v_cvt_pk_bf16_f32 v78, v12, v13
    v_exp_f32 v15, v127
    v_mfma_f32_16x16x32_bf16 v[92:95], v[4:7], v[72:75], v[88:91]
    v_cvt_pk_bf16_f32 v79, v14, v15
    v_mfma_f32_32x32x16_bf16 a[48:63], a[156:159], a[92:95], a[48:63]
    buffer_load_dwordx4 a[92:95], v205, s[28:31], s57 offen offset:2560
    s_add_u32 s57, s57, 0x8000
    s_waitcnt vmcnt(14)
    s_barrier
    v_exp_f32 v8, v96
    v_exp_f32 v9, v97
    v_mfma_f32_16x16x32_bf16 v[92:95], v[4:7], v[76:79], v[92:95]
    v_exp_f32 v10, v98
    v_mfma_f32_32x32x16_bf16 v[160:175], v[60:63], v[68:71], v[160:175]
    ds_read_b128 v[40:43], v200 offset:8192
    ds_read_b128 v[44:47], v200 offset:10240
    ds_read_b128 v[48:51], v200 offset:9216
    ds_read_b128 v[52:55], v200 offset:11264
    v_cvt_pk_bf16_f32 v64, v8, v9
    v_exp_f32 v11, v99
    v_exp_f32 v12, v100
    v_mfma_f32_32x32x16_bf16 a[0:15], a[160:163], a[96:99], a[0:15]
    s_add_u32 m0, s61, 0
    v_cvt_pk_bf16_f32 v65, v10, v11
    v_exp_f32 v13, v101
    v_exp_f32 v14, v102
    v_mfma_f32_32x32x16_bf16 a[16:31], a[164:167], a[96:99], a[16:31]
    v_cmp_nge_f32 vcc, s63, v92
    v_cvt_pk_bf16_f32 v66, v12, v13
    v_exp_f32 v15, v103
    s_cbranch_vccnz L_p2_s36_go
L_p2_s36_back:
    v_mfma_f32_32x32x16_bf16 v[112:127], v[32:35], v[24:27], v[144:159]
    buffer_load_dwordx4 a[96:99], v204, s[28:31], s57 offen offset:0
    v_exp_f32 v8, v104
    v_cvt_pk_bf16_f32 v67, v14, v15
    v_exp_f32 v9, v105
    v_mfma_f32_32x32x16_bf16 v[112:127], v[36:39], v[28:31], v[112:127]
    buffer_load_dwordx4 v210, s[20:23], s59 offen lds
    v_exp_f32 v10, v106
    v_cvt_pk_bf16_f32 v68, v8, v9
    v_exp_f32 v11, v107
    v_mfma_f32_32x32x16_bf16 a[32:47], a[160:163], a[104:107], a[32:47]
    buffer_load_dwordx4 v210, s[24:27], s59 offen offset:1024 lds
    s_add_u32 s59, s59, 4096
    v_exp_f32 v12, v108
    v_cvt_pk_bf16_f32 v69, v10, v11
    v_exp_f32 v13, v109
    v_mfma_f32_32x32x16_bf16 v[176:191], v[56:59], v[72:75], v[176:191]
    s_add_u32 m0, s60, 49152
    ds_read_b64_tr_b16 a[128:129], v202 offset:0
    ds_read_b64_tr_b16 a[130:131], v202 offset:2048
    v_exp_f32 v14, v110
    v_cvt_pk_bf16_f32 v70, v12, v13
    v_exp_f32 v15, v111
    v_mfma_f32_16x16x32_bf16 v[80:83], v[4:7], v[64:67], v[84:87]
    v_cvt_pk_bf16_f32 v71, v14, v15
    v_mfma_f32_32x32x16_bf16 a[48:63], a[164:167], a[104:107], a[48:63]
    buffer_load_dwordx4 a[104:107], v204, s[28:31], s57 offen offset:2048
    v_exp_f32 v8, v112
    v_exp_f32 v9, v113
    v_mfma_f32_16x16x32_bf16 v[80:83], v[4:7], v[68:71], v[80:83]
    v_exp_f32 v10, v114
    v_mfma_f32_32x32x16_bf16 v[176:191], v[60:63], v[76:79], v[176:191]
    buffer_load_dwordx4 v206, s[32:35], s58 offen offset:0 lds
    v_cvt_pk_bf16_f32 v72, v8, v9
    v_exp_f32 v11, v115
    v_exp_f32 v12, v116
    v_mfma_f32_32x32x16_bf16 a[0:15], a[168:171], a[100:103], a[0:15]
    buffer_load_dwordx4 v207, s[32:35], s58 offen offset:1024 lds
    v_cvt_pk_bf16_f32 v73, v10, v11
    v_exp_f32 v13, v117
    v_exp_f32 v14, v118
    v_mfma_f32_32x32x16_bf16 a[16:31], a[172:175], a[100:103], a[16:31]
    v_cmp_nge_f32 vcc, s63, v80
    v_cvt_pk_bf16_f32 v74, v12, v13
    v_exp_f32 v15, v119
    s_cbranch_vccnz L_p2_s37_go
L_p2_s37_back:
    s_waitcnt lgkmcnt(0)
    v_mfma_f32_32x32x16_bf16 v[96:111], v[40:43], v[16:19], v[128:143]
    buffer_load_dwordx4 a[100:103], v204, s[28:31], s57 offen offset:512
    v_exp_f32 v8, v120
    v_cvt_pk_bf16_f32 v75, v14, v15
    v_exp_f32 v9, v121
    v_mfma_f32_32x32x16_bf16 v[96:111], v[44:47], v[20:23], v[96:111]
    ds_read_b64_tr_b16 a[132:133], v203 offset:0
    ds_read_b64_tr_b16 a[134:135], v203 offset:2048
    v_exp_f32 v10, v122
    v_cvt_pk_bf16_f32 v76, v8, v9
    v_exp_f32 v11, v123
    v_mfma_f32_32x32x16_bf16 a[32:47], a[168:171], a[108:111], a[32:47]
    ds_read_b64_tr_b16 a[136:137], v202 offset:1024
    ds_read_b64_tr_b16 a[138:139], v202 offset:3072
    v_exp_f32 v12, v124
    v_cvt_pk_bf16_f32 v77, v10, v11
    v_exp_f32 v13, v125
    v_mfma_f32_32x32x16_bf16 v[160:175], v[48:51], v[64:67], v[160:175]
    ds_read_b64_tr_b16 a[140:141], v203 offset:1024
    ds_read_b64_tr_b16 a[142:143], v203 offset:3072
    v_exp_f32 v14, v126
    v_cvt_pk_bf16_f32 v78, v12, v13
    v_exp_f32 v15, v127
    v_mfma_f32_16x16x32_bf16 v[88:91], v[4:7], v[72:75], v[92:95]
    v_cvt_pk_bf16_f32 v79, v14, v15
    v_mfma_f32_32x32x16_bf16 a[48:63], a[172:175], a[108:111], a[48:63]
    buffer_load_dwordx4 a[108:111], v204, s[28:31], s57 offen offset:2560
    v_exp_f32 v8, v96
    v_exp_f32 v9, v97
    v_mfma_f32_16x16x32_bf16 v[88:91], v[4:7], v[76:79], v[88:91]
    v_exp_f32 v10, v98
    v_mfma_f32_32x32x16_bf16 v[160:175], v[52:55], v[68:71], v[160:175]
    ds_read_b128 v[32:35], v200 offset:12288
    ds_read_b128 v[36:39], v200 offset:14336
    ds_read_b128 v[56:59], v200 offset:13312
    ds_read_b128 v[60:63], v200 offset:15360
    v_cvt_pk_bf16_f32 v64, v8, v9
    v_exp_f32 v11, v99
    v_exp_f32 v12, v100
    v_mfma_f32_32x32x16_bf16 a[0:15], a[176:179], a[112:115], a[0:15]
    ds_read_b64_tr_b16 a[144:145], v202 offset:4096
    ds_read_b64_tr_b16 a[146:147], v202 offset:6144
    v_cvt_pk_bf16_f32 v65, v10, v11
    v_exp_f32 v13, v101
    v_exp_f32 v14, v102
    v_mfma_f32_32x32x16_bf16 a[16:31], a[180:183], a[112:115], a[16:31]
    v_cmp_nge_f32 vcc, s63, v88
    v_cvt_pk_bf16_f32 v66, v12, v13
    v_exp_f32 v15, v103
    s_cbranch_vccnz L_p2_s38_go
L_p2_s38_back:
    v_mfma_f32_32x32x16_bf16 v[112:127], v[40:43], v[24:27], v[144:159]
    buffer_load_dwordx4 a[112:115], v205, s[28:31], s57 offen offset:0
    v_exp_f32 v8, v104
    v_cvt_pk_bf16_f32 v67, v14, v15
    v_exp_f32 v9, v105
    v_mfma_f32_32x32x16_bf16 v[112:127], v[44:47], v[28:31], v[112:127]
    ds_read_b64_tr_b16 a[148:149], v203 offset:4096
    ds_read_b64_tr_b16 a[150:151], v203 offset:6144
    v_exp_f32 v10, v106
    v_cvt_pk_bf16_f32 v68, v8, v9
    v_exp_f32 v11, v107
    v_mfma_f32_32x32x16_bf16 a[32:47], a[176:179], a[120:123], a[32:47]
    ds_read_b64_tr_b16 a[152:153], v202 offset:5120
    ds_read_b64_tr_b16 a[154:155], v202 offset:7168
    v_exp_f32 v12, v108
    v_cvt_pk_bf16_f32 v69, v10, v11
    v_exp_f32 v13, v109
    v_mfma_f32_32x32x16_bf16 v[176:191], v[48:51], v[72:75], v[176:191]
    ds_read_b64_tr_b16 a[156:157], v203 offset:5120
    ds_read_b64_tr_b16 a[158:159], v203 offset:7168
    v_exp_f32 v14, v110
    v_cvt_pk_bf16_f32 v70, v12, v13
    v_exp_f32 v15, v111
    v_mfma_f32_16x16x32_bf16 v[84:87], v[4:7], v[64:67], v[80:83]
    v_cvt_pk_bf16_f32 v71, v14, v15
    v_mfma_f32_32x32x16_bf16 a[48:63], a[180:183], a[120:123], a[48:63]
    buffer_load_dwordx4 a[120:123], v205, s[28:31], s57 offen offset:2048
    v_exp_f32 v8, v112
    v_exp_f32 v9, v113
    v_mfma_f32_16x16x32_bf16 v[84:87], v[4:7], v[68:71], v[84:87]
    v_exp_f32 v10, v114
    v_mfma_f32_32x32x16_bf16 v[176:191], v[52:55], v[76:79], v[176:191]
    buffer_load_dwordx4 v208, s[32:35], s58 offen offset:2048 lds
    v_cvt_pk_bf16_f32 v72, v8, v9
    v_exp_f32 v11, v115
    v_exp_f32 v12, v116
    v_mfma_f32_32x32x16_bf16 a[0:15], a[184:187], a[116:119], a[0:15]
    buffer_load_dwordx4 v209, s[32:35], s58 offen offset:3072 lds
    s_add_u32 s58, s58, 524288
    s_cmp_eq_u32 s62, 3
    s_cselect_b32 s58, s15, s58
    v_cvt_pk_bf16_f32 v73, v10, v11
    v_exp_f32 v13, v117
    v_exp_f32 v14, v118
    v_mfma_f32_32x32x16_bf16 a[16:31], a[188:191], a[116:119], a[16:31]
    v_cmp_nge_f32 vcc, s63, v84
    v_cvt_pk_bf16_f32 v74, v12, v13
    v_exp_f32 v15, v119
    s_cbranch_vccnz L_p2_s39_go
L_p2_s39_back:
    s_waitcnt lgkmcnt(0)
    v_mfma_f32_32x32x16_bf16 v[96:111], v[32:35], v[16:19], v[128:143]
    buffer_load_dwordx4 a[116:119], v205, s[28:31], s57 offen offset:512
    v_exp_f32 v8, v120
    v_cvt_pk_bf16_f32 v75, v14, v15
    v_exp_f32 v9, v121
    v_mfma_f32_32x32x16_bf16 v[96:111], v[36:39], v[20:23], v[96:111]
    v_exp_f32 v10, v122
    v_cvt_pk_bf16_f32 v76, v8, v9
    v_exp_f32 v11, v123
    v_mfma_f32_32x32x16_bf16 a[32:47], a[184:187], a[124:127], a[32:47]
    v_exp_f32 v12, v124
    v_cvt_pk_bf16_f32 v77, v10, v11
    v_exp_f32 v13, v125
    v_mfma_f32_32x32x16_bf16 v[160:175], v[56:59], v[64:67], v[160:175]
    v_exp_f32 v14, v126
    v_cvt_pk_bf16_f32 v78, v12, v13
    v_exp_f32 v15, v127
    v_mfma_f32_16x16x32_bf16 v[92:95], v[4:7], v[72:75], v[88:91]
    v_cvt_pk_bf16_f32 v79, v14, v15
    v_mfma_f32_32x32x16_bf16 a[48:63], a[188:191], a[124:127], a[48:63]
    buffer_load_dwordx4 a[124:127], v205, s[28:31], s57 offen offset:2560
    s_add_u32 s57, s57, 0x8000
    s_waitcnt vmcnt(14)
    s_barrier
    v_exp_f32 v8, v96
    v_exp_f32 v9, v97
    v_mfma_f32_16x16x32_bf16 v[92:95], v[4:7], v[76:79], v[92:95]
    v_exp_f32 v10, v98
    v_mfma_f32_32x32x16_bf16 v[160:175], v[60:63], v[68:71], v[160:175]
    ds_read_b128 v[40:43], v200 offset:16384
    ds_read_b128 v[44:47], v200 offset:18432
    ds_read_b128 v[48:51], v200 offset:17408
    ds_read_b128 v[52:55], v200 offset:19456
    v_cvt_pk_bf16_f32 v64, v8, v9
    v_exp_f32 v11, v99
    v_exp_f32 v12, v100
    v_mfma_f32_32x32x16_bf16 a[0:15], a[128:131], a[64:67], a[0:15]
    s_add_u32 m0, s61, 8192
    v_cvt_pk_bf16_f32 v65, v10, v11
    v_exp_f32 v13, v101
    v_exp_f32 v14, v102
    v_mfma_f32_32x32x16_bf16 a[16:31], a[132:135], a[64:67], a[16:31]
    v_cmp_nge_f32 vcc, s63, v92
    v_cvt_pk_bf16_f32 v66, v12, v13
    v_exp_f32 v15, v103
    s_cbranch_vccnz L_p2_s40_go
L_p2_s40_back:
    v_mfma_f32_32x32x16_bf16 v[112:127], v[32:35], v[24:27], v[144:159]
    buffer_load_dwordx4 a[64:67], v204, s[28:31], s57 offen offset:0
    v_exp_f32 v8, v104
    v_cvt_pk_bf16_f32 v67, v14, v15
    v_exp_f32 v9, v105
    v_mfma_f32_32x32x16_bf16 v[112:127], v[36:39], v[28:31], v[112:127]
    buffer_load_dwordx4 v210, s[20:23], s59 offen lds
    v_exp_f32 v10, v106
    v_cvt_pk_bf16_f32 v68, v8, v9
    v_exp_f32 v11, v107
    v_mfma_f32_32x32x16_bf16 a[32:47], a[128:131], a[72:75], a[32:47]
    buffer_load_dwordx4 v210, s[24:27], s59 offen offset:1024 lds
    s_add_u32 s59, s59, 4096
    v_exp_f32 v12, v108
    v_cvt_pk_bf16_f32 v69, v10, v11
    v_exp_f32 v13, v109
    v_mfma_f32_32x32x16_bf16 v[176:191], v[56:59], v[72:75], v[176:191]
    s_add_u32 m0, s60, 0
    ds_read_b64_tr_b16 a[160:161], v202 offset:16384
    ds_read_b64_tr_b16 a[162:163], v202 offset:18432
    v_exp_f32 v14, v110
    v_cvt_pk_bf16_f32 v70, v12, v13
    v_exp_f32 v15, v111
    v_mfma_f32_16x16x32_bf16 v[80:83], v[4:7], v[64:67], v[84:87]
    v_cvt_pk_bf16_f32 v71, v14, v15
    v_mfma_f32_32x32x16_bf16 a[48:63], a[132:135], a[72:75], a[48:63]
    buffer_load_dwordx4 a[72:75], v204, s[28:31], s57 offen offset:2048
    v_exp_f32 v8, v112
    v_exp_f32 v9, v113
    v_mfma_f32_16x16x32_bf16 v[80:83], v[4:7], v[68:71], v[80:83]
    v_exp_f32 v10, v114
    v_mfma_f32_32x32x16_bf16 v[176:191], v[60:63], v[76:79], v[176:191]
    buffer_load_dwordx4 v206, s[32:35], s58 offen offset:0 lds
    v_cvt_pk_bf16_f32 v72, v8, v9
    v_exp_f32 v11, v115
    v_exp_f32 v12, v116
    v_mfma_f32_32x32x16_bf16 a[0:15], a[136:139], a[68:71], a[0:15]
    buffer_load_dwordx4 v207, s[32:35], s58 offen offset:1024 lds
    v_cvt_pk_bf16_f32 v73, v10, v11
    v_exp_f32 v13, v117
    v_exp_f32 v14, v118
    v_mfma_f32_32x32x16_bf16 a[16:31], a[140:143], a[68:71], a[16:31]
    v_cmp_nge_f32 vcc, s63, v80
    v_cvt_pk_bf16_f32 v74, v12, v13
    v_exp_f32 v15, v119
    s_cbranch_vccnz L_p2_s41_go
L_p2_s41_back:
    s_waitcnt lgkmcnt(0)
    v_mfma_f32_32x32x16_bf16 v[96:111], v[40:43], v[16:19], v[128:143]
    buffer_load_dwordx4 a[68:71], v204, s[28:31], s57 offen offset:512
    v_exp_f32 v8, v120
    v_cvt_pk_bf16_f32 v75, v14, v15
    v_exp_f32 v9, v121
    v_mfma_f32_32x32x16_bf16 v[96:111], v[44:47], v[20:23], v[96:111]
    ds_read_b64_tr_b16 a[164:165], v203 offset:16384
    ds_read_b64_tr_b16 a[166:167], v203 offset:18432
    v_exp_f32 v10, v122
    v_cvt_pk_bf16_f32 v76, v8, v9
    v_exp_f32 v11, v123
    v_mfma_f32_32x32x16_bf16 a[32:47], a[136:139], a[76:79], a[32:47]
    ds_read_b64_tr_b16 a[168:169], v202 offset:17408
    ds_read_b64_tr_b16 a[170:171], v202 offset:19456
    v_exp_f32 v12, v124
    v_cvt_pk_bf16_f32 v77, v10, v11
    v_exp_f32 v13, v125
    v_mfma_f32_32x32x16_bf16 v[160:175], v[48:51], v[64:67], v[160:175]
    ds_read_b64_tr_b16 a[172:173], v203 offset:17408
    ds_read_b64_tr_b16 a[174:175], v203 offset:19456
    v_exp_f32 v14, v126
    v_cvt_pk_bf16_f32 v78, v12, v13
    v_exp_f32 v15, v127
    v_mfma_f32_16x16x32_bf16 v[88:91], v[4:7], v[72:75], v[92:95]
    v_cvt_pk_bf16_f32 v79, v14, v15
    v_mfma_f32_32x32x16_bf16 a[48:63], a[140:143], a[76:79], a[48:63]
    buffer_load_dwordx4 a[76:79], v204, s[28:31], s57 offen offset:2560
    v_exp_f32 v8, v96
    v_exp_f32 v9, v97
    v_mfma_f32_16x16x32_bf16 v[88:91], v[4:7], v[76:79], v[88:91]
    v_exp_f32 v10, v98
    v_mfma_f32_32x32x16_bf16 v[160:175], v[52:55], v[68:71], v[160:175]
    ds_read_b128 v[32:35], v200 offset:20480
    ds_read_b128 v[36:39], v200 offset:22528
    ds_read_b128 v[56:59], v200 offset:21504
    ds_read_b128 v[60:63], v200 offset:23552
    v_cvt_pk_bf16_f32 v64, v8, v9
    v_exp_f32 v11, v99
    v_exp_f32 v12, v100
    v_mfma_f32_32x32x16_bf16 a[0:15], a[144:147], a[80:83], a[0:15]
    ds_read_b64_tr_b16 a[176:177], v202 offset:20480
    ds_read_b64_tr_b16 a[178:179], v202 offset:22528
    v_cvt_pk_bf16_f32 v65, v10, v11
    v_exp_f32 v13, v101
    v_exp_f32 v14, v102
    v_mfma_f32_32x32x16_bf16 a[16:31], a[148:151], a[80:83], a[16:31]
    v_cmp_nge_f32 vcc, s63, v88
    v_cvt_pk_bf16_f32 v66, v12, v13
    v_exp_f32 v15, v103
    s_cbranch_vccnz L_p2_s42_go
L_p2_s42_back:
    v_mfma_f32_32x32x16_bf16 v[112:127], v[40:43], v[24:27], v[144:159]
    buffer_load_dwordx4 a[80:83], v205, s[28:31], s57 offen offset:0
    v_exp_f32 v8, v104
    v_cvt_pk_bf16_f32 v67, v14, v15
    v_exp_f32 v9, v105
    v_mfma_f32_32x32x16_bf16 v[112:127], v[44:47], v[28:31], v[112:127]
    ds_read_b64_tr_b16 a[180:181], v203 offset:20480
    ds_read_b64_tr_b16 a[182:183], v203 offset:22528
    v_exp_f32 v10, v106
    v_cvt_pk_bf16_f32 v68, v8, v9
    v_exp_f32 v11, v107
    v_mfma_f32_32x32x16_bf16 a[32:47], a[144:147], a[88:91], a[32:47]
    ds_read_b64_tr_b16 a[184:185], v202 offset:21504
    ds_read_b64_tr_b16 a[186:187], v202 offset:23552
    v_exp_f32 v12, v108
    v_cvt_pk_bf16_f32 v69, v10, v11
    v_exp_f32 v13, v109
    v_mfma_f32_32x32x16_bf16 v[176:191], v[48:51], v[72:75], v[176:191]
    ds_read_b64_tr_b16 a[188:189], v203 offset:21504
    ds_read_b64_tr_b16 a[190:191], v203 offset:23552
    v_exp_f32 v14, v110
    v_cvt_pk_bf16_f32 v70, v12, v13
    v_exp_f32 v15, v111
    v_mfma_f32_16x16x32_bf16 v[84:87], v[4:7], v[64:67], v[80:83]
    v_cvt_pk_bf16_f32 v71, v14, v15
    v_mfma_f32_32x32x16_bf16 a[48:63], a[148:151], a[88:91], a[48:63]
    buffer_load_dwordx4 a[88:91], v205, s[28:31], s57 offen offset:2048
    v_exp_f32 v8, v112
    v_exp_f32 v9, v113
    v_mfma_f32_16x16x32_bf16 v[84:87], v[4:7], v[68:71], v[84:87]
    v_exp_f32 v10, v114
    v_mfma_f32_32x32x16_bf16 v[176:191], v[52:55], v[76:79], v[176:191]
    buffer_load_dwordx4 v208, s[32:35], s58 offen offset:2048 lds
    v_cvt_pk_bf16_f32 v72, v8, v9
    v_exp_f32 v11, v115
    v_exp_f32 v12, v116
    v_mfma_f32_32x32x16_bf16 a[0:15], a[152:155], a[84:87], a[0:15]
    buffer_load_dwordx4 v209, s[32:35], s58 offen offset:3072 lds
    s_add_u32 s58, s58, 524288
    v_cvt_pk_bf16_f32 v73, v10, v11
    v_exp_f32 v13, v117
    v_exp_f32 v14, v118
    v_mfma_f32_32x32x16_bf16 a[16:31], a[156:159], a[84:87], a[16:31]
    v_cmp_nge_f32 vcc, s63, v84
    v_cvt_pk_bf16_f32 v74, v12, v13
    v_exp_f32 v15, v119
    s_cbranch_vccnz L_p2_s43_go
L_p2_s43_back:
    s_waitcnt lgkmcnt(0)
    v_mfma_f32_32x32x16_bf16 v[96:111], v[32:35], v[16:19], v[128:143]
    buffer_load_dwordx4 a[84:87], v205, s[28:31], s57 offen offset:512
    v_exp_f32 v8, v120
    v_cvt_pk_bf16_f32 v75, v14, v15
    v_exp_f32 v9, v121
    v_mfma_f32_32x32x16_bf16 v[96:111], v[36:39], v[20:23], v[96:111]
    v_exp_f32 v10, v122
    v_cvt_pk_bf16_f32 v76, v8, v9
    v_exp_f32 v11, v123
    v_mfma_f32_32x32x16_bf16 a[32:47], a[152:155], a[92:95], a[32:47]
    v_exp_f32 v12, v124
    v_cvt_pk_bf16_f32 v77, v10, v11
    v_exp_f32 v13, v125
    v_mfma_f32_32x32x16_bf16 v[160:175], v[56:59], v[64:67], v[160:175]
    v_exp_f32 v14, v126
    v_cvt_pk_bf16_f32 v78, v12, v13
    v_exp_f32 v15, v127
    v_mfma_f32_16x16x32_bf16 v[92:95], v[4:7], v[72:75], v[88:91]
    v_cvt_pk_bf16_f32 v79, v14, v15
    v_mfma_f32_32x32x16_bf16 a[48:63], a[156:159], a[92:95], a[48:63]
    buffer_load_dwordx4 a[92:95], v205, s[28:31], s57 offen offset:2560
    s_add_u32 s57, s57, 0x8000
    s_waitcnt vmcnt(14)
    s_barrier
    v_exp_f32 v8, v96
    v_exp_f32 v9, v97
    v_mfma_f32_16x16x32_bf16 v[92:95], v[4:7], v[76:79], v[92:95]
    v_exp_f32 v10, v98
    v_mfma_f32_32x32x16_bf16 v[160:175], v[60:63], v[68:71], v[160:175]
    ds_read_b128 v[40:43], v200 offset:24576
    ds_read_b128 v[44:47], v200 offset:26624
    ds_read_b128 v[48:51], v200 offset:25600
    ds_read_b128 v[52:55], v200 offset:27648
    v_cvt_pk_bf16_f32 v64, v8, v9
    v_exp_f32 v11, v99
    v_exp_f32 v12, v100
    v_mfma_f32_32x32x16_bf16 a[0:15], a[160:163], a[96:99], a[0:15]
    s_add_u32 m0, s61, 16384
    v_cvt_pk_bf16_f32 v65, v10, v11
    v_exp_f32 v13, v101
    v_exp_f32 v14, v102
    v_mfma_f32_32x32x16_bf16 a[16:31], a[164:167], a[96:99], a[16:31]
    v_cmp_nge_f32 vcc, s63, v92
    v_cvt_pk_bf16_f32 v66, v12, v13
    v_exp_f32 v15, v103
    s_cbranch_vccnz L_p2_s44_go
L_p2_s44_back:
    v_mfma_f32_32x32x16_bf16 v[112:127], v[32:35], v[24:27], v[144:159]
    buffer_load_dwordx4 a[96:99], v204, s[28:31], s57 offen offset:0
    v_exp_f32 v8, v104
    v_cvt_pk_bf16_f32 v67, v14, v15
    v_exp_f32 v9, v105
    v_mfma_f32_32x32x16_bf16 v[112:127], v[36:39], v[28:31], v[112:127]
    buffer_load_dwordx4 v210, s[20:23], s59 offen lds
    v_exp_f32 v10, v106
    v_cvt_pk_bf16_f32 v68, v8, v9
    v_exp_f32 v11, v107
    v_mfma_f32_32x32x16_bf16 a[32:47], a[160:163], a[104:107], a[32:47]
    buffer_load_dwordx4 v210, s[24:27], s59 offen offset:1024 lds
    s_add_u32 s59, s59, 4096
    v_exp_f32 v12, v108
    v_cvt_pk_bf16_f32 v69, v10, v11
    v_exp_f32 v13, v109
    v_mfma_f32_32x32x16_bf16 v[176:191], v[56:59], v[72:75], v[176:191]
    s_add_u32 m0, s60, 16384
    ds_read_b64_tr_b16 a[128:129], v202 offset:32768
    ds_read_b64_tr_b16 a[130:131], v202 offset:34816
    v_exp_f32 v14, v110
    v_cvt_pk_bf16_f32 v70, v12, v13
    v_exp_f32 v15, v111
    v_mfma_f32_16x16x32_bf16 v[80:83], v[4:7], v[64:67], v[84:87]
    v_cvt_pk_bf16_f32 v71, v14, v15
    v_mfma_f32_32x32x16_bf16 a[48:63], a[164:167], a[104:107], a[48:63]
    buffer_load_dwordx4 a[104:107], v204, s[28:31], s57 offen offset:2048
    v_exp_f32 v8, v112
    v_exp_f32 v9, v113
    v_mfma_f32_16x16x32_bf16 v[80:83], v[4:7], v[68:71], v[80:83]
    v_exp_f32 v10, v114
    v_mfma_f32_32x32x16_bf16 v[176:191], v[60:63], v[76:79], v[176:191]
    buffer_load_dwordx4 v206, s[32:35], s58 offen offset:0 lds
    v_cvt_pk_bf16_f32 v72, v8, v9
    v_exp_f32 v11, v115
    v_exp_f32 v12, v116
    v_mfma_f32_32x32x16_bf16 a[0:15], a[168:171], a[100:103], a[0:15]
    buffer_load_dwordx4 v207, s[32:35], s58 offen offset:1024 lds
    v_cvt_pk_bf16_f32 v73, v10, v11
    v_exp_f32 v13, v117
    v_exp_f32 v14, v118
    v_mfma_f32_32x32x16_bf16 a[16:31], a[172:175], a[100:103], a[16:31]
    v_cmp_nge_f32 vcc, s63, v80
    v_cvt_pk_bf16_f32 v74, v12, v13
    v_exp_f32 v15, v119
    s_cbranch_vccnz L_p2_s45_go
L_p2_s45_back:
    s_waitcnt lgkmcnt(0)
    v_mfma_f32_32x32x16_bf16 v[96:111], v[40:43], v[16:19], v[128:143]
    buffer_load_dwordx4 a[100:103], v204, s[28:31], s57 offen offset:512
    v_exp_f32 v8, v120
    v_cvt_pk_bf16_f32 v75, v14, v15
    v_exp_f32 v9, v121
    v_mfma_f32_32x32x16_bf16 v[96:111], v[44:47], v[20:23], v[96:111]
    ds_read_b64_tr_b16 a[132:133], v203 offset:32768
    ds_read_b64_tr_b16 a[134:135], v203 offset:34816
    v_exp_f32 v10, v122
    v_cvt_pk_bf16_f32 v76, v8, v9
    v_exp_f32 v11, v123
    v_mfma_f32_32x32x16_bf16 a[32:47], a[168:171], a[108:111], a[32:47]
    ds_read_b64_tr_b16 a[136:137], v202 offset:33792
    ds_read_b64_tr_b16 a[138:139], v202 offset:35840
    v_exp_f32 v12, v124
    v_cvt_pk_bf16_f32 v77, v10, v11
    v_exp_f32 v13, v125
    v_mfma_f32_32x32x16_bf16 v[160:175], v[48:51], v[64:67], v[160:175]
    ds_read_b64_tr_b16 a[140:141], v203 offset:33792
    ds_read_b64_tr_b16 a[142:143], v203 offset:35840
    v_exp_f32 v14, v126
    v_cvt_pk_bf16_f32 v78, v12, v13
    v_exp_f32 v15, v127
    v_mfma_f32_16x16x32_bf16 v[88:91], v[4:7], v[72:75], v[92:95]
    v_cvt_pk_bf16_f32 v79, v14, v15
    v_mfma_f32_32x32x16_bf16 a[48:63], a[172:175], a[108:111], a[48:63]
    buffer_load_dwordx4 a[108:111], v204, s[28:31], s57 offen offset:2560
    v_exp_f32 v8, v96
    v_exp_f32 v9, v97
    v_mfma_f32_16x16x32_bf16 v[88:91], v[4:7], v[76:79], v[88:91]
    v_exp_f32 v10, v98
    v_mfma_f32_32x32x16_bf16 v[160:175], v[52:55], v[68:71], v[160:175]
    ds_read_b128 v[32:35], v200 offset:28672
    ds_read_b128 v[36:39], v200 offset:30720
    ds_read_b128 v[56:59], v200 offset:29696
    ds_read_b128 v[60:63], v200 offset:31744
    v_cvt_pk_bf16_f32 v64, v8, v9
    v_exp_f32 v11, v99
    v_exp_f32 v12, v100
    v_mfma_f32_32x32x16_bf16 a[0:15], a[176:179], a[112:115], a[0:15]
    ds_read_b64_tr_b16 a[144:145], v202 offset:36864
    ds_read_b64_tr_b16 a[146:147], v202 offset:38912
    v_cvt_pk_bf16_f32 v65, v10, v11
    v_exp_f32 v13, v101
    v_exp_f32 v14, v102
    v_mfma_f32_32x32x16_bf16 a[16:31], a[180:183], a[112:115], a[16:31]
    v_cmp_nge_f32 vcc, s63, v88
    v_cvt_pk_bf16_f32 v66, v12, v13
    v_exp_f32 v15, v103
    s_cbranch_vccnz L_p2_s46_go
L_p2_s46_back:
    v_mfma_f32_32x32x16_bf16 v[112:127], v[40:43], v[24:27], v[144:159]
    buffer_load_dwordx4 a[112:115], v205, s[28:31], s57 offen offset:0
    v_exp_f32 v8, v104
    v_cvt_pk_bf16_f32 v67, v14, v15
    v_exp_f32 v9, v105
    v_mfma_f32_32x32x16_bf16 v[112:127], v[44:47], v[28:31], v[112:127]
    ds_read_b64_tr_b16 a[148:149], v203 offset:36864
    ds_read_b64_tr_b16 a[150:151], v203 offset:38912
    v_exp_f32 v10, v106
    v_cvt_pk_bf16_f32 v68, v8, v9
    v_exp_f32 v11, v107
    v_mfma_f32_32x32x16_bf16 a[32:47], a[176:179], a[120:123], a[32:47]
    ds_read_b64_tr_b16 a[152:153], v202 offset:37888
    ds_read_b64_tr_b16 a[154:155], v202 offset:39936
    v_exp_f32 v12, v108
    v_cvt_pk_bf16_f32 v69, v10, v11
    v_exp_f32 v13, v109
    v_mfma_f32_32x32x16_bf16 v[176:191], v[48:51], v[72:75], v[176:191]
    ds_read_b64_tr_b16 a[156:157], v203 offset:37888
    ds_read_b64_tr_b16 a[158:159], v203 offset:39936
    v_exp_f32 v14, v110
    v_cvt_pk_bf16_f32 v70, v12, v13
    v_exp_f32 v15, v111
    v_mfma_f32_16x16x32_bf16 v[84:87], v[4:7], v[64:67], v[80:83]
    v_cvt_pk_bf16_f32 v71, v14, v15
    v_mfma_f32_32x32x16_bf16 a[48:63], a[180:183], a[120:123], a[48:63]
    buffer_load_dwordx4 a[120:123], v205, s[28:31], s57 offen offset:2048
    v_exp_f32 v8, v112
    v_exp_f32 v9, v113
    v_mfma_f32_16x16x32_bf16 v[84:87], v[4:7], v[68:71], v[84:87]
    v_exp_f32 v10, v114
    v_mfma_f32_32x32x16_bf16 v[176:191], v[52:55], v[76:79], v[176:191]
    buffer_load_dwordx4 v208, s[32:35], s58 offen offset:2048 lds
    v_cvt_pk_bf16_f32 v72, v8, v9
    v_exp_f32 v11, v115
    v_exp_f32 v12, v116
    v_mfma_f32_32x32x16_bf16 a[0:15], a[184:187], a[116:119], a[0:15]
    buffer_load_dwordx4 v209, s[32:35], s58 offen offset:3072 lds
    s_add_u32 s58, s58, 524288
    s_sub_u32 s62, s62, 1
    v_cvt_pk_bf16_f32 v73, v10, v11
    v_exp_f32 v13, v117
    v_exp_f32 v14, v118
    v_mfma_f32_32x32x16_bf16 a[16:31], a[188:191], a[116:119], a[16:31]
    v_cmp_nge_f32 vcc, s63, v84
    v_cvt_pk_bf16_f32 v74, v12, v13
    v_exp_f32 v15, v119
    s_cbranch_vccnz L_p2_s47_go
L_p2_s47_back:
    s_waitcnt lgkmcnt(0)
    v_mfma_f32_32x32x16_bf16 v[96:111], v[32:35], v[16:19], v[128:143]
    buffer_load_dwordx4 a[116:119], v205, s[28:31], s57 offen offset:512
    v_exp_f32 v8, v120
    v_cvt_pk_bf16_f32 v75, v14, v15
    v_exp_f32 v9, v121
    v_mfma_f32_32x32x16_bf16 v[96:111], v[36:39], v[20:23], v[96:111]
    v_exp_f32 v10, v122
    v_cvt_pk_bf16_f32 v76, v8, v9
    v_exp_f32 v11, v123
    v_mfma_f32_32x32x16_bf16 a[32:47], a[184:187], a[124:127], a[32:47]
    v_exp_f32 v12, v124
    v_cvt_pk_bf16_f32 v77, v10, v11
    v_exp_f32 v13, v125
    v_mfma_f32_32x32x16_bf16 v[160:175], v[56:59], v[64:67], v[160:175]
    v_exp_f32 v14, v126
    v_cvt_pk_bf16_f32 v78, v12, v13
    v_exp_f32 v15, v127
    v_mfma_f32_16x16x32_bf16 v[92:95], v[4:7], v[72:75], v[88:91]
    v_cvt_pk_bf16_f32 v79, v14, v15
    v_mfma_f32_32x32x16_bf16 a[48:63], a[188:191], a[124:127], a[48:63]
    buffer_load_dwordx4 a[124:127], v205, s[28:31], s57 offen offset:2560
    s_add_u32 s57, s57, 0x8000
    s_cmp_lg_u32 s62, 0
    s_cbranch_scc1 L_p2_loop
    s_lshl_b32 s78, s36, 16
    s_add_u32 s78, s78, 1048576
    s_waitcnt vmcnt(14)
    s_barrier
    v_exp_f32 v8, v96
    v_exp_f32 v9, v97
    v_mfma_f32_16x16x32_bf16 v[92:95], v[4:7], v[76:79], v[92:95]
    v_exp_f32 v10, v98
    v_mfma_f32_32x32x16_bf16 v[160:175], v[60:63], v[68:71], v[160:175]
    ds_read_b128 v[40:43], v200 offset:0
    ds_read_b128 v[44:47], v200 offset:2048
    ds_read_b128 v[48:51], v200 offset:1024
    ds_read_b128 v[52:55], v200 offset:3072
    v_cvt_pk_bf16_f32 v64, v8, v9
    v_exp_f32 v11, v99
    v_exp_f32 v12, v100
    v_mfma_f32_32x32x16_bf16 a[0:15], a[128:131], a[64:67], a[0:15]
    s_add_u32 m0, s61, 24576
    v_cvt_pk_bf16_f32 v65, v10, v11
    v_exp_f32 v13, v101
    v_exp_f32 v14, v102
    v_mfma_f32_32x32x16_bf16 a[16:31], a[132:135], a[64:67], a[16:31]
    v_cmp_nge_f32 vcc, s63, v92
    v_cvt_pk_bf16_f32 v66, v12, v13
    v_exp_f32 v15, v103
    s_cbranch_vccnz L_p2_s48_go
L_p2_s48_back:
    v_mfma_f32_32x32x16_bf16 v[112:127], v[32:35], v[24:27], v[144:159]
    buffer_load_dwordx4 a[64:67], v204, s[28:31], s57 offen offset:0
    v_exp_f32 v8, v104
    v_cvt_pk_bf16_f32 v67, v14, v15
    v_exp_f32 v9, v105
    v_mfma_f32_32x32x16_bf16 v[112:127], v[36:39], v[28:31], v[112:127]
    buffer_load_dwordx4 v210, s[20:23], s59 offen lds
    v_exp_f32 v10, v106
    v_cvt_pk_bf16_f32 v68, v8, v9
    v_exp_f32 v11, v107
    v_mfma_f32_32x32x16_bf16 a[32:47], a[128:131], a[72:75], a[32:47]
    buffer_load_dwordx4 v210, s[24:27], s59 offen offset:1024 lds
    s_add_u32 s59, s59, 4096
    v_exp_f32 v12, v108
    v_cvt_pk_bf16_f32 v69, v10, v11
    v_exp_f32 v13, v109
    v_mfma_f32_32x32x16_bf16 v[176:191], v[56:59], v[72:75], v[176:191]
    s_add_u32 m0, s60, 32768
    ds_read_b64_tr_b16 a[160:161], v202 offset:49152
    ds_read_b64_tr_b16 a[162:163], v202 offset:51200
    v_exp_f32 v14, v110
    v_cvt_pk_bf16_f32 v70, v12, v13
    v_exp_f32 v15, v111
    v_mfma_f32_16x16x32_bf16 v[80:83], v[4:7], v[64:67], v[84:87]
    v_cvt_pk_bf16_f32 v71, v14, v15
    v_mfma_f32_32x32x16_bf16 a[48:63], a[132:135], a[72:75], a[48:63]
    buffer_load_dwordx4 a[72:75], v204, s[28:31], s57 offen offset:2048
    v_exp_f32 v8, v112
    v_exp_f32 v9, v113
    v_mfma_f32_16x16x32_bf16 v[80:83], v[4:7], v[68:71], v[80:83]
    v_exp_f32 v10, v114
    v_mfma_f32_32x32x16_bf16 v[176:191], v[60:63], v[76:79], v[176:191]
    buffer_load_dwordx4 v206, s[32:35], s58 offen offset:0 lds
    v_cvt_pk_bf16_f32 v72, v8, v9
    v_exp_f32 v11, v115
    v_exp_f32 v12, v116
    v_mfma_f32_32x32x16_bf16 a[0:15], a[136:139], a[68:71], a[0:15]
    buffer_load_dwordx4 v207, s[32:35], s58 offen offset:1024 lds
    v_cvt_pk_bf16_f32 v73, v10, v11
    v_exp_f32 v13, v117
    v_exp_f32 v14, v118
    v_mfma_f32_32x32x16_bf16 a[16:31], a[140:143], a[68:71], a[16:31]
    v_cmp_nge_f32 vcc, s63, v80
    v_cvt_pk_bf16_f32 v74, v12, v13
    v_exp_f32 v15, v119
    s_cbranch_vccnz L_p2_s49_go
L_p2_s49_back:
    s_waitcnt lgkmcnt(0)
    v_mfma_f32_32x32x16_bf16 v[96:111], v[40:43], v[16:19], v[128:143]
    buffer_load_dwordx4 a[68:71], v204, s[28:31], s57 offen offset:512
    v_exp_f32 v8, v120
    v_cvt_pk_bf16_f32 v75, v14, v15
    v_exp_f32 v9, v121
    v_mfma_f32_32x32x16_bf16 v[96:111], v[44:47], v[20:23], v[96:111]
    ds_read_b64_tr_b16 a[164:165], v203 offset:49152
    ds_read_b64_tr_b16 a[166:167], v203 offset:51200
    v_exp_f32 v10, v122
    v_cvt_pk_bf16_f32 v76, v8, v9
    v_exp_f32 v11, v123
    v_mfma_f32_32x32x16_bf16 a[32:47], a[136:139], a[76:79], a[32:47]
    ds_read_b64_tr_b16 a[168:169], v202 offset:50176
    ds_read_b64_tr_b16 a[170:171], v202 offset:52224
    v_exp_f32 v12, v124
    v_cvt_pk_bf16_f32 v77, v10, v11
    v_exp_f32 v13, v125
    v_mfma_f32_32x32x16_bf16 v[160:175], v[48:51], v[64:67], v[160:175]
    ds_read_b64_tr_b16 a[172:173], v203 offset:50176
    ds_read_b64_tr_b16 a[174:175], v203 offset:52224
    v_exp_f32 v14, v126
    v_cvt_pk_bf16_f32 v78, v12, v13
    v_exp_f32 v15, v127
    v_mfma_f32_16x16x32_bf16 v[88:91], v[4:7], v[72:75], v[92:95]
    v_cvt_pk_bf16_f32 v79, v14, v15
    v_mfma_f32_32x32x16_bf16 a[48:63], a[140:143], a[76:79], a[48:63]
    buffer_load_dwordx4 a[76:79], v204, s[28:31], s57 offen offset:2560
    v_exp_f32 v8, v96
    v_exp_f32 v9, v97
    v_mfma_f32_16x16x32_bf16 v[88:91], v[4:7], v[76:79], v[88:91]
    v_exp_f32 v10, v98
    v_mfma_f32_32x32x16_bf16 v[160:175], v[52:55], v[68:71], v[160:175]
    ds_read_b128 v[32:35], v200 offset:4096
    ds_read_b128 v[36:39], v200 offset:6144
    ds_read_b128 v[56:59], v200 offset:5120
    ds_read_b128 v[60:63], v200 offset:7168
    v_cvt_pk_bf16_f32 v64, v8, v9
    v_exp_f32 v11, v99
    v_exp_f32 v12, v100
    v_mfma_f32_32x32x16_bf16 a[0:15], a[144:147], a[80:83], a[0:15]
    ds_read_b64_tr_b16 a[176:177], v202 offset:53248
    ds_read_b64_tr_b16 a[178:179], v202 offset:55296
    v_cvt_pk_bf16_f32 v65, v10, v11
    v_exp_f32 v13, v101
    v_exp_f32 v14, v102
    v_mfma_f32_32x32x16_bf16 a[16:31], a[148:151], a[80:83], a[16:31]
    v_cmp_nge_f32 vcc, s63, v88
    v_cvt_pk_bf16_f32 v66, v12, v13
    v_exp_f32 v15, v103
    s_cbranch_vccnz L_p2_s50_go
L_p2_s50_back:
    v_mfma_f32_32x32x16_bf16 v[112:127], v[40:43], v[24:27], v[144:159]
    buffer_load_dwordx4 a[80:83], v205, s[28:31], s57 offen offset:0
    v_exp_f32 v8, v104
    v_cvt_pk_bf16_f32 v67, v14, v15
    v_exp_f32 v9, v105
    v_mfma_f32_32x32x16_bf16 v[112:127], v[44:47], v[28:31], v[112:127]
    ds_read_b64_tr_b16 a[180:181], v203 offset:53248
    ds_read_b64_tr_b16 a[182:183], v203 offset:55296
    v_exp_f32 v10, v106
    v_cvt_pk_bf16_f32 v68, v8, v9
    v_exp_f32 v11, v107
    v_mfma_f32_32x32x16_bf16 a[32:47], a[144:147], a[88:91], a[32:47]
    ds_read_b64_tr_b16 a[184:185], v202 offset:54272
    ds_read_b64_tr_b16 a[186:187], v202 offset:56320
    v_exp_f32 v12, v108
    v_cvt_pk_bf16_f32 v69, v10, v11
    v_exp_f32 v13, v109
    v_mfma_f32_32x32x16_bf16 v[176:191], v[48:51], v[72:75], v[176:191]
    ds_read_b64_tr_b16 a[188:189], v203 offset:54272
    ds_read_b64_tr_b16 a[190:191], v203 offset:56320
    v_exp_f32 v14, v110
    v_cvt_pk_bf16_f32 v70, v12, v13
    v_exp_f32 v15, v111
    v_mfma_f32_16x16x32_bf16 v[84:87], v[4:7], v[64:67], v[80:83]
    v_cvt_pk_bf16_f32 v71, v14, v15
    v_mfma_f32_32x32x16_bf16 a[48:63], a[148:151], a[88:91], a[48:63]
    buffer_load_dwordx4 a[88:91], v205, s[28:31], s57 offen offset:2048
    v_exp_f32 v8, v112
    v_exp_f32 v9, v113
    v_mfma_f32_16x16x32_bf16 v[84:87], v[4:7], v[68:71], v[84:87]
    v_exp_f32 v10, v114
    v_mfma_f32_32x32x16_bf16 v[176:191], v[52:55], v[76:79], v[176:191]
    buffer_load_dwordx4 v208, s[32:35], s58 offen offset:2048 lds
    v_cvt_pk_bf16_f32 v72, v8, v9
    v_exp_f32 v11, v115
    v_exp_f32 v12, v116
    v_mfma_f32_32x32x16_bf16 a[0:15], a[152:155], a[84:87], a[0:15]
    buffer_load_dwordx4 v209, s[32:35], s58 offen offset:3072 lds
    s_add_u32 s58, s58, 524288
    v_cvt_pk_bf16_f32 v73, v10, v11
    v_exp_f32 v13, v117
    v_exp_f32 v14, v118
    v_mfma_f32_32x32x16_bf16 a[16:31], a[156:159], a[84:87], a[16:31]
    v_cmp_nge_f32 vcc, s63, v84
    v_cvt_pk_bf16_f32 v74, v12, v13
    v_exp_f32 v15, v119
    s_cbranch_vccnz L_p2_s51_go
L_p2_s51_back:
    s_waitcnt lgkmcnt(0)
    v_mfma_f32_32x32x16_bf16 v[96:111], v[32:35], v[16:19], v[128:143]
    buffer_load_dwordx4 a[84:87], v205, s[28:31], s57 offen offset:512
    v_exp_f32 v8, v120
    v_cvt_pk_bf16_f32 v75, v14, v15
    v_exp_f32 v9, v121
    v_mfma_f32_32x32x16_bf16 v[96:111], v[36:39], v[20:23], v[96:111]
    s_add_u32 m0, s60, 65536
    s_nop 0
    buffer_load_dwordx4 v206, s[40:43], s78 offen offset:0 lds
    v_exp_f32 v10, v122
    v_cvt_pk_bf16_f32 v76, v8, v9
    v_exp_f32 v11, v123
    v_mfma_f32_32x32x16_bf16 a[32:47], a[152:155], a[92:95], a[32:47]
    buffer_load_dwordx4 v207, s[40:43], s78 offen offset:1024 lds
    v_exp_f32 v12, v124
    v_cvt_pk_bf16_f32 v77, v10, v11
    v_exp_f32 v13, v125
    v_mfma_f32_32x32x16_bf16 v[160:175], v[56:59], v[64:67], v[160:175]
    buffer_load_dwordx4 v208, s[40:43], s78 offen offset:2048 lds
    buffer_load_dwordx4 v209, s[40:43], s78 offen offset:3072 lds
    s_add_u32 s78, s78, 262144
    v_exp_f32 v14, v126
    v_cvt_pk_bf16_f32 v78, v12, v13
    v_exp_f32 v15, v127
    v_mfma_f32_16x16x32_bf16 v[92:95], v[4:7], v[72:75], v[88:91]
    v_cvt_pk_bf16_f32 v79, v14, v15
    v_mfma_f32_32x32x16_bf16 a[48:63], a[156:159], a[92:95], a[48:63]
    buffer_load_dwordx4 a[92:95], v205, s[28:31], s57 offen offset:2560
    s_add_u32 s57, s57, 0x8000
    s_waitcnt vmcnt(18)
    s_barrier
    v_exp_f32 v8, v96
    v_exp_f32 v9, v97
    v_mfma_f32_16x16x32_bf16 v[92:95], v[4:7], v[76:79], v[92:95]
    v_exp_f32 v10, v98
    v_mfma_f32_32x32x16_bf16 v[160:175], v[60:63], v[68:71], v[160:175]
    ds_read_b128 v[40:43], v200 offset:8192
    ds_read_b128 v[44:47], v200 offset:10240
    ds_read_b128 v[48:51], v200 offset:9216
    ds_read_b128 v[52:55], v200 offset:11264
    v_cvt_pk_bf16_f32 v64, v8, v9
    v_exp_f32 v11, v99
    v_exp_f32 v12, v100
    v_mfma_f32_32x32x16_bf16 a[0:15], a[160:163], a[96:99], a[0:15]
    v_cvt_pk_bf16_f32 v65, v10, v11
    v_exp_f32 v13, v101
    v_exp_f32 v14, v102
    v_mfma_f32_32x32x16_bf16 a[16:31], a[164:167], a[96:99], a[16:31]
    v_cmp_nge_f32 vcc, s63, v92
    v_cvt_pk_bf16_f32 v66, v12, v13
    v_exp_f32 v15, v103
    s_cbranch_vccnz L_p2_s52_go
L_p2_s52_back:
    v_mfma_f32_32x32x16_bf16 v[112:127], v[32:35], v[24:27], v[144:159]
    buffer_load_dwordx4 a[96:99], v204, s[28:31], s57 offen offset:0
    v_exp_f32 v8, v104
    v_cvt_pk_bf16_f32 v67, v14, v15
    v_exp_f32 v9, v105
    v_mfma_f32_32x32x16_bf16 v[112:127], v[36:39], v[28:31], v[112:127]
    v_exp_f32 v10, v106
    v_cvt_pk_bf16_f32 v68, v8, v9
    v_exp_f32 v11, v107
    v_mfma_f32_32x32x16_bf16 a[32:47], a[160:163], a[104:107], a[32:47]
    v_exp_f32 v12, v108
    v_cvt_pk_bf16_f32 v69, v10, v11
    v_exp_f32 v13, v109
    v_mfma_f32_32x32x16_bf16 v[176:191], v[56:59], v[72:75], v[176:191]
    s_add_u32 m0, s60, 49152
    ds_read_b64_tr_b16 a[128:129], v202 offset:0
    ds_read_b64_tr_b16 a[130:131], v202 offset:2048
    v_exp_f32 v14, v110
    v_cvt_pk_bf16_f32 v70, v12, v13
    v_exp_f32 v15, v111
    v_mfma_f32_16x16x32_bf16 v[80:83], v[4:7], v[64:67], v[84:87]
    v_cvt_pk_bf16_f32 v71, v14, v15
    v_mfma_f32_32x32x16_bf16 a[48:63], a[164:167], a[104:107], a[48:63]
    buffer_load_dwordx4 a[104:107], v204, s[28:31], s57 offen offset:2048
    v_exp_f32 v8, v112
    v_exp_f32 v9, v113
    v_mfma_f32_16x16x32_bf16 v[80:83], v[4:7], v[68:71], v[80:83]
    v_exp_f32 v10, v114
    v_mfma_f32_32x32x16_bf16 v[176:191], v[60:63], v[76:79], v[176:191]
    buffer_load_dwordx4 v206, s[32:35], s58 offen offset:0 lds
    v_cvt_pk_bf16_f32 v72, v8, v9
    v_exp_f32 v11, v115
    v_exp_f32 v12, v116
    v_mfma_f32_32x32x16_bf16 a[0:15], a[168:171], a[100:103], a[0:15]
    buffer_load_dwordx4 v207, s[32:35], s58 offen offset:1024 lds
    v_cvt_pk_bf16_f32 v73, v10, v11
    v_exp_f32 v13, v117
    v_exp_f32 v14, v118
    v_mfma_f32_32x32x16_bf16 a[16:31], a[172:175], a[100:103], a[16:31]
    v_cmp_nge_f32 vcc, s63, v80
    v_cvt_pk_bf16_f32 v74, v12, v13
    v_exp_f32 v15, v119
    s_cbranch_vccnz L_p2_s53_go
L_p2_s53_back:
    s_waitcnt lgkmcnt(0)
    v_mfma_f32_32x32x16_bf16 v[96:111], v[40:43], v[16:19], v[128:143]
    buffer_load_dwordx4 a[100:103], v204, s[28:31], s57 offen offset:512
    v_exp_f32 v8, v120
    v_cvt_pk_bf16_f32 v75, v14, v15
    v_exp_f32 v9, v121
    v_mfma_f32_32x32x16_bf16 v[96:111], v[44:47], v[20:23], v[96:111]
    ds_read_b64_tr_b16 a[132:133], v203 offset:0
    ds_read_b64_tr_b16 a[134:135], v203 offset:2048
    v_exp_f32 v10, v122
    v_cvt_pk_bf16_f32 v76, v8, v9
    v_exp_f32 v11, v123
    v_mfma_f32_32x32x16_bf16 a[32:47], a[168:171], a[108:111], a[32:47]
    ds_read_b64_tr_b16 a[136:137], v202 offset:1024
    ds_read_b64_tr_b16 a[138:139], v202 offset:3072
    v_exp_f32 v12, v124
    v_cvt_pk_bf16_f32 v77, v10, v11
    v_exp_f32 v13, v125
    v_mfma_f32_32x32x16_bf16 v[160:175], v[48:51], v[64:67], v[160:175]
    ds_read_b64_tr_b16 a[140:141], v203 offset:1024
    ds_read_b64_tr_b16 a[142:143], v203 offset:3072
    v_exp_f32 v14, v126
    v_cvt_pk_bf16_f32 v78, v12, v13
    v_exp_f32 v15, v127
    v_mfma_f32_16x16x32_bf16 v[88:91], v[4:7], v[72:75], v[92:95]
    v_cvt_pk_bf16_f32 v79, v14, v15
    v_mfma_f32_32x32x16_bf16 a[48:63], a[172:175], a[108:111], a[48:63]
    buffer_load_dwordx4 a[108:111], v204, s[28:31], s57 offen offset:2560
    v_exp_f32 v8, v96
    v_exp_f32 v9, v97
    v_mfma_f32_16x16x32_bf16 v[88:91], v[4:7], v[76:79], v[88:91]
    v_exp_f32 v10, v98
    v_mfma_f32_32x32x16_bf16 v[160:175], v[52:55], v[68:71], v[160:175]
    ds_read_b128 v[32:35], v200 offset:12288
    ds_read_b128 v[36:39], v200 offset:14336
    ds_read_b128 v[56:59], v200 offset:13312
    ds_read_b128 v[60:63], v200 offset:15360
    v_cvt_pk_bf16_f32 v64, v8, v9
    v_exp_f32 v11, v99
    v_exp_f32 v12, v100
    v_mfma_f32_32x32x16_bf16 a[0:15], a[176:179], a[112:115], a[0:15]
    ds_read_b64_tr_b16 a[144:145], v202 offset:4096
    ds_read_b64_tr_b16 a[146:147], v202 offset:6144
    v_cvt_pk_bf16_f32 v65, v10, v11
    v_exp_f32 v13, v101
    v_exp_f32 v14, v102
    v_mfma_f32_32x32x16_bf16 a[16:31], a[180:183], a[112:115], a[16:31]
    v_cmp_nge_f32 vcc, s63, v88
    v_cvt_pk_bf16_f32 v66, v12, v13
    v_exp_f32 v15, v103
    s_cbranch_vccnz L_p2_s54_go
L_p2_s54_back:
    v_mfma_f32_32x32x16_bf16 v[112:127], v[40:43], v[24:27], v[144:159]
    buffer_load_dwordx4 a[112:115], v205, s[28:31], s57 offen offset:0
    v_exp_f32 v8, v104
    v_cvt_pk_bf16_f32 v67, v14, v15
    v_exp_f32 v9, v105
    v_mfma_f32_32x32x16_bf16 v[112:127], v[44:47], v[28:31], v[112:127]
    ds_read_b64_tr_b16 a[148:149], v203 offset:4096
    ds_read_b64_tr_b16 a[150:151], v203 offset:6144
    v_exp_f32 v10, v106
    v_cvt_pk_bf16_f32 v68, v8, v9
    v_exp_f32 v11, v107
    v_mfma_f32_32x32x16_bf16 a[32:47], a[176:179], a[120:123], a[32:47]
    ds_read_b64_tr_b16 a[152:153], v202 offset:5120
    ds_read_b64_tr_b16 a[154:155], v202 offset:7168
    v_exp_f32 v12, v108
    v_cvt_pk_bf16_f32 v69, v10, v11
    v_exp_f32 v13, v109
    v_mfma_f32_32x32x16_bf16 v[176:191], v[48:51], v[72:75], v[176:191]
    ds_read_b64_tr_b16 a[156:157], v203 offset:5120
    ds_read_b64_tr_b16 a[158:159], v203 offset:7168
    v_exp_f32 v14, v110
    v_cvt_pk_bf16_f32 v70, v12, v13
    v_exp_f32 v15, v111
    v_mfma_f32_16x16x32_bf16 v[84:87], v[4:7], v[64:67], v[80:83]
    v_cvt_pk_bf16_f32 v71, v14, v15
    v_mfma_f32_32x32x16_bf16 a[48:63], a[180:183], a[120:123], a[48:63]
    buffer_load_dwordx4 a[120:123], v205, s[28:31], s57 offen offset:2048
    v_exp_f32 v8, v112
    v_exp_f32 v9, v113
    v_mfma_f32_16x16x32_bf16 v[84:87], v[4:7], v[68:71], v[84:87]
    v_exp_f32 v10, v114
    v_mfma_f32_32x32x16_bf16 v[176:191], v[52:55], v[76:79], v[176:191]
    buffer_load_dwordx4 v208, s[32:35], s58 offen offset:2048 lds
    v_cvt_pk_bf16_f32 v72, v8, v9
    v_exp_f32 v11, v115
    v_exp_f32 v12, v116
    v_mfma_f32_32x32x16_bf16 a[0:15], a[184:187], a[116:119], a[0:15]
    buffer_load_dwordx4 v209, s[32:35], s58 offen offset:3072 lds
    s_add_u32 s58, s58, 524288
    v_cvt_pk_bf16_f32 v73, v10, v11
    v_exp_f32 v13, v117
    v_exp_f32 v14, v118
    v_mfma_f32_32x32x16_bf16 a[16:31], a[188:191], a[116:119], a[16:31]
    v_cmp_nge_f32 vcc, s63, v84
    v_cvt_pk_bf16_f32 v74, v12, v13
    v_exp_f32 v15, v119
    s_cbranch_vccnz L_p2_s55_go
L_p2_s55_back:
    s_waitcnt lgkmcnt(0)
    v_mfma_f32_32x32x16_bf16 v[96:111], v[32:35], v[16:19], v[128:143]
    buffer_load_dwordx4 a[116:119], v205, s[28:31], s57 offen offset:512
    v_exp_f32 v8, v120
    v_cvt_pk_bf16_f32 v75, v14, v15
    v_exp_f32 v9, v121
    v_mfma_f32_32x32x16_bf16 v[96:111], v[36:39], v[20:23], v[96:111]
    s_add_u32 m0, s60, 81920
    s_nop 0
    buffer_load_dwordx4 v206, s[40:43], s78 offen offset:0 lds
    v_exp_f32 v10, v122
    v_cvt_pk_bf16_f32 v76, v8, v9
    v_exp_f32 v11, v123
    v_mfma_f32_32x32x16_bf16 a[32:47], a[184:187], a[124:127], a[32:47]
    buffer_load_dwordx4 v207, s[40:43], s78 offen offset:1024 lds
    v_exp_f32 v12, v124
    v_cvt_pk_bf16_f32 v77, v10, v11
    v_exp_f32 v13, v125
    v_mfma_f32_32x32x16_bf16 v[160:175], v[56:59], v[64:67], v[160:175]
    buffer_load_dwordx4 v208, s[40:43], s78 offen offset:2048 lds
    buffer_load_dwordx4 v209, s[40:43], s78 offen offset:3072 lds
    s_add_u32 s78, s78, 262144
    v_exp_f32 v14, v126
    v_cvt_pk_bf16_f32 v78, v12, v13
    v_exp_f32 v15, v127
    v_mfma_f32_16x16x32_bf16 v[92:95], v[4:7], v[72:75], v[88:91]
    v_cvt_pk_bf16_f32 v79, v14, v15
    v_mfma_f32_32x32x16_bf16 a[48:63], a[188:191], a[124:127], a[48:63]
    buffer_load_dwordx4 a[124:127], v205, s[28:31], s57 offen offset:2560
    s_add_u32 s57, s57, 0x8000
    s_waitcnt vmcnt(16)
    s_barrier
    v_exp_f32 v8, v96
    v_exp_f32 v9, v97
    v_mfma_f32_16x16x32_bf16 v[92:95], v[4:7], v[76:79], v[92:95]
    v_exp_f32 v10, v98
    v_mfma_f32_32x32x16_bf16 v[160:175], v[60:63], v[68:71], v[160:175]
    ds_read_b128 v[40:43], v200 offset:16384
    ds_read_b128 v[44:47], v200 offset:18432
    ds_read_b128 v[48:51], v200 offset:17408
    ds_read_b128 v[52:55], v200 offset:19456
    v_cvt_pk_bf16_f32 v64, v8, v9
    v_exp_f32 v11, v99
    v_exp_f32 v12, v100
    v_mfma_f32_32x32x16_bf16 a[0:15], a[128:131], a[64:67], a[0:15]
    s_add_u32 m0, s60, 98304
    s_nop 0
    buffer_load_dwordx4 v206, s[40:43], s78 offen offset:0 lds
    v_cvt_pk_bf16_f32 v65, v10, v11
    v_exp_f32 v13, v101
    v_exp_f32 v14, v102
    v_mfma_f32_32x32x16_bf16 a[16:31], a[132:135], a[64:67], a[16:31]
    v_cmp_nge_f32 vcc, s63, v92
    v_cvt_pk_bf16_f32 v66, v12, v13
    v_exp_f32 v15, v103
    s_cbranch_vccnz L_p2_s56_go
L_p2_s56_back:
    v_mfma_f32_32x32x16_bf16 v[112:127], v[32:35], v[24:27], v[144:159]
    buffer_load_dwordx4 a[64:67], v204, s[28:31], s57 offen offset:0
    v_exp_f32 v8, v104
    v_cvt_pk_bf16_f32 v67, v14, v15
    v_exp_f32 v9, v105
    v_mfma_f32_32x32x16_bf16 v[112:127], v[36:39], v[28:31], v[112:127]
    buffer_load_dwordx4 v207, s[40:43], s78 offen offset:1024 lds
    v_exp_f32 v10, v106
    v_cvt_pk_bf16_f32 v68, v8, v9
    v_exp_f32 v11, v107
    v_mfma_f32_32x32x16_bf16 a[32:47], a[128:131], a[72:75], a[32:47]
    buffer_load_dwordx4 v208, s[40:43], s78 offen offset:2048 lds
    v_exp_f32 v12, v108
    v_cvt_pk_bf16_f32 v69, v10, v11
    v_exp_f32 v13, v109
    v_mfma_f32_32x32x16_bf16 v[176:191], v[56:59], v[72:75], v[176:191]
    ds_read_b64_tr_b16 a[160:161], v202 offset:16384
    ds_read_b64_tr_b16 a[162:163], v202 offset:18432
    v_exp_f32 v14, v110
    v_cvt_pk_bf16_f32 v70, v12, v13
    v_exp_f32 v15, v111
    v_mfma_f32_16x16x32_bf16 v[80:83], v[4:7], v[64:67], v[84:87]
    v_cvt_pk_bf16_f32 v71, v14, v15
    v_mfma_f32_32x32x16_bf16 a[48:63], a[132:135], a[72:75], a[48:63]
    buffer_load_dwordx4 a[72:75], v204, s[28:31], s57 offen offset:2048
    v_exp_f32 v8, v112
    v_exp_f32 v9, v113
    v_mfma_f32_16x16x32_bf16 v[80:83], v[4:7], v[68:71], v[80:83]
    v_exp_f32 v10, v114
    v_mfma_f32_32x32x16_bf16 v[176:191], v[60:63], v[76:79], v[176:191]
    buffer_load_dwordx4 v209, s[40:43], s78 offen offset:3072 lds
    v_cvt_pk_bf16_f32 v72, v8, v9
    v_exp_f32 v11, v115
    v_exp_f32 v12, v116
    v_mfma_f32_32x32x16_bf16 a[0:15], a[136:139], a[68:71], a[0:15]
    s_add_u32 s78, s78, 262144
    s_add_u32 m0, s60, 114688
    s_nop 0
    buffer_load_dwordx4 v206, s[40:43], s78 offen offset:0 lds
    v_cvt_pk_bf16_f32 v73, v10, v11
    v_exp_f32 v13, v117
    v_exp_f32 v14, v118
    v_mfma_f32_32x32x16_bf16 a[16:31], a[140:143], a[68:71], a[16:31]
    v_cmp_nge_f32 vcc, s63, v80
    v_cvt_pk_bf16_f32 v74, v12, v13
    v_exp_f32 v15, v119
    s_cbranch_vccnz L_p2_s57_go
L_p2_s57_back:
    s_waitcnt lgkmcnt(0)
    v_mfma_f32_32x32x16_bf16 v[96:111], v[40:43], v[16:19], v[128:143]
    buffer_load_dwordx4 a[68:71], v204, s[28:31], s57 offen offset:512
    v_exp_f32 v8, v120
    v_cvt_pk_bf16_f32 v75, v14, v15
    v_exp_f32 v9, v121
    v_mfma_f32_32x32x16_bf16 v[96:111], v[44:47], v[20:23], v[96:111]
    ds_read_b64_tr_b16 a[164:165], v203 offset:16384
    ds_read_b64_tr_b16 a[166:167], v203 offset:18432
    v_exp_f32 v10, v122
    v_cvt_pk_bf16_f32 v76, v8, v9
    v_exp_f32 v11, v123
    v_mfma_f32_32x32x16_bf16 a[32:47], a[136:139], a[76:79], a[32:47]
    ds_read_b64_tr_b16 a[168:169], v202 offset:17408
    ds_read_b64_tr_b16 a[170:171], v202 offset:19456
    v_exp_f32 v12, v124
    v_cvt_pk_bf16_f32 v77, v10, v11
    v_exp_f32 v13, v125
    v_mfma_f32_32x32x16_bf16 v[160:175], v[48:51], v[64:67], v[160:175]
    ds_read_b64_tr_b16 a[172:173], v203 offset:17408
    ds_read_b64_tr_b16 a[174:175], v203 offset:19456
    v_exp_f32 v14, v126
    v_cvt_pk_bf16_f32 v78, v12, v13
    v_exp_f32 v15, v127
    v_mfma_f32_16x16x32_bf16 v[88:91], v[4:7], v[72:75], v[92:95]
    v_cvt_pk_bf16_f32 v79, v14, v15
    v_mfma_f32_32x32x16_bf16 a[48:63], a[140:143], a[76:79], a[48:63]
    buffer_load_dwordx4 a[76:79], v204, s[28:31], s57 offen offset:2560
    v_exp_f32 v8, v96
    v_exp_f32 v9, v97
    v_mfma_f32_16x16x32_bf16 v[88:91], v[4:7], v[76:79], v[88:91]
    v_exp_f32 v10, v98
    v_mfma_f32_32x32x16_bf16 v[160:175], v[52:55], v[68:71], v[160:175]
    ds_read_b128 v[32:35], v200 offset:20480
    ds_read_b128 v[36:39], v200 offset:22528
    ds_read_b128 v[56:59], v200 offset:21504
    ds_read_b128 v[60:63], v200 offset:23552
    v_cvt_pk_bf16_f32 v64, v8, v9
    v_exp_f32 v11, v99
    v_exp_f32 v12, v100
    v_mfma_f32_32x32x16_bf16 a[0:15], a[144:147], a[80:83], a[0:15]
    ds_read_b64_tr_b16 a[176:177], v202 offset:20480
    ds_read_b64_tr_b16 a[178:179], v202 offset:22528
    v_cvt_pk_bf16_f32 v65, v10, v11
    v_exp_f32 v13, v101
    v_exp_f32 v14, v102
    v_mfma_f32_32x32x16_bf16 a[16:31], a[148:151], a[80:83], a[16:31]
    v_cmp_nge_f32 vcc, s63, v88
    v_cvt_pk_bf16_f32 v66, v12, v13
    v_exp_f32 v15, v103
    s_cbranch_vccnz L_p2_s58_go
L_p2_s58_back:
    v_mfma_f32_32x32x16_bf16 v[112:127], v[40:43], v[24:27], v[144:159]
    buffer_load_dwordx4 a[80:83], v205, s[28:31], s57 offen offset:0
    v_exp_f32 v8, v104
    v_cvt_pk_bf16_f32 v67, v14, v15
    v_exp_f32 v9, v105
    v_mfma_f32_32x32x16_bf16 v[112:127], v[44:47], v[28:31], v[112:127]
    ds_read_b64_tr_b16 a[180:181], v203 offset:20480
    ds_read_b64_tr_b16 a[182:183], v203 offset:22528
    v_exp_f32 v10, v106
    v_cvt_pk_bf16_f32 v68, v8, v9
    v_exp_f32 v11, v107
    v_mfma_f32_32x32x16_bf16 a[32:47], a[144:147], a[88:91], a[32:47]
    ds_read_b64_tr_b16 a[184:185], v202 offset:21504
    ds_read_b64_tr_b16 a[186:187], v202 offset:23552
    v_exp_f32 v12, v108
    v_cvt_pk_bf16_f32 v69, v10, v11
    v_exp_f32 v13, v109
    v_mfma_f32_32x32x16_bf16 v[176:191], v[48:51], v[72:75], v[176:191]
    ds_read_b64_tr_b16 a[188:189], v203 offset:21504
    ds_read_b64_tr_b16 a[190:191], v203 offset:23552
    v_exp_f32 v14, v110
    v_cvt_pk_bf16_f32 v70, v12, v13
    v_exp_f32 v15, v111
    v_mfma_f32_16x16x32_bf16 v[84:87], v[4:7], v[64:67], v[80:83]
    v_cvt_pk_bf16_f32 v71, v14, v15
    v_mfma_f32_32x32x16_bf16 a[48:63], a[148:151], a[88:91], a[48:63]
    buffer_load_dwordx4 a[88:91], v205, s[28:31], s57 offen offset:2048
    v_exp_f32 v8, v112
    v_exp_f32 v9, v113
    v_mfma_f32_16x16x32_bf16 v[84:87], v[4:7], v[68:71], v[84:87]
    v_exp_f32 v10, v114
    v_mfma_f32_32x32x16_bf16 v[176:191], v[52:55], v[76:79], v[176:191]
    buffer_load_dwordx4 v207, s[40:43], s78 offen offset:1024 lds
    v_cvt_pk_bf16_f32 v72, v8, v9
    v_exp_f32 v11, v115
    v_exp_f32 v12, v116
    v_mfma_f32_32x32x16_bf16 a[0:15], a[152:155], a[84:87], a[0:15]
    buffer_load_dwordx4 v208, s[40:43], s78 offen offset:2048 lds
    v_cvt_pk_bf16_f32 v73, v10, v11
    v_exp_f32 v13, v117
    v_exp_f32 v14, v118
    v_mfma_f32_32x32x16_bf16 a[16:31], a[156:159], a[84:87], a[16:31]
    v_cmp_nge_f32 vcc, s63, v84
    v_cvt_pk_bf16_f32 v74, v12, v13
    v_exp_f32 v15, v119
    s_cbranch_vccnz L_p2_s59_go
L_p2_s59_back:
    s_waitcnt lgkmcnt(0)
    v_mfma_f32_32x32x16_bf16 v[96:111], v[32:35], v[16:19], v[128:143]
    buffer_load_dwordx4 a[84:87], v205, s[28:31], s57 offen offset:512
    v_exp_f32 v8, v120
    v_cvt_pk_bf16_f32 v75, v14, v15
    v_exp_f32 v9, v121
    v_mfma_f32_32x32x16_bf16 v[96:111], v[36:39], v[20:23], v[96:111]
    buffer_load_dwordx4 v209, s[40:43], s78 offen offset:3072 lds
    v_exp_f32 v10, v122
    v_cvt_pk_bf16_f32 v76, v8, v9
    v_exp_f32 v11, v123
    v_mfma_f32_32x32x16_bf16 a[32:47], a[152:155], a[92:95], a[32:47]
    s_add_u32 s78, s78, 262144
    v_exp_f32 v12, v124
    v_cvt_pk_bf16_f32 v77, v10, v11
    v_exp_f32 v13, v125
    v_mfma_f32_32x32x16_bf16 v[160:175], v[56:59], v[64:67], v[160:175]
    v_exp_f32 v14, v126
    v_cvt_pk_bf16_f32 v78, v12, v13
    v_exp_f32 v15, v127
    v_mfma_f32_16x16x32_bf16 v[92:95], v[4:7], v[72:75], v[88:91]
    v_cvt_pk_bf16_f32 v79, v14, v15
    v_mfma_f32_32x32x16_bf16 a[48:63], a[156:159], a[92:95], a[48:63]
    buffer_load_dwordx4 a[92:95], v205, s[28:31], s57 offen offset:2560
    s_add_u32 s57, s57, 0x8000
    s_waitcnt vmcnt(16)
    s_barrier
    v_exp_f32 v8, v96
    v_exp_f32 v9, v97
    v_mfma_f32_16x16x32_bf16 v[92:95], v[4:7], v[76:79], v[92:95]
    v_exp_f32 v10, v98
    v_mfma_f32_32x32x16_bf16 v[160:175], v[60:63], v[68:71], v[160:175]
    ds_read_b128 v[40:43], v200 offset:24576
    ds_read_b128 v[44:47], v200 offset:26624
    ds_read_b128 v[48:51], v200 offset:25600
    ds_read_b128 v[52:55], v200 offset:27648
    v_cvt_pk_bf16_f32 v64, v8, v9
    v_exp_f32 v11, v99
    v_exp_f32 v12, v100
    v_mfma_f32_32x32x16_bf16 a[0:15], a[160:163], a[96:99], a[0:15]
    v_cvt_pk_bf16_f32 v65, v10, v11
    v_exp_f32 v13, v101
    v_exp_f32 v14, v102
    v_mfma_f32_32x32x16_bf16 a[16:31], a[164:167], a[96:99], a[16:31]
    v_cmp_nge_f32 vcc, s63, v92
    v_cvt_pk_bf16_f32 v66, v12, v13
    v_exp_f32 v15, v103
    s_cbranch_vccnz L_p2_s60_go
L_p2_s60_back:
    v_mfma_f32_32x32x16_bf16 v[112:127], v[32:35], v[24:27], v[144:159]
    buffer_load_dwordx4 a[96:99], v204, s[28:31], s57 offen offset:0
    v_exp_f32 v8, v104
    v_cvt_pk_bf16_f32 v67, v14, v15
    v_exp_f32 v9, v105
    v_mfma_f32_32x32x16_bf16 v[112:127], v[36:39], v[28:31], v[112:127]
    v_exp_f32 v10, v106
    v_cvt_pk_bf16_f32 v68, v8, v9
    v_exp_f32 v11, v107
    v_mfma_f32_32x32x16_bf16 a[32:47], a[160:163], a[104:107], a[32:47]
    v_exp_f32 v12, v108
    v_cvt_pk_bf16_f32 v69, v10, v11
    v_exp_f32 v13, v109
    v_mfma_f32_32x32x16_bf16 v[176:191], v[56:59], v[72:75], v[176:191]
    ds_read_b64_tr_b16 a[128:129], v202 offset:32768
    ds_read_b64_tr_b16 a[130:131], v202 offset:34816
    v_exp_f32 v14, v110
    v_cvt_pk_bf16_f32 v70, v12, v13
    v_exp_f32 v15, v111
    v_mfma_f32_16x16x32_bf16 v[80:83], v[4:7], v[64:67], v[84:87]
    v_cvt_pk_bf16_f32 v71, v14, v15
    v_mfma_f32_32x32x16_bf16 a[48:63], a[164:167], a[104:107], a[48:63]
    buffer_load_dwordx4 a[104:107], v204, s[28:31], s57 offen offset:2048
    v_exp_f32 v8, v112
    v_exp_f32 v9, v113
    v_mfma_f32_16x16x32_bf16 v[80:83], v[4:7], v[68:71], v[80:83]
    v_exp_f32 v10, v114
    v_mfma_f32_32x32x16_bf16 v[176:191], v[60:63], v[76:79], v[176:191]
    v_cvt_pk_bf16_f32 v72, v8, v9
    v_exp_f32 v11, v115
    v_exp_f32 v12, v116
    v_mfma_f32_32x32x16_bf16 a[0:15], a[168:171], a[100:103], a[0:15]
    v_cvt_pk_bf16_f32 v73, v10, v11
    v_exp_f32 v13, v117
    v_exp_f32 v14, v118
    v_mfma_f32_32x32x16_bf16 a[16:31], a[172:175], a[100:103], a[16:31]
    v_cmp_nge_f32 vcc, s63, v80
    v_cvt_pk_bf16_f32 v74, v12, v13
    v_exp_f32 v15, v119
    s_cbranch_vccnz L_p2_s61_go
L_p2_s61_back:
    s_waitcnt lgkmcnt(0)
    v_mfma_f32_32x32x16_bf16 v[96:111], v[40:43], v[16:19], v[128:143]
    buffer_load_dwordx4 a[100:103], v204, s[28:31], s57 offen offset:512
    v_exp_f32 v8, v120
    v_cvt_pk_bf16_f32 v75, v14, v15
    v_exp_f32 v9, v121
    v_mfma_f32_32x32x16_bf16 v[96:111], v[44:47], v[20:23], v[96:111]
    ds_read_b64_tr_b16 a[132:133], v203 offset:32768
    ds_read_b64_tr_b16 a[134:135], v203 offset:34816
    v_exp_f32 v10, v122
    v_cvt_pk_bf16_f32 v76, v8, v9
    v_exp_f32 v11, v123
    v_mfma_f32_32x32x16_bf16 a[32:47], a[168:171], a[108:111], a[32:47]
    ds_read_b64_tr_b16 a[136:137], v202 offset:33792
    ds_read_b64_tr_b16 a[138:139], v202 offset:35840
    v_exp_f32 v12, v124
    v_cvt_pk_bf16_f32 v77, v10, v11
    v_exp_f32 v13, v125
    v_mfma_f32_32x32x16_bf16 v[160:175], v[48:51], v[64:67], v[160:175]
    ds_read_b64_tr_b16 a[140:141], v203 offset:33792
    ds_read_b64_tr_b16 a[142:143], v203 offset:35840
    v_exp_f32 v14, v126
    v_cvt_pk_bf16_f32 v78, v12, v13
    v_exp_f32 v15, v127
    v_mfma_f32_16x16x32_bf16 v[88:91], v[4:7], v[72:75], v[92:95]
    v_cvt_pk_bf16_f32 v79, v14, v15
    v_mfma_f32_32x32x16_bf16 a[48:63], a[172:175], a[108:111], a[48:63]
    buffer_load_dwordx4 a[108:111], v204, s[28:31], s57 offen offset:2560
    v_exp_f32 v8, v96
    v_exp_f32 v9, v97
    v_mfma_f32_16x16x32_bf16 v[88:91], v[4:7], v[76:79], v[88:91]
    v_exp_f32 v10, v98
    v_mfma_f32_32x32x16_bf16 v[160:175], v[52:55], v[68:71], v[160:175]
    ds_read_b128 v[32:35], v200 offset:28672
    ds_read_b128 v[36:39], v200 offset:30720
    ds_read_b128 v[56:59], v200 offset:29696
    ds_read_b128 v[60:63], v200 offset:31744
    v_cvt_pk_bf16_f32 v64, v8, v9
    v_exp_f32 v11, v99
    v_exp_f32 v12, v100
    v_mfma_f32_32x32x16_bf16 a[0:15], a[176:179], a[112:115], a[0:15]
    ds_read_b64_tr_b16 a[144:145], v202 offset:36864
    ds_read_b64_tr_b16 a[146:147], v202 offset:38912
    v_cvt_pk_bf16_f32 v65, v10, v11
    v_exp_f32 v13, v101
    v_exp_f32 v14, v102
    v_mfma_f32_32x32x16_bf16 a[16:31], a[180:183], a[112:115], a[16:31]
    v_cmp_nge_f32 vcc, s63, v88
    v_cvt_pk_bf16_f32 v66, v12, v13
    v_exp_f32 v15, v103
    s_cbranch_vccnz L_p2_s62_go
L_p2_s62_back:
    v_mfma_f32_32x32x16_bf16 v[112:127], v[40:43], v[24:27], v[144:159]
    buffer_load_dwordx4 a[112:115], v205, s[28:31], s57 offen offset:0
    v_exp_f32 v8, v104
    v_cvt_pk_bf16_f32 v67, v14, v15
    v_exp_f32 v9, v105
    v_mfma_f32_32x32x16_bf16 v[112:127], v[44:47], v[28:31], v[112:127]
    ds_read_b64_tr_b16 a[148:149], v203 offset:36864
    ds_read_b64_tr_b16 a[150:151], v203 offset:38912
    v_exp_f32 v10, v106
    v_cvt_pk_bf16_f32 v68, v8, v9
    v_exp_f32 v11, v107
    v_mfma_f32_32x32x16_bf16 a[32:47], a[176:179], a[120:123], a[32:47]
    ds_read_b64_tr_b16 a[152:153], v202 offset:37888
    ds_read_b64_tr_b16 a[154:155], v202 offset:39936
    v_exp_f32 v12, v108
    v_cvt_pk_bf16_f32 v69, v10, v11
    v_exp_f32 v13, v109
    v_mfma_f32_32x32x16_bf16 v[176:191], v[48:51], v[72:75], v[176:191]
    ds_read_b64_tr_b16 a[156:157], v203 offset:37888
    ds_read_b64_tr_b16 a[158:159], v203 offset:39936
    v_exp_f32 v14, v110
    v_cvt_pk_bf16_f32 v70, v12, v13
    v_exp_f32 v15, v111
    v_mfma_f32_16x16x32_bf16 v[84:87], v[4:7], v[64:67], v[80:83]
    v_cvt_pk_bf16_f32 v71, v14, v15
    v_mfma_f32_32x32x16_bf16 a[48:63], a[180:183], a[120:123], a[48:63]
    buffer_load_dwordx4 a[120:123], v205, s[28:31], s57 offen offset:2048
    v_exp_f32 v8, v112
    v_exp_f32 v9, v113
    v_mfma_f32_16x16x32_bf16 v[84:87], v[4:7], v[68:71], v[84:87]
    v_exp_f32 v10, v114
    v_mfma_f32_32x32x16_bf16 v[176:191], v[52:55], v[76:79], v[176:191]
    v_cvt_pk_bf16_f32 v72, v8, v9
    v_exp_f32 v11, v115
    v_exp_f32 v12, v116
    v_mfma_f32_32x32x16_bf16 a[0:15], a[184:187], a[116:119], a[0:15]
    v_cvt_pk_bf16_f32 v73, v10, v11
    v_exp_f32 v13, v117
    v_exp_f32 v14, v118
    v_mfma_f32_32x32x16_bf16 a[16:31], a[188:191], a[116:119], a[16:31]
    v_cmp_nge_f32 vcc, s63, v84
    v_cvt_pk_bf16_f32 v74, v12, v13
    v_exp_f32 v15, v119
    s_cbranch_vccnz L_p2_s63_go
L_p2_s63_back:
    s_waitcnt lgkmcnt(0)
    v_mfma_f32_32x32x16_bf16 v[96:111], v[32:35], v[16:19], v[128:143]
    buffer_load_dwordx4 a[116:119], v205, s[28:31], s57 offen offset:512
    v_exp_f32 v8, v120
    v_cvt_pk_bf16_f32 v75, v14, v15
    v_exp_f32 v9, v121
    v_mfma_f32_32x32x16_bf16 v[96:111], v[36:39], v[20:23], v[96:111]
    v_exp_f32 v10, v122
    v_cvt_pk_bf16_f32 v76, v8, v9
    v_exp_f32 v11, v123
    v_mfma_f32_32x32x16_bf16 a[32:47], a[184:187], a[124:127], a[32:47]
    v_exp_f32 v12, v124
    v_cvt_pk_bf16_f32 v77, v10, v11
    v_exp_f32 v13, v125
    v_mfma_f32_32x32x16_bf16 v[160:175], v[56:59], v[64:67], v[160:175]
    v_exp_f32 v14, v126
    v_cvt_pk_bf16_f32 v78, v12, v13
    v_exp_f32 v15, v127
    v_mfma_f32_16x16x32_bf16 v[92:95], v[4:7], v[72:75], v[88:91]
    v_cvt_pk_bf16_f32 v79, v14, v15
    v_mfma_f32_32x32x16_bf16 a[48:63], a[188:191], a[124:127], a[48:63]
    buffer_load_dwordx4 a[124:127], v205, s[28:31], s57 offen offset:2560
    s_add_u32 s57, s57, 0x8000
    v_mfma_f32_32x32x16_bf16 v[160:175], v[60:63], v[68:71], v[160:175]
    s_nop 0
    v_mfma_f32_16x16x32_bf16 v[92:95], v[4:7], v[76:79], v[92:95]
    s_add_u32 s16, s4, 16777216
    s_addc_u32 s17, s5, 0
    s_mov_b32 s18, 4194304
    s_mov_b32 s19, 0x00020000
    s_nop 3
    v_cmp_nge_f32 vcc, s63, v92
    s_cbranch_vccnz L_p2_s64_go
L_p2_s64_back:
    v_mfma_f32_32x32x16_bf16 v[176:191], v[56:59], v[72:75], v[176:191]
    v_mfma_f32_32x32x16_bf16 v[176:191], v[60:63], v[76:79], v[176:191]
    v_rcp_f32 v192, v84
    v_rcp_f32 v193, v92
    v_mul_f32 v160, v160, v192
    v_mul_f32 v161, v161, v192
    v_mul_f32 v162, v162, v192
    v_mul_f32 v163, v163, v192
    v_mul_f32 v164, v164, v192
    v_mul_f32 v165, v165, v192
    v_mul_f32 v166, v166, v192
    v_mul_f32 v167, v167, v192
    v_mul_f32 v168, v168, v192
    v_mul_f32 v169, v169, v192
    v_mul_f32 v170, v170, v192
    v_mul_f32 v171, v171, v192
    v_mul_f32 v172, v172, v192
    v_mul_f32 v173, v173, v192
    v_mul_f32 v174, v174, v192
    v_mul_f32 v175, v175, v192
    v_cvt_pk_bf16_f32 v96, v160, v161
    v_cvt_pk_bf16_f32 v97, v162, v163
    v_cvt_pk_bf16_f32 v98, v168, v169
    v_cvt_pk_bf16_f32 v99, v170, v171
    buffer_store_dwordx4 v[96:99], v3, s[16:19], s68 offen offset:0 sc1
    v_cvt_pk_bf16_f32 v100, v164, v165
    v_cvt_pk_bf16_f32 v101, v166, v167
    v_cvt_pk_bf16_f32 v102, v172, v173
    v_cvt_pk_bf16_f32 v103, v174, v175
    buffer_store_dwordx4 v[100:103], v3, s[16:19], s68 offen offset:512 sc1
    v_mul_f32 v176, v176, v193
    v_mul_f32 v177, v177, v193
    v_mul_f32 v178, v178, v193
    v_mul_f32 v179, v179, v193
    v_mul_f32 v180, v180, v193
    v_mul_f32 v181, v181, v193
    v_mul_f32 v182, v182, v193
    v_mul_f32 v183, v183, v193
    v_mul_f32 v184, v184, v193
    v_mul_f32 v185, v185, v193
    v_mul_f32 v186, v186, v193
    v_mul_f32 v187, v187, v193
    v_mul_f32 v188, v188, v193
    v_mul_f32 v189, v189, v193
    v_mul_f32 v190, v190, v193
    v_mul_f32 v191, v191, v193
    v_cvt_pk_bf16_f32 v104, v176, v177
    v_cvt_pk_bf16_f32 v105, v178, v179
    v_cvt_pk_bf16_f32 v106, v184, v185
    v_cvt_pk_bf16_f32 v107, v186, v187
    buffer_store_dwordx4 v[104:107], v3, s[16:19], s68 offen offset:2048 sc1
    v_cvt_pk_bf16_f32 v108, v180, v181
    v_cvt_pk_bf16_f32 v109, v182, v183
    v_cvt_pk_bf16_f32 v110, v188, v189
    v_cvt_pk_bf16_f32 v111, v190, v191
    buffer_store_dwordx4 v[108:111], v3, s[16:19], s68 offen offset:2560 sc1
    s_lshl_b32 s74, s36, 13
    v_add_u32 v4, s74, v200
    v_xor_b32 v5, 0x2000, v4
    s_waitcnt vmcnt(12) lgkmcnt(0)
    s_barrier
    v_mfma_f32_32x32x16_bf16 a[0:15], a[128:131], a[64:67], a[0:15]
    ds_read_b64_tr_b16 a[160:161], v202 offset:49152
    ds_read_b64_tr_b16 a[162:163], v202 offset:51200
    v_mfma_f32_32x32x16_bf16 a[16:31], a[132:135], a[64:67], a[16:31]
    ds_read_b64_tr_b16 a[164:165], v203 offset:49152
    ds_read_b64_tr_b16 a[166:167], v203 offset:51200
    v_mfma_f32_32x32x16_bf16 a[32:47], a[128:131], a[72:75], a[32:47]
    ds_read_b64_tr_b16 a[168:169], v202 offset:50176
    ds_read_b64_tr_b16 a[170:171], v202 offset:52224
    v_mfma_f32_32x32x16_bf16 a[48:63], a[132:135], a[72:75], a[48:63]
    ds_read_b64_tr_b16 a[172:173], v203 offset:50176
    ds_read_b64_tr_b16 a[174:175], v203 offset:52224
    v_mfma_f32_32x32x16_bf16 a[0:15], a[136:139], a[68:71], a[0:15]
    ds_read_b64_tr_b16 a[176:177], v202 offset:53248
    ds_read_b64_tr_b16 a[178:179], v202 offset:55296
    v_mfma_f32_32x32x16_bf16 a[16:31], a[140:143], a[68:71], a[16:31]
    ds_read_b64_tr_b16 a[180:181], v203 offset:53248
    ds_read_b64_tr_b16 a[182:183], v203 offset:55296
    v_mfma_f32_32x32x16_bf16 a[32:47], a[136:139], a[76:79], a[32:47]
    ds_read_b64_tr_b16 a[184:185], v202 offset:54272
    ds_read_b64_tr_b16 a[186:187], v202 offset:56320
    v_mfma_f32_32x32x16_bf16 a[48:63], a[140:143], a[76:79], a[48:63]
    ds_read_b64_tr_b16 a[188:189], v203 offset:54272
    ds_read_b64_tr_b16 a[190:191], v203 offset:56320
    v_mfma_f32_32x32x16_bf16 a[0:15], a[144:147], a[80:83], a[0:15]
    v_lshlrev_b32 v144, 16, v220
    v_and_b32 v145, 0xffff0000, v220
    v_lshlrev_b32 v146, 16, v221
    v_and_b32 v147, 0xffff0000, v221
    v_mfma_f32_32x32x16_bf16 a[16:31], a[148:151], a[80:83], a[16:31]
    v_lshlrev_b32 v148, 16, v222
    v_and_b32 v149, 0xffff0000, v222
    v_lshlrev_b32 v150, 16, v223
    v_and_b32 v151, 0xffff0000, v223
    v_mfma_f32_32x32x16_bf16 a[32:47], a[144:147], a[88:91], a[32:47]
    v_lshlrev_b32 v152, 16, v224
    v_and_b32 v153, 0xffff0000, v224
    v_lshlrev_b32 v154, 16, v225
    v_and_b32 v155, 0xffff0000, v225
    v_mfma_f32_32x32x16_bf16 a[48:63], a[148:151], a[88:91], a[48:63]
    v_lshlrev_b32 v156, 16, v226
    v_and_b32 v157, 0xffff0000, v226
    v_lshlrev_b32 v158, 16, v227
    v_and_b32 v159, 0xffff0000, v227
    v_mfma_f32_32x32x16_bf16 a[0:15], a[152:155], a[84:87], a[0:15]
    v_lshlrev_b32 v160, 16, v228
    v_and_b32 v161, 0xffff0000, v228
    v_lshlrev_b32 v162, 16, v229
    v_and_b32 v163, 0xffff0000, v229
    v_mfma_f32_32x32x16_bf16 a[16:31], a[156:159], a[84:87], a[16:31]
    v_lshlrev_b32 v164, 16, v230
    v_and_b32 v165, 0xffff0000, v230
    v_lshlrev_b32 v166, 16, v231
    v_and_b32 v167, 0xffff0000, v231
    v_mfma_f32_32x32x16_bf16 a[32:47], a[152:155], a[92:95], a[32:47]
    v_lshlrev_b32 v168, 16, v232
    v_and_b32 v169, 0xffff0000, v232
    v_lshlrev_b32 v170, 16, v233
    v_and_b32 v171, 0xffff0000, v233
    v_mfma_f32_32x32x16_bf16 a[48:63], a[156:159], a[92:95], a[48:63]
    v_lshlrev_b32 v172, 16, v234
    v_and_b32 v173, 0xffff0000, v234
    v_lshlrev_b32 v174, 16, v235
    v_and_b32 v175, 0xffff0000, v235
    s_waitcnt vmcnt(4) lgkmcnt(0)
    s_and_b32 s74, s36, 1
    s_cmp_lg_u32 s74, 0
    s_cbranch_scc1 L_p2_red1
    v_mfma_f32_32x32x16_bf16 a[32:47], a[160:163], a[104:107], a[32:47]
    v_mfma_f32_32x32x16_bf16 a[32:47], a[168:171], a[108:111], a[32:47]
    v_mfma_f32_32x32x16_bf16 a[32:47], a[176:179], a[120:123], a[32:47]
    v_mfma_f32_32x32x16_bf16 a[32:47], a[184:187], a[124:127], a[32:47]
    v_mfma_f32_32x32x16_bf16 a[48:63], a[164:167], a[104:107], a[48:63]
    v_mfma_f32_32x32x16_bf16 a[48:63], a[172:175], a[108:111], a[48:63]
    v_mfma_f32_32x32x16_bf16 a[48:63], a[180:183], a[120:123], a[48:63]
    v_mfma_f32_32x32x16_bf16 a[48:63], a[188:191], a[124:127], a[48:63]
    v_mfma_f32_32x32x16_bf16 a[0:15], a[160:163], a[96:99], a[0:15]
    v_mfma_f32_32x32x16_bf16 a[0:15], a[168:171], a[100:103], a[0:15]
    v_mfma_f32_32x32x16_bf16 a[0:15], a[176:179], a[112:115], a[0:15]
    v_mfma_f32_32x32x16_bf16 a[0:15], a[184:187], a[116:119], a[0:15]
    v_mfma_f32_32x32x16_bf16 a[16:31], a[164:167], a[96:99], a[16:31]
    ds_write_b128 v5, a[32:35] offset:0
    v_mfma_f32_32x32x16_bf16 a[16:31], a[172:175], a[100:103], a[16:31]
    ds_write_b128 v5, a[36:39] offset:1024
    v_mfma_f32_32x32x16_bf16 a[16:31], a[180:183], a[112:115], a[16:31]
    ds_write_b128 v5, a[40:43] offset:2048
    v_mfma_f32_32x32x16_bf16 a[16:31], a[188:191], a[116:119], a[16:31]
    ds_write_b128 v5, a[44:47] offset:3072
    ds_write_b128 v5, a[48:51] offset:4096
    ds_write_b128 v5, a[52:55] offset:5120
    ds_write_b128 v5, a[56:59] offset:6144
    ds_write_b128 v5, a[60:63] offset:7168
    s_nop 1
    v_accvgpr_read_b32 v48, a0
    v_accvgpr_read_b32 v49, a1
    v_accvgpr_read_b32 v50, a2
    v_accvgpr_read_b32 v51, a3
    v_accvgpr_read_b32 v52, a4
    v_accvgpr_read_b32 v53, a5
    v_accvgpr_read_b32 v54, a6
    v_accvgpr_read_b32 v55, a7
    v_accvgpr_read_b32 v56, a8
    v_accvgpr_read_b32 v57, a9
    v_accvgpr_read_b32 v58, a10
    v_accvgpr_read_b32 v59, a11
    v_accvgpr_read_b32 v60, a12
    v_accvgpr_read_b32 v61, a13
    v_accvgpr_read_b32 v62, a14
    v_accvgpr_read_b32 v63, a15
    v_accvgpr_read_b32 v64, a16
    v_accvgpr_read_b32 v65, a17
    v_accvgpr_read_b32 v66, a18
    v_accvgpr_read_b32 v67, a19
    v_accvgpr_read_b32 v68, a20
    v_accvgpr_read_b32 v69, a21
    v_accvgpr_read_b32 v70, a22
    v_accvgpr_read_b32 v71, a23
    v_accvgpr_read_b32 v72, a24
    v_accvgpr_read_b32 v73, a25
    v_accvgpr_read_b32 v74, a26
    v_accvgpr_read_b32 v75, a27
    v_accvgpr_read_b32 v76, a28
    v_accvgpr_read_b32 v77, a29
    v_accvgpr_read_b32 v78, a30
    v_accvgpr_read_b32 v79, a31
    s_branch L_p2_red_done
L_p2_red1:
    v_mfma_f32_32x32x16_bf16 a[0:15], a[160:163], a[96:99], a[0:15]
    v_mfma_f32_32x32x16_bf16 a[0:15], a[168:171], a[100:103], a[0:15]
    v_mfma_f32_32x32x16_bf16 a[0:15], a[176:179], a[112:115], a[0:15]
    v_mfma_f32_32x32x16_bf16 a[0:15], a[184:187], a[116:119], a[0:15]
    v_mfma_f32_32x32x16_bf16 a[16:31], a[164:167], a[96:99], a[16:31]
    v_mfma_f32_32x32x16_bf16 a[16:31], a[172:175], a[100:103], a[16:31]
    v_mfma_f32_32x32x16_bf16 a[16:31], a[180:183], a[112:115], a[16:31]
    v_mfma_f32_32x32x16_bf16 a[16:31], a[188:191], a[116:119], a[16:31]
    v_mfma_f32_32x32x16_bf16 a[32:47], a[160:163], a[104:107], a[32:47]
    v_mfma_f32_32x32x16_bf16 a[32:47], a[168:171], a[108:111], a[32:47]
    v_mfma_f32_32x32x16_bf16 a[32:47], a[176:179], a[120:123], a[32:47]
    v_mfma_f32_32x32x16_bf16 a[32:47], a[184:187], a[124:127], a[32:47]
    v_mfma_f32_32x32x16_bf16 a[48:63], a[164:167], a[104:107], a[48:63]
    ds_write_b128 v5, a[0:3] offset:0
    v_mfma_f32_32x32x16_bf16 a[48:63], a[172:175], a[108:111], a[48:63]
    ds_write_b128 v5, a[4:7] offset:1024
    v_mfma_f32_32x32x16_bf16 a[48:63], a[180:183], a[120:123], a[48:63]
    ds_write_b128 v5, a[8:11] offset:2048
    v_mfma_f32_32x32x16_bf16 a[48:63], a[188:191], a[124:127], a[48:63]
    ds_write_b128 v5, a[12:15] offset:3072
    ds_write_b128 v5, a[16:19] offset:4096
    ds_write_b128 v5, a[20:23] offset:5120
    ds_write_b128 v5, a[24:27] offset:6144
    ds_write_b128 v5, a[28:31] offset:7168
    s_nop 1
    v_accvgpr_read_b32 v48, a32
    v_accvgpr_read_b32 v49, a33
    v_accvgpr_read_b32 v50, a34
    v_accvgpr_read_b32 v51, a35
    v_accvgpr_read_b32 v52, a36
    v_accvgpr_read_b32 v53, a37
    v_accvgpr_read_b32 v54, a38
    v_accvgpr_read_b32 v55, a39
    v_accvgpr_read_b32 v56, a40
    v_accvgpr_read_b32 v57, a41
    v_accvgpr_read_b32 v58, a42
    v_accvgpr_read_b32 v59, a43
    v_accvgpr_read_b32 v60, a44
    v_accvgpr_read_b32 v61, a45
    v_accvgpr_read_b32 v62, a46
    v_accvgpr_read_b32 v63, a47
    v_accvgpr_read_b32 v64, a48
    v_accvgpr_read_b32 v65, a49
    v_accvgpr_read_b32 v66, a50
    v_accvgpr_read_b32 v67, a51
    v_accvgpr_read_b32 v68, a52
    v_accvgpr_read_b32 v69, a53
    v_accvgpr_read_b32 v70, a54
    v_accvgpr_read_b32 v71, a55
    v_accvgpr_read_b32 v72, a56
    v_accvgpr_read_b32 v73, a57
    v_accvgpr_read_b32 v74, a58
    v_accvgpr_read_b32 v75, a59
    v_accvgpr_read_b32 v76, a60
    v_accvgpr_read_b32 v77, a61
    v_accvgpr_read_b32 v78, a62
    v_accvgpr_read_b32 v79, a63
L_p2_red_done:
    s_waitcnt vmcnt(0) lgkmcnt(0)
    s_barrier
    ds_read_b128 v[96:99], v4 offset:0
    ds_read_b128 v[100:103], v4 offset:1024
    ds_read_b128 v[104:107], v4 offset:2048
    ds_read_b128 v[108:111], v4 offset:3072
    ds_read_b128 v[112:115], v4 offset:4096
    ds_read_b128 v[116:119], v4 offset:5120
    ds_read_b128 v[120:123], v4 offset:6144
    ds_read_b128 v[124:127], v4 offset:7168
    s_cmp_lg_u32 s36, 3
    s_cbranch_scc1 L_p2_nopub
    s_lshl_b32 s75, s38, 10
    v_mov_b32 v212, 1
    v_lshlrev_b32 v213, 7, v0
    s_mov_b64 exec, 0xff
    buffer_atomic_add v212, v213, s[52:55], s75 offen sc1
    s_mov_b64 exec, -1
L_p2_nopub:
    s_lshl_b32 s75, s74, 13
    v_subrev_u32 v202, s75, v202
    v_add_u32 v8, 0x10000, v202
    v_subrev_u32 v203, s75, v203
    v_add_u32 v9, 0x10000, v203
    s_lshl_b32 s75, s74, 11
    v_add_u32 v204, s75, v204
    s_lshl_b32 s75, s39, 18
    s_add_u32 s75, s75, 16777216
    s_add_u32 s28, s4, s75
    s_addc_u32 s29, s5, 0
    s_mov_b32 s30, 262144
    s_mov_b32 s31, 0x00020000
    s_mov_b32 s57, 131072
    s_mov_b32 s20, 0xbfb8aa3b
    s_mov_b32 s21, 0xbfb8aa3b
    s_mov_b32 s22, 1.0
    s_mov_b32 s23, 1.0
    s_lshr_b32 s78, s39, 1
    s_mul_i32 s78, s78, 8
    s_and_b32 s79, s56, 7
    s_add_u32 s78, s78, s79
    s_lshl_b32 s78, s78, 7
    v_mov_b32 v215, s78
    s_lshl_b32 s78, s36, 16
    s_waitcnt lgkmcnt(0)
    s_add_u32 m0, s60, 0
    s_nop 0
    buffer_load_dwordx4 v206, s[40:43], s78 offen offset:0 lds
    v_pk_add_f32 v[48:49], v[48:49], v[96:97]
    v_pk_add_f32 v[50:51], v[50:51], v[98:99]
    v_pk_add_f32 v[52:53], v[52:53], v[100:101]
    v_pk_add_f32 v[54:55], v[54:55], v[102:103]
    v_pk_add_f32 v[56:57], v[56:57], v[104:105]
    v_pk_add_f32 v[58:59], v[58:59], v[106:107]
    v_pk_add_f32 v[60:61], v[60:61], v[108:109]
    buffer_load_dwordx4 v207, s[40:43], s78 offen offset:1024 lds
    v_pk_add_f32 v[62:63], v[62:63], v[110:111]
    v_pk_add_f32 v[64:65], v[64:65], v[112:113]
    v_pk_add_f32 v[66:67], v[66:67], v[114:115]
    v_pk_add_f32 v[68:69], v[68:69], v[116:117]
    v_pk_add_f32 v[70:71], v[70:71], v[118:119]
    v_pk_add_f32 v[72:73], v[72:73], v[120:121]
    v_pk_add_f32 v[74:75], v[74:75], v[122:123]
    buffer_load_dwordx4 v208, s[40:43], s78 offen offset:2048 lds
    v_pk_add_f32 v[76:77], v[76:77], v[124:125]
    v_pk_add_f32 v[78:79], v[78:79], v[126:127]
    v_pk_mul_f32 v[16:17], v[48:49], s[20:21]
    v_pk_mul_f32 v[18:19], v[50:51], s[20:21]
    v_pk_mul_f32 v[20:21], v[52:53], s[20:21]
    v_pk_mul_f32 v[22:23], v[54:55], s[20:21]
    v_pk_mul_f32 v[24:25], v[56:57], s[20:21]
    buffer_load_dwordx4 v209, s[40:43], s78 offen offset:3072 lds
    v_pk_mul_f32 v[26:27], v[58:59], s[20:21]
    v_pk_mul_f32 v[28:29], v[60:61], s[20:21]
    v_pk_mul_f32 v[30:31], v[62:63], s[20:21]
    v_pk_mul_f32 v[32:33], v[64:65], s[20:21]
    v_pk_mul_f32 v[34:35], v[66:67], s[20:21]
    v_pk_mul_f32 v[36:37], v[68:69], s[20:21]
    v_pk_mul_f32 v[38:39], v[70:71], s[20:21]
    s_add_u32 s78, s78, 262144
    s_add_u32 m0, s60, 16384
    s_nop 0
    buffer_load_dwordx4 v206, s[40:43], s78 offen offset:0 lds
    v_pk_mul_f32 v[40:41], v[72:73], s[20:21]
    v_pk_mul_f32 v[42:43], v[74:75], s[20:21]
    v_pk_mul_f32 v[44:45], v[76:77], s[20:21]
    v_pk_mul_f32 v[46:47], v[78:79], s[20:21]
    v_exp_f32 v16, v16
    v_exp_f32 v17, v17
    v_exp_f32 v18, v18
    buffer_load_dwordx4 v207, s[40:43], s78 offen offset:1024 lds
    v_exp_f32 v19, v19
    v_exp_f32 v20, v20
    v_exp_f32 v21, v21
    v_exp_f32 v22, v22
    v_exp_f32 v23, v23
    v_exp_f32 v24, v24
    v_exp_f32 v25, v25
    buffer_load_dwordx4 v208, s[40:43], s78 offen offset:2048 lds
    v_exp_f32 v26, v26
    v_exp_f32 v27, v27
    v_exp_f32 v28, v28
    v_exp_f32 v29, v29
    v_exp_f32 v30, v30
    v_exp_f32 v31, v31
    v_exp_f32 v32, v32
    buffer_load_dwordx4 v209, s[40:43], s78 offen offset:3072 lds
    v_exp_f32 v33, v33
    v_exp_f32 v34, v34
    v_exp_f32 v35, v35
    v_exp_f32 v36, v36
    v_exp_f32 v37, v37
    v_exp_f32 v38, v38
    v_exp_f32 v39, v39
    s_add_u32 s78, s78, 262144
    s_add_u32 m0, s60, 32768
    s_nop 0
    buffer_load_dwordx4 v206, s[40:43], s78 offen offset:0 lds
    v_exp_f32 v40, v40
    v_exp_f32 v41, v41
    v_exp_f32 v42, v42
    v_exp_f32 v43, v43
    v_exp_f32 v44, v44
    v_exp_f32 v45, v45
    v_exp_f32 v46, v46
    buffer_load_dwordx4 v207, s[40:43], s78 offen offset:1024 lds
    v_exp_f32 v47, v47
    v_pk_add_f32 v[16:17], v[16:17], s[22:23]
    v_pk_add_f32 v[18:19], v[18:19], s[22:23]
    v_pk_add_f32 v[20:21], v[20:21], s[22:23]
    v_pk_add_f32 v[22:23], v[22:23], s[22:23]
    v_pk_add_f32 v[24:25], v[24:25], s[22:23]
    v_pk_add_f32 v[26:27], v[26:27], s[22:23]
    buffer_load_dwordx4 v208, s[40:43], s78 offen offset:2048 lds
    v_pk_add_f32 v[28:29], v[28:29], s[22:23]
    v_pk_add_f32 v[30:31], v[30:31], s[22:23]
    v_pk_add_f32 v[32:33], v[32:33], s[22:23]
    v_pk_add_f32 v[34:35], v[34:35], s[22:23]
    v_pk_add_f32 v[36:37], v[36:37], s[22:23]
    v_pk_add_f32 v[38:39], v[38:39], s[22:23]
    v_pk_add_f32 v[40:41], v[40:41], s[22:23]
    buffer_load_dwordx4 v209, s[40:43], s78 offen offset:3072 lds
    v_pk_add_f32 v[42:43], v[42:43], s[22:23]
    v_pk_add_f32 v[44:45], v[44:45], s[22:23]
    v_pk_add_f32 v[46:47], v[46:47], s[22:23]
    v_rcp_f32 v16, v16
    v_rcp_f32 v17, v17
    v_rcp_f32 v18, v18
    v_rcp_f32 v19, v19
    s_add_u32 s78, s78, 262144
    s_add_u32 m0, s60, 49152
    s_nop 0
    buffer_load_dwordx4 v206, s[40:43], s78 offen offset:0 lds
    v_rcp_f32 v20, v20
    v_rcp_f32 v21, v21
    v_rcp_f32 v22, v22
    v_rcp_f32 v23, v23
    v_rcp_f32 v24, v24
    v_rcp_f32 v25, v25
    v_rcp_f32 v26, v26
    buffer_load_dwordx4 v207, s[40:43], s78 offen offset:1024 lds
    v_rcp_f32 v27, v27
    v_rcp_f32 v28, v28
    v_rcp_f32 v29, v29
    v_rcp_f32 v30, v30
    v_rcp_f32 v31, v31
    v_rcp_f32 v32, v32
    v_rcp_f32 v33, v33
    buffer_load_dwordx4 v208, s[40:43], s78 offen offset:2048 lds
    v_rcp_f32 v34, v34
    v_rcp_f32 v35, v35
    v_rcp_f32 v36, v36
    v_rcp_f32 v37, v37
    v_rcp_f32 v38, v38
    v_rcp_f32 v39, v39
    v_rcp_f32 v40, v40
    buffer_load_dwordx4 v209, s[40:43], s78 offen offset:3072 lds
    v_rcp_f32 v41, v41
    v_rcp_f32 v42, v42
    v_rcp_f32 v43, v43
    v_rcp_f32 v44, v44
    v_rcp_f32 v45, v45
    v_rcp_f32 v46, v46
    v_rcp_f32 v47, v47
    s_add_u32 s78, s78, 262144
    v_pk_mul_f32 v[16:17], v[16:17], v[48:49]
    v_pk_mul_f32 v[18:19], v[18:19], v[50:51]
    v_pk_mul_f32 v[20:21], v[20:21], v[52:53]
    v_pk_mul_f32 v[22:23], v[22:23], v[54:55]
    v_pk_mul_f32 v[24:25], v[24:25], v[56:57]
    v_pk_mul_f32 v[26:27], v[26:27], v[58:59]
    v_pk_mul_f32 v[28:29], v[28:29], v[60:61]
    v_pk_mul_f32 v[30:31], v[30:31], v[62:63]
    v_pk_mul_f32 v[32:33], v[32:33], v[64:65]
    v_pk_mul_f32 v[34:35], v[34:35], v[66:67]
    v_pk_mul_f32 v[36:37], v[36:37], v[68:69]
    v_pk_mul_f32 v[38:39], v[38:39], v[70:71]
    v_pk_mul_f32 v[40:41], v[40:41], v[72:73]
    v_pk_mul_f32 v[42:43], v[42:43], v[74:75]
    v_pk_mul_f32 v[44:45], v[44:45], v[76:77]
    v_pk_mul_f32 v[46:47], v[46:47], v[78:79]
    s_cmp_lg_u32 s36, 0
    s_cbranch_scc1 L_p2_nopoll
    s_mov_b32 s74, 65536
L_p2_poll:
    buffer_load_dword v214, v215, s[52:55], 0 offen sc1
    s_sub_u32 s74, s74, 1
    s_cbranch_scc1 L_p2_poll_end
    s_waitcnt vmcnt(0)
    v_cmp_gt_u32 vcc, 32, v214
    s_cbranch_vccnz L_p2_poll
L_p2_poll_end:
L_p2_nopoll:
    s_barrier
    buffer_load_dwordx4 a[0:3], v204, s[28:31], s57 offen offset:0
    buffer_load_dwordx4 a[4:7], v204, s[28:31], s57 offen offset:512
    s_add_u32 s57, s57, 8192
    buffer_load_dwordx4 a[8:11], v204, s[28:31], s57 offen offset:0
    buffer_load_dwordx4 a[12:15], v204, s[28:31], s57 offen offset:512
    s_add_u32 s57, s57, 8192
    buffer_load_dwordx4 a[16:19], v204, s[28:31], s57 offen offset:0
    buffer_load_dwordx4 a[20:23], v204, s[28:31], s57 offen offset:512
    s_add_u32 s57, s57, 8192
    buffer_load_dwordx4 a[24:27], v204, s[28:31], s57 offen offset:0
    buffer_load_dwordx4 a[28:31], v204, s[28:31], s57 offen offset:512
    s_add_u32 s57, s57, 8192
    buffer_load_dwordx4 a[32:35], v204, s[28:31], s57 offen offset:0
    buffer_load_dwordx4 a[36:39], v204, s[28:31], s57 offen offset:512
    s_add_u32 s57, s57, 8192
    ds_read_b64_tr_b16 v[96:97], v8 offset:0
    ds_read_b64_tr_b16 v[98:99], v8 offset:2048
    ds_read_b64_tr_b16 v[100:101], v9 offset:0
    ds_read_b64_tr_b16 v[102:103], v9 offset:2048
    ds_read_b64_tr_b16 v[104:105], v8 offset:1024
    ds_read_b64_tr_b16 v[106:107], v8 offset:3072
    ds_read_b64_tr_b16 v[108:109], v9 offset:1024
    ds_read_b64_tr_b16 v[110:111], v9 offset:3072
    ds_read_b64_tr_b16 v[112:113], v8 offset:4096
    ds_read_b64_tr_b16 v[114:115], v8 offset:6144
    ds_read_b64_tr_b16 v[116:117], v9 offset:4096
    ds_read_b64_tr_b16 v[118:119], v9 offset:6144
    ds_read_b64_tr_b16 v[120:121], v8 offset:5120
    ds_read_b64_tr_b16 v[122:123], v8 offset:7168
    ds_read_b64_tr_b16 v[124:125], v9 offset:5120
    ds_read_b64_tr_b16 v[126:127], v9 offset:7168
    s_waitcnt vmcnt(8) lgkmcnt(8)
    v_mfma_f32_32x32x16_bf16 v[48:63], v[96:99], a[0:3], 0
    ds_read_b64_tr_b16 v[128:129], v8 offset:8192
    ds_read_b64_tr_b16 v[130:131], v8 offset:10240
    buffer_load_dwordx4 a[40:43], v204, s[28:31], s57 offen offset:0
    v_mfma_f32_32x32x16_bf16 v[64:79], v[100:103], a[0:3], 0
    ds_read_b64_tr_b16 v[132:133], v9 offset:8192
    ds_read_b64_tr_b16 v[134:135], v9 offset:10240
    buffer_load_dwordx4 a[44:47], v204, s[28:31], s57 offen offset:512
    s_add_u32 s57, s57, 8192
    v_mfma_f32_32x32x16_bf16 v[48:63], v[104:107], a[4:7], v[48:63]
    ds_read_b64_tr_b16 v[136:137], v8 offset:9216
    ds_read_b64_tr_b16 v[138:139], v8 offset:11264
    buffer_load_dwordx4 a[48:51], v204, s[28:31], s57 offen offset:0
    v_mfma_f32_32x32x16_bf16 v[64:79], v[108:111], a[4:7], v[64:79]
    ds_read_b64_tr_b16 v[140:141], v9 offset:9216
    ds_read_b64_tr_b16 v[142:143], v9 offset:11264
    buffer_load_dwordx4 a[52:55], v204, s[28:31], s57 offen offset:512
    s_add_u32 s57, s57, 8192
    s_waitcnt vmcnt(10) lgkmcnt(8)
    v_mfma_f32_32x32x16_bf16 v[48:63], v[112:115], a[8:11], v[48:63]
    ds_read_b64_tr_b16 v[96:97], v8 offset:12288
    ds_read_b64_tr_b16 v[98:99], v8 offset:14336
    buffer_load_dwordx4 a[56:59], v204, s[28:31], s57 offen offset:0
    v_mfma_f32_32x32x16_bf16 v[64:79], v[116:119], a[8:11], v[64:79]
    ds_read_b64_tr_b16 v[100:101], v9 offset:12288
    ds_read_b64_tr_b16 v[102:103], v9 offset:14336
    buffer_load_dwordx4 a[60:63], v204, s[28:31], s57 offen offset:512
    s_add_u32 s57, s57, 8192
    v_mfma_f32_32x32x16_bf16 v[48:63], v[120:123], a[12:15], v[48:63]
    ds_read_b64_tr_b16 v[104:105], v8 offset:13312
    ds_read_b64_tr_b16 v[106:107], v8 offset:15360
    buffer_load_dwordx4 a[64:67], v204, s[28:31], s57 offen offset:0
    v_mfma_f32_32x32x16_bf16 v[64:79], v[124:127], a[12:15], v[64:79]
    ds_read_b64_tr_b16 v[108:109], v9 offset:13312
    ds_read_b64_tr_b16 v[110:111], v9 offset:15360
    buffer_load_dwordx4 a[68:71], v204, s[28:31], s57 offen offset:512
    s_add_u32 s57, s57, 8192
    s_waitcnt vmcnt(12) lgkmcnt(8)
    v_mfma_f32_32x32x16_bf16 v[48:63], v[128:131], a[16:19], v[48:63]
    ds_read_b64_tr_b16 v[112:113], v8 offset:16384
    ds_read_b64_tr_b16 v[114:115], v8 offset:18432
    buffer_load_dwordx4 a[72:75], v204, s[28:31], s57 offen offset:0
    v_mfma_f32_32x32x16_bf16 v[64:79], v[132:135], a[16:19], v[64:79]
    ds_read_b64_tr_b16 v[116:117], v9 offset:16384
    ds_read_b64_tr_b16 v[118:119], v9 offset:18432
    buffer_load_dwordx4 a[76:79], v204, s[28:31], s57 offen offset:512
    s_add_u32 s57, s57, 8192
    v_mfma_f32_32x32x16_bf16 v[48:63], v[136:139], a[20:23], v[48:63]
    ds_read_b64_tr_b16 v[120:121], v8 offset:17408
    ds_read_b64_tr_b16 v[122:123], v8 offset:19456
    buffer_load_dwordx4 a[80:83], v204, s[28:31], s57 offen offset:0
    v_mfma_f32_32x32x16_bf16 v[64:79], v[140:143], a[20:23], v[64:79]
    ds_read_b64_tr_b16 v[124:125], v9 offset:17408
    ds_read_b64_tr_b16 v[126:127], v9 offset:19456
    buffer_load_dwordx4 a[84:87], v204, s[28:31], s57 offen offset:512
    s_add_u32 s57, s57, 8192
    s_waitcnt vmcnt(14) lgkmcnt(8)
    v_mfma_f32_32x32x16_bf16 v[48:63], v[96:99], a[24:27], v[48:63]
    ds_read_b64_tr_b16 v[128:129], v8 offset:20480
    ds_read_b64_tr_b16 v[130:131], v8 offset:22528
    buffer_load_dwordx4 a[88:91], v204, s[28:31], s57 offen offset:0
    v_mfma_f32_32x32x16_bf16 v[64:79], v[100:103], a[24:27], v[64:79]
    ds_read_b64_tr_b16 v[132:133], v9 offset:20480
    ds_read_b64_tr_b16 v[134:135], v9 offset:22528
    buffer_load_dwordx4 a[92:95], v204, s[28:31], s57 offen offset:512
    s_add_u32 s57, s57, 8192
    v_mfma_f32_32x32x16_bf16 v[48:63], v[104:107], a[28:31], v[48:63]
    ds_read_b64_tr_b16 v[136:137], v8 offset:21504
    ds_read_b64_tr_b16 v[138:139], v8 offset:23552
    buffer_load_dwordx4 a[96:99], v204, s[28:31], s57 offen offset:0
    v_mfma_f32_32x32x16_bf16 v[64:79], v[108:111], a[28:31], v[64:79]
    ds_read_b64_tr_b16 v[140:141], v9 offset:21504
    ds_read_b64_tr_b16 v[142:143], v9 offset:23552
    buffer_load_dwordx4 a[100:103], v204, s[28:31], s57 offen offset:512
    s_add_u32 s57, s57, 8192
    s_waitcnt vmcnt(16) lgkmcnt(8)
    v_mfma_f32_32x32x16_bf16 v[48:63], v[112:115], a[32:35], v[48:63]
    ds_read_b64_tr_b16 v[96:97], v8 offset:24576
    ds_read_b64_tr_b16 v[98:99], v8 offset:26624
    buffer_load_dwordx4 a[104:107], v204, s[28:31], s57 offen offset:0
    v_mfma_f32_32x32x16_bf16 v[64:79], v[116:119], a[32:35], v[64:79]
    ds_read_b64_tr_b16 v[100:101], v9 offset:24576
    ds_read_b64_tr_b16 v[102:103], v9 offset:26624
    buffer_load_dwordx4 a[108:111], v204, s[28:31], s57 offen offset:512
    s_add_u32 s57, s57, 8192
    v_mfma_f32_32x32x16_bf16 v[48:63], v[120:123], a[36:39], v[48:63]
    ds_read_b64_tr_b16 v[104:105], v8 offset:25600
    ds_read_b64_tr_b16 v[106:107], v8 offset:27648
    buffer_load_dwordx4 a[112:115], v204, s[28:31], s57 offen offset:0
    v_mfma_f32_32x32x16_bf16 v[64:79], v[124:127], a[36:39], v[64:79]
    ds_read_b64_tr_b16 v[108:109], v9 offset:25600
    ds_read_b64_tr_b16 v[110:111], v9 offset:27648
    buffer_load_dwordx4 a[116:119], v204, s[28:31], s57 offen offset:512
    s_add_u32 s57, s57, 8192
    s_waitcnt vmcnt(18) lgkmcnt(8)
    v_mfma_f32_32x32x16_bf16 v[48:63], v[128:131], a[40:43], v[48:63]
    ds_read_b64_tr_b16 v[112:113], v8 offset:28672
    ds_read_b64_tr_b16 v[114:115], v8 offset:30720
    buffer_load_dwordx4 a[120:123], v204, s[28:31], s57 offen offset:0
    v_mfma_f32_32x32x16_bf16 v[64:79], v[132:135], a[40:43], v[64:79]
    ds_read_b64_tr_b16 v[116:117], v9 offset:28672
    ds_read_b64_tr_b16 v[118:119], v9 offset:30720
    buffer_load_dwordx4 a[124:127], v204, s[28:31], s57 offen offset:512
    s_mov_b32 s57, 0
    v_mfma_f32_32x32x16_bf16 v[48:63], v[136:139], a[44:47], v[48:63]
    ds_read_b64_tr_b16 v[120:121], v8 offset:29696
    ds_read_b64_tr_b16 v[122:123], v8 offset:31744
    buffer_load_dwordx4 a[128:131], v204, s[28:31], s57 offen offset:0
    v_mfma_f32_32x32x16_bf16 v[64:79], v[140:143], a[44:47], v[64:79]
    ds_read_b64_tr_b16 v[124:125], v9 offset:29696
    ds_read_b64_tr_b16 v[126:127], v9 offset:31744
    buffer_load_dwordx4 a[132:135], v204, s[28:31], s57 offen offset:512
    s_add_u32 s57, s57, 8192
    s_waitcnt vmcnt(20) lgkmcnt(8)
    v_mfma_f32_32x32x16_bf16 v[48:63], v[96:99], a[48:51], v[48:63]
    ds_read_b64_tr_b16 v[128:129], v8 offset:32768
    ds_read_b64_tr_b16 v[130:131], v8 offset:34816
    buffer_load_dwordx4 a[136:139], v204, s[28:31], s57 offen offset:0
    v_mfma_f32_32x32x16_bf16 v[64:79], v[100:103], a[48:51], v[64:79]
    ds_read_b64_tr_b16 v[132:133], v9 offset:32768
    ds_read_b64_tr_b16 v[134:135], v9 offset:34816
    buffer_load_dwordx4 a[140:143], v204, s[28:31], s57 offen offset:512
    s_add_u32 s57, s57, 8192
    v_mfma_f32_32x32x16_bf16 v[48:63], v[104:107], a[52:55], v[48:63]
    ds_read_b64_tr_b16 v[136:137], v8 offset:33792
    ds_read_b64_tr_b16 v[138:139], v8 offset:35840
    buffer_load_dwordx4 a[144:147], v204, s[28:31], s57 offen offset:0
    v_mfma_f32_32x32x16_bf16 v[64:79], v[108:111], a[52:55], v[64:79]
    ds_read_b64_tr_b16 v[140:141], v9 offset:33792
    ds_read_b64_tr_b16 v[142:143], v9 offset:35840
    buffer_load_dwordx4 a[148:151], v204, s[28:31], s57 offen offset:512
    s_add_u32 s57, s57, 8192
    s_waitcnt vmcnt(22) lgkmcnt(8)
    v_mfma_f32_32x32x16_bf16 v[48:63], v[112:115], a[56:59], v[48:63]
    ds_read_b64_tr_b16 v[96:97], v8 offset:36864
    ds_read_b64_tr_b16 v[98:99], v8 offset:38912
    buffer_load_dwordx4 a[152:155], v204, s[28:31], s57 offen offset:0
    v_mfma_f32_32x32x16_bf16 v[64:79], v[116:119], a[56:59], v[64:79]
    ds_read_b64_tr_b16 v[100:101], v9 offset:36864
    ds_read_b64_tr_b16 v[102:103], v9 offset:38912
    v_mfma_f32_32x32x16_bf16 v[48:63], v[120:123], a[60:63], v[48:63]
    ds_read_b64_tr_b16 v[104:105], v8 offset:37888
    ds_read_b64_tr_b16 v[106:107], v8 offset:39936
    buffer_load_dwordx4 a[156:159], v204, s[28:31], s57 offen offset:512
    s_add_u32 s57, s57, 8192
    v_mfma_f32_32x32x16_bf16 v[64:79], v[124:127], a[60:63], v[64:79]
    ds_read_b64_tr_b16 v[108:109], v9 offset:37888
    ds_read_b64_tr_b16 v[110:111], v9 offset:39936
    s_waitcnt vmcnt(22) lgkmcnt(8)
    v_mfma_f32_32x32x16_bf16 v[48:63], v[128:131], a[64:67], v[48:63]
    ds_read_b64_tr_b16 v[112:113], v8 offset:40960
    ds_read_b64_tr_b16 v[114:115], v8 offset:43008
    buffer_load_dwordx4 a[160:163], v204, s[28:31], s57 offen offset:0
    v_mfma_f32_32x32x16_bf16 v[64:79], v[132:135], a[64:67], v[64:79]
    ds_read_b64_tr_b16 v[116:117], v9 offset:40960
    ds_read_b64_tr_b16 v[118:119], v9 offset:43008
    v_mfma_f32_32x32x16_bf16 v[48:63], v[136:139], a[68:71], v[48:63]
    ds_read_b64_tr_b16 v[120:121], v8 offset:41984
    ds_read_b64_tr_b16 v[122:123], v8 offset:44032
    buffer_load_dwordx4 a[164:167], v204, s[28:31], s57 offen offset:512
    s_add_u32 s57, s57, 8192
    v_mfma_f32_32x32x16_bf16 v[64:79], v[140:143], a[68:71], v[64:79]
    ds_read_b64_tr_b16 v[124:125], v9 offset:41984
    ds_read_b64_tr_b16 v[126:127], v9 offset:44032
    s_waitcnt vmcnt(22) lgkmcnt(8)
    v_mfma_f32_32x32x16_bf16 v[48:63], v[96:99], a[72:75], v[48:63]
    ds_read_b64_tr_b16 v[128:129], v8 offset:45056
    ds_read_b64_tr_b16 v[130:131], v8 offset:47104
    buffer_load_dwordx4 a[168:171], v204, s[28:31], s57 offen offset:0
    v_mfma_f32_32x32x16_bf16 v[64:79], v[100:103], a[72:75], v[64:79]
    ds_read_b64_tr_b16 v[132:133], v9 offset:45056
    ds_read_b64_tr_b16 v[134:135], v9 offset:47104
    v_mfma_f32_32x32x16_bf16 v[48:63], v[104:107], a[76:79], v[48:63]
    ds_read_b64_tr_b16 v[136:137], v8 offset:46080
    ds_read_b64_tr_b16 v[138:139], v8 offset:48128
    buffer_load_dwordx4 a[172:175], v204, s[28:31], s57 offen offset:512
    s_add_u32 s57, s57, 8192
    v_mfma_f32_32x32x16_bf16 v[64:79], v[108:111], a[76:79], v[64:79]
    ds_read_b64_tr_b16 v[140:141], v9 offset:46080
    ds_read_b64_tr_b16 v[142:143], v9 offset:48128
    s_waitcnt vmcnt(22) lgkmcnt(8)
    v_mfma_f32_32x32x16_bf16 v[48:63], v[112:115], a[80:83], v[48:63]
    ds_read_b64_tr_b16 v[96:97], v8 offset:49152
    ds_read_b64_tr_b16 v[98:99], v8 offset:51200
    buffer_load_dwordx4 a[176:179], v204, s[28:31], s57 offen offset:0
    v_mfma_f32_32x32x16_bf16 v[64:79], v[116:119], a[80:83], v[64:79]
    ds_read_b64_tr_b16 v[100:101], v9 offset:49152
    ds_read_b64_tr_b16 v[102:103], v9 offset:51200
    v_mfma_f32_32x32x16_bf16 v[48:63], v[120:123], a[84:87], v[48:63]
    ds_read_b64_tr_b16 v[104:105], v8 offset:50176
    ds_read_b64_tr_b16 v[106:107], v8 offset:52224
    buffer_load_dwordx4 a[180:183], v204, s[28:31], s57 offen offset:512
    s_add_u32 s57, s57, 8192
    v_mfma_f32_32x32x16_bf16 v[64:79], v[124:127], a[84:87], v[64:79]
    ds_read_b64_tr_b16 v[108:109], v9 offset:50176
    ds_read_b64_tr_b16 v[110:111], v9 offset:52224
    s_waitcnt vmcnt(22) lgkmcnt(8)
    v_mfma_f32_32x32x16_bf16 v[48:63], v[128:131], a[88:91], v[48:63]
    ds_read_b64_tr_b16 v[112:113], v8 offset:53248
    ds_read_b64_tr_b16 v[114:115], v8 offset:55296
    buffer_load_dwordx4 a[184:187], v204, s[28:31], s57 offen offset:0
    v_mfma_f32_32x32x16_bf16 v[64:79], v[132:135], a[88:91], v[64:79]
    ds_read_b64_tr_b16 v[116:117], v9 offset:53248
    ds_read_b64_tr_b16 v[118:119], v9 offset:55296
    v_mfma_f32_32x32x16_bf16 v[48:63], v[136:139], a[92:95], v[48:63]
    ds_read_b64_tr_b16 v[120:121], v8 offset:54272
    ds_read_b64_tr_b16 v[122:123], v8 offset:56320
    buffer_load_dwordx4 a[188:191], v204, s[28:31], s57 offen offset:512
    s_add_u32 s57, s57, 8192
    v_mfma_f32_32x32x16_bf16 v[64:79], v[140:143], a[92:95], v[64:79]
    ds_read_b64_tr_b16 v[124:125], v9 offset:54272
    ds_read_b64_tr_b16 v[126:127], v9 offset:56320
    s_waitcnt vmcnt(22) lgkmcnt(8)
    v_mfma_f32_32x32x16_bf16 v[48:63], v[96:99], a[96:99], v[48:63]
    ds_read_b64_tr_b16 v[128:129], v8 offset:57344
    ds_read_b64_tr_b16 v[130:131], v8 offset:59392
    buffer_load_dwordx4 a[0:3], v204, s[28:31], s57 offen offset:0
    v_mfma_f32_32x32x16_bf16 v[64:79], v[100:103], a[96:99], v[64:79]
    ds_read_b64_tr_b16 v[132:133], v9 offset:57344
    ds_read_b64_tr_b16 v[134:135], v9 offset:59392
    v_mfma_f32_32x32x16_bf16 v[48:63], v[104:107], a[100:103], v[48:63]
    ds_read_b64_tr_b16 v[136:137], v8 offset:58368
    ds_read_b64_tr_b16 v[138:139], v8 offset:60416
    buffer_load_dwordx4 a[4:7], v204, s[28:31], s57 offen offset:512
    s_add_u32 s57, s57, 8192
    v_mfma_f32_32x32x16_bf16 v[64:79], v[108:111], a[100:103], v[64:79]
    ds_read_b64_tr_b16 v[140:141], v9 offset:58368
    ds_read_b64_tr_b16 v[142:143], v9 offset:60416
    s_waitcnt vmcnt(22) lgkmcnt(8)
    v_mfma_f32_32x32x16_bf16 v[48:63], v[112:115], a[104:107], v[48:63]
    ds_read_b64_tr_b16 v[96:97], v8 offset:61440
    ds_read_b64_tr_b16 v[98:99], v8 offset:63488
    buffer_load_dwordx4 a[8:11], v204, s[28:31], s57 offen offset:0
    v_mfma_f32_32x32x16_bf16 v[64:79], v[116:119], a[104:107], v[64:79]
    ds_read_b64_tr_b16 v[100:101], v9 offset:61440
    ds_read_b64_tr_b16 v[102:103], v9 offset:63488
    v_mfma_f32_32x32x16_bf16 v[48:63], v[120:123], a[108:111], v[48:63]
    ds_read_b64_tr_b16 v[104:105], v8 offset:62464
    ds_read_b64_tr_b16 v[106:107], v8 offset:64512
    buffer_load_dwordx4 a[12:15], v204, s[28:31], s57 offen offset:512
    s_add_u32 s57, s57, 8192
    v_mfma_f32_32x32x16_bf16 v[64:79], v[124:127], a[108:111], v[64:79]
    ds_read_b64_tr_b16 v[108:109], v9 offset:62464
    ds_read_b64_tr_b16 v[110:111], v9 offset:64512
    s_waitcnt vmcnt(22) lgkmcnt(8)
    s_barrier
    v_mfma_f32_32x32x16_bf16 v[48:63], v[128:131], a[112:115], v[48:63]
    ds_read_b64_tr_b16 v[112:113], v202 offset:0
    ds_read_b64_tr_b16 v[114:115], v202 offset:2048
    buffer_load_dwordx4 a[16:19], v204, s[28:31], s57 offen offset:0
    v_mfma_f32_32x32x16_bf16 v[64:79], v[132:135], a[112:115], v[64:79]
    ds_read_b64_tr_b16 v[116:117], v203 offset:0
    ds_read_b64_tr_b16 v[118:119], v203 offset:2048
    v_mfma_f32_32x32x16_bf16 v[48:63], v[136:139], a[116:119], v[48:63]
    ds_read_b64_tr_b16 v[120:121], v202 offset:1024
    ds_read_b64_tr_b16 v[122:123], v202 offset:3072
    buffer_load_dwordx4 a[20:23], v204, s[28:31], s57 offen offset:512
    s_add_u32 s57, s57, 8192
    v_mfma_f32_32x32x16_bf16 v[64:79], v[140:143], a[116:119], v[64:79]
    ds_read_b64_tr_b16 v[124:125], v203 offset:1024
    ds_read_b64_tr_b16 v[126:127], v203 offset:3072
    s_waitcnt vmcnt(22) lgkmcnt(8)
    v_mfma_f32_32x32x16_bf16 v[48:63], v[96:99], a[120:123], v[48:63]
    ds_read_b64_tr_b16 v[128:129], v202 offset:4096
    ds_read_b64_tr_b16 v[130:131], v202 offset:6144
    buffer_load_dwordx4 a[24:27], v204, s[28:31], s57 offen offset:0
    v_mfma_f32_32x32x16_bf16 v[64:79], v[100:103], a[120:123], v[64:79]
    ds_read_b64_tr_b16 v[132:133], v203 offset:4096
    ds_read_b64_tr_b16 v[134:135], v203 offset:6144
    v_mfma_f32_32x32x16_bf16 v[48:63], v[104:107], a[124:127], v[48:63]
    ds_read_b64_tr_b16 v[136:137], v202 offset:5120
    ds_read_b64_tr_b16 v[138:139], v202 offset:7168
    buffer_load_dwordx4 a[28:31], v204, s[28:31], s57 offen offset:512
    s_add_u32 s57, s57, 8192
    v_mfma_f32_32x32x16_bf16 v[64:79], v[108:111], a[124:127], v[64:79]
    ds_read_b64_tr_b16 v[140:141], v203 offset:5120
    ds_read_b64_tr_b16 v[142:143], v203 offset:7168
    s_waitcnt vmcnt(22) lgkmcnt(8)
    v_mfma_f32_32x32x16_bf16 v[48:63], v[112:115], a[128:131], v[48:63]
    ds_read_b64_tr_b16 v[96:97], v202 offset:8192
    ds_read_b64_tr_b16 v[98:99], v202 offset:10240
    buffer_load_dwordx4 a[32:35], v204, s[28:31], s57 offen offset:0
    v_mfma_f32_32x32x16_bf16 v[64:79], v[116:119], a[128:131], v[64:79]
    ds_read_b64_tr_b16 v[100:101], v203 offset:8192
    ds_read_b64_tr_b16 v[102:103], v203 offset:10240
    v_mfma_f32_32x32x16_bf16 v[48:63], v[120:123], a[132:135], v[48:63]
    ds_read_b64_tr_b16 v[104:105], v202 offset:9216
    ds_read_b64_tr_b16 v[106:107], v202 offset:11264
    buffer_load_dwordx4 a[36:39], v204, s[28:31], s57 offen offset:512
    s_add_u32 s57, s57, 8192
    v_mfma_f32_32x32x16_bf16 v[64:79], v[124:127], a[132:135], v[64:79]
    ds_read_b64_tr_b16 v[108:109], v203 offset:9216
    ds_read_b64_tr_b16 v[110:111], v203 offset:11264
    s_waitcnt vmcnt(22) lgkmcnt(8)
    v_mfma_f32_32x32x16_bf16 v[48:63], v[128:131], a[136:139], v[48:63]
    ds_read_b64_tr_b16 v[112:113], v202 offset:12288
    ds_read_b64_tr_b16 v[114:115], v202 offset:14336
    buffer_load_dwordx4 a[40:43], v204, s[28:31], s57 offen offset:0
    v_mfma_f32_32x32x16_bf16 v[64:79], v[132:135], a[136:139], v[64:79]
    ds_read_b64_tr_b16 v[116:117], v203 offset:12288
    ds_read_b64_tr_b16 v[118:119], v203 offset:14336
    v_mfma_f32_32x32x16_bf16 v[48:63], v[136:139], a[140:143], v[48:63]
    ds_read_b64_tr_b16 v[120:121], v202 offset:13312
    ds_read_b64_tr_b16 v[122:123], v202 offset:15360
    buffer_load_dwordx4 a[44:47], v204, s[28:31], s57 offen offset:512
    s_add_u32 s57, s57, 8192
    v_mfma_f32_32x32x16_bf16 v[64:79], v[140:143], a[140:143], v[64:79]
    ds_read_b64_tr_b16 v[124:125], v203 offset:13312
    ds_read_b64_tr_b16 v[126:127], v203 offset:15360
    s_waitcnt vmcnt(22) lgkmcnt(8)
    v_mfma_f32_32x32x16_bf16 v[48:63], v[96:99], a[144:147], v[48:63]
    ds_read_b64_tr_b16 v[128:129], v202 offset:16384
    ds_read_b64_tr_b16 v[130:131], v202 offset:18432
    buffer_load_dwordx4 a[48:51], v204, s[28:31], s57 offen offset:0
    v_mfma_f32_32x32x16_bf16 v[64:79], v[100:103], a[144:147], v[64:79]
    ds_read_b64_tr_b16 v[132:133], v203 offset:16384
    ds_read_b64_tr_b16 v[134:135], v203 offset:18432
    v_mfma_f32_32x32x16_bf16 v[48:63], v[104:107], a[148:151], v[48:63]
    ds_read_b64_tr_b16 v[136:137], v202 offset:17408
    ds_read_b64_tr_b16 v[138:139], v202 offset:19456
    buffer_load_dwordx4 a[52:55], v204, s[28:31], s57 offen offset:512
    s_add_u32 s57, s57, 8192
    v_mfma_f32_32x32x16_bf16 v[64:79], v[108:111], a[148:151], v[64:79]
    ds_read_b64_tr_b16 v[140:141], v203 offset:17408
    ds_read_b64_tr_b16 v[142:143], v203 offset:19456
    s_waitcnt vmcnt(22) lgkmcnt(8)
    v_mfma_f32_32x32x16_bf16 v[48:63], v[112:115], a[152:155], v[48:63]
    ds_read_b64_tr_b16 v[96:97], v202 offset:20480
    ds_read_b64_tr_b16 v[98:99], v202 offset:22528
    buffer_load_dwordx4 a[56:59], v204, s[28:31], s57 offen offset:0
    v_mfma_f32_32x32x16_bf16 v[64:79], v[116:119], a[152:155], v[64:79]
    ds_read_b64_tr_b16 v[100:101], v203 offset:20480
    ds_read_b64_tr_b16 v[102:103], v203 offset:22528
    v_mfma_f32_32x32x16_bf16 v[48:63], v[120:123], a[156:159], v[48:63]
    ds_read_b64_tr_b16 v[104:105], v202 offset:21504
    ds_read_b64_tr_b16 v[106:107], v202 offset:23552
    buffer_load_dwordx4 a[60:63], v204, s[28:31], s57 offen offset:512
    s_add_u32 s57, s57, 8192
    v_mfma_f32_32x32x16_bf16 v[64:79], v[124:127], a[156:159], v[64:79]
    ds_read_b64_tr_b16 v[108:109], v203 offset:21504
    ds_read_b64_tr_b16 v[110:111], v203 offset:23552
    s_waitcnt vmcnt(22) lgkmcnt(8)
    v_mfma_f32_32x32x16_bf16 v[48:63], v[128:131], a[160:163], v[48:63]
    ds_read_b64_tr_b16 v[112:113], v202 offset:24576
    ds_read_b64_tr_b16 v[114:115], v202 offset:26624
    v_mfma_f32_32x32x16_bf16 v[64:79], v[132:135], a[160:163], v[64:79]
    ds_read_b64_tr_b16 v[116:117], v203 offset:24576
    ds_read_b64_tr_b16 v[118:119], v203 offset:26624
    v_mfma_f32_32x32x16_bf16 v[48:63], v[136:139], a[164:167], v[48:63]
    ds_read_b64_tr_b16 v[120:121], v202 offset:25600
    ds_read_b64_tr_b16 v[122:123], v202 offset:27648
    v_mfma_f32_32x32x16_bf16 v[64:79], v[140:143], a[164:167], v[64:79]
    ds_read_b64_tr_b16 v[124:125], v203 offset:25600
    ds_read_b64_tr_b16 v[126:127], v203 offset:27648
    s_waitcnt vmcnt(20) lgkmcnt(8)
    v_mfma_f32_32x32x16_bf16 v[48:63], v[96:99], a[168:171], v[48:63]
    ds_read_b64_tr_b16 v[128:129], v202 offset:28672
    ds_read_b64_tr_b16 v[130:131], v202 offset:30720
    v_mfma_f32_32x32x16_bf16 v[64:79], v[100:103], a[168:171], v[64:79]
    ds_read_b64_tr_b16 v[132:133], v203 offset:28672
    ds_read_b64_tr_b16 v[134:135], v203 offset:30720
    v_mfma_f32_32x32x16_bf16 v[48:63], v[104:107], a[172:175], v[48:63]
    ds_read_b64_tr_b16 v[136:137], v202 offset:29696
    ds_read_b64_tr_b16 v[138:139], v202 offset:31744
    v_mfma_f32_32x32x16_bf16 v[64:79], v[108:111], a[172:175], v[64:79]
    ds_read_b64_tr_b16 v[140:141], v203 offset:29696
    ds_read_b64_tr_b16 v[142:143], v203 offset:31744
    s_waitcnt vmcnt(18) lgkmcnt(8)
    v_mfma_f32_32x32x16_bf16 v[48:63], v[112:115], a[176:179], v[48:63]
    ds_read_b64_tr_b16 v[96:97], v202 offset:32768
    ds_read_b64_tr_b16 v[98:99], v202 offset:34816
    v_mfma_f32_32x32x16_bf16 v[64:79], v[116:119], a[176:179], v[64:79]
    ds_read_b64_tr_b16 v[100:101], v203 offset:32768
    ds_read_b64_tr_b16 v[102:103], v203 offset:34816
    v_mfma_f32_32x32x16_bf16 v[48:63], v[120:123], a[180:183], v[48:63]
    ds_read_b64_tr_b16 v[104:105], v202 offset:33792
    ds_read_b64_tr_b16 v[106:107], v202 offset:35840
    v_mfma_f32_32x32x16_bf16 v[64:79], v[124:127], a[180:183], v[64:79]
    ds_read_b64_tr_b16 v[108:109], v203 offset:33792
    ds_read_b64_tr_b16 v[110:111], v203 offset:35840
    s_waitcnt vmcnt(16) lgkmcnt(8)
    v_mfma_f32_32x32x16_bf16 v[48:63], v[128:131], a[184:187], v[48:63]
    ds_read_b64_tr_b16 v[112:113], v202 offset:36864
    ds_read_b64_tr_b16 v[114:115], v202 offset:38912
    v_mfma_f32_32x32x16_bf16 v[64:79], v[132:135], a[184:187], v[64:79]
    ds_read_b64_tr_b16 v[116:117], v203 offset:36864
    ds_read_b64_tr_b16 v[118:119], v203 offset:38912
    v_mfma_f32_32x32x16_bf16 v[48:63], v[136:139], a[188:191], v[48:63]
    ds_read_b64_tr_b16 v[120:121], v202 offset:37888
    ds_read_b64_tr_b16 v[122:123], v202 offset:39936
    v_mfma_f32_32x32x16_bf16 v[64:79], v[140:143], a[188:191], v[64:79]
    ds_read_b64_tr_b16 v[124:125], v203 offset:37888
    ds_read_b64_tr_b16 v[126:127], v203 offset:39936
    s_waitcnt vmcnt(14) lgkmcnt(8)
    v_mfma_f32_32x32x16_bf16 v[48:63], v[96:99], a[0:3], v[48:63]
    ds_read_b64_tr_b16 v[128:129], v202 offset:40960
    ds_read_b64_tr_b16 v[130:131], v202 offset:43008
    v_mfma_f32_32x32x16_bf16 v[64:79], v[100:103], a[0:3], v[64:79]
    ds_read_b64_tr_b16 v[132:133], v203 offset:40960
    ds_read_b64_tr_b16 v[134:135], v203 offset:43008
    v_mfma_f32_32x32x16_bf16 v[48:63], v[104:107], a[4:7], v[48:63]
    ds_read_b64_tr_b16 v[136:137], v202 offset:41984
    ds_read_b64_tr_b16 v[138:139], v202 offset:44032
    v_mfma_f32_32x32x16_bf16 v[64:79], v[108:111], a[4:7], v[64:79]
    ds_read_b64_tr_b16 v[140:141], v203 offset:41984
    ds_read_b64_tr_b16 v[142:143], v203 offset:44032
    s_waitcnt vmcnt(12) lgkmcnt(8)
    v_mfma_f32_32x32x16_bf16 v[48:63], v[112:115], a[8:11], v[48:63]
    ds_read_b64_tr_b16 v[96:97], v202 offset:45056
    ds_read_b64_tr_b16 v[98:99], v202 offset:47104
    v_mfma_f32_32x32x16_bf16 v[64:79], v[116:119], a[8:11], v[64:79]
    ds_read_b64_tr_b16 v[100:101], v203 offset:45056
    ds_read_b64_tr_b16 v[102:103], v203 offset:47104
    v_mfma_f32_32x32x16_bf16 v[48:63], v[120:123], a[12:15], v[48:63]
    ds_read_b64_tr_b16 v[104:105], v202 offset:46080
    ds_read_b64_tr_b16 v[106:107], v202 offset:48128
    v_mfma_f32_32x32x16_bf16 v[64:79], v[124:127], a[12:15], v[64:79]
    ds_read_b64_tr_b16 v[108:109], v203 offset:46080
    ds_read_b64_tr_b16 v[110:111], v203 offset:48128
    s_waitcnt vmcnt(10) lgkmcnt(8)
    v_mfma_f32_32x32x16_bf16 v[48:63], v[128:131], a[16:19], v[48:63]
    ds_read_b64_tr_b16 v[112:113], v202 offset:49152
    ds_read_b64_tr_b16 v[114:115], v202 offset:51200
    v_mfma_f32_32x32x16_bf16 v[64:79], v[132:135], a[16:19], v[64:79]
    ds_read_b64_tr_b16 v[116:117], v203 offset:49152
    ds_read_b64_tr_b16 v[118:119], v203 offset:51200
    v_mfma_f32_32x32x16_bf16 v[48:63], v[136:139], a[20:23], v[48:63]
    ds_read_b64_tr_b16 v[120:121], v202 offset:50176
    ds_read_b64_tr_b16 v[122:123], v202 offset:52224
    v_mfma_f32_32x32x16_bf16 v[64:79], v[140:143], a[20:23], v[64:79]
    ds_read_b64_tr_b16 v[124:125], v203 offset:50176
    ds_read_b64_tr_b16 v[126:127], v203 offset:52224
    s_waitcnt vmcnt(8) lgkmcnt(8)
    v_mfma_f32_32x32x16_bf16 v[48:63], v[96:99], a[24:27], v[48:63]
    ds_read_b64_tr_b16 v[128:129], v202 offset:53248
    ds_read_b64_tr_b16 v[130:131], v202 offset:55296
    v_mfma_f32_32x32x16_bf16 v[64:79], v[100:103], a[24:27], v[64:79]
    ds_read_b64_tr_b16 v[132:133], v203 offset:53248
    ds_read_b64_tr_b16 v[134:135], v203 offset:55296
    v_mfma_f32_32x32x16_bf16 v[48:63], v[104:107], a[28:31], v[48:63]
    ds_read_b64_tr_b16 v[136:137], v202 offset:54272
    ds_read_b64_tr_b16 v[138:139], v202 offset:56320
    v_mfma_f32_32x32x16_bf16 v[64:79], v[108:111], a[28:31], v[64:79]
    ds_read_b64_tr_b16 v[140:141], v203 offset:54272
    ds_read_b64_tr_b16 v[142:143], v203 offset:56320
    s_waitcnt vmcnt(6) lgkmcnt(8)
    v_mfma_f32_32x32x16_bf16 v[48:63], v[112:115], a[32:35], v[48:63]
    ds_read_b64_tr_b16 v[96:97], v202 offset:57344
    ds_read_b64_tr_b16 v[98:99], v202 offset:59392
    v_mfma_f32_32x32x16_bf16 v[64:79], v[116:119], a[32:35], v[64:79]
    ds_read_b64_tr_b16 v[100:101], v203 offset:57344
    ds_read_b64_tr_b16 v[102:103], v203 offset:59392
    v_mfma_f32_32x32x16_bf16 v[48:63], v[120:123], a[36:39], v[48:63]
    ds_read_b64_tr_b16 v[104:105], v202 offset:58368
    ds_read_b64_tr_b16 v[106:107], v202 offset:60416
    v_mfma_f32_32x32x16_bf16 v[64:79], v[124:127], a[36:39], v[64:79]
    ds_read_b64_tr_b16 v[108:109], v203 offset:58368
    ds_read_b64_tr_b16 v[110:111], v203 offset:60416
    s_waitcnt vmcnt(4) lgkmcnt(8)
    v_mfma_f32_32x32x16_bf16 v[48:63], v[128:131], a[40:43], v[48:63]
    ds_read_b64_tr_b16 v[112:113], v202 offset:61440
    ds_read_b64_tr_b16 v[114:115], v202 offset:63488
    v_mfma_f32_32x32x16_bf16 v[64:79], v[132:135], a[40:43], v[64:79]
    ds_read_b64_tr_b16 v[116:117], v203 offset:61440
    ds_read_b64_tr_b16 v[118:119], v203 offset:63488
    v_mfma_f32_32x32x16_bf16 v[48:63], v[136:139], a[44:47], v[48:63]
    ds_read_b64_tr_b16 v[120:121], v202 offset:62464
    ds_read_b64_tr_b16 v[122:123], v202 offset:64512
    v_mfma_f32_32x32x16_bf16 v[64:79], v[140:143], a[44:47], v[64:79]
    ds_read_b64_tr_b16 v[124:125], v203 offset:62464
    ds_read_b64_tr_b16 v[126:127], v203 offset:64512
    s_waitcnt vmcnt(2) lgkmcnt(8)
    v_mfma_f32_32x32x16_bf16 v[48:63], v[96:99], a[48:51], v[48:63]
    v_mfma_f32_32x32x16_bf16 v[64:79], v[100:103], a[48:51], v[64:79]
    v_mfma_f32_32x32x16_bf16 v[48:63], v[104:107], a[52:55], v[48:63]
    v_mfma_f32_32x32x16_bf16 v[64:79], v[108:111], a[52:55], v[64:79]
    s_waitcnt vmcnt(0) lgkmcnt(0)
    v_mfma_f32_32x32x16_bf16 v[48:63], v[112:115], a[56:59], v[48:63]
    v_mfma_f32_32x32x16_bf16 v[48:63], v[120:123], a[60:63], v[48:63]
    v_mfma_f32_32x32x16_bf16 v[64:79], v[116:119], a[56:59], v[64:79]
    v_mfma_f32_32x32x16_bf16 v[64:79], v[124:127], a[60:63], v[64:79]
    s_nop 5
    s_nop 3
    v_mul_f32 v48, v48, v16
    v_mul_f32 v49, v49, v17
    v_mul_f32 v50, v50, v18
    v_mul_f32 v51, v51, v19
    v_mul_f32 v52, v52, v20
    v_mul_f32 v53, v53, v21
    v_mul_f32 v54, v54, v22
    v_mul_f32 v55, v55, v23
    s_nop 0
    v_permlane32_swap_b32 v48, v52
    v_permlane32_swap_b32 v49, v53
    v_permlane32_swap_b32 v50, v54
    v_permlane32_swap_b32 v51, v55
    v_add_f32 v48, v48, v144
    v_add_f32 v49, v49, v145
    v_add_f32 v50, v50, v146
    v_add_f32 v51, v51, v147
    v_add_f32 v52, v52, v148
    v_add_f32 v53, v53, v149
    v_add_f32 v54, v54, v150
    v_add_f32 v55, v55, v151
    v_cvt_pk_bf16_f32 v96, v48, v49
    v_cvt_pk_bf16_f32 v97, v50, v51
    v_cvt_pk_bf16_f32 v98, v52, v53
    v_cvt_pk_bf16_f32 v99, v54, v55
    buffer_store_dwordx4 v[96:99], v211, s[48:51], s69 offen offset:0
    v_mul_f32 v56, v56, v24
    v_mul_f32 v57, v57, v25
    v_mul_f32 v58, v58, v26
    v_mul_f32 v59, v59, v27
    v_mul_f32 v60, v60, v28
    v_mul_f32 v61, v61, v29
    v_mul_f32 v62, v62, v30
    v_mul_f32 v63, v63, v31
    s_nop 0
    v_permlane32_swap_b32 v56, v60
    v_permlane32_swap_b32 v57, v61
    v_permlane32_swap_b32 v58, v62
    v_permlane32_swap_b32 v59, v63
    v_add_f32 v56, v56, v152
    v_add_f32 v57, v57, v153
    v_add_f32 v58, v58, v154
    v_add_f32 v59, v59, v155
    v_add_f32 v60, v60, v156
    v_add_f32 v61, v61, v157
    v_add_f32 v62, v62, v158
    v_add_f32 v63, v63, v159
    v_cvt_pk_bf16_f32 v100, v56, v57
    v_cvt_pk_bf16_f32 v101, v58, v59
    v_cvt_pk_bf16_f32 v102, v60, v61
    v_cvt_pk_bf16_f32 v103, v62, v63
    buffer_store_dwordx4 v[100:103], v211, s[48:51], s69 offen offset:32
    v_mul_f32 v64, v64, v32
    v_mul_f32 v65, v65, v33
    v_mul_f32 v66, v66, v34
    v_mul_f32 v67, v67, v35
    v_mul_f32 v68, v68, v36
    v_mul_f32 v69, v69, v37
    v_mul_f32 v70, v70, v38
    v_mul_f32 v71, v71, v39
    s_nop 0
    v_permlane32_swap_b32 v64, v68
    v_permlane32_swap_b32 v65, v69
    v_permlane32_swap_b32 v66, v70
    v_permlane32_swap_b32 v67, v71
    v_add_f32 v64, v64, v160
    v_add_f32 v65, v65, v161
    v_add_f32 v66, v66, v162
    v_add_f32 v67, v67, v163
    v_add_f32 v68, v68, v164
    v_add_f32 v69, v69, v165
    v_add_f32 v70, v70, v166
    v_add_f32 v71, v71, v167
    v_cvt_pk_bf16_f32 v104, v64, v65
    v_cvt_pk_bf16_f32 v105, v66, v67
    v_cvt_pk_bf16_f32 v106, v68, v69
    v_cvt_pk_bf16_f32 v107, v70, v71
    buffer_store_dwordx4 v[104:107], v211, s[48:51], s69 offen offset:64
    v_mul_f32 v72, v72, v40
    v_mul_f32 v73, v73, v41
    v_mul_f32 v74, v74, v42
    v_mul_f32 v75, v75, v43
    v_mul_f32 v76, v76, v44
    v_mul_f32 v77, v77, v45
    v_mul_f32 v78, v78, v46
    v_mul_f32 v79, v79, v47
    s_nop 0
    v_permlane32_swap_b32 v72, v76
    v_permlane32_swap_b32 v73, v77
    v_permlane32_swap_b32 v74, v78
    v_permlane32_swap_b32 v75, v79
    v_add_f32 v72, v72, v168
    v_add_f32 v73, v73, v169
    v_add_f32 v74, v74, v170
    v_add_f32 v75, v75, v171
    v_add_f32 v76, v76, v172
    v_add_f32 v77, v77, v173
    v_add_f32 v78, v78, v174
    v_add_f32 v79, v79, v175
    v_cvt_pk_bf16_f32 v108, v72, v73
    v_cvt_pk_bf16_f32 v109, v74, v75
    v_cvt_pk_bf16_f32 v110, v76, v77
    v_cvt_pk_bf16_f32 v111, v78, v79
    buffer_store_dwordx4 v[108:111], v211, s[48:51], s69 offen offset:96
    s_endpgm
L_p2_s0_go:
    s_call_b64 s[72:73], L_p2_fix11_slow
    s_branch L_p2_s0_back
L_p2_s1_go:
    s_call_b64 s[72:73], L_p2_fix00_slow
    s_branch L_p2_s1_back
L_p2_s2_go:
    s_call_b64 s[72:73], L_p2_fix10_slow
    s_branch L_p2_s2_back
L_p2_s3_go:
    s_call_b64 s[72:73], L_p2_fix01_slow
    s_branch L_p2_s3_back
L_p2_s4_go:
    s_call_b64 s[72:73], L_p2_fix11_slow
    s_branch L_p2_s4_back
L_p2_s5_go:
    s_call_b64 s[72:73], L_p2_fix00_slow
    s_branch L_p2_s5_back
L_p2_s6_go:
    s_call_b64 s[72:73], L_p2_fix10_slow
    s_branch L_p2_s6_back
L_p2_s7_go:
    s_call_b64 s[72:73], L_p2_fix01_slow
    s_branch L_p2_s7_back
L_p2_s8_go:
    s_call_b64 s[72:73], L_p2_fix11_slow
    s_branch L_p2_s8_back
L_p2_s9_go:
    s_call_b64 s[72:73], L_p2_fix00_slow
    s_branch L_p2_s9_back
L_p2_s10_go:
    s_call_b64 s[72:73], L_p2_fix10_slow
    s_branch L_p2_s10_back
L_p2_s11_go:
    s_call_b64 s[72:73], L_p2_fix01_slow
    s_branch L_p2_s11_back
L_p2_s12_go:
    s_call_b64 s[72:73], L_p2_fix11_slow
    s_branch L_p2_s12_back
L_p2_s13_go:
    s_call_b64 s[72:73], L_p2_fix00_slow
    s_branch L_p2_s13_back
L_p2_s14_go:
    s_call_b64 s[72:73], L_p2_fix10_slow
    s_branch L_p2_s14_back
L_p2_s15_go:
    s_call_b64 s[72:73], L_p2_fix01_slow
    s_branch L_p2_s15_back
L_p2_s16_go:
    s_call_b64 s[72:73], L_p2_fix11_slow
    s_branch L_p2_s16_back
L_p2_s17_go:
    s_call_b64 s[72:73], L_p2_fix00_slow
    s_branch L_p2_s17_back
L_p2_s18_go:
    s_call_b64 s[72:73], L_p2_fix10_slow
    s_branch L_p2_s18_back
L_p2_s19_go:
    s_call_b64 s[72:73], L_p2_fix01_slow
    s_branch L_p2_s19_back
L_p2_s20_go:
    s_call_b64 s[72:73], L_p2_fix11_slow
    s_branch L_p2_s20_back
L_p2_s21_go:
    s_call_b64 s[72:73], L_p2_fix00_slow
    s_branch L_p2_s21_back
L_p2_s22_go:
    s_call_b64 s[72:73], L_p2_fix10_slow
    s_branch L_p2_s22_back
L_p2_s23_go:
    s_call_b64 s[72:73], L_p2_fix01_slow
    s_branch L_p2_s23_back
L_p2_s24_go:
    s_call_b64 s[72:73], L_p2_fix11_slow
    s_branch L_p2_s24_back
L_p2_s25_go:
    s_call_b64 s[72:73], L_p2_fix00_slow
    s_branch L_p2_s25_back
L_p2_s26_go:
    s_call_b64 s[72:73], L_p2_fix10_slow
    s_branch L_p2_s26_back
L_p2_s27_go:
    s_call_b64 s[72:73], L_p2_fix01_slow
    s_branch L_p2_s27_back
L_p2_s28_go:
    s_call_b64 s[72:73], L_p2_fix11_slow
    s_branch L_p2_s28_back
L_p2_s29_go:
    s_call_b64 s[72:73], L_p2_fix00_slow
    s_branch L_p2_s29_back
L_p2_s30_go:
    s_call_b64 s[72:73], L_p2_fix10_slow
    s_branch L_p2_s30_back
L_p2_s31_go:
    s_call_b64 s[72:73], L_p2_fix01_slow
    s_branch L_p2_s31_back
L_p2_s32_go:
    s_call_b64 s[72:73], L_p2_fix11_slow
    s_branch L_p2_s32_back
L_p2_s33_go:
    s_call_b64 s[72:73], L_p2_fix00_slow
    s_branch L_p2_s33_back
L_p2_s34_go:
    s_call_b64 s[72:73], L_p2_fix10_slow
    s_branch L_p2_s34_back
L_p2_s35_go:
    s_call_b64 s[72:73], L_p2_fix01_slow
    s_branch L_p2_s35_back
L_p2_s36_go:
    s_call_b64 s[72:73], L_p2_fix11_slow
    s_branch L_p2_s36_back
L_p2_s37_go:
    s_call_b64 s[72:73], L_p2_fix00_slow
    s_branch L_p2_s37_back
L_p2_s38_go:
    s_call_b64 s[72:73], L_p2_fix10_slow
    s_branch L_p2_s38_back
L_p2_s39_go:
    s_call_b64 s[72:73], L_p2_fix01_slow
    s_branch L_p2_s39_back
L_p2_s40_go:
    s_call_b64 s[72:73], L_p2_fix11_slow
    s_branch L_p2_s40_back
L_p2_s41_go:
    s_call_b64 s[72:73], L_p2_fix00_slow
    s_branch L_p2_s41_back
L_p2_s42_go:
    s_call_b64 s[72:73], L_p2_fix10_slow
    s_branch L_p2_s42_back
L_p2_s43_go:
    s_call_b64 s[72:73], L_p2_fix01_slow
    s_branch L_p2_s43_back
L_p2_s44_go:
    s_call_b64 s[72:73], L_p2_fix11_slow
    s_branch L_p2_s44_back
L_p2_s45_go:
    s_call_b64 s[72:73], L_p2_fix00_slow
    s_branch L_p2_s45_back
L_p2_s46_go:
    s_call_b64 s[72:73], L_p2_fix10_slow
    s_branch L_p2_s46_back
L_p2_s47_go:
    s_call_b64 s[72:73], L_p2_fix01_slow
    s_branch L_p2_s47_back
L_p2_s48_go:
    s_call_b64 s[72:73], L_p2_fix11_slow
    s_branch L_p2_s48_back
L_p2_s49_go:
    s_call_b64 s[72:73], L_p2_fix00_slow
    s_branch L_p2_s49_back
L_p2_s50_go:
    s_call_b64 s[72:73], L_p2_fix10_slow
    s_branch L_p2_s50_back
L_p2_s51_go:
    s_call_b64 s[72:73], L_p2_fix01_slow
    s_branch L_p2_s51_back
L_p2_s52_go:
    s_call_b64 s[72:73], L_p2_fix11_slow
    s_branch L_p2_s52_back
L_p2_s53_go:
    s_call_b64 s[72:73], L_p2_fix00_slow
    s_branch L_p2_s53_back
L_p2_s54_go:
    s_call_b64 s[72:73], L_p2_fix10_slow
    s_branch L_p2_s54_back
L_p2_s55_go:
    s_call_b64 s[72:73], L_p2_fix01_slow
    s_branch L_p2_s55_back
L_p2_s56_go:
    s_call_b64 s[72:73], L_p2_fix11_slow
    s_branch L_p2_s56_back
L_p2_s57_go:
    s_call_b64 s[72:73], L_p2_fix00_slow
    s_branch L_p2_s57_back
L_p2_s58_go:
    s_call_b64 s[72:73], L_p2_fix10_slow
    s_branch L_p2_s58_back
L_p2_s59_go:
    s_call_b64 s[72:73], L_p2_fix01_slow
    s_branch L_p2_s59_back
L_p2_s60_go:
    s_call_b64 s[72:73], L_p2_fix11_slow
    s_branch L_p2_s60_back
L_p2_s61_go:
    s_call_b64 s[72:73], L_p2_fix00_slow
    s_branch L_p2_s61_back
L_p2_s62_go:
    s_call_b64 s[72:73], L_p2_fix10_slow
    s_branch L_p2_s62_back
L_p2_s63_go:
    s_call_b64 s[72:73], L_p2_fix01_slow
    s_branch L_p2_s63_back
L_p2_s64_go:
    s_call_b64 s[72:73], L_p2_fix11_slow
    s_branch L_p2_s64_back
L_p2_fix00_slow:
    v_max3_f32 v192, v96, v97, v98
    v_max3_f32 v192, v192, v99, v100
    v_max3_f32 v192, v192, v101, v102
    v_max3_f32 v192, v192, v103, v104
    v_max3_f32 v192, v192, v105, v106
    v_max3_f32 v192, v192, v107, v108
    v_max3_f32 v192, v192, v109, v110
    v_max_f32 v192, v192, v111
    v_mov_b32 v193, v192
    s_nop 1
    v_permlane32_swap_b32 v192, v193
    v_max_f32 v192, v192, v193
    v_add_f32 v192, 0x42800000, v192
    v_ceil_f32 v192, v192
    v_max_f32 v192, 0, v192
    v_sub_f32 v193, 0, v192
    v_cvt_i32_f32 v193, v193
    v_sub_f32 v96, v96, v192
    v_sub_f32 v128, v128, v192
    v_ldexp_f32 v160, v160, v193
    v_sub_f32 v97, v97, v192
    v_sub_f32 v129, v129, v192
    v_ldexp_f32 v161, v161, v193
    v_sub_f32 v98, v98, v192
    v_sub_f32 v130, v130, v192
    v_ldexp_f32 v162, v162, v193
    v_sub_f32 v99, v99, v192
    v_sub_f32 v131, v131, v192
    v_ldexp_f32 v163, v163, v193
    v_sub_f32 v100, v100, v192
    v_sub_f32 v132, v132, v192
    v_ldexp_f32 v164, v164, v193
    v_sub_f32 v101, v101, v192
    v_sub_f32 v133, v133, v192
    v_ldexp_f32 v165, v165, v193
    v_sub_f32 v102, v102, v192
    v_sub_f32 v134, v134, v192
    v_ldexp_f32 v166, v166, v193
    v_sub_f32 v103, v103, v192
    v_sub_f32 v135, v135, v192
    v_ldexp_f32 v167, v167, v193
    v_sub_f32 v104, v104, v192
    v_sub_f32 v136, v136, v192
    v_ldexp_f32 v168, v168, v193
    v_sub_f32 v105, v105, v192
    v_sub_f32 v137, v137, v192
    v_ldexp_f32 v169, v169, v193
    v_sub_f32 v106, v106, v192
    v_sub_f32 v138, v138, v192
    v_ldexp_f32 v170, v170, v193
    v_sub_f32 v107, v107, v192
    v_sub_f32 v139, v139, v192
    v_ldexp_f32 v171, v171, v193
    v_sub_f32 v108, v108, v192
    v_sub_f32 v140, v140, v192
    v_ldexp_f32 v172, v172, v193
    v_sub_f32 v109, v109, v192
    v_sub_f32 v141, v141, v192
    v_ldexp_f32 v173, v173, v193
    v_sub_f32 v110, v110, v192
    v_sub_f32 v142, v142, v192
    v_ldexp_f32 v174, v174, v193
    v_sub_f32 v111, v111, v192
    v_sub_f32 v143, v143, v192
    v_ldexp_f32 v175, v175, v193
    v_ldexp_f32 v84, v84, v193
    v_exp_f32 v194, v96
    v_exp_f32 v195, v97
    s_nop 0
    v_cvt_pk_bf16_f32 v64, v194, v195
    v_exp_f32 v194, v98
    v_exp_f32 v195, v99
    s_nop 0
    v_cvt_pk_bf16_f32 v65, v194, v195
    v_exp_f32 v194, v100
    v_exp_f32 v195, v101
    s_nop 0
    v_cvt_pk_bf16_f32 v66, v194, v195
    v_exp_f32 v194, v102
    v_exp_f32 v195, v103
    s_nop 0
    v_cvt_pk_bf16_f32 v67, v194, v195
    v_exp_f32 v194, v104
    v_exp_f32 v195, v105
    s_nop 0
    v_cvt_pk_bf16_f32 v68, v194, v195
    v_exp_f32 v194, v106
    v_exp_f32 v195, v107
    s_nop 0
    v_cvt_pk_bf16_f32 v69, v194, v195
    v_exp_f32 v194, v108
    v_exp_f32 v195, v109
    s_nop 0
    v_cvt_pk_bf16_f32 v70, v194, v195
    v_exp_f32 v194, v110
    v_exp_f32 v195, v111
    s_nop 0
    v_cvt_pk_bf16_f32 v71, v194, v195
    s_nop 1
    v_mfma_f32_16x16x32_bf16 v[80:83], v[4:7], v[64:67], v[84:87]
    v_mfma_f32_16x16x32_bf16 v[80:83], v[4:7], v[68:71], v[80:83]
    s_nop 7
    s_setpc_b64 s[72:73]
L_p2_fix01_slow:
    v_max3_f32 v192, v96, v97, v98
    v_max3_f32 v192, v192, v99, v100
    v_max3_f32 v192, v192, v101, v102
    v_max3_f32 v192, v192, v103, v104
    v_max3_f32 v192, v192, v105, v106
    v_max3_f32 v192, v192, v107, v108
    v_max3_f32 v192, v192, v109, v110
    v_max_f32 v192, v192, v111
    v_mov_b32 v193, v192
    s_nop 1
    v_permlane32_swap_b32 v192, v193
    v_max_f32 v192, v192, v193
    v_add_f32 v192, 0x42800000, v192
    v_ceil_f32 v192, v192
    v_max_f32 v192, 0, v192
    v_sub_f32 v193, 0, v192
    v_cvt_i32_f32 v193, v193
    v_sub_f32 v96, v96, v192
    v_sub_f32 v128, v128, v192
    v_ldexp_f32 v160, v160, v193
    v_sub_f32 v97, v97, v192
    v_sub_f32 v129, v129, v192
    v_ldexp_f32 v161, v161, v193
    v_sub_f32 v98, v98, v192
    v_sub_f32 v130, v130, v192
    v_ldexp_f32 v162, v162, v193
    v_sub_f32 v99, v99, v192
    v_sub_f32 v131, v131, v192
    v_ldexp_f32 v163, v163, v193
    v_sub_f32 v100, v100, v192
    v_sub_f32 v132, v132, v192
    v_ldexp_f32 v164, v164, v193
    v_sub_f32 v101, v101, v192
    v_sub_f32 v133, v133, v192
    v_ldexp_f32 v165, v165, v193
    v_sub_f32 v102, v102, v192
    v_sub_f32 v134, v134, v192
    v_ldexp_f32 v166, v166, v193
    v_sub_f32 v103, v103, v192
    v_sub_f32 v135, v135, v192
    v_ldexp_f32 v167, v167, v193
    v_sub_f32 v104, v104, v192
    v_sub_f32 v136, v136, v192
    v_ldexp_f32 v168, v168, v193
    v_sub_f32 v105, v105, v192
    v_sub_f32 v137, v137, v192
    v_ldexp_f32 v169, v169, v193
    v_sub_f32 v106, v106, v192
    v_sub_f32 v138, v138, v192
    v_ldexp_f32 v170, v170, v193
    v_sub_f32 v107, v107, v192
    v_sub_f32 v139, v139, v192
    v_ldexp_f32 v171, v171, v193
    v_sub_f32 v108, v108, v192
    v_sub_f32 v140, v140, v192
    v_ldexp_f32 v172, v172, v193
    v_sub_f32 v109, v109, v192
    v_sub_f32 v141, v141, v192
    v_ldexp_f32 v173, v173, v193
    v_sub_f32 v110, v110, v192
    v_sub_f32 v142, v142, v192
    v_ldexp_f32 v174, v174, v193
    v_sub_f32 v111, v111, v192
    v_sub_f32 v143, v143, v192
    v_ldexp_f32 v175, v175, v193
    v_ldexp_f32 v80, v80, v193
    v_exp_f32 v194, v96
    v_exp_f32 v195, v97
    s_nop 0
    v_cvt_pk_bf16_f32 v64, v194, v195
    v_exp_f32 v194, v98
    v_exp_f32 v195, v99
    s_nop 0
    v_cvt_pk_bf16_f32 v65, v194, v195
    v_exp_f32 v194, v100
    v_exp_f32 v195, v101
    s_nop 0
    v_cvt_pk_bf16_f32 v66, v194, v195
    v_exp_f32 v194, v102
    v_exp_f32 v195, v103
    s_nop 0
    v_cvt_pk_bf16_f32 v67, v194, v195
    v_exp_f32 v194, v104
    v_exp_f32 v195, v105
    s_nop 0
    v_cvt_pk_bf16_f32 v68, v194, v195
    v_exp_f32 v194, v106
    v_exp_f32 v195, v107
    s_nop 0
    v_cvt_pk_bf16_f32 v69, v194, v195
    v_exp_f32 v194, v108
    v_exp_f32 v195, v109
    s_nop 0
    v_cvt_pk_bf16_f32 v70, v194, v195
    v_exp_f32 v194, v110
    v_exp_f32 v195, v111
    s_nop 0
    v_cvt_pk_bf16_f32 v71, v194, v195
    s_nop 1
    v_mfma_f32_16x16x32_bf16 v[84:87], v[4:7], v[64:67], v[80:83]
    v_mfma_f32_16x16x32_bf16 v[84:87], v[4:7], v[68:71], v[84:87]
    s_nop 7
    s_setpc_b64 s[72:73]
L_p2_fix10_slow:
    v_max3_f32 v192, v112, v113, v114
    v_max3_f32 v192, v192, v115, v116
    v_max3_f32 v192, v192, v117, v118
    v_max3_f32 v192, v192, v119, v120
    v_max3_f32 v192, v192, v121, v122
    v_max3_f32 v192, v192, v123, v124
    v_max3_f32 v192, v192, v125, v126
    v_max_f32 v192, v192, v127
    v_mov_b32 v193, v192
    s_nop 1
    v_permlane32_swap_b32 v192, v193
    v_max_f32 v192, v192, v193
    v_add_f32 v192, 0x42800000, v192
    v_ceil_f32 v192, v192
    v_max_f32 v192, 0, v192
    v_sub_f32 v193, 0, v192
    v_cvt_i32_f32 v193, v193
    v_sub_f32 v112, v112, v192
    v_sub_f32 v144, v144, v192
    v_ldexp_f32 v176, v176, v193
    v_sub_f32 v113, v113, v192
    v_sub_f32 v145, v145, v192
    v_ldexp_f32 v177, v177, v193
    v_sub_f32 v114, v114, v192
    v_sub_f32 v146, v146, v192
    v_ldexp_f32 v178, v178, v193
    v_sub_f32 v115, v115, v192
    v_sub_f32 v147, v147, v192
    v_ldexp_f32 v179, v179, v193
    v_sub_f32 v116, v116, v192
    v_sub_f32 v148, v148, v192
    v_ldexp_f32 v180, v180, v193
    v_sub_f32 v117, v117, v192
    v_sub_f32 v149, v149, v192
    v_ldexp_f32 v181, v181, v193
    v_sub_f32 v118, v118, v192
    v_sub_f32 v150, v150, v192
    v_ldexp_f32 v182, v182, v193
    v_sub_f32 v119, v119, v192
    v_sub_f32 v151, v151, v192
    v_ldexp_f32 v183, v183, v193
    v_sub_f32 v120, v120, v192
    v_sub_f32 v152, v152, v192
    v_ldexp_f32 v184, v184, v193
    v_sub_f32 v121, v121, v192
    v_sub_f32 v153, v153, v192
    v_ldexp_f32 v185, v185, v193
    v_sub_f32 v122, v122, v192
    v_sub_f32 v154, v154, v192
    v_ldexp_f32 v186, v186, v193
    v_sub_f32 v123, v123, v192
    v_sub_f32 v155, v155, v192
    v_ldexp_f32 v187, v187, v193
    v_sub_f32 v124, v124, v192
    v_sub_f32 v156, v156, v192
    v_ldexp_f32 v188, v188, v193
    v_sub_f32 v125, v125, v192
    v_sub_f32 v157, v157, v192
    v_ldexp_f32 v189, v189, v193
    v_sub_f32 v126, v126, v192
    v_sub_f32 v158, v158, v192
    v_ldexp_f32 v190, v190, v193
    v_sub_f32 v127, v127, v192
    v_sub_f32 v159, v159, v192
    v_ldexp_f32 v191, v191, v193
    v_ldexp_f32 v92, v92, v193
    v_exp_f32 v194, v112
    v_exp_f32 v195, v113
    s_nop 0
    v_cvt_pk_bf16_f32 v72, v194, v195
    v_exp_f32 v194, v114
    v_exp_f32 v195, v115
    s_nop 0
    v_cvt_pk_bf16_f32 v73, v194, v195
    v_exp_f32 v194, v116
    v_exp_f32 v195, v117
    s_nop 0
    v_cvt_pk_bf16_f32 v74, v194, v195
    v_exp_f32 v194, v118
    v_exp_f32 v195, v119
    s_nop 0
    v_cvt_pk_bf16_f32 v75, v194, v195
    v_exp_f32 v194, v120
    v_exp_f32 v195, v121
    s_nop 0
    v_cvt_pk_bf16_f32 v76, v194, v195
    v_exp_f32 v194, v122
    v_exp_f32 v195, v123
    s_nop 0
    v_cvt_pk_bf16_f32 v77, v194, v195
    v_exp_f32 v194, v124
    v_exp_f32 v195, v125
    s_nop 0
    v_cvt_pk_bf16_f32 v78, v194, v195
    v_exp_f32 v194, v126
    v_exp_f32 v195, v127
    s_nop 0
    v_cvt_pk_bf16_f32 v79, v194, v195
    s_nop 1
    v_mfma_f32_16x16x32_bf16 v[88:91], v[4:7], v[72:75], v[92:95]
    v_mfma_f32_16x16x32_bf16 v[88:91], v[4:7], v[76:79], v[88:91]
    s_nop 7
    s_setpc_b64 s[72:73]
L_p2_fix11_slow:
    v_max3_f32 v192, v112, v113, v114
    v_max3_f32 v192, v192, v115, v116
    v_max3_f32 v192, v192, v117, v118
    v_max3_f32 v192, v192, v119, v120
    v_max3_f32 v192, v192, v121, v122
    v_max3_f32 v192, v192, v123, v124
    v_max3_f32 v192, v192, v125, v126
    v_max_f32 v192, v192, v127
    v_mov_b32 v193, v192
    s_nop 1
    v_permlane32_swap_b32 v192, v193
    v_max_f32 v192, v192, v193
    v_add_f32 v192, 0x42800000, v192
    v_ceil_f32 v192, v192
    v_max_f32 v192, 0, v192
    v_sub_f32 v193, 0, v192
    v_cvt_i32_f32 v193, v193
    v_sub_f32 v112, v112, v192
    v_sub_f32 v144, v144, v192
    v_ldexp_f32 v176, v176, v193
    v_sub_f32 v113, v113, v192
    v_sub_f32 v145, v145, v192
    v_ldexp_f32 v177, v177, v193
    v_sub_f32 v114, v114, v192
    v_sub_f32 v146, v146, v192
    v_ldexp_f32 v178, v178, v193
    v_sub_f32 v115, v115, v192
    v_sub_f32 v147, v147, v192
    v_ldexp_f32 v179, v179, v193
    v_sub_f32 v116, v116, v192
    v_sub_f32 v148, v148, v192
    v_ldexp_f32 v180, v180, v193
    v_sub_f32 v117, v117, v192
    v_sub_f32 v149, v149, v192
    v_ldexp_f32 v181, v181, v193
    v_sub_f32 v118, v118, v192
    v_sub_f32 v150, v150, v192
    v_ldexp_f32 v182, v182, v193
    v_sub_f32 v119, v119, v192
    v_sub_f32 v151, v151, v192
    v_ldexp_f32 v183, v183, v193
    v_sub_f32 v120, v120, v192
    v_sub_f32 v152, v152, v192
    v_ldexp_f32 v184, v184, v193
    v_sub_f32 v121, v121, v192
    v_sub_f32 v153, v153, v192
    v_ldexp_f32 v185, v185, v193
    v_sub_f32 v122, v122, v192
    v_sub_f32 v154, v154, v192
    v_ldexp_f32 v186, v186, v193
    v_sub_f32 v123, v123, v192
    v_sub_f32 v155, v155, v192
    v_ldexp_f32 v187, v187, v193
    v_sub_f32 v124, v124, v192
    v_sub_f32 v156, v156, v192
    v_ldexp_f32 v188, v188, v193
    v_sub_f32 v125, v125, v192
    v_sub_f32 v157, v157, v192
    v_ldexp_f32 v189, v189, v193
    v_sub_f32 v126, v126, v192
    v_sub_f32 v158, v158, v192
    v_ldexp_f32 v190, v190, v193
    v_sub_f32 v127, v127, v192
    v_sub_f32 v159, v159, v192
    v_ldexp_f32 v191, v191, v193
    v_ldexp_f32 v88, v88, v193
    v_exp_f32 v194, v112
    v_exp_f32 v195, v113
    s_nop 0
    v_cvt_pk_bf16_f32 v72, v194, v195
    v_exp_f32 v194, v114
    v_exp_f32 v195, v115
    s_nop 0
    v_cvt_pk_bf16_f32 v73, v194, v195
    v_exp_f32 v194, v116
    v_exp_f32 v195, v117
    s_nop 0
    v_cvt_pk_bf16_f32 v74, v194, v195
    v_exp_f32 v194, v118
    v_exp_f32 v195, v119
    s_nop 0
    v_cvt_pk_bf16_f32 v75, v194, v195
    v_exp_f32 v194, v120
    v_exp_f32 v195, v121
    s_nop 0
    v_cvt_pk_bf16_f32 v76, v194, v195
    v_exp_f32 v194, v122
    v_exp_f32 v195, v123
    s_nop 0
    v_cvt_pk_bf16_f32 v77, v194, v195
    v_exp_f32 v194, v124
    v_exp_f32 v195, v125
    s_nop 0
    v_cvt_pk_bf16_f32 v78, v194, v195
    v_exp_f32 v194, v126
    v_exp_f32 v195, v127
    s_nop 0
    v_cvt_pk_bf16_f32 v79, v194, v195
    s_nop 1
    v_mfma_f32_16x16x32_bf16 v[92:95], v[4:7], v[72:75], v[88:91]
    v_mfma_f32_16x16x32_bf16 v[92:95], v[4:7], v[76:79], v[92:95]
    s_nop 7
    s_setpc_b64 s[72:73]
L_p2_h1:
    s_cmp_eq_u32 s62, 3
    s_cbranch_scc1 L_p2_h1_peek
    s_cmp_eq_u32 s62, 2
    s_cbranch_scc1 L_p2_h1_check
    s_cmp_lg_u32 s62, 4
    s_cbranch_scc1 L_p2_h1_back
    s_waitcnt vmcnt(0)
    s_barrier
    s_cmp_lg_u32 s36, 3
    s_cbranch_scc1 L_p2_h1_back
    s_lshl_b32 s74, s14, 10
    s_add_u32 s74, s74, 32768
    v_mov_b32 v212, 1
    v_lshlrev_b32 v213, 7, v0
    s_mov_b64 exec, 0xff
    buffer_atomic_add v212, v213, s[52:55], s74 offen sc1
    s_mov_b64 exec, -1
    s_branch L_p2_h1_back
L_p2_h1_peek:
    s_lshr_b32 s76, s39, 1
    s_mul_i32 s76, s76, 8
    s_and_b32 s77, s56, 7
    s_add_u32 s76, s76, s77
    s_lshl_b32 s76, s76, 7
    s_add_u32 s76, s76, 32768
    v_mov_b32 v215, s76
    s_waitcnt vmcnt(14)
    buffer_load_dword v214, v215, s[52:55], 0 offen sc1
    s_branch L_p2_h1_back
L_p2_h1_check:
    s_waitcnt vmcnt(14)
    v_cmp_gt_u32 vcc, 32, v214
    s_cbranch_vccz L_p2_h1wait_end
    s_mov_b32 s74, 65536
L_p2_h1wait:
    buffer_load_dword v214, v215, s[52:55], 0 offen sc1
    s_sub_u32 s74, s74, 1
    s_cbranch_scc1 L_p2_h1wait_end
    s_waitcnt vmcnt(0)
    v_cmp_gt_u32 vcc, 32, v214
    s_cbranch_vccnz L_p2_h1wait
L_p2_h1wait_end:
    s_branch L_p2_h1_back
L_g1_done:
    s_endpgm
.section .rodata,"a"
.p2align 6
.amdhsa_kernel recurrent_scan__mha_block__glu_gated_reglu__prompt_kernel
  .amdhsa_next_free_vgpr 512
  .amdhsa_next_free_sgpr 102
  .amdhsa_accum_offset 256
  .amdhsa_group_segment_fixed_size 0
  .amdhsa_kernarg_size 80
  .amdhsa_user_sgpr_count 2
  .amdhsa_user_sgpr_kernarg_segment_ptr 1
  .amdhsa_system_sgpr_workgroup_id_x 1
  .amdhsa_float_denorm_mode_32 3
.end_amdhsa_kernel
```
